```python
import torch

def _softmax(x, axis=-1):
    return torch.softmax(x, dim=axis)
def _gelu(x):
    return torch.nn.functional.gelu(x, approximate="tanh")
def _silu(x):
    return torch.nn.functional.silu(x)
def _sigmoid(x):
    return torch.sigmoid(x)
def _layernorm(x, axis=-1, eps=1e-5):
    m = x.mean(dim=axis, keepdim=True)
    v = x.var(dim=axis, keepdim=True, unbiased=False)
    return (x - m) / torch.sqrt(v + eps)
def _scatter_add(tgt, idx, src, axis=0):
    return tgt.clone().index_add_(axis, idx, src)
def _segment_sum(src, seg, n):
    out = torch.zeros((n,) + src.shape[1:], dtype=src.dtype)
    return out.index_add_(0, seg, src)
def _pad(x, pw):
    flat = tuple(v for pair in reversed(pw) for v in pair)
    return torch.nn.functional.pad(x, flat)

kernel_name = 'interleave_layers__spectral_gfnet__ssm_conv_s5__prompt'

def setup_inputs():

    _w = (lambda a: (lambda t: t.to(torch.bfloat16) if t.is_floating_point() else t)(torch.as_tensor(a)))
    def _A_setup():
        B, S, D = 1, 2048, 448
        Df = D // 2 + 1
        return {
            "x": _w((lambda *s: torch.randn(*s, dtype=torch.bfloat16) * 0.05)(B, S, D)),
            "w_r": _w((lambda *s: torch.randn(*s, dtype=torch.bfloat16) * 1.6)(S, Df) * 0.02),
            "w_i": _w((lambda *s: torch.randn(*s, dtype=torch.bfloat16) * 1.6)(S, Df) * 0.02),
        }
    _A_in = _A_setup()

    def _B_setup():
        B, S, D = 1, 2048, 448
        P = D
        Lambda_re = -0.5 * (lambda _x: torch.exp(torch.as_tensor(_x)))((lambda *s: torch.randn(*s, dtype=torch.bfloat16) * 0.2)(P))
        Lambda_im = (lambda *s: torch.randn(*s, dtype=torch.bfloat16) * 0.8)(P) * 1.0
        B_re = (lambda *s: torch.randn(*s, dtype=torch.bfloat16) * 0.2)(P, D) * (D ** -0.5)
        B_im = (lambda *s: torch.randn(*s, dtype=torch.bfloat16) * 0.2)(P, D) * (D ** -0.5)
        C_re = (lambda *s: torch.randn(*s, dtype=torch.bfloat16) * 0.2)(D, P) * (P ** -0.5)
        C_im = (lambda *s: torch.randn(*s, dtype=torch.bfloat16) * 0.2)(D, P) * (P ** -0.5)
        log_dt = (lambda *s: torch.randn(*s, dtype=torch.bfloat16) * 0.2)(P) * 0.3 - 2.0
        Dskip = (lambda *s: torch.randn(*s, dtype=torch.bfloat16) * 0.05)(D)
        return {
            "x": _w((lambda *s: torch.randn(*s, dtype=torch.bfloat16) * 0.05)(B, S, D)),
            "Lambda_re": _w(Lambda_re),
            "Lambda_im": _w(Lambda_im),
            "B_re": _w(B_re),
            "B_im": _w(B_im),
            "C_re": _w(C_re),
            "C_im": _w(C_im),
            "log_dt": _w(log_dt),
            "Dskip": _w(Dskip),
        }
    _B_in = _B_setup()

    return {
        "A_x": _A_in["x"],
        "A_w_r": _A_in["w_r"],
        "A_w_i": _A_in["w_i"],
        "B_x": _B_in["x"],
        "B_Lambda_re": _B_in["Lambda_re"],
        "B_Lambda_im": _B_in["Lambda_im"],
        "B_B_re": _B_in["B_re"],
        "B_B_im": _B_in["B_im"],
        "B_C_re": _B_in["C_re"],
        "B_C_im": _B_in["C_im"],
        "B_log_dt": _B_in["log_dt"],
        "B_Dskip": _B_in["Dskip"],
    }

def reference(A_x, A_w_r, A_w_i, B_x, B_Lambda_re, B_Lambda_im, B_B_re, B_B_im, B_C_re, B_C_im, B_log_dt, B_Dskip):
    def _A_ref(x, w_r, w_i):
        B, S, D = x.shape
        X = (lambda x, axes=(-2,-1): torch.fft.rfft2(x.float(), dim=axes))(x, axes=(-2, -1))
        W = w_r + 1j * w_i
        X = X * W
        y = (lambda x, s, axes=(-2,-1): torch.fft.irfft2(x, s=s, dim=axes).to(torch.bfloat16))(X, (S, D), axes=(-2, -1))
        return y

    def _B_ref(x, Lambda_re, Lambda_im, B_re, B_im, C_re, C_im, log_dt, Dskip):
        Bsz, L, H = x.shape
        Lam = Lambda_re + 1j * Lambda_im
        Bmat = B_re + 1j * B_im
        Cmat = C_re + 1j * C_im
        dt = torch.exp(log_dt)
        Lam_bar = torch.exp(dt * Lam)
        B_bar = ((Lam_bar - 1.0) / Lam)[:, None] * Bmat
        Bu = torch.einsum("bld,pd->blp", x + 0j, B_bar)
        h = torch.zeros_like(Bu[:, 0, :])
        hs = []
        for t in range(L):
            h = Lam_bar[None, :] * h + Bu[:, t, :]
            hs.append(h)
        hseq = torch.stack(hs, 1)
        y = 2.0 * torch.einsum("blp,dp->bld", hseq, Cmat).real + x * Dskip[None, None, :]
        return y

    x = A_x
    x = x + _A_ref(_layernorm(x, axis=-1), A_w_r, A_w_i)
    x = x + _B_ref(_layernorm(x, axis=-1), B_Lambda_re, B_Lambda_im, B_B_re, B_B_im, B_C_re, B_C_im, B_log_dt, B_Dskip)
    x = x + _A_ref(_layernorm(x, axis=-1), A_w_r, A_w_i)
    x = x + _B_ref(_layernorm(x, axis=-1), B_Lambda_re, B_Lambda_im, B_B_re, B_B_im, B_C_re, B_C_im, B_log_dt, B_Dskip)
    return x
```

```asm
; @launch kernel=k1_kernel grid=(256,1,1) block=(256,1,1) lds=129024
; @launch kernel=kp_kernel grid=(256,1,1) block=(256,1,1) lds=148240
.amdgcn_target "amdgcn-amd-amdhsa--gfx950"
.text
.globl k1_kernel
.p2align 8
.type k1_kernel,@function
k1_kernel:
s_getpc_b64 s[10:11]
s_add_u32 s10, s10, k1_kernel@rel32@lo+4
s_addc_u32 s11, s11, k1_kernel@rel32@hi+12
s_mov_b32 s52, s10
s_and_b32 s53, s11, 0xffff
s_mov_b32 s54, 0x0
s_mov_b32 s55, 0x20000
s_mov_b32 s54, L_k1_end-k1_kernel
s_lshr_b32 s3, s2, 3
s_lshl_b32 s3, s3, 10
v_lshlrev_b32 v247, 2, v0
buffer_load_dword v255, v247, s[52:55], s3 offen
s_load_dwordx16 s[16:31], s[0:1], 0
s_load_dwordx8 s[32:39], s[0:1], 64
s_load_dwordx4 s[40:43], s[0:1], 96
s_load_dwordx2 s[44:45], s[0:1], 112
s_cmp_ge_u32 s2, 256
s_cbranch_scc1 L_k1_x2
v_lshrrev_b32 v6, 6, v0
v_and_b32 v1, 63, v0
v_readfirstlane_b32 s7, v6
v_lshlrev_b32 v2, 4, v1
v_and_b32 v3, 15, v1
v_lshrrev_b32 v4, 4, v1
s_cmp_ge_u32 s2, 224
s_cbranch_scc1 L_k1_w1
s_lshr_b32 s6, s2, 3
s_mul_i32 s4, s6, 37
s_lshr_b32 s4, s4, 8
s_mul_i32 s5, s4, 7
s_sub_u32 s5, s6, s5
s_lshl_b32 s4, s4, 3
s_and_b32 s6, s2, 7
s_add_u32 s4, s4, s6
s_movk_i32 s3, 896
s_lshl_b32 s12, s4, 6
s_lshl_b32 s13, s7, 4
s_add_u32 s12, s12, s13
s_and_b32 s13, s7, 1
v_lshrrev_b32 v8, 5, v1
v_xor_b32 v8, s13, v8
v_lshlrev_b32 v8, 1, v8
v_bfe_u32 v9, v1, 3, 1
v_lshl_add_u32 v8, v9, 3, v8
v_bfe_u32 v9, v1, 4, 1
v_add3_u32 v8, v8, v9, s12
s_lshl_b32 s13, s7, 1
v_and_b32 v7, 7, v1
v_xor_b32 v6, v7, v9
v_xor_b32 v6, s13, v6
v_lshlrev_b32 v6, 4, v6
v_mad_u32_u24 v9, v8, s3, v6
v_add_u32 v196, 2560, v9
s_lshl_b32 s6, s7, 11
s_lshl_b32 s64, s5, 7
s_add_u32 s65, s64, 128
s_cmp_eq_u32 s65, 896
s_cselect_b32 s65, 0, s65
s_add_u32 s66, s65, 128
s_cmp_eq_u32 s66, 896
s_cselect_b32 s66, 0, s66
s_add_u32 s67, s66, 128
s_cmp_eq_u32 s67, 896
s_cselect_b32 s67, 0, s67
s_add_u32 s68, s67, 128
s_cmp_eq_u32 s68, 896
s_cselect_b32 s68, 0, s68
s_add_u32 s69, s68, 128
s_cmp_eq_u32 s69, 896
s_cselect_b32 s69, 0, s69
s_add_u32 s70, s69, 128
s_cmp_eq_u32 s70, 896
s_cselect_b32 s70, 0, s70
s_waitcnt lgkmcnt(0)
s_mov_b32 s56, s16
s_and_b32 s57, s17, 0xffff
s_mov_b32 s58, 0x1c0000
s_mov_b32 s59, 0x20000
s_cmp_ge_u32 s4, 28
s_cbranch_scc1 L_k1_d4
s_cmp_ge_u32 s4, 14
s_cbranch_scc1 L_k1_c3
s_add_u32 m0, s6, 0
s_nop 0
buffer_load_dwordx4 v9, s[56:59], s64 offen lds
buffer_load_dwordx4 v196, s[56:59], s64 offen offset:1024 lds
s_add_u32 m0, s6, 8192
s_nop 0
buffer_load_dwordx4 v9, s[56:59], s65 offen lds
buffer_load_dwordx4 v196, s[56:59], s65 offen offset:1024 lds
s_add_u32 m0, s6, 16384
s_nop 0
buffer_load_dwordx4 v9, s[56:59], s66 offen lds
buffer_load_dwordx4 v196, s[56:59], s66 offen offset:1024 lds
s_add_u32 m0, s6, 24576
s_nop 0
buffer_load_dwordx4 v9, s[56:59], s67 offen lds
buffer_load_dwordx4 v196, s[56:59], s67 offen offset:1024 lds
s_add_u32 m0, s6, 32768
s_nop 0
buffer_load_dwordx4 v9, s[56:59], s68 offen lds
buffer_load_dwordx4 v196, s[56:59], s68 offen offset:1024 lds
s_add_u32 m0, s6, 40960
s_nop 0
buffer_load_dwordx4 v9, s[56:59], s69 offen lds
buffer_load_dwordx4 v196, s[56:59], s69 offen offset:1024 lds
s_add_u32 m0, s6, 49152
s_nop 0
buffer_load_dwordx4 v9, s[56:59], s70 offen lds
buffer_load_dwordx4 v196, s[56:59], s70 offen offset:1024 lds
s_mov_b32 s48, s44
s_and_b32 s49, s45, 0xffff
s_mov_b32 s50, 0x2000000
s_mov_b32 s51, 0x20000
v_lshrrev_b32 v6, 2, v3
v_bfe_u32 v8, v3, 1, 1
v_lshl_or_b32 v8, v6, 1, v8
v_xor_b32 v8, v8, v4
v_lshlrev_b32 v8, 4, v8
v_lshl_add_u32 v8, v6, 11, v8
v_and_b32 v6, 3, v3
v_lshl_add_u32 v198, v6, 7, v8
v_xor_b32 v199, 64, v198
s_add_u32 s6, s6, 57344
s_lshl_b32 s8, s4, 5
v_add_u32 v5, s8, v3
v_lshlrev_b32 v5, 1, v5
global_load_ushort v200, v5, s[24:25] offset:0
global_load_ushort v201, v5, s[26:27] offset:0
global_load_ushort v202, v5, s[36:37] offset:0
global_load_ushort v208, v5, s[24:25] offset:32
global_load_ushort v209, v5, s[26:27] offset:32
global_load_ushort v210, v5, s[36:37] offset:32
s_lshl_b32 s8, s4, 5
s_and_b32 s13, s7, 1
s_lshl_b32 s13, s13, 4
s_add_u32 s13, s13, s8
v_lshrrev_b32 v6, 3, v1
v_add_u32 v6, s13, v6
v_xor_b32 v7, v7, v4
v_lshlrev_b32 v7, 4, v7
v_mad_u32_u24 v10, v6, s3, v7
v_xor_b32 v197, 64, v10
v_add_u32 v197, 6144, v197
s_cmp_lt_u32 s7, 2
s_cselect_b32 s14, s28, s30
s_cselect_b32 s15, s29, s31
s_mov_b32 s52, s14
s_and_b32 s53, s15, 0xffff
s_mov_b32 s54, 0x62000
s_mov_b32 s55, 0x20000
s_lshl_b32 s12, s5, 6
s_lshr_b32 s13, s7, 1
s_lshl_b32 s13, s13, 5
s_add_u32 s12, s12, s13
s_and_b32 s13, s7, 1
s_lshl_b32 s13, s13, 2
s_add_u32 s12, s12, s13
v_and_b32 v6, 12, v3
v_add3_u32 v6, v6, v3, s12
v_mov_b32 v11, v6
v_lshrrev_b32 v192, 1, v6
v_and_b32 v194, 1, v6
v_cvt_f32_u32 v194, v194
v_mul_f32 v194, 0x3e800000, v194
v_mov_b32 v15, 0x3d88d677
v_mov_b32 v7, 0x3d41848f
v_cmp_gt_u32 vcc, 2, v6
s_nop 1
v_cndmask_b32 v15, v15, v7, vcc
v_cndmask_b32 v194, v194, 0, vcc
v_mov_b32 v7, 224
v_cmp_eq_u32 vcc, 1, v6
s_nop 1
v_cndmask_b32 v192, v192, v7, vcc
s_lshl_b32 s12, s5, 6
v_lshl_add_u32 v7, v4, 3, s12
v_mul_u32_u24 v193, v192, v7
v_cvt_f32_u32 v192, v192
v_cvt_f32_u32 v193, v193
v_mul_f32 v7, 0x3b124925, v193
v_floor_f32 v7, v7
v_fmac_f32 v193, 0xc3e00000, v7
v_mul_f32 v7, 0x3d924925, v192
v_cos_f32 v14, v7
v_mov_b32 v128, v193
v_add_f32 v129, v193, v192
v_add_f32 v6, v192, v192
v_mul_f32 v8, 0x42000000, v192
v_add_f32 v14, v14, v14
s_mov_b32 s12, 0x3b124925
v_pk_add_f32 v[130:131], v[128:129], v[6:7] op_sel:[0,0] op_sel_hi:[1,0]
v_pk_add_f32 v[132:133], v[130:131], v[6:7] op_sel:[0,0] op_sel_hi:[1,0]
v_pk_add_f32 v[134:135], v[132:133], v[6:7] op_sel:[0,0] op_sel_hi:[1,0]
v_pk_add_f32 v[136:137], v[128:129], v[8:9] op_sel:[0,0] op_sel_hi:[1,0]
v_pk_add_f32 v[138:139], v[130:131], v[8:9] op_sel:[0,0] op_sel_hi:[1,0]
v_pk_add_f32 v[140:141], v[132:133], v[8:9] op_sel:[0,0] op_sel_hi:[1,0]
v_pk_add_f32 v[142:143], v[134:135], v[8:9] op_sel:[0,0] op_sel_hi:[1,0]
v_pk_fma_f32 v[128:129], v[128:129], s[12:13], v[194:195] op_sel:[0,0,0] op_sel_hi:[1,0,0]
v_pk_fma_f32 v[130:131], v[130:131], s[12:13], v[194:195] op_sel:[0,0,0] op_sel_hi:[1,0,0]
v_pk_fma_f32 v[132:133], v[132:133], s[12:13], v[194:195] op_sel:[0,0,0] op_sel_hi:[1,0,0]
v_pk_fma_f32 v[134:135], v[134:135], s[12:13], v[194:195] op_sel:[0,0,0] op_sel_hi:[1,0,0]
v_pk_fma_f32 v[136:137], v[136:137], s[12:13], v[194:195] op_sel:[0,0,0] op_sel_hi:[1,0,0]
v_pk_fma_f32 v[138:139], v[138:139], s[12:13], v[194:195] op_sel:[0,0,0] op_sel_hi:[1,0,0]
v_pk_fma_f32 v[140:141], v[140:141], s[12:13], v[194:195] op_sel:[0,0,0] op_sel_hi:[1,0,0]
v_pk_fma_f32 v[142:143], v[142:143], s[12:13], v[194:195] op_sel:[0,0,0] op_sel_hi:[1,0,0]
v_cos_f32 v128, v128
v_cos_f32 v129, v129
v_cos_f32 v130, v130
v_cos_f32 v131, v131
v_cos_f32 v132, v132
v_cos_f32 v133, v133
v_cos_f32 v134, v134
v_cos_f32 v135, v135
v_cos_f32 v136, v136
v_cos_f32 v137, v137
v_cos_f32 v138, v138
v_cos_f32 v139, v139
v_cos_f32 v140, v140
v_cos_f32 v141, v141
v_cos_f32 v142, v142
v_cos_f32 v143, v143
v_pk_mul_f32 v[128:129], v[128:129], v[14:15] op_sel:[0,1] op_sel_hi:[1,1]
v_pk_mul_f32 v[130:131], v[130:131], v[14:15] op_sel:[0,1] op_sel_hi:[1,1]
v_pk_mul_f32 v[132:133], v[132:133], v[14:15] op_sel:[0,1] op_sel_hi:[1,1]
v_pk_mul_f32 v[134:135], v[134:135], v[14:15] op_sel:[0,1] op_sel_hi:[1,1]
v_pk_mul_f32 v[136:137], v[136:137], v[14:15] op_sel:[0,1] op_sel_hi:[1,1]
v_pk_mul_f32 v[138:139], v[138:139], v[14:15] op_sel:[0,1] op_sel_hi:[1,1]
v_pk_mul_f32 v[140:141], v[140:141], v[14:15] op_sel:[0,1] op_sel_hi:[1,1]
v_pk_mul_f32 v[142:143], v[142:143], v[14:15] op_sel:[0,1] op_sel_hi:[1,1]
v_cvt_pk_bf16_f32 v16, v128, v129
v_cvt_pk_bf16_f32 v17, v130, v131
v_cvt_pk_bf16_f32 v18, v132, v133
v_cvt_pk_bf16_f32 v19, v134, v135
v_cvt_pk_bf16_f32 v20, v136, v137
v_cvt_pk_bf16_f32 v21, v138, v139
v_cvt_pk_bf16_f32 v22, v140, v141
v_cvt_pk_bf16_f32 v23, v142, v143
v_pk_fma_f32 v[128:129], v[14:15], v[136:137], v[128:129] op_sel:[0,0,0] op_sel_hi:[0,1,1] neg_lo:[0,0,1] neg_hi:[0,0,1]
v_pk_fma_f32 v[130:131], v[14:15], v[138:139], v[130:131] op_sel:[0,0,0] op_sel_hi:[0,1,1] neg_lo:[0,0,1] neg_hi:[0,0,1]
v_pk_fma_f32 v[132:133], v[14:15], v[140:141], v[132:133] op_sel:[0,0,0] op_sel_hi:[0,1,1] neg_lo:[0,0,1] neg_hi:[0,0,1]
v_pk_fma_f32 v[134:135], v[14:15], v[142:143], v[134:135] op_sel:[0,0,0] op_sel_hi:[0,1,1] neg_lo:[0,0,1] neg_hi:[0,0,1]
v_cvt_pk_bf16_f32 v24, v128, v129
v_cvt_pk_bf16_f32 v25, v130, v131
v_cvt_pk_bf16_f32 v26, v132, v133
v_cvt_pk_bf16_f32 v27, v134, v135
v_pk_fma_f32 v[136:137], v[14:15], v[128:129], v[136:137] op_sel:[0,0,0] op_sel_hi:[0,1,1] neg_lo:[0,0,1] neg_hi:[0,0,1]
v_pk_fma_f32 v[138:139], v[14:15], v[130:131], v[138:139] op_sel:[0,0,0] op_sel_hi:[0,1,1] neg_lo:[0,0,1] neg_hi:[0,0,1]
v_pk_fma_f32 v[140:141], v[14:15], v[132:133], v[140:141] op_sel:[0,0,0] op_sel_hi:[0,1,1] neg_lo:[0,0,1] neg_hi:[0,0,1]
v_pk_fma_f32 v[142:143], v[14:15], v[134:135], v[142:143] op_sel:[0,0,0] op_sel_hi:[0,1,1] neg_lo:[0,0,1] neg_hi:[0,0,1]
v_cvt_pk_bf16_f32 v28, v136, v137
v_cvt_pk_bf16_f32 v29, v138, v139
v_cvt_pk_bf16_f32 v30, v140, v141
v_cvt_pk_bf16_f32 v31, v142, v143
v_pk_fma_f32 v[128:129], v[14:15], v[136:137], v[128:129] op_sel:[0,0,0] op_sel_hi:[0,1,1] neg_lo:[0,0,1] neg_hi:[0,0,1]
v_pk_fma_f32 v[130:131], v[14:15], v[138:139], v[130:131] op_sel:[0,0,0] op_sel_hi:[0,1,1] neg_lo:[0,0,1] neg_hi:[0,0,1]
v_pk_fma_f32 v[132:133], v[14:15], v[140:141], v[132:133] op_sel:[0,0,0] op_sel_hi:[0,1,1] neg_lo:[0,0,1] neg_hi:[0,0,1]
v_pk_fma_f32 v[134:135], v[14:15], v[142:143], v[134:135] op_sel:[0,0,0] op_sel_hi:[0,1,1] neg_lo:[0,0,1] neg_hi:[0,0,1]
v_cvt_pk_bf16_f32 v32, v128, v129
v_cvt_pk_bf16_f32 v33, v130, v131
v_cvt_pk_bf16_f32 v34, v132, v133
v_cvt_pk_bf16_f32 v35, v134, v135
v_pk_fma_f32 v[136:137], v[14:15], v[128:129], v[136:137] op_sel:[0,0,0] op_sel_hi:[0,1,1] neg_lo:[0,0,1] neg_hi:[0,0,1]
v_pk_fma_f32 v[138:139], v[14:15], v[130:131], v[138:139] op_sel:[0,0,0] op_sel_hi:[0,1,1] neg_lo:[0,0,1] neg_hi:[0,0,1]
v_pk_fma_f32 v[140:141], v[14:15], v[132:133], v[140:141] op_sel:[0,0,0] op_sel_hi:[0,1,1] neg_lo:[0,0,1] neg_hi:[0,0,1]
v_pk_fma_f32 v[142:143], v[14:15], v[134:135], v[142:143] op_sel:[0,0,0] op_sel_hi:[0,1,1] neg_lo:[0,0,1] neg_hi:[0,0,1]
v_cvt_pk_bf16_f32 v36, v136, v137
v_cvt_pk_bf16_f32 v37, v138, v139
v_cvt_pk_bf16_f32 v38, v140, v141
v_cvt_pk_bf16_f32 v39, v142, v143
v_pk_fma_f32 v[128:129], v[14:15], v[136:137], v[128:129] op_sel:[0,0,0] op_sel_hi:[0,1,1] neg_lo:[0,0,1] neg_hi:[0,0,1]
v_pk_fma_f32 v[130:131], v[14:15], v[138:139], v[130:131] op_sel:[0,0,0] op_sel_hi:[0,1,1] neg_lo:[0,0,1] neg_hi:[0,0,1]
v_pk_fma_f32 v[132:133], v[14:15], v[140:141], v[132:133] op_sel:[0,0,0] op_sel_hi:[0,1,1] neg_lo:[0,0,1] neg_hi:[0,0,1]
v_pk_fma_f32 v[134:135], v[14:15], v[142:143], v[134:135] op_sel:[0,0,0] op_sel_hi:[0,1,1] neg_lo:[0,0,1] neg_hi:[0,0,1]
v_cvt_pk_bf16_f32 v40, v128, v129
v_cvt_pk_bf16_f32 v41, v130, v131
v_cvt_pk_bf16_f32 v42, v132, v133
v_cvt_pk_bf16_f32 v43, v134, v135
v_pk_fma_f32 v[136:137], v[14:15], v[128:129], v[136:137] op_sel:[0,0,0] op_sel_hi:[0,1,1] neg_lo:[0,0,1] neg_hi:[0,0,1]
v_pk_fma_f32 v[138:139], v[14:15], v[130:131], v[138:139] op_sel:[0,0,0] op_sel_hi:[0,1,1] neg_lo:[0,0,1] neg_hi:[0,0,1]
v_pk_fma_f32 v[140:141], v[14:15], v[132:133], v[140:141] op_sel:[0,0,0] op_sel_hi:[0,1,1] neg_lo:[0,0,1] neg_hi:[0,0,1]
v_pk_fma_f32 v[142:143], v[14:15], v[134:135], v[142:143] op_sel:[0,0,0] op_sel_hi:[0,1,1] neg_lo:[0,0,1] neg_hi:[0,0,1]
v_cvt_pk_bf16_f32 v44, v136, v137
v_cvt_pk_bf16_f32 v45, v138, v139
v_cvt_pk_bf16_f32 v46, v140, v141
v_cvt_pk_bf16_f32 v47, v142, v143
v_pk_fma_f32 v[128:129], v[14:15], v[136:137], v[128:129] op_sel:[0,0,0] op_sel_hi:[0,1,1] neg_lo:[0,0,1] neg_hi:[0,0,1]
v_pk_fma_f32 v[130:131], v[14:15], v[138:139], v[130:131] op_sel:[0,0,0] op_sel_hi:[0,1,1] neg_lo:[0,0,1] neg_hi:[0,0,1]
v_pk_fma_f32 v[132:133], v[14:15], v[140:141], v[132:133] op_sel:[0,0,0] op_sel_hi:[0,1,1] neg_lo:[0,0,1] neg_hi:[0,0,1]
v_pk_fma_f32 v[134:135], v[14:15], v[142:143], v[134:135] op_sel:[0,0,0] op_sel_hi:[0,1,1] neg_lo:[0,0,1] neg_hi:[0,0,1]
v_cvt_pk_bf16_f32 v48, v128, v129
v_cvt_pk_bf16_f32 v49, v130, v131
v_cvt_pk_bf16_f32 v50, v132, v133
v_cvt_pk_bf16_f32 v51, v134, v135
v_pk_fma_f32 v[136:137], v[14:15], v[128:129], v[136:137] op_sel:[0,0,0] op_sel_hi:[0,1,1] neg_lo:[0,0,1] neg_hi:[0,0,1]
v_pk_fma_f32 v[138:139], v[14:15], v[130:131], v[138:139] op_sel:[0,0,0] op_sel_hi:[0,1,1] neg_lo:[0,0,1] neg_hi:[0,0,1]
v_pk_fma_f32 v[140:141], v[14:15], v[132:133], v[140:141] op_sel:[0,0,0] op_sel_hi:[0,1,1] neg_lo:[0,0,1] neg_hi:[0,0,1]
v_pk_fma_f32 v[142:143], v[14:15], v[134:135], v[142:143] op_sel:[0,0,0] op_sel_hi:[0,1,1] neg_lo:[0,0,1] neg_hi:[0,0,1]
v_cvt_pk_bf16_f32 v52, v136, v137
v_cvt_pk_bf16_f32 v53, v138, v139
v_cvt_pk_bf16_f32 v54, v140, v141
v_cvt_pk_bf16_f32 v55, v142, v143
v_pk_fma_f32 v[128:129], v[14:15], v[136:137], v[128:129] op_sel:[0,0,0] op_sel_hi:[0,1,1] neg_lo:[0,0,1] neg_hi:[0,0,1]
v_pk_fma_f32 v[130:131], v[14:15], v[138:139], v[130:131] op_sel:[0,0,0] op_sel_hi:[0,1,1] neg_lo:[0,0,1] neg_hi:[0,0,1]
v_pk_fma_f32 v[132:133], v[14:15], v[140:141], v[132:133] op_sel:[0,0,0] op_sel_hi:[0,1,1] neg_lo:[0,0,1] neg_hi:[0,0,1]
v_pk_fma_f32 v[134:135], v[14:15], v[142:143], v[134:135] op_sel:[0,0,0] op_sel_hi:[0,1,1] neg_lo:[0,0,1] neg_hi:[0,0,1]
v_cvt_pk_bf16_f32 v56, v128, v129
v_cvt_pk_bf16_f32 v57, v130, v131
v_cvt_pk_bf16_f32 v58, v132, v133
v_cvt_pk_bf16_f32 v59, v134, v135
v_pk_fma_f32 v[136:137], v[14:15], v[128:129], v[136:137] op_sel:[0,0,0] op_sel_hi:[0,1,1] neg_lo:[0,0,1] neg_hi:[0,0,1]
v_pk_fma_f32 v[138:139], v[14:15], v[130:131], v[138:139] op_sel:[0,0,0] op_sel_hi:[0,1,1] neg_lo:[0,0,1] neg_hi:[0,0,1]
v_pk_fma_f32 v[140:141], v[14:15], v[132:133], v[140:141] op_sel:[0,0,0] op_sel_hi:[0,1,1] neg_lo:[0,0,1] neg_hi:[0,0,1]
v_pk_fma_f32 v[142:143], v[14:15], v[134:135], v[142:143] op_sel:[0,0,0] op_sel_hi:[0,1,1] neg_lo:[0,0,1] neg_hi:[0,0,1]
v_cvt_pk_bf16_f32 v60, v136, v137
v_cvt_pk_bf16_f32 v61, v138, v139
v_cvt_pk_bf16_f32 v62, v140, v141
v_cvt_pk_bf16_f32 v63, v142, v143
v_pk_fma_f32 v[128:129], v[14:15], v[136:137], v[128:129] op_sel:[0,0,0] op_sel_hi:[0,1,1] neg_lo:[0,0,1] neg_hi:[0,0,1]
v_pk_fma_f32 v[130:131], v[14:15], v[138:139], v[130:131] op_sel:[0,0,0] op_sel_hi:[0,1,1] neg_lo:[0,0,1] neg_hi:[0,0,1]
v_pk_fma_f32 v[132:133], v[14:15], v[140:141], v[132:133] op_sel:[0,0,0] op_sel_hi:[0,1,1] neg_lo:[0,0,1] neg_hi:[0,0,1]
v_pk_fma_f32 v[134:135], v[14:15], v[142:143], v[134:135] op_sel:[0,0,0] op_sel_hi:[0,1,1] neg_lo:[0,0,1] neg_hi:[0,0,1]
v_cvt_pk_bf16_f32 v64, v128, v129
v_cvt_pk_bf16_f32 v65, v130, v131
v_cvt_pk_bf16_f32 v66, v132, v133
v_cvt_pk_bf16_f32 v67, v134, v135
v_pk_fma_f32 v[136:137], v[14:15], v[128:129], v[136:137] op_sel:[0,0,0] op_sel_hi:[0,1,1] neg_lo:[0,0,1] neg_hi:[0,0,1]
v_pk_fma_f32 v[138:139], v[14:15], v[130:131], v[138:139] op_sel:[0,0,0] op_sel_hi:[0,1,1] neg_lo:[0,0,1] neg_hi:[0,0,1]
v_pk_fma_f32 v[140:141], v[14:15], v[132:133], v[140:141] op_sel:[0,0,0] op_sel_hi:[0,1,1] neg_lo:[0,0,1] neg_hi:[0,0,1]
v_pk_fma_f32 v[142:143], v[14:15], v[134:135], v[142:143] op_sel:[0,0,0] op_sel_hi:[0,1,1] neg_lo:[0,0,1] neg_hi:[0,0,1]
v_cvt_pk_bf16_f32 v68, v136, v137
v_cvt_pk_bf16_f32 v69, v138, v139
v_cvt_pk_bf16_f32 v70, v140, v141
v_cvt_pk_bf16_f32 v71, v142, v143
s_add_u32 m0, s6, 0
s_nop 0
buffer_load_dwordx4 v10, s[52:55], s64 offen lds
buffer_load_dwordx4 v197, s[52:55], s64 offen offset:1024 lds
s_add_u32 m0, s6, 8192
s_nop 0
buffer_load_dwordx4 v10, s[52:55], s65 offen lds
buffer_load_dwordx4 v197, s[52:55], s65 offen offset:1024 lds
s_add_u32 m0, s6, 16384
s_nop 0
buffer_load_dwordx4 v10, s[52:55], s66 offen lds
buffer_load_dwordx4 v197, s[52:55], s66 offen offset:1024 lds
s_add_u32 m0, s6, 24576
s_nop 0
buffer_load_dwordx4 v10, s[52:55], s67 offen lds
buffer_load_dwordx4 v197, s[52:55], s67 offen offset:1024 lds
s_add_u32 m0, s6, 32768
s_nop 0
buffer_load_dwordx4 v10, s[52:55], s68 offen lds
buffer_load_dwordx4 v197, s[52:55], s68 offen offset:1024 lds
s_add_u32 m0, s6, 40960
s_nop 0
buffer_load_dwordx4 v10, s[52:55], s69 offen lds
buffer_load_dwordx4 v197, s[52:55], s69 offen offset:1024 lds
s_add_u32 m0, s6, 49152
s_nop 0
buffer_load_dwordx4 v10, s[52:55], s70 offen lds
buffer_load_dwordx4 v197, s[52:55], s70 offen offset:1024 lds
v_lshrrev_b32 v6, 1, v3
v_xor_b32 v6, v6, v4
v_lshlrev_b32 v6, 4, v6
v_lshl_add_u32 v6, v3, 7, v6
v_add_u32 v5, 57344, v6
v_xor_b32 v12, 64, v5
s_waitcnt vmcnt(19)
v_lshlrev_b32 v200, 16, v200
s_waitcnt vmcnt(18)
v_lshlrev_b32 v201, 16, v201
s_waitcnt vmcnt(17)
v_lshlrev_b32 v202, 16, v202
v_mul_f32 v6, 0x3fb8aa3b, v202
v_exp_f32 v6, v6
s_nop 0
v_cvt_pk_bf16_f32 v6, v6, v6
v_and_b32 v6, 0xffff0000, v6
v_mul_f32 v7, v6, v200
v_mul_f32 v7, 0x3fb8aa3b, v7
v_exp_f32 v7, v7
v_mul_f32 v6, v6, v201
v_mul_f32 v6, 0x3e22f983, v6
v_fract_f32 v6, v6
v_cos_f32 v203, v6
v_sin_f32 v204, v6
v_mul_f32 v203, v203, v7
v_mul_f32 v204, v204, v7
v_add_f32 v203, -1.0, v203
v_mul_f32 v6, v200, v200
v_fmac_f32 v6, v201, v201
v_rcp_f32 v6, v6
v_mul_f32 v205, v203, v200
v_add_f32 v6, v6, v6
v_fmac_f32 v205, v204, v201
v_mul_f32 v206, v204, v200
v_fma_f32 v206, -v203, v201, v206
v_mul_f32 v205, v205, v6
v_mul_f32 v206, v206, v6
s_waitcnt vmcnt(16)
v_lshlrev_b32 v208, 16, v208
s_waitcnt vmcnt(15)
v_lshlrev_b32 v209, 16, v209
s_waitcnt vmcnt(14)
v_lshlrev_b32 v210, 16, v210
v_mul_f32 v6, 0x3fb8aa3b, v210
v_exp_f32 v6, v6
s_nop 0
v_cvt_pk_bf16_f32 v6, v6, v6
v_and_b32 v6, 0xffff0000, v6
v_mul_f32 v7, v6, v208
v_mul_f32 v7, 0x3fb8aa3b, v7
v_exp_f32 v7, v7
v_mul_f32 v6, v6, v209
v_mul_f32 v6, 0x3e22f983, v6
v_fract_f32 v6, v6
v_cos_f32 v211, v6
v_sin_f32 v212, v6
v_mul_f32 v211, v211, v7
v_mul_f32 v212, v212, v7
v_add_f32 v211, -1.0, v211
v_mul_f32 v6, v208, v208
v_fmac_f32 v6, v209, v209
v_rcp_f32 v6, v6
v_mul_f32 v213, v211, v208
v_add_f32 v6, v6, v6
v_fmac_f32 v213, v212, v209
v_mul_f32 v214, v212, v208
v_fma_f32 v214, -v211, v209, v214
v_mul_f32 v213, v213, v6
v_mul_f32 v214, v214, v6
v_mov_b32 v13, 1.0
v_cmp_gt_u32 vcc, 16, v1
s_add_u32 s12, s5, s7
s_cmp_eq_u32 s12, 0
s_cselect_b64 vcc, vcc, 0
v_cndmask_b32 v13, v13, 0, vcc
s_barrier
ds_read_b128 v[160:163], v198 offset:0
ds_read_b128 v[164:167], v198 offset:512
ds_read_b128 v[168:171], v198 offset:1024
ds_read_b128 v[172:175], v198 offset:1536
s_waitcnt lgkmcnt(3)
v_mfma_f32_16x16x32_bf16 v[144:147], v[160:163], v[16:19], 0
ds_read_b128 v[176:179], v199 offset:0
s_waitcnt lgkmcnt(3)
v_mfma_f32_16x16x32_bf16 v[148:151], v[164:167], v[16:19], 0
ds_read_b128 v[180:183], v199 offset:512
s_waitcnt lgkmcnt(3)
v_mfma_f32_16x16x32_bf16 v[152:155], v[168:171], v[16:19], 0
ds_read_b128 v[184:187], v199 offset:1024
s_waitcnt lgkmcnt(3)
v_mfma_f32_16x16x32_bf16 v[156:159], v[172:175], v[16:19], 0
ds_read_b128 v[188:191], v199 offset:1536
s_waitcnt lgkmcnt(3)
v_mfma_f32_16x16x32_bf16 v[144:147], v[176:179], v[20:23], v[144:147]
ds_read_b128 v[160:163], v198 offset:8192
s_waitcnt lgkmcnt(3)
v_mfma_f32_16x16x32_bf16 v[148:151], v[180:183], v[20:23], v[148:151]
ds_read_b128 v[164:167], v198 offset:8704
s_waitcnt lgkmcnt(3)
v_mfma_f32_16x16x32_bf16 v[152:155], v[184:187], v[20:23], v[152:155]
ds_read_b128 v[168:171], v198 offset:9216
s_waitcnt lgkmcnt(3)
v_mfma_f32_16x16x32_bf16 v[156:159], v[188:191], v[20:23], v[156:159]
ds_read_b128 v[172:175], v198 offset:9728
s_waitcnt lgkmcnt(3)
v_mfma_f32_16x16x32_bf16 v[144:147], v[160:163], v[24:27], v[144:147]
ds_read_b128 v[176:179], v199 offset:8192
s_waitcnt lgkmcnt(3)
v_mfma_f32_16x16x32_bf16 v[148:151], v[164:167], v[24:27], v[148:151]
ds_read_b128 v[180:183], v199 offset:8704
s_waitcnt lgkmcnt(3)
v_mfma_f32_16x16x32_bf16 v[152:155], v[168:171], v[24:27], v[152:155]
ds_read_b128 v[184:187], v199 offset:9216
s_waitcnt lgkmcnt(3)
v_mfma_f32_16x16x32_bf16 v[156:159], v[172:175], v[24:27], v[156:159]
ds_read_b128 v[188:191], v199 offset:9728
s_waitcnt lgkmcnt(3)
v_mfma_f32_16x16x32_bf16 v[144:147], v[176:179], v[28:31], v[144:147]
ds_read_b128 v[160:163], v198 offset:16384
s_waitcnt lgkmcnt(3)
v_mfma_f32_16x16x32_bf16 v[148:151], v[180:183], v[28:31], v[148:151]
ds_read_b128 v[164:167], v198 offset:16896
s_waitcnt lgkmcnt(3)
v_mfma_f32_16x16x32_bf16 v[152:155], v[184:187], v[28:31], v[152:155]
ds_read_b128 v[168:171], v198 offset:17408
s_waitcnt lgkmcnt(3)
v_mfma_f32_16x16x32_bf16 v[156:159], v[188:191], v[28:31], v[156:159]
ds_read_b128 v[172:175], v198 offset:17920
s_waitcnt lgkmcnt(3)
v_mfma_f32_16x16x32_bf16 v[144:147], v[160:163], v[32:35], v[144:147]
ds_read_b128 v[176:179], v199 offset:16384
s_waitcnt lgkmcnt(3)
v_mfma_f32_16x16x32_bf16 v[148:151], v[164:167], v[32:35], v[148:151]
ds_read_b128 v[180:183], v199 offset:16896
s_waitcnt lgkmcnt(3)
v_mfma_f32_16x16x32_bf16 v[152:155], v[168:171], v[32:35], v[152:155]
ds_read_b128 v[184:187], v199 offset:17408
s_waitcnt lgkmcnt(3)
v_mfma_f32_16x16x32_bf16 v[156:159], v[172:175], v[32:35], v[156:159]
ds_read_b128 v[188:191], v199 offset:17920
s_waitcnt lgkmcnt(3)
v_mfma_f32_16x16x32_bf16 v[144:147], v[176:179], v[36:39], v[144:147]
ds_read_b128 v[160:163], v198 offset:24576
s_waitcnt lgkmcnt(3)
v_mfma_f32_16x16x32_bf16 v[148:151], v[180:183], v[36:39], v[148:151]
ds_read_b128 v[164:167], v198 offset:25088
s_waitcnt lgkmcnt(3)
v_mfma_f32_16x16x32_bf16 v[152:155], v[184:187], v[36:39], v[152:155]
ds_read_b128 v[168:171], v198 offset:25600
s_waitcnt lgkmcnt(3)
v_mfma_f32_16x16x32_bf16 v[156:159], v[188:191], v[36:39], v[156:159]
ds_read_b128 v[172:175], v198 offset:26112
s_waitcnt lgkmcnt(3)
v_mfma_f32_16x16x32_bf16 v[144:147], v[160:163], v[40:43], v[144:147]
ds_read_b128 v[176:179], v199 offset:24576
s_waitcnt lgkmcnt(3)
v_mfma_f32_16x16x32_bf16 v[148:151], v[164:167], v[40:43], v[148:151]
ds_read_b128 v[180:183], v199 offset:25088
s_waitcnt lgkmcnt(3)
v_mfma_f32_16x16x32_bf16 v[152:155], v[168:171], v[40:43], v[152:155]
ds_read_b128 v[184:187], v199 offset:25600
s_waitcnt lgkmcnt(3)
v_mfma_f32_16x16x32_bf16 v[156:159], v[172:175], v[40:43], v[156:159]
ds_read_b128 v[188:191], v199 offset:26112
s_waitcnt lgkmcnt(3)
v_mfma_f32_16x16x32_bf16 v[144:147], v[176:179], v[44:47], v[144:147]
ds_read_b128 v[160:163], v198 offset:32768
s_waitcnt lgkmcnt(3)
v_mfma_f32_16x16x32_bf16 v[148:151], v[180:183], v[44:47], v[148:151]
ds_read_b128 v[164:167], v198 offset:33280
s_waitcnt lgkmcnt(3)
v_mfma_f32_16x16x32_bf16 v[152:155], v[184:187], v[44:47], v[152:155]
ds_read_b128 v[168:171], v198 offset:33792
s_waitcnt lgkmcnt(3)
v_mfma_f32_16x16x32_bf16 v[156:159], v[188:191], v[44:47], v[156:159]
ds_read_b128 v[172:175], v198 offset:34304
s_waitcnt lgkmcnt(3)
v_mfma_f32_16x16x32_bf16 v[144:147], v[160:163], v[48:51], v[144:147]
ds_read_b128 v[176:179], v199 offset:32768
s_waitcnt lgkmcnt(3)
v_mfma_f32_16x16x32_bf16 v[148:151], v[164:167], v[48:51], v[148:151]
ds_read_b128 v[180:183], v199 offset:33280
s_waitcnt lgkmcnt(3)
v_mfma_f32_16x16x32_bf16 v[152:155], v[168:171], v[48:51], v[152:155]
ds_read_b128 v[184:187], v199 offset:33792
s_waitcnt lgkmcnt(3)
v_mfma_f32_16x16x32_bf16 v[156:159], v[172:175], v[48:51], v[156:159]
ds_read_b128 v[188:191], v199 offset:34304
s_waitcnt lgkmcnt(3)
v_mfma_f32_16x16x32_bf16 v[144:147], v[176:179], v[52:55], v[144:147]
ds_read_b128 v[160:163], v198 offset:40960
s_waitcnt lgkmcnt(3)
v_mfma_f32_16x16x32_bf16 v[148:151], v[180:183], v[52:55], v[148:151]
ds_read_b128 v[164:167], v198 offset:41472
s_waitcnt lgkmcnt(3)
v_mfma_f32_16x16x32_bf16 v[152:155], v[184:187], v[52:55], v[152:155]
ds_read_b128 v[168:171], v198 offset:41984
s_waitcnt lgkmcnt(3)
v_mfma_f32_16x16x32_bf16 v[156:159], v[188:191], v[52:55], v[156:159]
ds_read_b128 v[172:175], v198 offset:42496
s_waitcnt lgkmcnt(3)
v_mfma_f32_16x16x32_bf16 v[144:147], v[160:163], v[56:59], v[144:147]
ds_read_b128 v[176:179], v199 offset:40960
s_waitcnt lgkmcnt(3)
v_mfma_f32_16x16x32_bf16 v[148:151], v[164:167], v[56:59], v[148:151]
ds_read_b128 v[180:183], v199 offset:41472
s_waitcnt lgkmcnt(3)
v_mfma_f32_16x16x32_bf16 v[152:155], v[168:171], v[56:59], v[152:155]
ds_read_b128 v[184:187], v199 offset:41984
s_waitcnt lgkmcnt(3)
v_mfma_f32_16x16x32_bf16 v[156:159], v[172:175], v[56:59], v[156:159]
ds_read_b128 v[188:191], v199 offset:42496
s_waitcnt lgkmcnt(3)
v_mfma_f32_16x16x32_bf16 v[144:147], v[176:179], v[60:63], v[144:147]
ds_read_b128 v[160:163], v198 offset:49152
s_waitcnt lgkmcnt(3)
v_mfma_f32_16x16x32_bf16 v[148:151], v[180:183], v[60:63], v[148:151]
ds_read_b128 v[164:167], v198 offset:49664
s_waitcnt lgkmcnt(3)
v_mfma_f32_16x16x32_bf16 v[152:155], v[184:187], v[60:63], v[152:155]
ds_read_b128 v[168:171], v198 offset:50176
s_waitcnt lgkmcnt(3)
v_mfma_f32_16x16x32_bf16 v[156:159], v[188:191], v[60:63], v[156:159]
ds_read_b128 v[172:175], v198 offset:50688
s_waitcnt lgkmcnt(3)
v_mfma_f32_16x16x32_bf16 v[144:147], v[160:163], v[64:67], v[144:147]
ds_read_b128 v[176:179], v199 offset:49152
s_waitcnt lgkmcnt(3)
v_mfma_f32_16x16x32_bf16 v[148:151], v[164:167], v[64:67], v[148:151]
ds_read_b128 v[180:183], v199 offset:49664
s_waitcnt lgkmcnt(3)
v_mfma_f32_16x16x32_bf16 v[152:155], v[168:171], v[64:67], v[152:155]
ds_read_b128 v[184:187], v199 offset:50176
s_waitcnt lgkmcnt(3)
v_mfma_f32_16x16x32_bf16 v[156:159], v[172:175], v[64:67], v[156:159]
ds_read_b128 v[188:191], v199 offset:50688
s_waitcnt lgkmcnt(3)
v_mfma_f32_16x16x32_bf16 v[144:147], v[176:179], v[68:71], v[144:147]
s_waitcnt lgkmcnt(2)
v_mfma_f32_16x16x32_bf16 v[148:151], v[180:183], v[68:71], v[148:151]
s_waitcnt lgkmcnt(1)
v_mfma_f32_16x16x32_bf16 v[152:155], v[184:187], v[68:71], v[152:155]
s_waitcnt lgkmcnt(0)
v_mfma_f32_16x16x32_bf16 v[156:159], v[188:191], v[68:71], v[156:159]
v_and_b32 v6, -17, v11
v_lshlrev_b32 v6, 12, v6
v_bfe_u32 v7, v1, 3, 1
v_lshl_or_b32 v7, v4, 1, v7
v_lshl_add_u32 v6, v7, 4, v6
s_lshl_b32 s13, s4, 7
s_add_u32 s12, s13, 0
s_add_u32 s14, s12, 65536
v_cmp_ne_u32 vcc, 0, v11
s_nop 1
v_cndmask_b32 v8, 0, 1.0, vcc
v_cvt_pk_bf16_f32 v160, v144, v145
v_cvt_pk_bf16_f32 v161, v146, v147
v_cvt_pk_bf16_f32 v162, v148, v149
v_cvt_pk_bf16_f32 v163, v150, v151
v_cvt_pk_bf16_f32 v164, v152, v153
v_cvt_pk_bf16_f32 v165, v154, v155
v_cvt_pk_bf16_f32 v166, v156, v157
v_cvt_pk_bf16_f32 v167, v158, v159
v_mov_b32 v168, v160
v_mov_b32 v169, v161
v_mov_b32 v170, v162
v_mov_b32 v171, v163
v_mov_b32_dpp v160, v164 row_ror:8 row_mask:0xf bank_mask:0xc
v_mov_b32_dpp v161, v165 row_ror:8 row_mask:0xf bank_mask:0xc
v_mov_b32_dpp v162, v166 row_ror:8 row_mask:0xf bank_mask:0xc
v_mov_b32_dpp v163, v167 row_ror:8 row_mask:0xf bank_mask:0xc
v_mov_b32_dpp v164, v168 row_ror:8 row_mask:0xf bank_mask:0x3
v_mov_b32_dpp v165, v169 row_ror:8 row_mask:0xf bank_mask:0x3
v_mov_b32_dpp v166, v170 row_ror:8 row_mask:0xf bank_mask:0x3
v_mov_b32_dpp v167, v171 row_ror:8 row_mask:0xf bank_mask:0x3
buffer_store_dwordx4 v[160:163], v6, s[48:51], s12 offen sc1
buffer_store_dwordx4 v[164:167], v6, s[48:51], s14 offen sc1
v_pk_mul_f32 v[72:73], v[144:145], v[8:9] op_sel:[0,0] op_sel_hi:[1,0]
v_pk_mul_f32 v[74:75], v[146:147], v[8:9] op_sel:[0,0] op_sel_hi:[1,0]
v_pk_mul_f32 v[76:77], v[148:149], v[8:9] op_sel:[0,0] op_sel_hi:[1,0]
v_pk_mul_f32 v[78:79], v[150:151], v[8:9] op_sel:[0,0] op_sel_hi:[1,0]
v_pk_mul_f32 v[80:81], v[152:153], v[8:9] op_sel:[0,0] op_sel_hi:[1,0]
v_pk_mul_f32 v[82:83], v[154:155], v[8:9] op_sel:[0,0] op_sel_hi:[1,0]
v_pk_mul_f32 v[84:85], v[156:157], v[8:9] op_sel:[0,0] op_sel_hi:[1,0]
v_pk_mul_f32 v[86:87], v[158:159], v[8:9] op_sel:[0,0] op_sel_hi:[1,0]
v_pk_mul_f32 v[72:73], v[72:73], v[144:145] op_sel:[0,0] op_sel_hi:[1,1]
v_pk_mul_f32 v[74:75], v[74:75], v[146:147] op_sel:[0,0] op_sel_hi:[1,1]
v_pk_mul_f32 v[76:77], v[76:77], v[148:149] op_sel:[0,0] op_sel_hi:[1,1]
v_pk_mul_f32 v[78:79], v[78:79], v[150:151] op_sel:[0,0] op_sel_hi:[1,1]
v_pk_mul_f32 v[80:81], v[80:81], v[152:153] op_sel:[0,0] op_sel_hi:[1,1]
v_pk_mul_f32 v[82:83], v[82:83], v[154:155] op_sel:[0,0] op_sel_hi:[1,1]
v_pk_mul_f32 v[84:85], v[84:85], v[156:157] op_sel:[0,0] op_sel_hi:[1,1]
v_pk_mul_f32 v[86:87], v[86:87], v[158:159] op_sel:[0,0] op_sel_hi:[1,1]
s_waitcnt vmcnt(2)
s_waitcnt lgkmcnt(0)
s_barrier
ds_read_b128 v[160:163], v5 offset:0
ds_read_b128 v[164:167], v5 offset:2048
ds_read_b128 v[168:171], v5 offset:4096
ds_read_b128 v[172:175], v5 offset:6144
s_waitcnt lgkmcnt(3)
v_mfma_f32_16x16x32_bf16 v[144:147], v[16:19], v[160:163], 0
ds_read_b128 v[176:179], v12 offset:0
v_and_b32 v6, 8, v1
v_cmp_ne_u32 vcc, 0, v6
s_waitcnt lgkmcnt(3)
v_mfma_f32_16x16x32_bf16 v[148:151], v[16:19], v[164:167], 0
ds_read_b128 v[180:183], v12 offset:2048
v_cndmask_b32 v88, v80, v72, vcc
v_cndmask_b32 v72, v72, v80, vcc
s_waitcnt lgkmcnt(3)
v_mfma_f32_16x16x32_bf16 v[152:155], v[16:19], v[168:171], 0
ds_read_b128 v[184:187], v12 offset:4096
v_cndmask_b32 v89, v81, v73, vcc
v_cndmask_b32 v73, v73, v81, vcc
s_waitcnt lgkmcnt(3)
v_mfma_f32_16x16x32_bf16 v[156:159], v[16:19], v[172:175], 0
ds_read_b128 v[188:191], v12 offset:6144
v_cndmask_b32 v90, v82, v74, vcc
v_cndmask_b32 v74, v74, v82, vcc
s_waitcnt lgkmcnt(3)
v_mfma_f32_16x16x32_bf16 v[144:147], v[20:23], v[176:179], v[144:147]
ds_read_b128 v[160:163], v5 offset:8192
v_cndmask_b32 v91, v83, v75, vcc
v_cndmask_b32 v75, v75, v83, vcc
s_waitcnt lgkmcnt(3)
v_mfma_f32_16x16x32_bf16 v[148:151], v[20:23], v[180:183], v[148:151]
ds_read_b128 v[164:167], v5 offset:10240
v_cndmask_b32 v92, v84, v76, vcc
v_cndmask_b32 v76, v76, v84, vcc
s_waitcnt lgkmcnt(3)
v_mfma_f32_16x16x32_bf16 v[152:155], v[20:23], v[184:187], v[152:155]
ds_read_b128 v[168:171], v5 offset:12288
v_cndmask_b32 v93, v85, v77, vcc
v_cndmask_b32 v77, v77, v85, vcc
s_waitcnt lgkmcnt(3)
v_mfma_f32_16x16x32_bf16 v[156:159], v[20:23], v[188:191], v[156:159]
ds_read_b128 v[172:175], v5 offset:14336
v_cndmask_b32 v94, v86, v78, vcc
v_cndmask_b32 v78, v78, v86, vcc
s_waitcnt lgkmcnt(3)
v_mfma_f32_16x16x32_bf16 v[144:147], v[24:27], v[160:163], v[144:147]
ds_read_b128 v[176:179], v12 offset:8192
v_cndmask_b32 v95, v87, v79, vcc
v_cndmask_b32 v79, v79, v87, vcc
s_waitcnt lgkmcnt(3)
v_mfma_f32_16x16x32_bf16 v[148:151], v[24:27], v[164:167], v[148:151]
ds_read_b128 v[180:183], v12 offset:10240
v_add_f32_dpp v72, v88, v72 row_ror:8 row_mask:0xf bank_mask:0xf
v_add_f32_dpp v73, v89, v73 row_ror:8 row_mask:0xf bank_mask:0xf
s_waitcnt lgkmcnt(3)
v_mfma_f32_16x16x32_bf16 v[152:155], v[24:27], v[168:171], v[152:155]
ds_read_b128 v[184:187], v12 offset:12288
v_add_f32_dpp v74, v90, v74 row_ror:8 row_mask:0xf bank_mask:0xf
v_add_f32_dpp v75, v91, v75 row_ror:8 row_mask:0xf bank_mask:0xf
s_waitcnt lgkmcnt(3)
v_mfma_f32_16x16x32_bf16 v[156:159], v[24:27], v[172:175], v[156:159]
ds_read_b128 v[188:191], v12 offset:14336
v_add_f32_dpp v76, v92, v76 row_ror:8 row_mask:0xf bank_mask:0xf
v_add_f32_dpp v77, v93, v77 row_ror:8 row_mask:0xf bank_mask:0xf
s_waitcnt lgkmcnt(3)
v_mfma_f32_16x16x32_bf16 v[144:147], v[28:31], v[176:179], v[144:147]
ds_read_b128 v[160:163], v5 offset:16384
v_add_f32_dpp v78, v94, v78 row_ror:8 row_mask:0xf bank_mask:0xf
v_add_f32_dpp v79, v95, v79 row_ror:8 row_mask:0xf bank_mask:0xf
s_waitcnt lgkmcnt(3)
v_mfma_f32_16x16x32_bf16 v[148:151], v[28:31], v[180:183], v[148:151]
ds_read_b128 v[164:167], v5 offset:18432
v_and_b32 v6, 4, v1
v_cmp_ne_u32 vcc, 0, v6
s_waitcnt lgkmcnt(3)
v_mfma_f32_16x16x32_bf16 v[152:155], v[28:31], v[184:187], v[152:155]
ds_read_b128 v[168:171], v5 offset:20480
v_cndmask_b32 v88, v76, v72, vcc
v_cndmask_b32 v72, v72, v76, vcc
s_waitcnt lgkmcnt(3)
v_mfma_f32_16x16x32_bf16 v[156:159], v[28:31], v[188:191], v[156:159]
ds_read_b128 v[172:175], v5 offset:22528
v_cndmask_b32 v89, v77, v73, vcc
v_cndmask_b32 v73, v73, v77, vcc
s_waitcnt lgkmcnt(3)
v_mfma_f32_16x16x32_bf16 v[144:147], v[32:35], v[160:163], v[144:147]
ds_read_b128 v[176:179], v12 offset:16384
v_cndmask_b32 v90, v78, v74, vcc
v_cndmask_b32 v74, v74, v78, vcc
s_waitcnt lgkmcnt(3)
v_mfma_f32_16x16x32_bf16 v[148:151], v[32:35], v[164:167], v[148:151]
ds_read_b128 v[180:183], v12 offset:18432
v_cndmask_b32 v91, v79, v75, vcc
v_cndmask_b32 v75, v75, v79, vcc
s_waitcnt lgkmcnt(3)
v_mfma_f32_16x16x32_bf16 v[152:155], v[32:35], v[168:171], v[152:155]
ds_read_b128 v[184:187], v12 offset:20480
v_add_f32_dpp v72, v88, v72 row_half_mirror row_mask:0xf bank_mask:0xf
v_add_f32_dpp v73, v89, v73 row_half_mirror row_mask:0xf bank_mask:0xf
s_waitcnt lgkmcnt(3)
v_mfma_f32_16x16x32_bf16 v[156:159], v[32:35], v[172:175], v[156:159]
ds_read_b128 v[188:191], v12 offset:22528
v_add_f32_dpp v74, v90, v74 row_half_mirror row_mask:0xf bank_mask:0xf
v_add_f32_dpp v75, v91, v75 row_half_mirror row_mask:0xf bank_mask:0xf
s_waitcnt lgkmcnt(3)
v_mfma_f32_16x16x32_bf16 v[144:147], v[36:39], v[176:179], v[144:147]
ds_read_b128 v[160:163], v5 offset:24576
v_and_b32 v6, 2, v1
v_cmp_ne_u32 vcc, 0, v6
s_waitcnt lgkmcnt(3)
v_mfma_f32_16x16x32_bf16 v[148:151], v[36:39], v[180:183], v[148:151]
ds_read_b128 v[164:167], v5 offset:26624
v_cndmask_b32 v88, v74, v72, vcc
v_cndmask_b32 v72, v72, v74, vcc
s_waitcnt lgkmcnt(3)
v_mfma_f32_16x16x32_bf16 v[152:155], v[36:39], v[184:187], v[152:155]
ds_read_b128 v[168:171], v5 offset:28672
v_cndmask_b32 v89, v75, v73, vcc
v_cndmask_b32 v73, v73, v75, vcc
s_waitcnt lgkmcnt(3)
v_mfma_f32_16x16x32_bf16 v[156:159], v[36:39], v[188:191], v[156:159]
ds_read_b128 v[172:175], v5 offset:30720
v_add_f32_dpp v72, v88, v72 quad_perm:[2,3,0,1] row_mask:0xf bank_mask:0xf
v_add_f32_dpp v73, v89, v73 quad_perm:[2,3,0,1] row_mask:0xf bank_mask:0xf
s_waitcnt lgkmcnt(3)
v_mfma_f32_16x16x32_bf16 v[144:147], v[40:43], v[160:163], v[144:147]
ds_read_b128 v[176:179], v12 offset:24576
v_and_b32 v6, 1, v1
v_cmp_ne_u32 vcc, 0, v6
s_waitcnt lgkmcnt(3)
v_mfma_f32_16x16x32_bf16 v[148:151], v[40:43], v[164:167], v[148:151]
ds_read_b128 v[180:183], v12 offset:26624
v_cndmask_b32 v88, v73, v72, vcc
v_cndmask_b32 v72, v72, v73, vcc
s_waitcnt lgkmcnt(3)
v_mfma_f32_16x16x32_bf16 v[152:155], v[40:43], v[168:171], v[152:155]
ds_read_b128 v[184:187], v12 offset:28672
v_add_f32_dpp v72, v88, v72 quad_perm:[1,0,3,2] row_mask:0xf bank_mask:0xf
v_lshlrev_b32 v6, 2, v0
s_waitcnt lgkmcnt(3)
v_mfma_f32_16x16x32_bf16 v[156:159], v[40:43], v[172:175], v[156:159]
ds_read_b128 v[188:191], v12 offset:30720
v_add_u32 v6, 114688, v6
ds_write_b32 v6, v72
s_waitcnt lgkmcnt(4)
v_mfma_f32_16x16x32_bf16 v[144:147], v[44:47], v[176:179], v[144:147]
ds_read_b128 v[160:163], v5 offset:32768
v_mov_b32 v128, -1
v_mov_b32 v129, -1
s_waitcnt lgkmcnt(4)
v_mfma_f32_16x16x32_bf16 v[148:151], v[44:47], v[180:183], v[148:151]
ds_read_b128 v[164:167], v5 offset:34816
v_mov_b32 v130, -1
v_mov_b32 v131, -1
s_waitcnt lgkmcnt(4)
v_mfma_f32_16x16x32_bf16 v[152:155], v[44:47], v[184:187], v[152:155]
ds_read_b128 v[168:171], v5 offset:36864
v_lshlrev_b32 v6, 4, v0
s_lshl_b32 s14, s2, 13
s_waitcnt lgkmcnt(4)
v_mfma_f32_16x16x32_bf16 v[156:159], v[44:47], v[188:191], v[156:159]
ds_read_b128 v[172:175], v5 offset:38912
s_add_u32 s14, s14, 2097152
s_add_u32 s15, s14, 4096
s_waitcnt lgkmcnt(3)
v_mfma_f32_16x16x32_bf16 v[144:147], v[48:51], v[160:163], v[144:147]
ds_read_b128 v[176:179], v12 offset:32768
buffer_store_dwordx4 v[128:131], v6, s[48:51], s14 offen sc1
buffer_store_dwordx4 v[128:131], v6, s[48:51], s15 offen sc1
s_waitcnt lgkmcnt(3)
v_mfma_f32_16x16x32_bf16 v[148:151], v[48:51], v[164:167], v[148:151]
ds_read_b128 v[180:183], v12 offset:34816
s_lshl_b32 s14, s2, 12
s_add_u32 s15, s14, 26931200
s_waitcnt lgkmcnt(3)
v_mfma_f32_16x16x32_bf16 v[152:155], v[48:51], v[168:171], v[152:155]
ds_read_b128 v[184:187], v12 offset:36864
s_add_u32 s14, s14, 28311552
s_cmp_lt_u32 s2, 113
s_waitcnt lgkmcnt(3)
v_mfma_f32_16x16x32_bf16 v[156:159], v[48:51], v[172:175], v[156:159]
ds_read_b128 v[188:191], v12 offset:38912
s_cselect_b32 s14, s14, s15
s_cmp_lt_u32 s2, 120
s_waitcnt lgkmcnt(3)
v_mfma_f32_16x16x32_bf16 v[144:147], v[52:55], v[176:179], v[144:147]
ds_read_b128 v[160:163], v5 offset:40960
s_cselect_b32 s62, s50, 0
s_mov_b32 s60, s48
s_waitcnt lgkmcnt(3)
v_mfma_f32_16x16x32_bf16 v[148:151], v[52:55], v[180:183], v[148:151]
ds_read_b128 v[164:167], v5 offset:43008
s_mov_b32 s61, s49
s_mov_b32 s63, s51
s_waitcnt lgkmcnt(3)
v_mfma_f32_16x16x32_bf16 v[152:155], v[52:55], v[184:187], v[152:155]
ds_read_b128 v[168:171], v5 offset:45056
buffer_store_dwordx4 v[128:131], v6, s[60:63], s14 offen sc1
s_waitcnt lgkmcnt(3)
v_mfma_f32_16x16x32_bf16 v[156:159], v[52:55], v[188:191], v[156:159]
ds_read_b128 v[172:175], v5 offset:47104
s_waitcnt lgkmcnt(3)
v_mfma_f32_16x16x32_bf16 v[144:147], v[56:59], v[160:163], v[144:147]
ds_read_b128 v[176:179], v12 offset:40960
s_waitcnt lgkmcnt(3)
v_mfma_f32_16x16x32_bf16 v[148:151], v[56:59], v[164:167], v[148:151]
ds_read_b128 v[180:183], v12 offset:43008
s_waitcnt lgkmcnt(3)
v_mfma_f32_16x16x32_bf16 v[152:155], v[56:59], v[168:171], v[152:155]
ds_read_b128 v[184:187], v12 offset:45056
s_waitcnt lgkmcnt(3)
v_mfma_f32_16x16x32_bf16 v[156:159], v[56:59], v[172:175], v[156:159]
ds_read_b128 v[188:191], v12 offset:47104
s_waitcnt lgkmcnt(3)
v_mfma_f32_16x16x32_bf16 v[144:147], v[60:63], v[176:179], v[144:147]
ds_read_b128 v[160:163], v5 offset:49152
s_waitcnt lgkmcnt(3)
v_mfma_f32_16x16x32_bf16 v[148:151], v[60:63], v[180:183], v[148:151]
ds_read_b128 v[164:167], v5 offset:51200
s_waitcnt lgkmcnt(3)
v_mfma_f32_16x16x32_bf16 v[152:155], v[60:63], v[184:187], v[152:155]
ds_read_b128 v[168:171], v5 offset:53248
s_waitcnt lgkmcnt(3)
v_mfma_f32_16x16x32_bf16 v[156:159], v[60:63], v[188:191], v[156:159]
ds_read_b128 v[172:175], v5 offset:55296
s_waitcnt lgkmcnt(3)
v_mfma_f32_16x16x32_bf16 v[144:147], v[64:67], v[160:163], v[144:147]
ds_read_b128 v[176:179], v12 offset:49152
s_waitcnt lgkmcnt(3)
v_mfma_f32_16x16x32_bf16 v[148:151], v[64:67], v[164:167], v[148:151]
ds_read_b128 v[180:183], v12 offset:51200
s_waitcnt lgkmcnt(3)
v_mfma_f32_16x16x32_bf16 v[152:155], v[64:67], v[168:171], v[152:155]
ds_read_b128 v[184:187], v12 offset:53248
s_waitcnt lgkmcnt(3)
v_mfma_f32_16x16x32_bf16 v[156:159], v[64:67], v[172:175], v[156:159]
ds_read_b128 v[188:191], v12 offset:55296
s_waitcnt lgkmcnt(3)
v_mfma_f32_16x16x32_bf16 v[144:147], v[68:71], v[176:179], v[144:147]
s_waitcnt lgkmcnt(2)
v_mfma_f32_16x16x32_bf16 v[148:151], v[68:71], v[180:183], v[148:151]
s_waitcnt lgkmcnt(1)
v_mfma_f32_16x16x32_bf16 v[152:155], v[68:71], v[184:187], v[152:155]
s_waitcnt lgkmcnt(0)
v_mfma_f32_16x16x32_bf16 v[156:159], v[68:71], v[188:191], v[156:159]
s_lshl_b32 s13, s4, 1
s_and_b32 s14, s7, 1
s_add_u32 s13, s13, s14
s_mul_i32 s13, s13, 28
s_lshl_b32 s14, s5, 1
s_add_u32 s13, s13, s14
s_lshr_b32 s14, s7, 1
s_add_u32 s13, s13, s14
s_lshl_b32 s13, s13, 10
s_add_u32 s13, s13, 23068672
v_mul_f32 v144, v144, v13
v_mul_f32 v148, v148, v13
v_mul_f32 v152, v152, v13
v_mul_f32 v156, v156, v13
v_mul_f32 v104, v144, v205
v_mul_f32 v108, v144, v206
v_fma_f32 v104, -v152, v206, v104
v_fmac_f32 v108, v152, v205
v_mul_f32 v105, v145, v205
v_mul_f32 v109, v145, v206
v_fma_f32 v105, -v153, v206, v105
v_fmac_f32 v109, v153, v205
v_mul_f32 v106, v146, v205
v_mul_f32 v110, v146, v206
v_fma_f32 v106, -v154, v206, v106
v_fmac_f32 v110, v154, v205
v_mul_f32 v107, v147, v205
v_mul_f32 v111, v147, v206
v_fma_f32 v107, -v155, v206, v107
v_fmac_f32 v111, v155, v205
v_cvt_pk_bf16_f32 v160, v104, v105
v_cvt_pk_bf16_f32 v161, v106, v107
v_cvt_pk_bf16_f32 v162, v108, v109
v_cvt_pk_bf16_f32 v163, v110, v111
v_mul_f32 v104, v148, v213
v_mul_f32 v108, v148, v214
v_fma_f32 v104, -v156, v214, v104
v_fmac_f32 v108, v156, v213
v_mul_f32 v105, v149, v213
v_mul_f32 v109, v149, v214
v_fma_f32 v105, -v157, v214, v105
v_fmac_f32 v109, v157, v213
v_mul_f32 v106, v150, v213
v_mul_f32 v110, v150, v214
v_fma_f32 v106, -v158, v214, v106
v_fmac_f32 v110, v158, v213
v_mul_f32 v107, v151, v213
v_mul_f32 v111, v151, v214
v_fma_f32 v107, -v159, v214, v107
v_fmac_f32 v111, v159, v213
v_cvt_pk_bf16_f32 v164, v104, v105
v_cvt_pk_bf16_f32 v165, v106, v107
v_cvt_pk_bf16_f32 v166, v108, v109
v_cvt_pk_bf16_f32 v167, v110, v111
s_lshl_b32 s12, s7, 10
s_add_u32 s12, s12, 116736
v_add_u32 v6, s12, v2
v_xor_b32 v7, 1024, v6
s_add_u32 s14, s13, 14336
s_bitcmp1_b32 s7, 0
s_cbranch_scc1 L_k1_po5
ds_write_b128 v6, v[164:167]
v_mov_b32 v168, v160
v_mov_b32 v169, v161
v_mov_b32 v172, v162
v_mov_b32 v173, v163
s_waitcnt lgkmcnt(0)
s_barrier
ds_read_b64 v[170:171], v7
ds_read_b64 v[174:175], v7 offset:8
s_branch L_k1_po6
L_k1_po5:
ds_write_b128 v6, v[160:163]
v_mov_b32 v170, v164
v_mov_b32 v171, v165
v_mov_b32 v174, v166
v_mov_b32 v175, v167
s_waitcnt lgkmcnt(0)
s_barrier
ds_read_b64 v[168:169], v7
ds_read_b64 v[172:173], v7 offset:8
L_k1_po6:
s_waitcnt lgkmcnt(0)
buffer_store_dwordx4 v[168:171], v2, s[48:51], s13 offen sc1
buffer_store_dwordx4 v[172:175], v2, s[48:51], s14 offen sc1
v_lshlrev_b32 v7, 5, v1
v_add_u32 v7, 114688, v7
s_mov_b64 exec, 0xff
ds_read_b128 v[72:75], v7 offset:0
ds_read_b128 v[76:79], v7 offset:16
ds_read_b128 v[80:83], v7 offset:256
ds_read_b128 v[84:87], v7 offset:272
ds_read_b128 v[88:91], v7 offset:512
ds_read_b128 v[92:95], v7 offset:528
ds_read_b128 v[96:99], v7 offset:768
ds_read_b128 v[100:103], v7 offset:784
s_lshl_b32 s13, s4, 7
s_lshl_b32 s15, s5, 12
s_add_u32 s13, s13, s15
s_add_u32 s13, s13, 27328512
s_cmp_eq_u32 s7, 0
s_cselect_b32 s62, s50, 0
s_waitcnt lgkmcnt(5)
v_pk_add_f32 v[72:73], v[72:73], v[80:81] op_sel:[0,0] op_sel_hi:[1,1]
v_pk_add_f32 v[74:75], v[74:75], v[82:83] op_sel:[0,0] op_sel_hi:[1,1]
s_waitcnt lgkmcnt(4)
v_pk_add_f32 v[76:77], v[76:77], v[84:85] op_sel:[0,0] op_sel_hi:[1,1]
v_pk_add_f32 v[78:79], v[78:79], v[86:87] op_sel:[0,0] op_sel_hi:[1,1]
s_waitcnt lgkmcnt(1)
v_pk_add_f32 v[88:89], v[88:89], v[96:97] op_sel:[0,0] op_sel_hi:[1,1]
v_pk_add_f32 v[90:91], v[90:91], v[98:99] op_sel:[0,0] op_sel_hi:[1,1]
s_waitcnt lgkmcnt(0)
v_pk_add_f32 v[92:93], v[92:93], v[100:101] op_sel:[0,0] op_sel_hi:[1,1]
v_pk_add_f32 v[94:95], v[94:95], v[102:103] op_sel:[0,0] op_sel_hi:[1,1]
v_pk_add_f32 v[72:73], v[72:73], v[88:89] op_sel:[0,0] op_sel_hi:[1,1]
v_pk_add_f32 v[74:75], v[74:75], v[90:91] op_sel:[0,0] op_sel_hi:[1,1]
v_pk_add_f32 v[76:77], v[76:77], v[92:93] op_sel:[0,0] op_sel_hi:[1,1]
v_pk_add_f32 v[78:79], v[78:79], v[94:95] op_sel:[0,0] op_sel_hi:[1,1]
v_cvt_pk_bf16_f32 v72, v72, v73
v_cvt_pk_bf16_f32 v73, v74, v75
v_cvt_pk_bf16_f32 v74, v76, v77
v_cvt_pk_bf16_f32 v75, v78, v79
buffer_store_dwordx4 v[72:75], v2, s[60:63], s13 offen sc1
s_endpgm
L_k1_c3:
s_add_u32 m0, s6, 0
s_nop 0
buffer_load_dwordx4 v9, s[56:59], s64 offen lds
buffer_load_dwordx4 v196, s[56:59], s64 offen offset:1024 lds
s_add_u32 m0, s6, 8192
s_nop 0
buffer_load_dwordx4 v9, s[56:59], s65 offen lds
buffer_load_dwordx4 v196, s[56:59], s65 offen offset:1024 lds
s_add_u32 m0, s6, 16384
s_nop 0
buffer_load_dwordx4 v9, s[56:59], s66 offen lds
buffer_load_dwordx4 v196, s[56:59], s66 offen offset:1024 lds
s_add_u32 m0, s6, 24576
s_nop 0
buffer_load_dwordx4 v9, s[56:59], s67 offen lds
buffer_load_dwordx4 v196, s[56:59], s67 offen offset:1024 lds
s_add_u32 m0, s6, 32768
s_nop 0
buffer_load_dwordx4 v9, s[56:59], s68 offen lds
buffer_load_dwordx4 v196, s[56:59], s68 offen offset:1024 lds
s_add_u32 m0, s6, 40960
s_nop 0
buffer_load_dwordx4 v9, s[56:59], s69 offen lds
buffer_load_dwordx4 v196, s[56:59], s69 offen offset:1024 lds
s_add_u32 m0, s6, 49152
s_nop 0
buffer_load_dwordx4 v9, s[56:59], s70 offen lds
buffer_load_dwordx4 v196, s[56:59], s70 offen offset:1024 lds
s_mov_b32 s48, s44
s_and_b32 s49, s45, 0xffff
s_mov_b32 s50, 0x2000000
s_mov_b32 s51, 0x20000
v_lshrrev_b32 v6, 2, v3
v_bfe_u32 v8, v3, 1, 1
v_lshl_or_b32 v8, v6, 1, v8
v_xor_b32 v8, v8, v4
v_lshlrev_b32 v8, 4, v8
v_lshl_add_u32 v8, v6, 11, v8
v_and_b32 v6, 3, v3
v_lshl_add_u32 v198, v6, 7, v8
v_xor_b32 v199, 64, v198
s_add_u32 s6, s6, 57344
s_sub_u32 s8, s4, 14
s_and_b32 s9, s8, 1
s_lshr_b32 s8, s8, 1
v_lshrrev_b32 v6, 3, v1
v_mul_u32_u24 v10, 896, v6
v_bfe_u32 v6, v1, 4, 1
v_lshlrev_b32 v6, 2, v6
v_xor_b32 v6, v6, v7
s_and_b32 s13, s7, 1
v_xor_b32 v6, s13, v6
v_lshl_add_u32 v10, v6, 4, v10
s_lshl_b32 s13, s8, 7
s_mul_i32 s14, s7, 7168
s_add_u32 s13, s13, s14
v_add_u32 v10, s13, v10
v_add_u32 v197, 27648, v10
s_cmp_eq_u32 s9, 0
s_cselect_b32 s14, s32, s34
s_cselect_b32 s15, s33, s35
s_mov_b32 s52, s14
s_and_b32 s53, s15, 0xffff
s_mov_b32 s54, 0x62000
s_mov_b32 s55, 0x20000
s_lshl_b32 s12, s5, 2
s_add_u32 s12, s12, s7
s_lshl_b32 s12, s12, 4
v_add_u32 v6, s12, v3
v_mov_b32 v11, v6
v_lshrrev_b32 v192, 1, v6
v_and_b32 v194, 1, v6
v_cvt_f32_u32 v194, v194
v_mul_f32 v194, 0x3e800000, v194
v_mov_b32 v15, 0x3d88d677
v_mov_b32 v7, 0x3d41848f
v_cmp_gt_u32 vcc, 2, v6
s_nop 1
v_cndmask_b32 v15, v15, v7, vcc
v_cndmask_b32 v194, v194, 0, vcc
v_mov_b32 v7, 224
v_cmp_eq_u32 vcc, 1, v6
s_nop 1
v_cndmask_b32 v192, v192, v7, vcc
s_lshl_b32 s12, s5, 6
v_lshl_add_u32 v7, v4, 3, s12
v_mul_u32_u24 v193, v192, v7
v_cvt_f32_u32 v192, v192
v_cvt_f32_u32 v193, v193
v_mul_f32 v7, 0x3b124925, v193
v_floor_f32 v7, v7
v_fmac_f32 v193, 0xc3e00000, v7
v_mul_f32 v7, 0x3d924925, v192
v_cos_f32 v14, v7
v_mov_b32 v128, v193
v_add_f32 v129, v193, v192
v_add_f32 v6, v192, v192
v_mul_f32 v8, 0x42000000, v192
v_add_f32 v14, v14, v14
s_mov_b32 s12, 0x3b124925
v_pk_add_f32 v[130:131], v[128:129], v[6:7] op_sel:[0,0] op_sel_hi:[1,0]
v_pk_add_f32 v[132:133], v[130:131], v[6:7] op_sel:[0,0] op_sel_hi:[1,0]
v_pk_add_f32 v[134:135], v[132:133], v[6:7] op_sel:[0,0] op_sel_hi:[1,0]
v_pk_add_f32 v[136:137], v[128:129], v[8:9] op_sel:[0,0] op_sel_hi:[1,0]
v_pk_add_f32 v[138:139], v[130:131], v[8:9] op_sel:[0,0] op_sel_hi:[1,0]
v_pk_add_f32 v[140:141], v[132:133], v[8:9] op_sel:[0,0] op_sel_hi:[1,0]
v_pk_add_f32 v[142:143], v[134:135], v[8:9] op_sel:[0,0] op_sel_hi:[1,0]
v_pk_fma_f32 v[128:129], v[128:129], s[12:13], v[194:195] op_sel:[0,0,0] op_sel_hi:[1,0,0]
v_pk_fma_f32 v[130:131], v[130:131], s[12:13], v[194:195] op_sel:[0,0,0] op_sel_hi:[1,0,0]
v_pk_fma_f32 v[132:133], v[132:133], s[12:13], v[194:195] op_sel:[0,0,0] op_sel_hi:[1,0,0]
v_pk_fma_f32 v[134:135], v[134:135], s[12:13], v[194:195] op_sel:[0,0,0] op_sel_hi:[1,0,0]
v_pk_fma_f32 v[136:137], v[136:137], s[12:13], v[194:195] op_sel:[0,0,0] op_sel_hi:[1,0,0]
v_pk_fma_f32 v[138:139], v[138:139], s[12:13], v[194:195] op_sel:[0,0,0] op_sel_hi:[1,0,0]
v_pk_fma_f32 v[140:141], v[140:141], s[12:13], v[194:195] op_sel:[0,0,0] op_sel_hi:[1,0,0]
v_pk_fma_f32 v[142:143], v[142:143], s[12:13], v[194:195] op_sel:[0,0,0] op_sel_hi:[1,0,0]
v_cos_f32 v128, v128
v_cos_f32 v129, v129
v_cos_f32 v130, v130
v_cos_f32 v131, v131
v_cos_f32 v132, v132
v_cos_f32 v133, v133
v_cos_f32 v134, v134
v_cos_f32 v135, v135
v_cos_f32 v136, v136
v_cos_f32 v137, v137
v_cos_f32 v138, v138
v_cos_f32 v139, v139
v_cos_f32 v140, v140
v_cos_f32 v141, v141
v_cos_f32 v142, v142
v_cos_f32 v143, v143
v_pk_mul_f32 v[128:129], v[128:129], v[14:15] op_sel:[0,1] op_sel_hi:[1,1]
v_pk_mul_f32 v[130:131], v[130:131], v[14:15] op_sel:[0,1] op_sel_hi:[1,1]
v_pk_mul_f32 v[132:133], v[132:133], v[14:15] op_sel:[0,1] op_sel_hi:[1,1]
v_pk_mul_f32 v[134:135], v[134:135], v[14:15] op_sel:[0,1] op_sel_hi:[1,1]
v_pk_mul_f32 v[136:137], v[136:137], v[14:15] op_sel:[0,1] op_sel_hi:[1,1]
v_pk_mul_f32 v[138:139], v[138:139], v[14:15] op_sel:[0,1] op_sel_hi:[1,1]
v_pk_mul_f32 v[140:141], v[140:141], v[14:15] op_sel:[0,1] op_sel_hi:[1,1]
v_pk_mul_f32 v[142:143], v[142:143], v[14:15] op_sel:[0,1] op_sel_hi:[1,1]
v_cvt_pk_bf16_f32 v16, v128, v129
v_cvt_pk_bf16_f32 v17, v130, v131
v_cvt_pk_bf16_f32 v18, v132, v133
v_cvt_pk_bf16_f32 v19, v134, v135
v_cvt_pk_bf16_f32 v20, v136, v137
v_cvt_pk_bf16_f32 v21, v138, v139
v_cvt_pk_bf16_f32 v22, v140, v141
v_cvt_pk_bf16_f32 v23, v142, v143
v_pk_fma_f32 v[128:129], v[14:15], v[136:137], v[128:129] op_sel:[0,0,0] op_sel_hi:[0,1,1] neg_lo:[0,0,1] neg_hi:[0,0,1]
v_pk_fma_f32 v[130:131], v[14:15], v[138:139], v[130:131] op_sel:[0,0,0] op_sel_hi:[0,1,1] neg_lo:[0,0,1] neg_hi:[0,0,1]
v_pk_fma_f32 v[132:133], v[14:15], v[140:141], v[132:133] op_sel:[0,0,0] op_sel_hi:[0,1,1] neg_lo:[0,0,1] neg_hi:[0,0,1]
v_pk_fma_f32 v[134:135], v[14:15], v[142:143], v[134:135] op_sel:[0,0,0] op_sel_hi:[0,1,1] neg_lo:[0,0,1] neg_hi:[0,0,1]
v_cvt_pk_bf16_f32 v24, v128, v129
v_cvt_pk_bf16_f32 v25, v130, v131
v_cvt_pk_bf16_f32 v26, v132, v133
v_cvt_pk_bf16_f32 v27, v134, v135
v_pk_fma_f32 v[136:137], v[14:15], v[128:129], v[136:137] op_sel:[0,0,0] op_sel_hi:[0,1,1] neg_lo:[0,0,1] neg_hi:[0,0,1]
v_pk_fma_f32 v[138:139], v[14:15], v[130:131], v[138:139] op_sel:[0,0,0] op_sel_hi:[0,1,1] neg_lo:[0,0,1] neg_hi:[0,0,1]
v_pk_fma_f32 v[140:141], v[14:15], v[132:133], v[140:141] op_sel:[0,0,0] op_sel_hi:[0,1,1] neg_lo:[0,0,1] neg_hi:[0,0,1]
v_pk_fma_f32 v[142:143], v[14:15], v[134:135], v[142:143] op_sel:[0,0,0] op_sel_hi:[0,1,1] neg_lo:[0,0,1] neg_hi:[0,0,1]
v_cvt_pk_bf16_f32 v28, v136, v137
v_cvt_pk_bf16_f32 v29, v138, v139
v_cvt_pk_bf16_f32 v30, v140, v141
v_cvt_pk_bf16_f32 v31, v142, v143
v_pk_fma_f32 v[128:129], v[14:15], v[136:137], v[128:129] op_sel:[0,0,0] op_sel_hi:[0,1,1] neg_lo:[0,0,1] neg_hi:[0,0,1]
v_pk_fma_f32 v[130:131], v[14:15], v[138:139], v[130:131] op_sel:[0,0,0] op_sel_hi:[0,1,1] neg_lo:[0,0,1] neg_hi:[0,0,1]
v_pk_fma_f32 v[132:133], v[14:15], v[140:141], v[132:133] op_sel:[0,0,0] op_sel_hi:[0,1,1] neg_lo:[0,0,1] neg_hi:[0,0,1]
v_pk_fma_f32 v[134:135], v[14:15], v[142:143], v[134:135] op_sel:[0,0,0] op_sel_hi:[0,1,1] neg_lo:[0,0,1] neg_hi:[0,0,1]
v_cvt_pk_bf16_f32 v32, v128, v129
v_cvt_pk_bf16_f32 v33, v130, v131
v_cvt_pk_bf16_f32 v34, v132, v133
v_cvt_pk_bf16_f32 v35, v134, v135
v_pk_fma_f32 v[136:137], v[14:15], v[128:129], v[136:137] op_sel:[0,0,0] op_sel_hi:[0,1,1] neg_lo:[0,0,1] neg_hi:[0,0,1]
v_pk_fma_f32 v[138:139], v[14:15], v[130:131], v[138:139] op_sel:[0,0,0] op_sel_hi:[0,1,1] neg_lo:[0,0,1] neg_hi:[0,0,1]
v_pk_fma_f32 v[140:141], v[14:15], v[132:133], v[140:141] op_sel:[0,0,0] op_sel_hi:[0,1,1] neg_lo:[0,0,1] neg_hi:[0,0,1]
v_pk_fma_f32 v[142:143], v[14:15], v[134:135], v[142:143] op_sel:[0,0,0] op_sel_hi:[0,1,1] neg_lo:[0,0,1] neg_hi:[0,0,1]
v_cvt_pk_bf16_f32 v36, v136, v137
v_cvt_pk_bf16_f32 v37, v138, v139
v_cvt_pk_bf16_f32 v38, v140, v141
v_cvt_pk_bf16_f32 v39, v142, v143
v_pk_fma_f32 v[128:129], v[14:15], v[136:137], v[128:129] op_sel:[0,0,0] op_sel_hi:[0,1,1] neg_lo:[0,0,1] neg_hi:[0,0,1]
v_pk_fma_f32 v[130:131], v[14:15], v[138:139], v[130:131] op_sel:[0,0,0] op_sel_hi:[0,1,1] neg_lo:[0,0,1] neg_hi:[0,0,1]
v_pk_fma_f32 v[132:133], v[14:15], v[140:141], v[132:133] op_sel:[0,0,0] op_sel_hi:[0,1,1] neg_lo:[0,0,1] neg_hi:[0,0,1]
v_pk_fma_f32 v[134:135], v[14:15], v[142:143], v[134:135] op_sel:[0,0,0] op_sel_hi:[0,1,1] neg_lo:[0,0,1] neg_hi:[0,0,1]
v_cvt_pk_bf16_f32 v40, v128, v129
v_cvt_pk_bf16_f32 v41, v130, v131
v_cvt_pk_bf16_f32 v42, v132, v133
v_cvt_pk_bf16_f32 v43, v134, v135
v_pk_fma_f32 v[136:137], v[14:15], v[128:129], v[136:137] op_sel:[0,0,0] op_sel_hi:[0,1,1] neg_lo:[0,0,1] neg_hi:[0,0,1]
v_pk_fma_f32 v[138:139], v[14:15], v[130:131], v[138:139] op_sel:[0,0,0] op_sel_hi:[0,1,1] neg_lo:[0,0,1] neg_hi:[0,0,1]
v_pk_fma_f32 v[140:141], v[14:15], v[132:133], v[140:141] op_sel:[0,0,0] op_sel_hi:[0,1,1] neg_lo:[0,0,1] neg_hi:[0,0,1]
v_pk_fma_f32 v[142:143], v[14:15], v[134:135], v[142:143] op_sel:[0,0,0] op_sel_hi:[0,1,1] neg_lo:[0,0,1] neg_hi:[0,0,1]
v_cvt_pk_bf16_f32 v44, v136, v137
v_cvt_pk_bf16_f32 v45, v138, v139
v_cvt_pk_bf16_f32 v46, v140, v141
v_cvt_pk_bf16_f32 v47, v142, v143
v_pk_fma_f32 v[128:129], v[14:15], v[136:137], v[128:129] op_sel:[0,0,0] op_sel_hi:[0,1,1] neg_lo:[0,0,1] neg_hi:[0,0,1]
v_pk_fma_f32 v[130:131], v[14:15], v[138:139], v[130:131] op_sel:[0,0,0] op_sel_hi:[0,1,1] neg_lo:[0,0,1] neg_hi:[0,0,1]
v_pk_fma_f32 v[132:133], v[14:15], v[140:141], v[132:133] op_sel:[0,0,0] op_sel_hi:[0,1,1] neg_lo:[0,0,1] neg_hi:[0,0,1]
v_pk_fma_f32 v[134:135], v[14:15], v[142:143], v[134:135] op_sel:[0,0,0] op_sel_hi:[0,1,1] neg_lo:[0,0,1] neg_hi:[0,0,1]
v_cvt_pk_bf16_f32 v48, v128, v129
v_cvt_pk_bf16_f32 v49, v130, v131
v_cvt_pk_bf16_f32 v50, v132, v133
v_cvt_pk_bf16_f32 v51, v134, v135
v_pk_fma_f32 v[136:137], v[14:15], v[128:129], v[136:137] op_sel:[0,0,0] op_sel_hi:[0,1,1] neg_lo:[0,0,1] neg_hi:[0,0,1]
v_pk_fma_f32 v[138:139], v[14:15], v[130:131], v[138:139] op_sel:[0,0,0] op_sel_hi:[0,1,1] neg_lo:[0,0,1] neg_hi:[0,0,1]
v_pk_fma_f32 v[140:141], v[14:15], v[132:133], v[140:141] op_sel:[0,0,0] op_sel_hi:[0,1,1] neg_lo:[0,0,1] neg_hi:[0,0,1]
v_pk_fma_f32 v[142:143], v[14:15], v[134:135], v[142:143] op_sel:[0,0,0] op_sel_hi:[0,1,1] neg_lo:[0,0,1] neg_hi:[0,0,1]
v_cvt_pk_bf16_f32 v52, v136, v137
v_cvt_pk_bf16_f32 v53, v138, v139
v_cvt_pk_bf16_f32 v54, v140, v141
v_cvt_pk_bf16_f32 v55, v142, v143
v_pk_fma_f32 v[128:129], v[14:15], v[136:137], v[128:129] op_sel:[0,0,0] op_sel_hi:[0,1,1] neg_lo:[0,0,1] neg_hi:[0,0,1]
v_pk_fma_f32 v[130:131], v[14:15], v[138:139], v[130:131] op_sel:[0,0,0] op_sel_hi:[0,1,1] neg_lo:[0,0,1] neg_hi:[0,0,1]
v_pk_fma_f32 v[132:133], v[14:15], v[140:141], v[132:133] op_sel:[0,0,0] op_sel_hi:[0,1,1] neg_lo:[0,0,1] neg_hi:[0,0,1]
v_pk_fma_f32 v[134:135], v[14:15], v[142:143], v[134:135] op_sel:[0,0,0] op_sel_hi:[0,1,1] neg_lo:[0,0,1] neg_hi:[0,0,1]
v_cvt_pk_bf16_f32 v56, v128, v129
v_cvt_pk_bf16_f32 v57, v130, v131
v_cvt_pk_bf16_f32 v58, v132, v133
v_cvt_pk_bf16_f32 v59, v134, v135
v_pk_fma_f32 v[136:137], v[14:15], v[128:129], v[136:137] op_sel:[0,0,0] op_sel_hi:[0,1,1] neg_lo:[0,0,1] neg_hi:[0,0,1]
v_pk_fma_f32 v[138:139], v[14:15], v[130:131], v[138:139] op_sel:[0,0,0] op_sel_hi:[0,1,1] neg_lo:[0,0,1] neg_hi:[0,0,1]
v_pk_fma_f32 v[140:141], v[14:15], v[132:133], v[140:141] op_sel:[0,0,0] op_sel_hi:[0,1,1] neg_lo:[0,0,1] neg_hi:[0,0,1]
v_pk_fma_f32 v[142:143], v[14:15], v[134:135], v[142:143] op_sel:[0,0,0] op_sel_hi:[0,1,1] neg_lo:[0,0,1] neg_hi:[0,0,1]
v_cvt_pk_bf16_f32 v60, v136, v137
v_cvt_pk_bf16_f32 v61, v138, v139
v_cvt_pk_bf16_f32 v62, v140, v141
v_cvt_pk_bf16_f32 v63, v142, v143
v_pk_fma_f32 v[128:129], v[14:15], v[136:137], v[128:129] op_sel:[0,0,0] op_sel_hi:[0,1,1] neg_lo:[0,0,1] neg_hi:[0,0,1]
v_pk_fma_f32 v[130:131], v[14:15], v[138:139], v[130:131] op_sel:[0,0,0] op_sel_hi:[0,1,1] neg_lo:[0,0,1] neg_hi:[0,0,1]
v_pk_fma_f32 v[132:133], v[14:15], v[140:141], v[132:133] op_sel:[0,0,0] op_sel_hi:[0,1,1] neg_lo:[0,0,1] neg_hi:[0,0,1]
v_pk_fma_f32 v[134:135], v[14:15], v[142:143], v[134:135] op_sel:[0,0,0] op_sel_hi:[0,1,1] neg_lo:[0,0,1] neg_hi:[0,0,1]
v_cvt_pk_bf16_f32 v64, v128, v129
v_cvt_pk_bf16_f32 v65, v130, v131
v_cvt_pk_bf16_f32 v66, v132, v133
v_cvt_pk_bf16_f32 v67, v134, v135
v_pk_fma_f32 v[136:137], v[14:15], v[128:129], v[136:137] op_sel:[0,0,0] op_sel_hi:[0,1,1] neg_lo:[0,0,1] neg_hi:[0,0,1]
v_pk_fma_f32 v[138:139], v[14:15], v[130:131], v[138:139] op_sel:[0,0,0] op_sel_hi:[0,1,1] neg_lo:[0,0,1] neg_hi:[0,0,1]
v_pk_fma_f32 v[140:141], v[14:15], v[132:133], v[140:141] op_sel:[0,0,0] op_sel_hi:[0,1,1] neg_lo:[0,0,1] neg_hi:[0,0,1]
v_pk_fma_f32 v[142:143], v[14:15], v[134:135], v[142:143] op_sel:[0,0,0] op_sel_hi:[0,1,1] neg_lo:[0,0,1] neg_hi:[0,0,1]
v_cvt_pk_bf16_f32 v68, v136, v137
v_cvt_pk_bf16_f32 v69, v138, v139
v_cvt_pk_bf16_f32 v70, v140, v141
v_cvt_pk_bf16_f32 v71, v142, v143
s_add_u32 m0, s6, 0
s_mul_i32 s11, s64, 448
buffer_load_dwordx4 v10, s[52:55], s11 offen lds
buffer_load_dwordx4 v197, s[52:55], s11 offen offset:1024 lds
s_add_u32 m0, s6, 8192
s_mul_i32 s11, s65, 448
buffer_load_dwordx4 v10, s[52:55], s11 offen lds
buffer_load_dwordx4 v197, s[52:55], s11 offen offset:1024 lds
s_add_u32 m0, s6, 16384
s_mul_i32 s11, s66, 448
buffer_load_dwordx4 v10, s[52:55], s11 offen lds
buffer_load_dwordx4 v197, s[52:55], s11 offen offset:1024 lds
s_add_u32 m0, s6, 24576
s_mul_i32 s11, s67, 448
buffer_load_dwordx4 v10, s[52:55], s11 offen lds
buffer_load_dwordx4 v197, s[52:55], s11 offen offset:1024 lds
s_add_u32 m0, s6, 32768
s_mul_i32 s11, s68, 448
buffer_load_dwordx4 v10, s[52:55], s11 offen lds
buffer_load_dwordx4 v197, s[52:55], s11 offen offset:1024 lds
s_add_u32 m0, s6, 40960
s_mul_i32 s11, s69, 448
buffer_load_dwordx4 v10, s[52:55], s11 offen lds
buffer_load_dwordx4 v197, s[52:55], s11 offen offset:1024 lds
s_add_u32 m0, s6, 49152
s_mul_i32 s11, s70, 448
buffer_load_dwordx4 v10, s[52:55], s11 offen lds
buffer_load_dwordx4 v197, s[52:55], s11 offen offset:1024 lds
v_bfe_u32 v7, v1, 2, 2
v_lshl_add_u32 v6, v4, 4, v7
v_lshlrev_b32 v200, 7, v6
v_and_b32 v6, 3, v1
v_and_b32 v7, 1, v4
v_xor_b32 v6, v6, v7
v_lshl_add_u32 v200, v6, 4, v200
v_bfe_u32 v6, v1, 3, 1
v_lshl_add_u32 v200, v6, 6, v200
v_and_b32 v6, 1, v1
v_lshl_add_u32 v200, v6, 3, v200
v_add_u32 v200, 57344, v200
v_xor_b32 v201, 8, v200
v_xor_b32 v202, 64, v200
v_xor_b32 v203, 72, v200
s_waitcnt vmcnt(14)
s_barrier
ds_read_b128 v[160:163], v198 offset:0
ds_read_b128 v[164:167], v198 offset:512
ds_read_b128 v[168:171], v198 offset:1024
ds_read_b128 v[172:175], v198 offset:1536
s_waitcnt lgkmcnt(3)
v_mfma_f32_16x16x32_bf16 v[144:147], v[160:163], v[16:19], 0
ds_read_b128 v[176:179], v199 offset:0
s_waitcnt lgkmcnt(3)
v_mfma_f32_16x16x32_bf16 v[148:151], v[164:167], v[16:19], 0
ds_read_b128 v[180:183], v199 offset:512
s_waitcnt lgkmcnt(3)
v_mfma_f32_16x16x32_bf16 v[152:155], v[168:171], v[16:19], 0
ds_read_b128 v[184:187], v199 offset:1024
s_waitcnt lgkmcnt(3)
v_mfma_f32_16x16x32_bf16 v[156:159], v[172:175], v[16:19], 0
ds_read_b128 v[188:191], v199 offset:1536
s_waitcnt lgkmcnt(3)
v_mfma_f32_16x16x32_bf16 v[144:147], v[176:179], v[20:23], v[144:147]
ds_read_b128 v[160:163], v198 offset:8192
s_waitcnt lgkmcnt(3)
v_mfma_f32_16x16x32_bf16 v[148:151], v[180:183], v[20:23], v[148:151]
ds_read_b128 v[164:167], v198 offset:8704
s_waitcnt lgkmcnt(3)
v_mfma_f32_16x16x32_bf16 v[152:155], v[184:187], v[20:23], v[152:155]
ds_read_b128 v[168:171], v198 offset:9216
s_waitcnt lgkmcnt(3)
v_mfma_f32_16x16x32_bf16 v[156:159], v[188:191], v[20:23], v[156:159]
ds_read_b128 v[172:175], v198 offset:9728
s_waitcnt lgkmcnt(3)
v_mfma_f32_16x16x32_bf16 v[144:147], v[160:163], v[24:27], v[144:147]
ds_read_b128 v[176:179], v199 offset:8192
s_waitcnt lgkmcnt(3)
v_mfma_f32_16x16x32_bf16 v[148:151], v[164:167], v[24:27], v[148:151]
ds_read_b128 v[180:183], v199 offset:8704
s_waitcnt lgkmcnt(3)
v_mfma_f32_16x16x32_bf16 v[152:155], v[168:171], v[24:27], v[152:155]
ds_read_b128 v[184:187], v199 offset:9216
s_waitcnt lgkmcnt(3)
v_mfma_f32_16x16x32_bf16 v[156:159], v[172:175], v[24:27], v[156:159]
ds_read_b128 v[188:191], v199 offset:9728
s_waitcnt lgkmcnt(3)
v_mfma_f32_16x16x32_bf16 v[144:147], v[176:179], v[28:31], v[144:147]
ds_read_b128 v[160:163], v198 offset:16384
s_waitcnt lgkmcnt(3)
v_mfma_f32_16x16x32_bf16 v[148:151], v[180:183], v[28:31], v[148:151]
ds_read_b128 v[164:167], v198 offset:16896
s_waitcnt lgkmcnt(3)
v_mfma_f32_16x16x32_bf16 v[152:155], v[184:187], v[28:31], v[152:155]
ds_read_b128 v[168:171], v198 offset:17408
s_waitcnt lgkmcnt(3)
v_mfma_f32_16x16x32_bf16 v[156:159], v[188:191], v[28:31], v[156:159]
ds_read_b128 v[172:175], v198 offset:17920
s_waitcnt lgkmcnt(3)
v_mfma_f32_16x16x32_bf16 v[144:147], v[160:163], v[32:35], v[144:147]
ds_read_b128 v[176:179], v199 offset:16384
s_waitcnt lgkmcnt(3)
v_mfma_f32_16x16x32_bf16 v[148:151], v[164:167], v[32:35], v[148:151]
ds_read_b128 v[180:183], v199 offset:16896
s_waitcnt lgkmcnt(3)
v_mfma_f32_16x16x32_bf16 v[152:155], v[168:171], v[32:35], v[152:155]
ds_read_b128 v[184:187], v199 offset:17408
s_waitcnt lgkmcnt(3)
v_mfma_f32_16x16x32_bf16 v[156:159], v[172:175], v[32:35], v[156:159]
ds_read_b128 v[188:191], v199 offset:17920
s_waitcnt lgkmcnt(3)
v_mfma_f32_16x16x32_bf16 v[144:147], v[176:179], v[36:39], v[144:147]
ds_read_b128 v[160:163], v198 offset:24576
s_waitcnt lgkmcnt(3)
v_mfma_f32_16x16x32_bf16 v[148:151], v[180:183], v[36:39], v[148:151]
ds_read_b128 v[164:167], v198 offset:25088
s_waitcnt lgkmcnt(3)
v_mfma_f32_16x16x32_bf16 v[152:155], v[184:187], v[36:39], v[152:155]
ds_read_b128 v[168:171], v198 offset:25600
s_waitcnt lgkmcnt(3)
v_mfma_f32_16x16x32_bf16 v[156:159], v[188:191], v[36:39], v[156:159]
ds_read_b128 v[172:175], v198 offset:26112
s_waitcnt lgkmcnt(3)
v_mfma_f32_16x16x32_bf16 v[144:147], v[160:163], v[40:43], v[144:147]
ds_read_b128 v[176:179], v199 offset:24576
s_waitcnt lgkmcnt(3)
v_mfma_f32_16x16x32_bf16 v[148:151], v[164:167], v[40:43], v[148:151]
ds_read_b128 v[180:183], v199 offset:25088
s_waitcnt lgkmcnt(3)
v_mfma_f32_16x16x32_bf16 v[152:155], v[168:171], v[40:43], v[152:155]
ds_read_b128 v[184:187], v199 offset:25600
s_waitcnt lgkmcnt(3)
v_mfma_f32_16x16x32_bf16 v[156:159], v[172:175], v[40:43], v[156:159]
ds_read_b128 v[188:191], v199 offset:26112
s_waitcnt lgkmcnt(3)
v_mfma_f32_16x16x32_bf16 v[144:147], v[176:179], v[44:47], v[144:147]
ds_read_b128 v[160:163], v198 offset:32768
s_waitcnt lgkmcnt(3)
v_mfma_f32_16x16x32_bf16 v[148:151], v[180:183], v[44:47], v[148:151]
ds_read_b128 v[164:167], v198 offset:33280
s_waitcnt lgkmcnt(3)
v_mfma_f32_16x16x32_bf16 v[152:155], v[184:187], v[44:47], v[152:155]
ds_read_b128 v[168:171], v198 offset:33792
s_waitcnt lgkmcnt(3)
v_mfma_f32_16x16x32_bf16 v[156:159], v[188:191], v[44:47], v[156:159]
ds_read_b128 v[172:175], v198 offset:34304
s_waitcnt lgkmcnt(3)
v_mfma_f32_16x16x32_bf16 v[144:147], v[160:163], v[48:51], v[144:147]
ds_read_b128 v[176:179], v199 offset:32768
s_waitcnt lgkmcnt(3)
v_mfma_f32_16x16x32_bf16 v[148:151], v[164:167], v[48:51], v[148:151]
ds_read_b128 v[180:183], v199 offset:33280
s_waitcnt lgkmcnt(3)
v_mfma_f32_16x16x32_bf16 v[152:155], v[168:171], v[48:51], v[152:155]
ds_read_b128 v[184:187], v199 offset:33792
s_waitcnt lgkmcnt(3)
v_mfma_f32_16x16x32_bf16 v[156:159], v[172:175], v[48:51], v[156:159]
ds_read_b128 v[188:191], v199 offset:34304
s_waitcnt lgkmcnt(3)
v_mfma_f32_16x16x32_bf16 v[144:147], v[176:179], v[52:55], v[144:147]
ds_read_b128 v[160:163], v198 offset:40960
s_waitcnt lgkmcnt(3)
v_mfma_f32_16x16x32_bf16 v[148:151], v[180:183], v[52:55], v[148:151]
ds_read_b128 v[164:167], v198 offset:41472
s_waitcnt lgkmcnt(3)
v_mfma_f32_16x16x32_bf16 v[152:155], v[184:187], v[52:55], v[152:155]
ds_read_b128 v[168:171], v198 offset:41984
s_waitcnt lgkmcnt(3)
v_mfma_f32_16x16x32_bf16 v[156:159], v[188:191], v[52:55], v[156:159]
ds_read_b128 v[172:175], v198 offset:42496
s_waitcnt lgkmcnt(3)
v_mfma_f32_16x16x32_bf16 v[144:147], v[160:163], v[56:59], v[144:147]
ds_read_b128 v[176:179], v199 offset:40960
s_waitcnt lgkmcnt(3)
v_mfma_f32_16x16x32_bf16 v[148:151], v[164:167], v[56:59], v[148:151]
ds_read_b128 v[180:183], v199 offset:41472
s_waitcnt lgkmcnt(3)
v_mfma_f32_16x16x32_bf16 v[152:155], v[168:171], v[56:59], v[152:155]
ds_read_b128 v[184:187], v199 offset:41984
s_waitcnt lgkmcnt(3)
v_mfma_f32_16x16x32_bf16 v[156:159], v[172:175], v[56:59], v[156:159]
ds_read_b128 v[188:191], v199 offset:42496
s_waitcnt lgkmcnt(3)
v_mfma_f32_16x16x32_bf16 v[144:147], v[176:179], v[60:63], v[144:147]
ds_read_b128 v[160:163], v198 offset:49152
s_waitcnt lgkmcnt(3)
v_mfma_f32_16x16x32_bf16 v[148:151], v[180:183], v[60:63], v[148:151]
ds_read_b128 v[164:167], v198 offset:49664
s_waitcnt lgkmcnt(3)
v_mfma_f32_16x16x32_bf16 v[152:155], v[184:187], v[60:63], v[152:155]
ds_read_b128 v[168:171], v198 offset:50176
s_waitcnt lgkmcnt(3)
v_mfma_f32_16x16x32_bf16 v[156:159], v[188:191], v[60:63], v[156:159]
ds_read_b128 v[172:175], v198 offset:50688
s_waitcnt lgkmcnt(3)
v_mfma_f32_16x16x32_bf16 v[144:147], v[160:163], v[64:67], v[144:147]
ds_read_b128 v[176:179], v199 offset:49152
s_waitcnt lgkmcnt(3)
v_mfma_f32_16x16x32_bf16 v[148:151], v[164:167], v[64:67], v[148:151]
ds_read_b128 v[180:183], v199 offset:49664
s_waitcnt lgkmcnt(3)
v_mfma_f32_16x16x32_bf16 v[152:155], v[168:171], v[64:67], v[152:155]
ds_read_b128 v[184:187], v199 offset:50176
s_waitcnt lgkmcnt(3)
v_mfma_f32_16x16x32_bf16 v[156:159], v[172:175], v[64:67], v[156:159]
ds_read_b128 v[188:191], v199 offset:50688
s_waitcnt lgkmcnt(3)
v_mfma_f32_16x16x32_bf16 v[144:147], v[176:179], v[68:71], v[144:147]
s_waitcnt lgkmcnt(2)
v_mfma_f32_16x16x32_bf16 v[148:151], v[180:183], v[68:71], v[148:151]
s_waitcnt lgkmcnt(1)
v_mfma_f32_16x16x32_bf16 v[152:155], v[184:187], v[68:71], v[152:155]
s_waitcnt lgkmcnt(0)
v_mfma_f32_16x16x32_bf16 v[156:159], v[188:191], v[68:71], v[156:159]
v_and_b32 v6, -9, v11
v_lshlrev_b32 v6, 12, v6
v_bfe_u32 v7, v1, 3, 1
v_lshl_or_b32 v7, v4, 1, v7
v_lshl_add_u32 v6, v7, 4, v6
s_lshl_b32 s13, s4, 7
s_add_u32 s12, s13, 0
s_add_u32 s14, s12, 32768
v_cmp_ne_u32 vcc, 0, v11
s_nop 1
v_cndmask_b32 v8, 0, 1.0, vcc
v_cvt_pk_bf16_f32 v160, v144, v145
v_cvt_pk_bf16_f32 v161, v146, v147
v_cvt_pk_bf16_f32 v162, v148, v149
v_cvt_pk_bf16_f32 v163, v150, v151
v_cvt_pk_bf16_f32 v164, v152, v153
v_cvt_pk_bf16_f32 v165, v154, v155
v_cvt_pk_bf16_f32 v166, v156, v157
v_cvt_pk_bf16_f32 v167, v158, v159
v_mov_b32 v168, v160
v_mov_b32 v169, v161
v_mov_b32 v170, v162
v_mov_b32 v171, v163
v_mov_b32_dpp v160, v164 row_ror:8 row_mask:0xf bank_mask:0xc
v_mov_b32_dpp v161, v165 row_ror:8 row_mask:0xf bank_mask:0xc
v_mov_b32_dpp v162, v166 row_ror:8 row_mask:0xf bank_mask:0xc
v_mov_b32_dpp v163, v167 row_ror:8 row_mask:0xf bank_mask:0xc
v_mov_b32_dpp v164, v168 row_ror:8 row_mask:0xf bank_mask:0x3
v_mov_b32_dpp v165, v169 row_ror:8 row_mask:0xf bank_mask:0x3
v_mov_b32_dpp v166, v170 row_ror:8 row_mask:0xf bank_mask:0x3
v_mov_b32_dpp v167, v171 row_ror:8 row_mask:0xf bank_mask:0x3
buffer_store_dwordx4 v[160:163], v6, s[48:51], s12 offen sc1
buffer_store_dwordx4 v[164:167], v6, s[48:51], s14 offen sc1
v_pk_mul_f32 v[72:73], v[144:145], v[8:9] op_sel:[0,0] op_sel_hi:[1,0]
v_pk_mul_f32 v[74:75], v[146:147], v[8:9] op_sel:[0,0] op_sel_hi:[1,0]
v_pk_mul_f32 v[76:77], v[148:149], v[8:9] op_sel:[0,0] op_sel_hi:[1,0]
v_pk_mul_f32 v[78:79], v[150:151], v[8:9] op_sel:[0,0] op_sel_hi:[1,0]
v_pk_mul_f32 v[80:81], v[152:153], v[8:9] op_sel:[0,0] op_sel_hi:[1,0]
v_pk_mul_f32 v[82:83], v[154:155], v[8:9] op_sel:[0,0] op_sel_hi:[1,0]
v_pk_mul_f32 v[84:85], v[156:157], v[8:9] op_sel:[0,0] op_sel_hi:[1,0]
v_pk_mul_f32 v[86:87], v[158:159], v[8:9] op_sel:[0,0] op_sel_hi:[1,0]
v_pk_mul_f32 v[72:73], v[72:73], v[144:145] op_sel:[0,0] op_sel_hi:[1,1]
v_pk_mul_f32 v[74:75], v[74:75], v[146:147] op_sel:[0,0] op_sel_hi:[1,1]
v_pk_mul_f32 v[76:77], v[76:77], v[148:149] op_sel:[0,0] op_sel_hi:[1,1]
v_pk_mul_f32 v[78:79], v[78:79], v[150:151] op_sel:[0,0] op_sel_hi:[1,1]
v_pk_mul_f32 v[80:81], v[80:81], v[152:153] op_sel:[0,0] op_sel_hi:[1,1]
v_pk_mul_f32 v[82:83], v[82:83], v[154:155] op_sel:[0,0] op_sel_hi:[1,1]
v_pk_mul_f32 v[84:85], v[84:85], v[156:157] op_sel:[0,0] op_sel_hi:[1,1]
v_pk_mul_f32 v[86:87], v[86:87], v[158:159] op_sel:[0,0] op_sel_hi:[1,1]
s_waitcnt vmcnt(2)
s_waitcnt lgkmcnt(0)
s_barrier
ds_read_b64_tr_b16 v[160:161], v200 offset:0
ds_read_b64_tr_b16 v[162:163], v200 offset:512
ds_read_b64_tr_b16 v[164:165], v201 offset:0
ds_read_b64_tr_b16 v[166:167], v201 offset:512
ds_read_b64_tr_b16 v[168:169], v202 offset:0
ds_read_b64_tr_b16 v[170:171], v202 offset:512
ds_read_b64_tr_b16 v[172:173], v203 offset:0
ds_read_b64_tr_b16 v[174:175], v203 offset:512
s_waitcnt lgkmcnt(6)
v_mfma_f32_16x16x32_bf16 v[144:147], v[160:163], v[16:19], 0
ds_read_b64_tr_b16 v[176:177], v200 offset:1024
ds_read_b64_tr_b16 v[178:179], v200 offset:1536
v_and_b32 v6, 8, v1
s_waitcnt lgkmcnt(6)
v_mfma_f32_16x16x32_bf16 v[148:151], v[164:167], v[16:19], 0
ds_read_b64_tr_b16 v[180:181], v201 offset:1024
ds_read_b64_tr_b16 v[182:183], v201 offset:1536
v_cmp_ne_u32 vcc, 0, v6
s_waitcnt lgkmcnt(6)
v_mfma_f32_16x16x32_bf16 v[152:155], v[168:171], v[16:19], 0
ds_read_b64_tr_b16 v[184:185], v202 offset:1024
ds_read_b64_tr_b16 v[186:187], v202 offset:1536
v_cndmask_b32 v88, v80, v72, vcc
s_waitcnt lgkmcnt(6)
v_mfma_f32_16x16x32_bf16 v[156:159], v[172:175], v[16:19], 0
ds_read_b64_tr_b16 v[188:189], v203 offset:1024
ds_read_b64_tr_b16 v[190:191], v203 offset:1536
v_cndmask_b32 v72, v72, v80, vcc
s_waitcnt lgkmcnt(6)
v_mfma_f32_16x16x32_bf16 v[144:147], v[176:179], v[20:23], v[144:147]
ds_read_b64_tr_b16 v[160:161], v200 offset:8192
ds_read_b64_tr_b16 v[162:163], v200 offset:8704
v_cndmask_b32 v89, v81, v73, vcc
s_waitcnt lgkmcnt(6)
v_mfma_f32_16x16x32_bf16 v[148:151], v[180:183], v[20:23], v[148:151]
ds_read_b64_tr_b16 v[164:165], v201 offset:8192
ds_read_b64_tr_b16 v[166:167], v201 offset:8704
v_cndmask_b32 v73, v73, v81, vcc
s_waitcnt lgkmcnt(6)
v_mfma_f32_16x16x32_bf16 v[152:155], v[184:187], v[20:23], v[152:155]
ds_read_b64_tr_b16 v[168:169], v202 offset:8192
ds_read_b64_tr_b16 v[170:171], v202 offset:8704
v_cndmask_b32 v90, v82, v74, vcc
s_waitcnt lgkmcnt(6)
v_mfma_f32_16x16x32_bf16 v[156:159], v[188:191], v[20:23], v[156:159]
ds_read_b64_tr_b16 v[172:173], v203 offset:8192
ds_read_b64_tr_b16 v[174:175], v203 offset:8704
v_cndmask_b32 v74, v74, v82, vcc
s_waitcnt lgkmcnt(6)
v_mfma_f32_16x16x32_bf16 v[144:147], v[160:163], v[24:27], v[144:147]
ds_read_b64_tr_b16 v[176:177], v200 offset:9216
ds_read_b64_tr_b16 v[178:179], v200 offset:9728
v_cndmask_b32 v91, v83, v75, vcc
s_waitcnt lgkmcnt(6)
v_mfma_f32_16x16x32_bf16 v[148:151], v[164:167], v[24:27], v[148:151]
ds_read_b64_tr_b16 v[180:181], v201 offset:9216
ds_read_b64_tr_b16 v[182:183], v201 offset:9728
v_cndmask_b32 v75, v75, v83, vcc
s_waitcnt lgkmcnt(6)
v_mfma_f32_16x16x32_bf16 v[152:155], v[168:171], v[24:27], v[152:155]
ds_read_b64_tr_b16 v[184:185], v202 offset:9216
ds_read_b64_tr_b16 v[186:187], v202 offset:9728
v_cndmask_b32 v92, v84, v76, vcc
s_waitcnt lgkmcnt(6)
v_mfma_f32_16x16x32_bf16 v[156:159], v[172:175], v[24:27], v[156:159]
ds_read_b64_tr_b16 v[188:189], v203 offset:9216
ds_read_b64_tr_b16 v[190:191], v203 offset:9728
v_cndmask_b32 v76, v76, v84, vcc
s_waitcnt lgkmcnt(6)
v_mfma_f32_16x16x32_bf16 v[144:147], v[176:179], v[28:31], v[144:147]
ds_read_b64_tr_b16 v[160:161], v200 offset:16384
ds_read_b64_tr_b16 v[162:163], v200 offset:16896
v_cndmask_b32 v93, v85, v77, vcc
s_waitcnt lgkmcnt(6)
v_mfma_f32_16x16x32_bf16 v[148:151], v[180:183], v[28:31], v[148:151]
ds_read_b64_tr_b16 v[164:165], v201 offset:16384
ds_read_b64_tr_b16 v[166:167], v201 offset:16896
v_cndmask_b32 v77, v77, v85, vcc
s_waitcnt lgkmcnt(6)
v_mfma_f32_16x16x32_bf16 v[152:155], v[184:187], v[28:31], v[152:155]
ds_read_b64_tr_b16 v[168:169], v202 offset:16384
ds_read_b64_tr_b16 v[170:171], v202 offset:16896
v_cndmask_b32 v94, v86, v78, vcc
s_waitcnt lgkmcnt(6)
v_mfma_f32_16x16x32_bf16 v[156:159], v[188:191], v[28:31], v[156:159]
ds_read_b64_tr_b16 v[172:173], v203 offset:16384
ds_read_b64_tr_b16 v[174:175], v203 offset:16896
v_cndmask_b32 v78, v78, v86, vcc
s_waitcnt lgkmcnt(6)
v_mfma_f32_16x16x32_bf16 v[144:147], v[160:163], v[32:35], v[144:147]
ds_read_b64_tr_b16 v[176:177], v200 offset:17408
ds_read_b64_tr_b16 v[178:179], v200 offset:17920
v_cndmask_b32 v95, v87, v79, vcc
s_waitcnt lgkmcnt(6)
v_mfma_f32_16x16x32_bf16 v[148:151], v[164:167], v[32:35], v[148:151]
ds_read_b64_tr_b16 v[180:181], v201 offset:17408
ds_read_b64_tr_b16 v[182:183], v201 offset:17920
v_cndmask_b32 v79, v79, v87, vcc
s_waitcnt lgkmcnt(6)
v_mfma_f32_16x16x32_bf16 v[152:155], v[168:171], v[32:35], v[152:155]
ds_read_b64_tr_b16 v[184:185], v202 offset:17408
ds_read_b64_tr_b16 v[186:187], v202 offset:17920
v_add_f32_dpp v72, v88, v72 row_ror:8 row_mask:0xf bank_mask:0xf
s_waitcnt lgkmcnt(6)
v_mfma_f32_16x16x32_bf16 v[156:159], v[172:175], v[32:35], v[156:159]
ds_read_b64_tr_b16 v[188:189], v203 offset:17408
ds_read_b64_tr_b16 v[190:191], v203 offset:17920
v_add_f32_dpp v73, v89, v73 row_ror:8 row_mask:0xf bank_mask:0xf
s_waitcnt lgkmcnt(6)
v_mfma_f32_16x16x32_bf16 v[144:147], v[176:179], v[36:39], v[144:147]
ds_read_b64_tr_b16 v[160:161], v200 offset:24576
ds_read_b64_tr_b16 v[162:163], v200 offset:25088
v_add_f32_dpp v74, v90, v74 row_ror:8 row_mask:0xf bank_mask:0xf
s_waitcnt lgkmcnt(6)
v_mfma_f32_16x16x32_bf16 v[148:151], v[180:183], v[36:39], v[148:151]
ds_read_b64_tr_b16 v[164:165], v201 offset:24576
ds_read_b64_tr_b16 v[166:167], v201 offset:25088
v_add_f32_dpp v75, v91, v75 row_ror:8 row_mask:0xf bank_mask:0xf
s_waitcnt lgkmcnt(6)
v_mfma_f32_16x16x32_bf16 v[152:155], v[184:187], v[36:39], v[152:155]
ds_read_b64_tr_b16 v[168:169], v202 offset:24576
ds_read_b64_tr_b16 v[170:171], v202 offset:25088
v_add_f32_dpp v76, v92, v76 row_ror:8 row_mask:0xf bank_mask:0xf
s_waitcnt lgkmcnt(6)
v_mfma_f32_16x16x32_bf16 v[156:159], v[188:191], v[36:39], v[156:159]
ds_read_b64_tr_b16 v[172:173], v203 offset:24576
ds_read_b64_tr_b16 v[174:175], v203 offset:25088
v_add_f32_dpp v77, v93, v77 row_ror:8 row_mask:0xf bank_mask:0xf
s_waitcnt lgkmcnt(6)
v_mfma_f32_16x16x32_bf16 v[144:147], v[160:163], v[40:43], v[144:147]
ds_read_b64_tr_b16 v[176:177], v200 offset:25600
ds_read_b64_tr_b16 v[178:179], v200 offset:26112
v_add_f32_dpp v78, v94, v78 row_ror:8 row_mask:0xf bank_mask:0xf
s_waitcnt lgkmcnt(6)
v_mfma_f32_16x16x32_bf16 v[148:151], v[164:167], v[40:43], v[148:151]
ds_read_b64_tr_b16 v[180:181], v201 offset:25600
ds_read_b64_tr_b16 v[182:183], v201 offset:26112
v_add_f32_dpp v79, v95, v79 row_ror:8 row_mask:0xf bank_mask:0xf
s_waitcnt lgkmcnt(6)
v_mfma_f32_16x16x32_bf16 v[152:155], v[168:171], v[40:43], v[152:155]
ds_read_b64_tr_b16 v[184:185], v202 offset:25600
ds_read_b64_tr_b16 v[186:187], v202 offset:26112
v_and_b32 v6, 4, v1
s_waitcnt lgkmcnt(6)
v_mfma_f32_16x16x32_bf16 v[156:159], v[172:175], v[40:43], v[156:159]
ds_read_b64_tr_b16 v[188:189], v203 offset:25600
ds_read_b64_tr_b16 v[190:191], v203 offset:26112
v_cmp_ne_u32 vcc, 0, v6
s_waitcnt lgkmcnt(6)
v_mfma_f32_16x16x32_bf16 v[144:147], v[176:179], v[44:47], v[144:147]
ds_read_b64_tr_b16 v[160:161], v200 offset:32768
ds_read_b64_tr_b16 v[162:163], v200 offset:33280
v_cndmask_b32 v88, v76, v72, vcc
s_waitcnt lgkmcnt(6)
v_mfma_f32_16x16x32_bf16 v[148:151], v[180:183], v[44:47], v[148:151]
ds_read_b64_tr_b16 v[164:165], v201 offset:32768
ds_read_b64_tr_b16 v[166:167], v201 offset:33280
v_cndmask_b32 v72, v72, v76, vcc
s_waitcnt lgkmcnt(6)
v_mfma_f32_16x16x32_bf16 v[152:155], v[184:187], v[44:47], v[152:155]
ds_read_b64_tr_b16 v[168:169], v202 offset:32768
ds_read_b64_tr_b16 v[170:171], v202 offset:33280
v_cndmask_b32 v89, v77, v73, vcc
s_waitcnt lgkmcnt(6)
v_mfma_f32_16x16x32_bf16 v[156:159], v[188:191], v[44:47], v[156:159]
ds_read_b64_tr_b16 v[172:173], v203 offset:32768
ds_read_b64_tr_b16 v[174:175], v203 offset:33280
v_cndmask_b32 v73, v73, v77, vcc
s_waitcnt lgkmcnt(6)
v_mfma_f32_16x16x32_bf16 v[144:147], v[160:163], v[48:51], v[144:147]
ds_read_b64_tr_b16 v[176:177], v200 offset:33792
ds_read_b64_tr_b16 v[178:179], v200 offset:34304
v_cndmask_b32 v90, v78, v74, vcc
s_waitcnt lgkmcnt(6)
v_mfma_f32_16x16x32_bf16 v[148:151], v[164:167], v[48:51], v[148:151]
ds_read_b64_tr_b16 v[180:181], v201 offset:33792
ds_read_b64_tr_b16 v[182:183], v201 offset:34304
v_cndmask_b32 v74, v74, v78, vcc
s_waitcnt lgkmcnt(6)
v_mfma_f32_16x16x32_bf16 v[152:155], v[168:171], v[48:51], v[152:155]
ds_read_b64_tr_b16 v[184:185], v202 offset:33792
ds_read_b64_tr_b16 v[186:187], v202 offset:34304
v_cndmask_b32 v91, v79, v75, vcc
s_waitcnt lgkmcnt(6)
v_mfma_f32_16x16x32_bf16 v[156:159], v[172:175], v[48:51], v[156:159]
ds_read_b64_tr_b16 v[188:189], v203 offset:33792
ds_read_b64_tr_b16 v[190:191], v203 offset:34304
v_cndmask_b32 v75, v75, v79, vcc
s_waitcnt lgkmcnt(6)
v_mfma_f32_16x16x32_bf16 v[144:147], v[176:179], v[52:55], v[144:147]
ds_read_b64_tr_b16 v[160:161], v200 offset:40960
ds_read_b64_tr_b16 v[162:163], v200 offset:41472
v_add_f32_dpp v72, v88, v72 row_half_mirror row_mask:0xf bank_mask:0xf
s_waitcnt lgkmcnt(6)
v_mfma_f32_16x16x32_bf16 v[148:151], v[180:183], v[52:55], v[148:151]
ds_read_b64_tr_b16 v[164:165], v201 offset:40960
ds_read_b64_tr_b16 v[166:167], v201 offset:41472
v_add_f32_dpp v73, v89, v73 row_half_mirror row_mask:0xf bank_mask:0xf
s_waitcnt lgkmcnt(6)
v_mfma_f32_16x16x32_bf16 v[152:155], v[184:187], v[52:55], v[152:155]
ds_read_b64_tr_b16 v[168:169], v202 offset:40960
ds_read_b64_tr_b16 v[170:171], v202 offset:41472
v_add_f32_dpp v74, v90, v74 row_half_mirror row_mask:0xf bank_mask:0xf
s_waitcnt lgkmcnt(6)
v_mfma_f32_16x16x32_bf16 v[156:159], v[188:191], v[52:55], v[156:159]
ds_read_b64_tr_b16 v[172:173], v203 offset:40960
ds_read_b64_tr_b16 v[174:175], v203 offset:41472
v_add_f32_dpp v75, v91, v75 row_half_mirror row_mask:0xf bank_mask:0xf
s_waitcnt lgkmcnt(6)
v_mfma_f32_16x16x32_bf16 v[144:147], v[160:163], v[56:59], v[144:147]
ds_read_b64_tr_b16 v[176:177], v200 offset:41984
ds_read_b64_tr_b16 v[178:179], v200 offset:42496
v_and_b32 v6, 2, v1
s_waitcnt lgkmcnt(6)
v_mfma_f32_16x16x32_bf16 v[148:151], v[164:167], v[56:59], v[148:151]
ds_read_b64_tr_b16 v[180:181], v201 offset:41984
ds_read_b64_tr_b16 v[182:183], v201 offset:42496
v_cmp_ne_u32 vcc, 0, v6
s_waitcnt lgkmcnt(6)
v_mfma_f32_16x16x32_bf16 v[152:155], v[168:171], v[56:59], v[152:155]
ds_read_b64_tr_b16 v[184:185], v202 offset:41984
ds_read_b64_tr_b16 v[186:187], v202 offset:42496
v_cndmask_b32 v88, v74, v72, vcc
s_waitcnt lgkmcnt(6)
v_mfma_f32_16x16x32_bf16 v[156:159], v[172:175], v[56:59], v[156:159]
ds_read_b64_tr_b16 v[188:189], v203 offset:41984
ds_read_b64_tr_b16 v[190:191], v203 offset:42496
v_cndmask_b32 v72, v72, v74, vcc
s_waitcnt lgkmcnt(6)
v_mfma_f32_16x16x32_bf16 v[144:147], v[176:179], v[60:63], v[144:147]
ds_read_b64_tr_b16 v[160:161], v200 offset:49152
ds_read_b64_tr_b16 v[162:163], v200 offset:49664
v_cndmask_b32 v89, v75, v73, vcc
s_waitcnt lgkmcnt(6)
v_mfma_f32_16x16x32_bf16 v[148:151], v[180:183], v[60:63], v[148:151]
ds_read_b64_tr_b16 v[164:165], v201 offset:49152
ds_read_b64_tr_b16 v[166:167], v201 offset:49664
v_cndmask_b32 v73, v73, v75, vcc
s_waitcnt lgkmcnt(6)
v_mfma_f32_16x16x32_bf16 v[152:155], v[184:187], v[60:63], v[152:155]
ds_read_b64_tr_b16 v[168:169], v202 offset:49152
ds_read_b64_tr_b16 v[170:171], v202 offset:49664
v_add_f32_dpp v72, v88, v72 quad_perm:[2,3,0,1] row_mask:0xf bank_mask:0xf
s_waitcnt lgkmcnt(6)
v_mfma_f32_16x16x32_bf16 v[156:159], v[188:191], v[60:63], v[156:159]
ds_read_b64_tr_b16 v[172:173], v203 offset:49152
ds_read_b64_tr_b16 v[174:175], v203 offset:49664
v_add_f32_dpp v73, v89, v73 quad_perm:[2,3,0,1] row_mask:0xf bank_mask:0xf
s_waitcnt lgkmcnt(6)
v_mfma_f32_16x16x32_bf16 v[144:147], v[160:163], v[64:67], v[144:147]
ds_read_b64_tr_b16 v[176:177], v200 offset:50176
ds_read_b64_tr_b16 v[178:179], v200 offset:50688
v_and_b32 v6, 1, v1
s_waitcnt lgkmcnt(6)
v_mfma_f32_16x16x32_bf16 v[148:151], v[164:167], v[64:67], v[148:151]
ds_read_b64_tr_b16 v[180:181], v201 offset:50176
ds_read_b64_tr_b16 v[182:183], v201 offset:50688
v_cmp_ne_u32 vcc, 0, v6
s_waitcnt lgkmcnt(6)
v_mfma_f32_16x16x32_bf16 v[152:155], v[168:171], v[64:67], v[152:155]
ds_read_b64_tr_b16 v[184:185], v202 offset:50176
ds_read_b64_tr_b16 v[186:187], v202 offset:50688
v_cndmask_b32 v88, v73, v72, vcc
s_waitcnt lgkmcnt(6)
v_mfma_f32_16x16x32_bf16 v[156:159], v[172:175], v[64:67], v[156:159]
ds_read_b64_tr_b16 v[188:189], v203 offset:50176
ds_read_b64_tr_b16 v[190:191], v203 offset:50688
v_cndmask_b32 v72, v72, v73, vcc
s_waitcnt lgkmcnt(6)
v_mfma_f32_16x16x32_bf16 v[144:147], v[176:179], v[68:71], v[144:147]
v_add_f32_dpp v72, v88, v72 quad_perm:[1,0,3,2] row_mask:0xf bank_mask:0xf
s_waitcnt lgkmcnt(4)
v_mfma_f32_16x16x32_bf16 v[148:151], v[180:183], v[68:71], v[148:151]
v_lshlrev_b32 v6, 2, v0
s_waitcnt lgkmcnt(2)
v_mfma_f32_16x16x32_bf16 v[152:155], v[184:187], v[68:71], v[152:155]
v_add_u32 v6, 114688, v6
s_waitcnt lgkmcnt(0)
v_mfma_f32_16x16x32_bf16 v[156:159], v[188:191], v[68:71], v[156:159]
ds_write_b32 v6, v72
v_mov_b32 v128, -1
v_mov_b32 v129, -1
v_mov_b32 v130, -1
v_mov_b32 v131, -1
v_lshlrev_b32 v6, 4, v0
s_lshl_b32 s14, s2, 13
s_add_u32 s14, s14, 2097152
s_add_u32 s15, s14, 4096
buffer_store_dwordx4 v[128:131], v6, s[48:51], s14 offen sc1
buffer_store_dwordx4 v[128:131], v6, s[48:51], s15 offen sc1
s_lshl_b32 s14, s2, 12
s_add_u32 s15, s14, 26931200
s_add_u32 s14, s14, 28311552
s_cmp_lt_u32 s2, 113
s_cselect_b32 s14, s14, s15
s_cmp_lt_u32 s2, 120
s_cselect_b32 s62, s50, 0
s_mov_b32 s60, s48
s_mov_b32 s61, s49
s_mov_b32 s63, s51
buffer_store_dwordx4 v[128:131], v6, s[60:63], s14 offen sc1
s_lshl_b32 s13, s5, 1
s_lshr_b32 s14, s7, 1
s_add_u32 s13, s13, s14
s_mul_i32 s13, s13, 56
s_mul_i32 s14, s9, 28
s_add_u32 s13, s13, s14
s_lshl_b32 s14, s8, 2
s_add_u32 s13, s13, s14
s_lshl_b32 s13, s13, 10
s_and_b32 s14, s7, 1
s_lshl_b32 s14, s14, 8
s_add_u32 s13, s13, s14
s_add_u32 s13, s13, 25165824
v_lshlrev_b32 v6, 4, v3
v_and_b32 v7, 1, v4
v_cmp_ne_u32 vcc, 0, v7
v_lshl_add_u32 v6, v7, 9, v6
v_lshrrev_b32 v7, 5, v1
v_lshl_add_u32 v6, v7, 10, v6
v_cvt_pk_bf16_f32 v160, v144, v145
v_cvt_pk_bf16_f32 v161, v146, v147
v_cvt_pk_bf16_f32 v162, v148, v149
v_cvt_pk_bf16_f32 v163, v150, v151
v_cndmask_b32 v164, v160, v162, vcc
v_cndmask_b32 v165, v161, v163, vcc
v_cndmask_b32 v166, v162, v160, vcc
v_cndmask_b32 v167, v163, v161, vcc
buffer_store_dwordx4 v[164:167], v6, s[48:51], s13 offen offset:0 sc1
v_cvt_pk_bf16_f32 v168, v152, v153
v_cvt_pk_bf16_f32 v169, v154, v155
v_cvt_pk_bf16_f32 v170, v156, v157
v_cvt_pk_bf16_f32 v171, v158, v159
v_cndmask_b32 v172, v168, v170, vcc
v_cndmask_b32 v173, v169, v171, vcc
v_cndmask_b32 v174, v170, v168, vcc
v_cndmask_b32 v175, v171, v169, vcc
buffer_store_dwordx4 v[172:175], v6, s[48:51], s13 offen offset:2048 sc1
s_waitcnt lgkmcnt(0)
s_barrier
v_lshlrev_b32 v7, 5, v1
v_add_u32 v7, 114688, v7
s_mov_b64 exec, 0xff
ds_read_b128 v[72:75], v7 offset:0
ds_read_b128 v[76:79], v7 offset:16
ds_read_b128 v[80:83], v7 offset:256
ds_read_b128 v[84:87], v7 offset:272
ds_read_b128 v[88:91], v7 offset:512
ds_read_b128 v[92:95], v7 offset:528
ds_read_b128 v[96:99], v7 offset:768
ds_read_b128 v[100:103], v7 offset:784
s_lshl_b32 s13, s4, 7
s_lshl_b32 s15, s5, 12
s_add_u32 s13, s13, s15
s_add_u32 s13, s13, 27328512
s_cmp_eq_u32 s7, 0
s_cselect_b32 s62, s50, 0
s_waitcnt lgkmcnt(5)
v_pk_add_f32 v[72:73], v[72:73], v[80:81] op_sel:[0,0] op_sel_hi:[1,1]
v_pk_add_f32 v[74:75], v[74:75], v[82:83] op_sel:[0,0] op_sel_hi:[1,1]
s_waitcnt lgkmcnt(4)
v_pk_add_f32 v[76:77], v[76:77], v[84:85] op_sel:[0,0] op_sel_hi:[1,1]
v_pk_add_f32 v[78:79], v[78:79], v[86:87] op_sel:[0,0] op_sel_hi:[1,1]
s_waitcnt lgkmcnt(1)
v_pk_add_f32 v[88:89], v[88:89], v[96:97] op_sel:[0,0] op_sel_hi:[1,1]
v_pk_add_f32 v[90:91], v[90:91], v[98:99] op_sel:[0,0] op_sel_hi:[1,1]
s_waitcnt lgkmcnt(0)
v_pk_add_f32 v[92:93], v[92:93], v[100:101] op_sel:[0,0] op_sel_hi:[1,1]
v_pk_add_f32 v[94:95], v[94:95], v[102:103] op_sel:[0,0] op_sel_hi:[1,1]
v_pk_add_f32 v[72:73], v[72:73], v[88:89] op_sel:[0,0] op_sel_hi:[1,1]
v_pk_add_f32 v[74:75], v[74:75], v[90:91] op_sel:[0,0] op_sel_hi:[1,1]
v_pk_add_f32 v[76:77], v[76:77], v[92:93] op_sel:[0,0] op_sel_hi:[1,1]
v_pk_add_f32 v[78:79], v[78:79], v[94:95] op_sel:[0,0] op_sel_hi:[1,1]
v_cvt_pk_bf16_f32 v72, v72, v73
v_cvt_pk_bf16_f32 v73, v74, v75
v_cvt_pk_bf16_f32 v74, v76, v77
v_cvt_pk_bf16_f32 v75, v78, v79
buffer_store_dwordx4 v[72:75], v2, s[60:63], s13 offen sc1
s_endpgm
L_k1_d4:
s_mov_b32 s52, s38
s_and_b32 s53, s39, 0xffff
s_mov_b32 s54, 0x380
s_mov_b32 s55, 0x20000
buffer_load_dwordx4 v[72:75], v2, s[52:55], 0 offen
s_add_u32 m0, s6, 0
s_nop 0
buffer_load_dwordx4 v9, s[56:59], s64 offen lds
buffer_load_dwordx4 v196, s[56:59], s64 offen offset:1024 lds
s_add_u32 m0, s6, 8192
s_nop 0
buffer_load_dwordx4 v9, s[56:59], s65 offen lds
buffer_load_dwordx4 v196, s[56:59], s65 offen offset:1024 lds
s_add_u32 m0, s6, 16384
s_nop 0
buffer_load_dwordx4 v9, s[56:59], s66 offen lds
buffer_load_dwordx4 v196, s[56:59], s66 offen offset:1024 lds
s_add_u32 m0, s6, 24576
s_nop 0
buffer_load_dwordx4 v9, s[56:59], s67 offen lds
buffer_load_dwordx4 v196, s[56:59], s67 offen offset:1024 lds
s_add_u32 m0, s6, 32768
s_nop 0
buffer_load_dwordx4 v9, s[56:59], s68 offen lds
buffer_load_dwordx4 v196, s[56:59], s68 offen offset:1024 lds
s_add_u32 m0, s6, 40960
s_nop 0
buffer_load_dwordx4 v9, s[56:59], s69 offen lds
buffer_load_dwordx4 v196, s[56:59], s69 offen offset:1024 lds
s_add_u32 m0, s6, 49152
s_nop 0
buffer_load_dwordx4 v9, s[56:59], s70 offen lds
buffer_load_dwordx4 v196, s[56:59], s70 offen offset:1024 lds
s_mov_b32 s48, s44
s_and_b32 s49, s45, 0xffff
s_mov_b32 s50, 0x2000000
s_mov_b32 s51, 0x20000
v_lshrrev_b32 v6, 2, v3
v_bfe_u32 v8, v3, 1, 1
v_lshl_or_b32 v8, v6, 1, v8
v_xor_b32 v8, v8, v4
v_lshlrev_b32 v8, 4, v8
v_lshl_add_u32 v8, v6, 11, v8
v_and_b32 v6, 3, v3
v_lshl_add_u32 v198, v6, 7, v8
v_xor_b32 v199, 64, v198
s_add_u32 s6, s6, 57344
s_sub_u32 s9, s4, 28
s_add_u32 s8, s9, s5
s_sub_u32 s13, s8, 7
s_cselect_b32 s8, s8, s13
s_lshl_b32 s12, s5, 6
s_lshr_b32 s13, s7, 1
s_lshl_b32 s13, s13, 5
s_add_u32 s12, s12, s13
s_and_b32 s13, s7, 1
s_lshl_b32 s13, s13, 2
s_add_u32 s12, s12, s13
v_and_b32 v6, 12, v3
v_add3_u32 v6, v6, v3, s12
v_mov_b32 v11, v6
v_lshrrev_b32 v192, 1, v6
v_and_b32 v194, 1, v6
v_cvt_f32_u32 v194, v194
v_mul_f32 v194, 0x3e800000, v194
v_mov_b32 v15, 0x3d88d677
v_mov_b32 v7, 0x3d41848f
v_cmp_gt_u32 vcc, 2, v6
s_nop 1
v_cndmask_b32 v15, v15, v7, vcc
v_cndmask_b32 v194, v194, 0, vcc
v_mov_b32 v7, 224
v_cmp_eq_u32 vcc, 1, v6
s_nop 1
v_cndmask_b32 v192, v192, v7, vcc
s_lshl_b32 s12, s5, 6
v_lshl_add_u32 v7, v4, 3, s12
v_mul_u32_u24 v193, v192, v7
v_cvt_f32_u32 v192, v192
v_cvt_f32_u32 v193, v193
v_mul_f32 v7, 0x3b124925, v193
v_floor_f32 v7, v7
v_fmac_f32 v193, 0xc3e00000, v7
v_mul_f32 v7, 0x3d924925, v192
v_cos_f32 v14, v7
v_mov_b32 v128, v193
v_add_f32 v129, v193, v192
v_add_f32 v6, v192, v192
v_mul_f32 v8, 0x42000000, v192
v_add_f32 v14, v14, v14
s_mov_b32 s12, 0x3b124925
v_pk_add_f32 v[130:131], v[128:129], v[6:7] op_sel:[0,0] op_sel_hi:[1,0]
v_pk_add_f32 v[132:133], v[130:131], v[6:7] op_sel:[0,0] op_sel_hi:[1,0]
v_pk_add_f32 v[134:135], v[132:133], v[6:7] op_sel:[0,0] op_sel_hi:[1,0]
v_pk_add_f32 v[136:137], v[128:129], v[8:9] op_sel:[0,0] op_sel_hi:[1,0]
v_pk_add_f32 v[138:139], v[130:131], v[8:9] op_sel:[0,0] op_sel_hi:[1,0]
v_pk_add_f32 v[140:141], v[132:133], v[8:9] op_sel:[0,0] op_sel_hi:[1,0]
v_pk_add_f32 v[142:143], v[134:135], v[8:9] op_sel:[0,0] op_sel_hi:[1,0]
v_pk_fma_f32 v[128:129], v[128:129], s[12:13], v[194:195] op_sel:[0,0,0] op_sel_hi:[1,0,0]
v_pk_fma_f32 v[130:131], v[130:131], s[12:13], v[194:195] op_sel:[0,0,0] op_sel_hi:[1,0,0]
v_pk_fma_f32 v[132:133], v[132:133], s[12:13], v[194:195] op_sel:[0,0,0] op_sel_hi:[1,0,0]
v_pk_fma_f32 v[134:135], v[134:135], s[12:13], v[194:195] op_sel:[0,0,0] op_sel_hi:[1,0,0]
v_pk_fma_f32 v[136:137], v[136:137], s[12:13], v[194:195] op_sel:[0,0,0] op_sel_hi:[1,0,0]
v_pk_fma_f32 v[138:139], v[138:139], s[12:13], v[194:195] op_sel:[0,0,0] op_sel_hi:[1,0,0]
v_pk_fma_f32 v[140:141], v[140:141], s[12:13], v[194:195] op_sel:[0,0,0] op_sel_hi:[1,0,0]
v_pk_fma_f32 v[142:143], v[142:143], s[12:13], v[194:195] op_sel:[0,0,0] op_sel_hi:[1,0,0]
v_cos_f32 v128, v128
v_cos_f32 v129, v129
v_cos_f32 v130, v130
v_cos_f32 v131, v131
v_cos_f32 v132, v132
v_cos_f32 v133, v133
v_cos_f32 v134, v134
v_cos_f32 v135, v135
v_cos_f32 v136, v136
v_cos_f32 v137, v137
v_cos_f32 v138, v138
v_cos_f32 v139, v139
v_cos_f32 v140, v140
v_cos_f32 v141, v141
v_cos_f32 v142, v142
v_cos_f32 v143, v143
v_pk_mul_f32 v[128:129], v[128:129], v[14:15] op_sel:[0,1] op_sel_hi:[1,1]
v_pk_mul_f32 v[130:131], v[130:131], v[14:15] op_sel:[0,1] op_sel_hi:[1,1]
v_pk_mul_f32 v[132:133], v[132:133], v[14:15] op_sel:[0,1] op_sel_hi:[1,1]
v_pk_mul_f32 v[134:135], v[134:135], v[14:15] op_sel:[0,1] op_sel_hi:[1,1]
v_pk_mul_f32 v[136:137], v[136:137], v[14:15] op_sel:[0,1] op_sel_hi:[1,1]
v_pk_mul_f32 v[138:139], v[138:139], v[14:15] op_sel:[0,1] op_sel_hi:[1,1]
v_pk_mul_f32 v[140:141], v[140:141], v[14:15] op_sel:[0,1] op_sel_hi:[1,1]
v_pk_mul_f32 v[142:143], v[142:143], v[14:15] op_sel:[0,1] op_sel_hi:[1,1]
v_cvt_pk_bf16_f32 v16, v128, v129
v_cvt_pk_bf16_f32 v17, v130, v131
v_cvt_pk_bf16_f32 v18, v132, v133
v_cvt_pk_bf16_f32 v19, v134, v135
v_cvt_pk_bf16_f32 v20, v136, v137
v_cvt_pk_bf16_f32 v21, v138, v139
v_cvt_pk_bf16_f32 v22, v140, v141
v_cvt_pk_bf16_f32 v23, v142, v143
v_pk_fma_f32 v[128:129], v[14:15], v[136:137], v[128:129] op_sel:[0,0,0] op_sel_hi:[0,1,1] neg_lo:[0,0,1] neg_hi:[0,0,1]
v_pk_fma_f32 v[130:131], v[14:15], v[138:139], v[130:131] op_sel:[0,0,0] op_sel_hi:[0,1,1] neg_lo:[0,0,1] neg_hi:[0,0,1]
v_pk_fma_f32 v[132:133], v[14:15], v[140:141], v[132:133] op_sel:[0,0,0] op_sel_hi:[0,1,1] neg_lo:[0,0,1] neg_hi:[0,0,1]
v_pk_fma_f32 v[134:135], v[14:15], v[142:143], v[134:135] op_sel:[0,0,0] op_sel_hi:[0,1,1] neg_lo:[0,0,1] neg_hi:[0,0,1]
v_cvt_pk_bf16_f32 v24, v128, v129
v_cvt_pk_bf16_f32 v25, v130, v131
v_cvt_pk_bf16_f32 v26, v132, v133
v_cvt_pk_bf16_f32 v27, v134, v135
v_pk_fma_f32 v[136:137], v[14:15], v[128:129], v[136:137] op_sel:[0,0,0] op_sel_hi:[0,1,1] neg_lo:[0,0,1] neg_hi:[0,0,1]
v_pk_fma_f32 v[138:139], v[14:15], v[130:131], v[138:139] op_sel:[0,0,0] op_sel_hi:[0,1,1] neg_lo:[0,0,1] neg_hi:[0,0,1]
v_pk_fma_f32 v[140:141], v[14:15], v[132:133], v[140:141] op_sel:[0,0,0] op_sel_hi:[0,1,1] neg_lo:[0,0,1] neg_hi:[0,0,1]
v_pk_fma_f32 v[142:143], v[14:15], v[134:135], v[142:143] op_sel:[0,0,0] op_sel_hi:[0,1,1] neg_lo:[0,0,1] neg_hi:[0,0,1]
v_cvt_pk_bf16_f32 v28, v136, v137
v_cvt_pk_bf16_f32 v29, v138, v139
v_cvt_pk_bf16_f32 v30, v140, v141
v_cvt_pk_bf16_f32 v31, v142, v143
v_pk_fma_f32 v[128:129], v[14:15], v[136:137], v[128:129] op_sel:[0,0,0] op_sel_hi:[0,1,1] neg_lo:[0,0,1] neg_hi:[0,0,1]
v_pk_fma_f32 v[130:131], v[14:15], v[138:139], v[130:131] op_sel:[0,0,0] op_sel_hi:[0,1,1] neg_lo:[0,0,1] neg_hi:[0,0,1]
v_pk_fma_f32 v[132:133], v[14:15], v[140:141], v[132:133] op_sel:[0,0,0] op_sel_hi:[0,1,1] neg_lo:[0,0,1] neg_hi:[0,0,1]
v_pk_fma_f32 v[134:135], v[14:15], v[142:143], v[134:135] op_sel:[0,0,0] op_sel_hi:[0,1,1] neg_lo:[0,0,1] neg_hi:[0,0,1]
v_cvt_pk_bf16_f32 v32, v128, v129
v_cvt_pk_bf16_f32 v33, v130, v131
v_cvt_pk_bf16_f32 v34, v132, v133
v_cvt_pk_bf16_f32 v35, v134, v135
v_pk_fma_f32 v[136:137], v[14:15], v[128:129], v[136:137] op_sel:[0,0,0] op_sel_hi:[0,1,1] neg_lo:[0,0,1] neg_hi:[0,0,1]
v_pk_fma_f32 v[138:139], v[14:15], v[130:131], v[138:139] op_sel:[0,0,0] op_sel_hi:[0,1,1] neg_lo:[0,0,1] neg_hi:[0,0,1]
v_pk_fma_f32 v[140:141], v[14:15], v[132:133], v[140:141] op_sel:[0,0,0] op_sel_hi:[0,1,1] neg_lo:[0,0,1] neg_hi:[0,0,1]
v_pk_fma_f32 v[142:143], v[14:15], v[134:135], v[142:143] op_sel:[0,0,0] op_sel_hi:[0,1,1] neg_lo:[0,0,1] neg_hi:[0,0,1]
v_cvt_pk_bf16_f32 v36, v136, v137
v_cvt_pk_bf16_f32 v37, v138, v139
v_cvt_pk_bf16_f32 v38, v140, v141
v_cvt_pk_bf16_f32 v39, v142, v143
v_pk_fma_f32 v[128:129], v[14:15], v[136:137], v[128:129] op_sel:[0,0,0] op_sel_hi:[0,1,1] neg_lo:[0,0,1] neg_hi:[0,0,1]
v_pk_fma_f32 v[130:131], v[14:15], v[138:139], v[130:131] op_sel:[0,0,0] op_sel_hi:[0,1,1] neg_lo:[0,0,1] neg_hi:[0,0,1]
v_pk_fma_f32 v[132:133], v[14:15], v[140:141], v[132:133] op_sel:[0,0,0] op_sel_hi:[0,1,1] neg_lo:[0,0,1] neg_hi:[0,0,1]
v_pk_fma_f32 v[134:135], v[14:15], v[142:143], v[134:135] op_sel:[0,0,0] op_sel_hi:[0,1,1] neg_lo:[0,0,1] neg_hi:[0,0,1]
v_cvt_pk_bf16_f32 v40, v128, v129
v_cvt_pk_bf16_f32 v41, v130, v131
v_cvt_pk_bf16_f32 v42, v132, v133
v_cvt_pk_bf16_f32 v43, v134, v135
v_pk_fma_f32 v[136:137], v[14:15], v[128:129], v[136:137] op_sel:[0,0,0] op_sel_hi:[0,1,1] neg_lo:[0,0,1] neg_hi:[0,0,1]
v_pk_fma_f32 v[138:139], v[14:15], v[130:131], v[138:139] op_sel:[0,0,0] op_sel_hi:[0,1,1] neg_lo:[0,0,1] neg_hi:[0,0,1]
v_pk_fma_f32 v[140:141], v[14:15], v[132:133], v[140:141] op_sel:[0,0,0] op_sel_hi:[0,1,1] neg_lo:[0,0,1] neg_hi:[0,0,1]
v_pk_fma_f32 v[142:143], v[14:15], v[134:135], v[142:143] op_sel:[0,0,0] op_sel_hi:[0,1,1] neg_lo:[0,0,1] neg_hi:[0,0,1]
v_cvt_pk_bf16_f32 v44, v136, v137
v_cvt_pk_bf16_f32 v45, v138, v139
v_cvt_pk_bf16_f32 v46, v140, v141
v_cvt_pk_bf16_f32 v47, v142, v143
v_pk_fma_f32 v[128:129], v[14:15], v[136:137], v[128:129] op_sel:[0,0,0] op_sel_hi:[0,1,1] neg_lo:[0,0,1] neg_hi:[0,0,1]
v_pk_fma_f32 v[130:131], v[14:15], v[138:139], v[130:131] op_sel:[0,0,0] op_sel_hi:[0,1,1] neg_lo:[0,0,1] neg_hi:[0,0,1]
v_pk_fma_f32 v[132:133], v[14:15], v[140:141], v[132:133] op_sel:[0,0,0] op_sel_hi:[0,1,1] neg_lo:[0,0,1] neg_hi:[0,0,1]
v_pk_fma_f32 v[134:135], v[14:15], v[142:143], v[134:135] op_sel:[0,0,0] op_sel_hi:[0,1,1] neg_lo:[0,0,1] neg_hi:[0,0,1]
v_cvt_pk_bf16_f32 v48, v128, v129
v_cvt_pk_bf16_f32 v49, v130, v131
v_cvt_pk_bf16_f32 v50, v132, v133
v_cvt_pk_bf16_f32 v51, v134, v135
v_pk_fma_f32 v[136:137], v[14:15], v[128:129], v[136:137] op_sel:[0,0,0] op_sel_hi:[0,1,1] neg_lo:[0,0,1] neg_hi:[0,0,1]
v_pk_fma_f32 v[138:139], v[14:15], v[130:131], v[138:139] op_sel:[0,0,0] op_sel_hi:[0,1,1] neg_lo:[0,0,1] neg_hi:[0,0,1]
v_pk_fma_f32 v[140:141], v[14:15], v[132:133], v[140:141] op_sel:[0,0,0] op_sel_hi:[0,1,1] neg_lo:[0,0,1] neg_hi:[0,0,1]
v_pk_fma_f32 v[142:143], v[14:15], v[134:135], v[142:143] op_sel:[0,0,0] op_sel_hi:[0,1,1] neg_lo:[0,0,1] neg_hi:[0,0,1]
v_cvt_pk_bf16_f32 v52, v136, v137
v_cvt_pk_bf16_f32 v53, v138, v139
v_cvt_pk_bf16_f32 v54, v140, v141
v_cvt_pk_bf16_f32 v55, v142, v143
v_pk_fma_f32 v[128:129], v[14:15], v[136:137], v[128:129] op_sel:[0,0,0] op_sel_hi:[0,1,1] neg_lo:[0,0,1] neg_hi:[0,0,1]
v_pk_fma_f32 v[130:131], v[14:15], v[138:139], v[130:131] op_sel:[0,0,0] op_sel_hi:[0,1,1] neg_lo:[0,0,1] neg_hi:[0,0,1]
v_pk_fma_f32 v[132:133], v[14:15], v[140:141], v[132:133] op_sel:[0,0,0] op_sel_hi:[0,1,1] neg_lo:[0,0,1] neg_hi:[0,0,1]
v_pk_fma_f32 v[134:135], v[14:15], v[142:143], v[134:135] op_sel:[0,0,0] op_sel_hi:[0,1,1] neg_lo:[0,0,1] neg_hi:[0,0,1]
v_cvt_pk_bf16_f32 v56, v128, v129
v_cvt_pk_bf16_f32 v57, v130, v131
v_cvt_pk_bf16_f32 v58, v132, v133
v_cvt_pk_bf16_f32 v59, v134, v135
v_pk_fma_f32 v[136:137], v[14:15], v[128:129], v[136:137] op_sel:[0,0,0] op_sel_hi:[0,1,1] neg_lo:[0,0,1] neg_hi:[0,0,1]
v_pk_fma_f32 v[138:139], v[14:15], v[130:131], v[138:139] op_sel:[0,0,0] op_sel_hi:[0,1,1] neg_lo:[0,0,1] neg_hi:[0,0,1]
v_pk_fma_f32 v[140:141], v[14:15], v[132:133], v[140:141] op_sel:[0,0,0] op_sel_hi:[0,1,1] neg_lo:[0,0,1] neg_hi:[0,0,1]
v_pk_fma_f32 v[142:143], v[14:15], v[134:135], v[142:143] op_sel:[0,0,0] op_sel_hi:[0,1,1] neg_lo:[0,0,1] neg_hi:[0,0,1]
v_cvt_pk_bf16_f32 v60, v136, v137
v_cvt_pk_bf16_f32 v61, v138, v139
v_cvt_pk_bf16_f32 v62, v140, v141
v_cvt_pk_bf16_f32 v63, v142, v143
v_pk_fma_f32 v[128:129], v[14:15], v[136:137], v[128:129] op_sel:[0,0,0] op_sel_hi:[0,1,1] neg_lo:[0,0,1] neg_hi:[0,0,1]
v_pk_fma_f32 v[130:131], v[14:15], v[138:139], v[130:131] op_sel:[0,0,0] op_sel_hi:[0,1,1] neg_lo:[0,0,1] neg_hi:[0,0,1]
v_pk_fma_f32 v[132:133], v[14:15], v[140:141], v[132:133] op_sel:[0,0,0] op_sel_hi:[0,1,1] neg_lo:[0,0,1] neg_hi:[0,0,1]
v_pk_fma_f32 v[134:135], v[14:15], v[142:143], v[134:135] op_sel:[0,0,0] op_sel_hi:[0,1,1] neg_lo:[0,0,1] neg_hi:[0,0,1]
v_cvt_pk_bf16_f32 v64, v128, v129
v_cvt_pk_bf16_f32 v65, v130, v131
v_cvt_pk_bf16_f32 v66, v132, v133
v_cvt_pk_bf16_f32 v67, v134, v135
v_pk_fma_f32 v[136:137], v[14:15], v[128:129], v[136:137] op_sel:[0,0,0] op_sel_hi:[0,1,1] neg_lo:[0,0,1] neg_hi:[0,0,1]
v_pk_fma_f32 v[138:139], v[14:15], v[130:131], v[138:139] op_sel:[0,0,0] op_sel_hi:[0,1,1] neg_lo:[0,0,1] neg_hi:[0,0,1]
v_pk_fma_f32 v[140:141], v[14:15], v[132:133], v[140:141] op_sel:[0,0,0] op_sel_hi:[0,1,1] neg_lo:[0,0,1] neg_hi:[0,0,1]
v_pk_fma_f32 v[142:143], v[14:15], v[134:135], v[142:143] op_sel:[0,0,0] op_sel_hi:[0,1,1] neg_lo:[0,0,1] neg_hi:[0,0,1]
v_cvt_pk_bf16_f32 v68, v136, v137
v_cvt_pk_bf16_f32 v69, v138, v139
v_cvt_pk_bf16_f32 v70, v140, v141
v_cvt_pk_bf16_f32 v71, v142, v143
s_lshl_b32 s12, s7, 11
s_add_u32 s12, s12, 120832
v_lshl_add_u32 v6, v1, 5, s12
v_lshl_add_u32 v10, v4, 5, s12
s_waitcnt vmcnt(14)
v_lshlrev_b32 v76, 16, v72
v_and_b32 v77, 0xffff0000, v72
v_lshlrev_b32 v78, 16, v73
v_and_b32 v79, 0xffff0000, v73
v_lshlrev_b32 v80, 16, v74
v_and_b32 v81, 0xffff0000, v74
v_lshlrev_b32 v82, 16, v75
v_and_b32 v83, 0xffff0000, v75
ds_write_b128 v6, v[76:79]
ds_write_b128 v6, v[80:83] offset:16
s_lshl_b32 s13, s64, 1
v_add_u32 v232, s13, v10
s_lshl_b32 s13, s65, 1
v_add_u32 v233, s13, v10
s_lshl_b32 s13, s66, 1
v_add_u32 v234, s13, v10
s_lshl_b32 s13, s67, 1
v_add_u32 v235, s13, v10
s_lshl_b32 s13, s68, 1
v_add_u32 v236, s13, v10
s_lshl_b32 s13, s69, 1
v_add_u32 v237, s13, v10
s_lshl_b32 s13, s70, 1
v_add_u32 v238, s13, v10
s_lshl_b32 s12, s8, 2
s_add_u32 s12, s12, s7
s_lshl_b32 s12, s12, 4
v_add_u32 v6, s12, v3
v_lshrrev_b32 v192, 1, v6
v_and_b32 v194, 1, v6
v_cvt_f32_u32 v194, v194
v_mul_f32 v194, 0x3e800000, v194
v_mov_b32 v15, 0x3d88d677
v_mov_b32 v7, 0x3d41848f
v_cmp_gt_u32 vcc, 2, v6
s_nop 1
v_cndmask_b32 v15, v15, v7, vcc
v_cndmask_b32 v194, v194, 0, vcc
v_mov_b32 v7, 224
v_cmp_eq_u32 vcc, 1, v6
s_nop 1
v_cndmask_b32 v192, v192, v7, vcc
s_lshl_b32 s12, s5, 6
v_lshl_add_u32 v7, v4, 3, s12
v_mul_u32_u24 v193, v192, v7
v_cvt_f32_u32 v192, v192
v_cvt_f32_u32 v193, v193
v_mul_f32 v7, 0x3b124925, v193
v_floor_f32 v7, v7
v_fmac_f32 v193, 0xc3e00000, v7
v_mul_f32 v7, 0x3d924925, v192
v_cos_f32 v14, v7
v_mov_b32 v128, v193
v_add_f32 v129, v193, v192
v_add_f32 v6, v192, v192
v_mul_f32 v8, 0x42000000, v192
v_add_f32 v14, v14, v14
s_mov_b32 s12, 0x3b124925
ds_read_b128 v[240:243], v232 offset:0
ds_read_b128 v[244:247], v232 offset:16
ds_read_b128 v[248:251], v232 offset:128
ds_read_b128 v[252:255], v232 offset:144
v_pk_add_f32 v[130:131], v[128:129], v[6:7] op_sel:[0,0] op_sel_hi:[1,0]
v_pk_add_f32 v[132:133], v[130:131], v[6:7] op_sel:[0,0] op_sel_hi:[1,0]
v_pk_add_f32 v[134:135], v[132:133], v[6:7] op_sel:[0,0] op_sel_hi:[1,0]
v_pk_add_f32 v[136:137], v[128:129], v[8:9] op_sel:[0,0] op_sel_hi:[1,0]
v_pk_add_f32 v[138:139], v[130:131], v[8:9] op_sel:[0,0] op_sel_hi:[1,0]
v_pk_add_f32 v[140:141], v[132:133], v[8:9] op_sel:[0,0] op_sel_hi:[1,0]
v_pk_add_f32 v[142:143], v[134:135], v[8:9] op_sel:[0,0] op_sel_hi:[1,0]
v_pk_fma_f32 v[128:129], v[128:129], s[12:13], v[194:195] op_sel:[0,0,0] op_sel_hi:[1,0,0]
v_pk_fma_f32 v[130:131], v[130:131], s[12:13], v[194:195] op_sel:[0,0,0] op_sel_hi:[1,0,0]
v_pk_fma_f32 v[132:133], v[132:133], s[12:13], v[194:195] op_sel:[0,0,0] op_sel_hi:[1,0,0]
v_pk_fma_f32 v[134:135], v[134:135], s[12:13], v[194:195] op_sel:[0,0,0] op_sel_hi:[1,0,0]
v_pk_fma_f32 v[136:137], v[136:137], s[12:13], v[194:195] op_sel:[0,0,0] op_sel_hi:[1,0,0]
v_pk_fma_f32 v[138:139], v[138:139], s[12:13], v[194:195] op_sel:[0,0,0] op_sel_hi:[1,0,0]
v_pk_fma_f32 v[140:141], v[140:141], s[12:13], v[194:195] op_sel:[0,0,0] op_sel_hi:[1,0,0]
v_pk_fma_f32 v[142:143], v[142:143], s[12:13], v[194:195] op_sel:[0,0,0] op_sel_hi:[1,0,0]
v_cos_f32 v128, v128
v_cos_f32 v129, v129
v_cos_f32 v130, v130
v_cos_f32 v131, v131
v_cos_f32 v132, v132
v_cos_f32 v133, v133
v_cos_f32 v134, v134
v_cos_f32 v135, v135
v_cos_f32 v136, v136
v_cos_f32 v137, v137
v_cos_f32 v138, v138
v_cos_f32 v139, v139
v_cos_f32 v140, v140
v_cos_f32 v141, v141
v_cos_f32 v142, v142
v_cos_f32 v143, v143
v_pk_mul_f32 v[128:129], v[128:129], v[14:15] op_sel:[0,1] op_sel_hi:[1,1]
v_pk_mul_f32 v[130:131], v[130:131], v[14:15] op_sel:[0,1] op_sel_hi:[1,1]
v_pk_mul_f32 v[132:133], v[132:133], v[14:15] op_sel:[0,1] op_sel_hi:[1,1]
v_pk_mul_f32 v[134:135], v[134:135], v[14:15] op_sel:[0,1] op_sel_hi:[1,1]
v_pk_mul_f32 v[136:137], v[136:137], v[14:15] op_sel:[0,1] op_sel_hi:[1,1]
v_pk_mul_f32 v[138:139], v[138:139], v[14:15] op_sel:[0,1] op_sel_hi:[1,1]
v_pk_mul_f32 v[140:141], v[140:141], v[14:15] op_sel:[0,1] op_sel_hi:[1,1]
v_pk_mul_f32 v[142:143], v[142:143], v[14:15] op_sel:[0,1] op_sel_hi:[1,1]
s_mul_i32 s12, s7, 14336
s_add_u32 s12, s12, 57344
v_add_u32 v7, s12, v2
s_waitcnt lgkmcnt(3)
v_pk_mul_f32 v[240:241], v[240:241], v[128:129] op_sel:[0,0] op_sel_hi:[1,1]
v_pk_mul_f32 v[242:243], v[242:243], v[130:131] op_sel:[0,0] op_sel_hi:[1,1]
s_waitcnt lgkmcnt(2)
v_pk_mul_f32 v[244:245], v[244:245], v[132:133] op_sel:[0,0] op_sel_hi:[1,1]
v_pk_mul_f32 v[246:247], v[246:247], v[134:135] op_sel:[0,0] op_sel_hi:[1,1]
v_cvt_pk_bf16_f32 v72, v240, v241
v_cvt_pk_bf16_f32 v73, v242, v243
v_cvt_pk_bf16_f32 v74, v244, v245
v_cvt_pk_bf16_f32 v75, v246, v247
ds_read_b128 v[240:243], v233 offset:0
ds_read_b128 v[244:247], v233 offset:16
ds_write_b128 v7, v[72:75] offset:0
s_waitcnt lgkmcnt(4)
v_pk_mul_f32 v[248:249], v[248:249], v[136:137] op_sel:[0,0] op_sel_hi:[1,1]
v_pk_mul_f32 v[250:251], v[250:251], v[138:139] op_sel:[0,0] op_sel_hi:[1,1]
s_waitcnt lgkmcnt(3)
v_pk_mul_f32 v[252:253], v[252:253], v[140:141] op_sel:[0,0] op_sel_hi:[1,1]
v_pk_mul_f32 v[254:255], v[254:255], v[142:143] op_sel:[0,0] op_sel_hi:[1,1]
v_cvt_pk_bf16_f32 v76, v248, v249
v_cvt_pk_bf16_f32 v77, v250, v251
v_cvt_pk_bf16_f32 v78, v252, v253
v_cvt_pk_bf16_f32 v79, v254, v255
ds_read_b128 v[248:251], v233 offset:128
ds_read_b128 v[252:255], v233 offset:144
ds_write_b128 v7, v[76:79] offset:1024
v_pk_fma_f32 v[128:129], v[14:15], v[136:137], v[128:129] op_sel:[0,0,0] op_sel_hi:[0,1,1] neg_lo:[0,0,1] neg_hi:[0,0,1]
v_pk_fma_f32 v[130:131], v[14:15], v[138:139], v[130:131] op_sel:[0,0,0] op_sel_hi:[0,1,1] neg_lo:[0,0,1] neg_hi:[0,0,1]
v_pk_fma_f32 v[132:133], v[14:15], v[140:141], v[132:133] op_sel:[0,0,0] op_sel_hi:[0,1,1] neg_lo:[0,0,1] neg_hi:[0,0,1]
v_pk_fma_f32 v[134:135], v[14:15], v[142:143], v[134:135] op_sel:[0,0,0] op_sel_hi:[0,1,1] neg_lo:[0,0,1] neg_hi:[0,0,1]
s_waitcnt lgkmcnt(5)
v_pk_mul_f32 v[240:241], v[240:241], v[128:129] op_sel:[0,0] op_sel_hi:[1,1]
v_pk_mul_f32 v[242:243], v[242:243], v[130:131] op_sel:[0,0] op_sel_hi:[1,1]
s_waitcnt lgkmcnt(4)
v_pk_mul_f32 v[244:245], v[244:245], v[132:133] op_sel:[0,0] op_sel_hi:[1,1]
v_pk_mul_f32 v[246:247], v[246:247], v[134:135] op_sel:[0,0] op_sel_hi:[1,1]
v_cvt_pk_bf16_f32 v80, v240, v241
v_cvt_pk_bf16_f32 v81, v242, v243
v_cvt_pk_bf16_f32 v82, v244, v245
v_cvt_pk_bf16_f32 v83, v246, v247
ds_read_b128 v[240:243], v234 offset:0
ds_read_b128 v[244:247], v234 offset:16
ds_write_b128 v7, v[80:83] offset:2048
v_pk_fma_f32 v[136:137], v[14:15], v[128:129], v[136:137] op_sel:[0,0,0] op_sel_hi:[0,1,1] neg_lo:[0,0,1] neg_hi:[0,0,1]
v_pk_fma_f32 v[138:139], v[14:15], v[130:131], v[138:139] op_sel:[0,0,0] op_sel_hi:[0,1,1] neg_lo:[0,0,1] neg_hi:[0,0,1]
v_pk_fma_f32 v[140:141], v[14:15], v[132:133], v[140:141] op_sel:[0,0,0] op_sel_hi:[0,1,1] neg_lo:[0,0,1] neg_hi:[0,0,1]
v_pk_fma_f32 v[142:143], v[14:15], v[134:135], v[142:143] op_sel:[0,0,0] op_sel_hi:[0,1,1] neg_lo:[0,0,1] neg_hi:[0,0,1]
s_waitcnt lgkmcnt(5)
v_pk_mul_f32 v[248:249], v[248:249], v[136:137] op_sel:[0,0] op_sel_hi:[1,1]
v_pk_mul_f32 v[250:251], v[250:251], v[138:139] op_sel:[0,0] op_sel_hi:[1,1]
s_waitcnt lgkmcnt(4)
v_pk_mul_f32 v[252:253], v[252:253], v[140:141] op_sel:[0,0] op_sel_hi:[1,1]
v_pk_mul_f32 v[254:255], v[254:255], v[142:143] op_sel:[0,0] op_sel_hi:[1,1]
v_cvt_pk_bf16_f32 v84, v248, v249
v_cvt_pk_bf16_f32 v85, v250, v251
v_cvt_pk_bf16_f32 v86, v252, v253
v_cvt_pk_bf16_f32 v87, v254, v255
ds_read_b128 v[248:251], v234 offset:128
ds_read_b128 v[252:255], v234 offset:144
ds_write_b128 v7, v[84:87] offset:3072
v_pk_fma_f32 v[128:129], v[14:15], v[136:137], v[128:129] op_sel:[0,0,0] op_sel_hi:[0,1,1] neg_lo:[0,0,1] neg_hi:[0,0,1]
v_pk_fma_f32 v[130:131], v[14:15], v[138:139], v[130:131] op_sel:[0,0,0] op_sel_hi:[0,1,1] neg_lo:[0,0,1] neg_hi:[0,0,1]
v_pk_fma_f32 v[132:133], v[14:15], v[140:141], v[132:133] op_sel:[0,0,0] op_sel_hi:[0,1,1] neg_lo:[0,0,1] neg_hi:[0,0,1]
v_pk_fma_f32 v[134:135], v[14:15], v[142:143], v[134:135] op_sel:[0,0,0] op_sel_hi:[0,1,1] neg_lo:[0,0,1] neg_hi:[0,0,1]
s_waitcnt lgkmcnt(5)
v_pk_mul_f32 v[240:241], v[240:241], v[128:129] op_sel:[0,0] op_sel_hi:[1,1]
v_pk_mul_f32 v[242:243], v[242:243], v[130:131] op_sel:[0,0] op_sel_hi:[1,1]
s_waitcnt lgkmcnt(4)
v_pk_mul_f32 v[244:245], v[244:245], v[132:133] op_sel:[0,0] op_sel_hi:[1,1]
v_pk_mul_f32 v[246:247], v[246:247], v[134:135] op_sel:[0,0] op_sel_hi:[1,1]
v_cvt_pk_bf16_f32 v88, v240, v241
v_cvt_pk_bf16_f32 v89, v242, v243
v_cvt_pk_bf16_f32 v90, v244, v245
v_cvt_pk_bf16_f32 v91, v246, v247
ds_read_b128 v[240:243], v235 offset:0
ds_read_b128 v[244:247], v235 offset:16
ds_write_b128 v7, v[88:91] offset:4096
v_pk_fma_f32 v[136:137], v[14:15], v[128:129], v[136:137] op_sel:[0,0,0] op_sel_hi:[0,1,1] neg_lo:[0,0,1] neg_hi:[0,0,1]
v_pk_fma_f32 v[138:139], v[14:15], v[130:131], v[138:139] op_sel:[0,0,0] op_sel_hi:[0,1,1] neg_lo:[0,0,1] neg_hi:[0,0,1]
v_pk_fma_f32 v[140:141], v[14:15], v[132:133], v[140:141] op_sel:[0,0,0] op_sel_hi:[0,1,1] neg_lo:[0,0,1] neg_hi:[0,0,1]
v_pk_fma_f32 v[142:143], v[14:15], v[134:135], v[142:143] op_sel:[0,0,0] op_sel_hi:[0,1,1] neg_lo:[0,0,1] neg_hi:[0,0,1]
s_waitcnt lgkmcnt(5)
v_pk_mul_f32 v[248:249], v[248:249], v[136:137] op_sel:[0,0] op_sel_hi:[1,1]
v_pk_mul_f32 v[250:251], v[250:251], v[138:139] op_sel:[0,0] op_sel_hi:[1,1]
s_waitcnt lgkmcnt(4)
v_pk_mul_f32 v[252:253], v[252:253], v[140:141] op_sel:[0,0] op_sel_hi:[1,1]
v_pk_mul_f32 v[254:255], v[254:255], v[142:143] op_sel:[0,0] op_sel_hi:[1,1]
v_cvt_pk_bf16_f32 v92, v248, v249
v_cvt_pk_bf16_f32 v93, v250, v251
v_cvt_pk_bf16_f32 v94, v252, v253
v_cvt_pk_bf16_f32 v95, v254, v255
ds_read_b128 v[248:251], v235 offset:128
ds_read_b128 v[252:255], v235 offset:144
ds_write_b128 v7, v[92:95] offset:5120
v_pk_fma_f32 v[128:129], v[14:15], v[136:137], v[128:129] op_sel:[0,0,0] op_sel_hi:[0,1,1] neg_lo:[0,0,1] neg_hi:[0,0,1]
v_pk_fma_f32 v[130:131], v[14:15], v[138:139], v[130:131] op_sel:[0,0,0] op_sel_hi:[0,1,1] neg_lo:[0,0,1] neg_hi:[0,0,1]
v_pk_fma_f32 v[132:133], v[14:15], v[140:141], v[132:133] op_sel:[0,0,0] op_sel_hi:[0,1,1] neg_lo:[0,0,1] neg_hi:[0,0,1]
v_pk_fma_f32 v[134:135], v[14:15], v[142:143], v[134:135] op_sel:[0,0,0] op_sel_hi:[0,1,1] neg_lo:[0,0,1] neg_hi:[0,0,1]
s_waitcnt lgkmcnt(5)
v_pk_mul_f32 v[240:241], v[240:241], v[128:129] op_sel:[0,0] op_sel_hi:[1,1]
v_pk_mul_f32 v[242:243], v[242:243], v[130:131] op_sel:[0,0] op_sel_hi:[1,1]
s_waitcnt lgkmcnt(4)
v_pk_mul_f32 v[244:245], v[244:245], v[132:133] op_sel:[0,0] op_sel_hi:[1,1]
v_pk_mul_f32 v[246:247], v[246:247], v[134:135] op_sel:[0,0] op_sel_hi:[1,1]
v_cvt_pk_bf16_f32 v96, v240, v241
v_cvt_pk_bf16_f32 v97, v242, v243
v_cvt_pk_bf16_f32 v98, v244, v245
v_cvt_pk_bf16_f32 v99, v246, v247
ds_read_b128 v[240:243], v236 offset:0
ds_read_b128 v[244:247], v236 offset:16
ds_write_b128 v7, v[96:99] offset:6144
v_pk_fma_f32 v[136:137], v[14:15], v[128:129], v[136:137] op_sel:[0,0,0] op_sel_hi:[0,1,1] neg_lo:[0,0,1] neg_hi:[0,0,1]
v_pk_fma_f32 v[138:139], v[14:15], v[130:131], v[138:139] op_sel:[0,0,0] op_sel_hi:[0,1,1] neg_lo:[0,0,1] neg_hi:[0,0,1]
v_pk_fma_f32 v[140:141], v[14:15], v[132:133], v[140:141] op_sel:[0,0,0] op_sel_hi:[0,1,1] neg_lo:[0,0,1] neg_hi:[0,0,1]
v_pk_fma_f32 v[142:143], v[14:15], v[134:135], v[142:143] op_sel:[0,0,0] op_sel_hi:[0,1,1] neg_lo:[0,0,1] neg_hi:[0,0,1]
s_waitcnt lgkmcnt(5)
v_pk_mul_f32 v[248:249], v[248:249], v[136:137] op_sel:[0,0] op_sel_hi:[1,1]
v_pk_mul_f32 v[250:251], v[250:251], v[138:139] op_sel:[0,0] op_sel_hi:[1,1]
s_waitcnt lgkmcnt(4)
v_pk_mul_f32 v[252:253], v[252:253], v[140:141] op_sel:[0,0] op_sel_hi:[1,1]
v_pk_mul_f32 v[254:255], v[254:255], v[142:143] op_sel:[0,0] op_sel_hi:[1,1]
v_cvt_pk_bf16_f32 v100, v248, v249
v_cvt_pk_bf16_f32 v101, v250, v251
v_cvt_pk_bf16_f32 v102, v252, v253
v_cvt_pk_bf16_f32 v103, v254, v255
ds_read_b128 v[248:251], v236 offset:128
ds_read_b128 v[252:255], v236 offset:144
ds_write_b128 v7, v[100:103] offset:7168
v_pk_fma_f32 v[128:129], v[14:15], v[136:137], v[128:129] op_sel:[0,0,0] op_sel_hi:[0,1,1] neg_lo:[0,0,1] neg_hi:[0,0,1]
v_pk_fma_f32 v[130:131], v[14:15], v[138:139], v[130:131] op_sel:[0,0,0] op_sel_hi:[0,1,1] neg_lo:[0,0,1] neg_hi:[0,0,1]
v_pk_fma_f32 v[132:133], v[14:15], v[140:141], v[132:133] op_sel:[0,0,0] op_sel_hi:[0,1,1] neg_lo:[0,0,1] neg_hi:[0,0,1]
v_pk_fma_f32 v[134:135], v[14:15], v[142:143], v[134:135] op_sel:[0,0,0] op_sel_hi:[0,1,1] neg_lo:[0,0,1] neg_hi:[0,0,1]
s_waitcnt lgkmcnt(5)
v_pk_mul_f32 v[240:241], v[240:241], v[128:129] op_sel:[0,0] op_sel_hi:[1,1]
v_pk_mul_f32 v[242:243], v[242:243], v[130:131] op_sel:[0,0] op_sel_hi:[1,1]
s_waitcnt lgkmcnt(4)
v_pk_mul_f32 v[244:245], v[244:245], v[132:133] op_sel:[0,0] op_sel_hi:[1,1]
v_pk_mul_f32 v[246:247], v[246:247], v[134:135] op_sel:[0,0] op_sel_hi:[1,1]
v_cvt_pk_bf16_f32 v104, v240, v241
v_cvt_pk_bf16_f32 v105, v242, v243
v_cvt_pk_bf16_f32 v106, v244, v245
v_cvt_pk_bf16_f32 v107, v246, v247
ds_read_b128 v[240:243], v237 offset:0
ds_read_b128 v[244:247], v237 offset:16
ds_write_b128 v7, v[104:107] offset:8192
v_pk_fma_f32 v[136:137], v[14:15], v[128:129], v[136:137] op_sel:[0,0,0] op_sel_hi:[0,1,1] neg_lo:[0,0,1] neg_hi:[0,0,1]
v_pk_fma_f32 v[138:139], v[14:15], v[130:131], v[138:139] op_sel:[0,0,0] op_sel_hi:[0,1,1] neg_lo:[0,0,1] neg_hi:[0,0,1]
v_pk_fma_f32 v[140:141], v[14:15], v[132:133], v[140:141] op_sel:[0,0,0] op_sel_hi:[0,1,1] neg_lo:[0,0,1] neg_hi:[0,0,1]
v_pk_fma_f32 v[142:143], v[14:15], v[134:135], v[142:143] op_sel:[0,0,0] op_sel_hi:[0,1,1] neg_lo:[0,0,1] neg_hi:[0,0,1]
s_waitcnt lgkmcnt(5)
v_pk_mul_f32 v[248:249], v[248:249], v[136:137] op_sel:[0,0] op_sel_hi:[1,1]
v_pk_mul_f32 v[250:251], v[250:251], v[138:139] op_sel:[0,0] op_sel_hi:[1,1]
s_waitcnt lgkmcnt(4)
v_pk_mul_f32 v[252:253], v[252:253], v[140:141] op_sel:[0,0] op_sel_hi:[1,1]
v_pk_mul_f32 v[254:255], v[254:255], v[142:143] op_sel:[0,0] op_sel_hi:[1,1]
v_cvt_pk_bf16_f32 v108, v248, v249
v_cvt_pk_bf16_f32 v109, v250, v251
v_cvt_pk_bf16_f32 v110, v252, v253
v_cvt_pk_bf16_f32 v111, v254, v255
ds_read_b128 v[248:251], v237 offset:128
ds_read_b128 v[252:255], v237 offset:144
ds_write_b128 v7, v[108:111] offset:9216
v_pk_fma_f32 v[128:129], v[14:15], v[136:137], v[128:129] op_sel:[0,0,0] op_sel_hi:[0,1,1] neg_lo:[0,0,1] neg_hi:[0,0,1]
v_pk_fma_f32 v[130:131], v[14:15], v[138:139], v[130:131] op_sel:[0,0,0] op_sel_hi:[0,1,1] neg_lo:[0,0,1] neg_hi:[0,0,1]
v_pk_fma_f32 v[132:133], v[14:15], v[140:141], v[132:133] op_sel:[0,0,0] op_sel_hi:[0,1,1] neg_lo:[0,0,1] neg_hi:[0,0,1]
v_pk_fma_f32 v[134:135], v[14:15], v[142:143], v[134:135] op_sel:[0,0,0] op_sel_hi:[0,1,1] neg_lo:[0,0,1] neg_hi:[0,0,1]
s_waitcnt lgkmcnt(5)
v_pk_mul_f32 v[240:241], v[240:241], v[128:129] op_sel:[0,0] op_sel_hi:[1,1]
v_pk_mul_f32 v[242:243], v[242:243], v[130:131] op_sel:[0,0] op_sel_hi:[1,1]
s_waitcnt lgkmcnt(4)
v_pk_mul_f32 v[244:245], v[244:245], v[132:133] op_sel:[0,0] op_sel_hi:[1,1]
v_pk_mul_f32 v[246:247], v[246:247], v[134:135] op_sel:[0,0] op_sel_hi:[1,1]
v_cvt_pk_bf16_f32 v112, v240, v241
v_cvt_pk_bf16_f32 v113, v242, v243
v_cvt_pk_bf16_f32 v114, v244, v245
v_cvt_pk_bf16_f32 v115, v246, v247
ds_read_b128 v[240:243], v238 offset:0
ds_read_b128 v[244:247], v238 offset:16
ds_write_b128 v7, v[112:115] offset:10240
v_pk_fma_f32 v[136:137], v[14:15], v[128:129], v[136:137] op_sel:[0,0,0] op_sel_hi:[0,1,1] neg_lo:[0,0,1] neg_hi:[0,0,1]
v_pk_fma_f32 v[138:139], v[14:15], v[130:131], v[138:139] op_sel:[0,0,0] op_sel_hi:[0,1,1] neg_lo:[0,0,1] neg_hi:[0,0,1]
v_pk_fma_f32 v[140:141], v[14:15], v[132:133], v[140:141] op_sel:[0,0,0] op_sel_hi:[0,1,1] neg_lo:[0,0,1] neg_hi:[0,0,1]
v_pk_fma_f32 v[142:143], v[14:15], v[134:135], v[142:143] op_sel:[0,0,0] op_sel_hi:[0,1,1] neg_lo:[0,0,1] neg_hi:[0,0,1]
s_waitcnt lgkmcnt(5)
v_pk_mul_f32 v[248:249], v[248:249], v[136:137] op_sel:[0,0] op_sel_hi:[1,1]
v_pk_mul_f32 v[250:251], v[250:251], v[138:139] op_sel:[0,0] op_sel_hi:[1,1]
s_waitcnt lgkmcnt(4)
v_pk_mul_f32 v[252:253], v[252:253], v[140:141] op_sel:[0,0] op_sel_hi:[1,1]
v_pk_mul_f32 v[254:255], v[254:255], v[142:143] op_sel:[0,0] op_sel_hi:[1,1]
v_cvt_pk_bf16_f32 v116, v248, v249
v_cvt_pk_bf16_f32 v117, v250, v251
v_cvt_pk_bf16_f32 v118, v252, v253
v_cvt_pk_bf16_f32 v119, v254, v255
ds_read_b128 v[248:251], v238 offset:128
ds_read_b128 v[252:255], v238 offset:144
ds_write_b128 v7, v[116:119] offset:11264
v_pk_fma_f32 v[128:129], v[14:15], v[136:137], v[128:129] op_sel:[0,0,0] op_sel_hi:[0,1,1] neg_lo:[0,0,1] neg_hi:[0,0,1]
v_pk_fma_f32 v[130:131], v[14:15], v[138:139], v[130:131] op_sel:[0,0,0] op_sel_hi:[0,1,1] neg_lo:[0,0,1] neg_hi:[0,0,1]
v_pk_fma_f32 v[132:133], v[14:15], v[140:141], v[132:133] op_sel:[0,0,0] op_sel_hi:[0,1,1] neg_lo:[0,0,1] neg_hi:[0,0,1]
v_pk_fma_f32 v[134:135], v[14:15], v[142:143], v[134:135] op_sel:[0,0,0] op_sel_hi:[0,1,1] neg_lo:[0,0,1] neg_hi:[0,0,1]
s_waitcnt lgkmcnt(5)
v_pk_mul_f32 v[240:241], v[240:241], v[128:129] op_sel:[0,0] op_sel_hi:[1,1]
v_pk_mul_f32 v[242:243], v[242:243], v[130:131] op_sel:[0,0] op_sel_hi:[1,1]
s_waitcnt lgkmcnt(4)
v_pk_mul_f32 v[244:245], v[244:245], v[132:133] op_sel:[0,0] op_sel_hi:[1,1]
v_pk_mul_f32 v[246:247], v[246:247], v[134:135] op_sel:[0,0] op_sel_hi:[1,1]
v_cvt_pk_bf16_f32 v120, v240, v241
v_cvt_pk_bf16_f32 v121, v242, v243
v_cvt_pk_bf16_f32 v122, v244, v245
v_cvt_pk_bf16_f32 v123, v246, v247
ds_write_b128 v7, v[120:123] offset:12288
v_pk_fma_f32 v[136:137], v[14:15], v[128:129], v[136:137] op_sel:[0,0,0] op_sel_hi:[0,1,1] neg_lo:[0,0,1] neg_hi:[0,0,1]
v_pk_fma_f32 v[138:139], v[14:15], v[130:131], v[138:139] op_sel:[0,0,0] op_sel_hi:[0,1,1] neg_lo:[0,0,1] neg_hi:[0,0,1]
v_pk_fma_f32 v[140:141], v[14:15], v[132:133], v[140:141] op_sel:[0,0,0] op_sel_hi:[0,1,1] neg_lo:[0,0,1] neg_hi:[0,0,1]
v_pk_fma_f32 v[142:143], v[14:15], v[134:135], v[142:143] op_sel:[0,0,0] op_sel_hi:[0,1,1] neg_lo:[0,0,1] neg_hi:[0,0,1]
s_waitcnt lgkmcnt(3)
v_pk_mul_f32 v[248:249], v[248:249], v[136:137] op_sel:[0,0] op_sel_hi:[1,1]
v_pk_mul_f32 v[250:251], v[250:251], v[138:139] op_sel:[0,0] op_sel_hi:[1,1]
s_waitcnt lgkmcnt(2)
v_pk_mul_f32 v[252:253], v[252:253], v[140:141] op_sel:[0,0] op_sel_hi:[1,1]
v_pk_mul_f32 v[254:255], v[254:255], v[142:143] op_sel:[0,0] op_sel_hi:[1,1]
v_cvt_pk_bf16_f32 v124, v248, v249
v_cvt_pk_bf16_f32 v125, v250, v251
v_cvt_pk_bf16_f32 v126, v252, v253
v_cvt_pk_bf16_f32 v127, v254, v255
ds_write_b128 v7, v[124:127] offset:13312
s_waitcnt vmcnt(0)
s_barrier
ds_read_b128 v[160:163], v198 offset:0
ds_read_b128 v[164:167], v198 offset:512
ds_read_b128 v[168:171], v198 offset:1024
ds_read_b128 v[172:175], v198 offset:1536
s_waitcnt lgkmcnt(3)
v_mfma_f32_16x16x32_bf16 v[144:147], v[160:163], v[16:19], 0
ds_read_b128 v[176:179], v199 offset:0
s_waitcnt lgkmcnt(3)
v_mfma_f32_16x16x32_bf16 v[148:151], v[164:167], v[16:19], 0
ds_read_b128 v[180:183], v199 offset:512
s_waitcnt lgkmcnt(3)
v_mfma_f32_16x16x32_bf16 v[152:155], v[168:171], v[16:19], 0
ds_read_b128 v[184:187], v199 offset:1024
s_waitcnt lgkmcnt(3)
v_mfma_f32_16x16x32_bf16 v[156:159], v[172:175], v[16:19], 0
ds_read_b128 v[188:191], v199 offset:1536
s_waitcnt lgkmcnt(3)
v_mfma_f32_16x16x32_bf16 v[144:147], v[176:179], v[20:23], v[144:147]
ds_read_b128 v[160:163], v198 offset:8192
s_waitcnt lgkmcnt(3)
v_mfma_f32_16x16x32_bf16 v[148:151], v[180:183], v[20:23], v[148:151]
ds_read_b128 v[164:167], v198 offset:8704
s_waitcnt lgkmcnt(3)
v_mfma_f32_16x16x32_bf16 v[152:155], v[184:187], v[20:23], v[152:155]
ds_read_b128 v[168:171], v198 offset:9216
s_waitcnt lgkmcnt(3)
v_mfma_f32_16x16x32_bf16 v[156:159], v[188:191], v[20:23], v[156:159]
ds_read_b128 v[172:175], v198 offset:9728
s_waitcnt lgkmcnt(3)
v_mfma_f32_16x16x32_bf16 v[144:147], v[160:163], v[24:27], v[144:147]
ds_read_b128 v[176:179], v199 offset:8192
s_waitcnt lgkmcnt(3)
v_mfma_f32_16x16x32_bf16 v[148:151], v[164:167], v[24:27], v[148:151]
ds_read_b128 v[180:183], v199 offset:8704
s_waitcnt lgkmcnt(3)
v_mfma_f32_16x16x32_bf16 v[152:155], v[168:171], v[24:27], v[152:155]
ds_read_b128 v[184:187], v199 offset:9216
s_waitcnt lgkmcnt(3)
v_mfma_f32_16x16x32_bf16 v[156:159], v[172:175], v[24:27], v[156:159]
ds_read_b128 v[188:191], v199 offset:9728
s_waitcnt lgkmcnt(3)
v_mfma_f32_16x16x32_bf16 v[144:147], v[176:179], v[28:31], v[144:147]
ds_read_b128 v[160:163], v198 offset:16384
s_waitcnt lgkmcnt(3)
v_mfma_f32_16x16x32_bf16 v[148:151], v[180:183], v[28:31], v[148:151]
ds_read_b128 v[164:167], v198 offset:16896
s_waitcnt lgkmcnt(3)
v_mfma_f32_16x16x32_bf16 v[152:155], v[184:187], v[28:31], v[152:155]
ds_read_b128 v[168:171], v198 offset:17408
s_waitcnt lgkmcnt(3)
v_mfma_f32_16x16x32_bf16 v[156:159], v[188:191], v[28:31], v[156:159]
ds_read_b128 v[172:175], v198 offset:17920
s_waitcnt lgkmcnt(3)
v_mfma_f32_16x16x32_bf16 v[144:147], v[160:163], v[32:35], v[144:147]
ds_read_b128 v[176:179], v199 offset:16384
s_waitcnt lgkmcnt(3)
v_mfma_f32_16x16x32_bf16 v[148:151], v[164:167], v[32:35], v[148:151]
ds_read_b128 v[180:183], v199 offset:16896
s_waitcnt lgkmcnt(3)
v_mfma_f32_16x16x32_bf16 v[152:155], v[168:171], v[32:35], v[152:155]
ds_read_b128 v[184:187], v199 offset:17408
s_waitcnt lgkmcnt(3)
v_mfma_f32_16x16x32_bf16 v[156:159], v[172:175], v[32:35], v[156:159]
ds_read_b128 v[188:191], v199 offset:17920
s_waitcnt lgkmcnt(3)
v_mfma_f32_16x16x32_bf16 v[144:147], v[176:179], v[36:39], v[144:147]
ds_read_b128 v[160:163], v198 offset:24576
s_waitcnt lgkmcnt(3)
v_mfma_f32_16x16x32_bf16 v[148:151], v[180:183], v[36:39], v[148:151]
ds_read_b128 v[164:167], v198 offset:25088
s_waitcnt lgkmcnt(3)
v_mfma_f32_16x16x32_bf16 v[152:155], v[184:187], v[36:39], v[152:155]
ds_read_b128 v[168:171], v198 offset:25600
s_waitcnt lgkmcnt(3)
v_mfma_f32_16x16x32_bf16 v[156:159], v[188:191], v[36:39], v[156:159]
ds_read_b128 v[172:175], v198 offset:26112
s_waitcnt lgkmcnt(3)
v_mfma_f32_16x16x32_bf16 v[144:147], v[160:163], v[40:43], v[144:147]
ds_read_b128 v[176:179], v199 offset:24576
s_waitcnt lgkmcnt(3)
v_mfma_f32_16x16x32_bf16 v[148:151], v[164:167], v[40:43], v[148:151]
ds_read_b128 v[180:183], v199 offset:25088
s_waitcnt lgkmcnt(3)
v_mfma_f32_16x16x32_bf16 v[152:155], v[168:171], v[40:43], v[152:155]
ds_read_b128 v[184:187], v199 offset:25600
s_waitcnt lgkmcnt(3)
v_mfma_f32_16x16x32_bf16 v[156:159], v[172:175], v[40:43], v[156:159]
ds_read_b128 v[188:191], v199 offset:26112
s_waitcnt lgkmcnt(3)
v_mfma_f32_16x16x32_bf16 v[144:147], v[176:179], v[44:47], v[144:147]
ds_read_b128 v[160:163], v198 offset:32768
s_waitcnt lgkmcnt(3)
v_mfma_f32_16x16x32_bf16 v[148:151], v[180:183], v[44:47], v[148:151]
ds_read_b128 v[164:167], v198 offset:33280
s_waitcnt lgkmcnt(3)
v_mfma_f32_16x16x32_bf16 v[152:155], v[184:187], v[44:47], v[152:155]
ds_read_b128 v[168:171], v198 offset:33792
s_waitcnt lgkmcnt(3)
v_mfma_f32_16x16x32_bf16 v[156:159], v[188:191], v[44:47], v[156:159]
ds_read_b128 v[172:175], v198 offset:34304
s_waitcnt lgkmcnt(3)
v_mfma_f32_16x16x32_bf16 v[144:147], v[160:163], v[48:51], v[144:147]
ds_read_b128 v[176:179], v199 offset:32768
s_waitcnt lgkmcnt(3)
v_mfma_f32_16x16x32_bf16 v[148:151], v[164:167], v[48:51], v[148:151]
ds_read_b128 v[180:183], v199 offset:33280
s_waitcnt lgkmcnt(3)
v_mfma_f32_16x16x32_bf16 v[152:155], v[168:171], v[48:51], v[152:155]
ds_read_b128 v[184:187], v199 offset:33792
s_waitcnt lgkmcnt(3)
v_mfma_f32_16x16x32_bf16 v[156:159], v[172:175], v[48:51], v[156:159]
ds_read_b128 v[188:191], v199 offset:34304
s_waitcnt lgkmcnt(3)
v_mfma_f32_16x16x32_bf16 v[144:147], v[176:179], v[52:55], v[144:147]
ds_read_b128 v[160:163], v198 offset:40960
s_waitcnt lgkmcnt(3)
v_mfma_f32_16x16x32_bf16 v[148:151], v[180:183], v[52:55], v[148:151]
ds_read_b128 v[164:167], v198 offset:41472
s_waitcnt lgkmcnt(3)
v_mfma_f32_16x16x32_bf16 v[152:155], v[184:187], v[52:55], v[152:155]
ds_read_b128 v[168:171], v198 offset:41984
s_waitcnt lgkmcnt(3)
v_mfma_f32_16x16x32_bf16 v[156:159], v[188:191], v[52:55], v[156:159]
ds_read_b128 v[172:175], v198 offset:42496
s_waitcnt lgkmcnt(3)
v_mfma_f32_16x16x32_bf16 v[144:147], v[160:163], v[56:59], v[144:147]
ds_read_b128 v[176:179], v199 offset:40960
s_waitcnt lgkmcnt(3)
v_mfma_f32_16x16x32_bf16 v[148:151], v[164:167], v[56:59], v[148:151]
ds_read_b128 v[180:183], v199 offset:41472
s_waitcnt lgkmcnt(3)
v_mfma_f32_16x16x32_bf16 v[152:155], v[168:171], v[56:59], v[152:155]
ds_read_b128 v[184:187], v199 offset:41984
s_waitcnt lgkmcnt(3)
v_mfma_f32_16x16x32_bf16 v[156:159], v[172:175], v[56:59], v[156:159]
ds_read_b128 v[188:191], v199 offset:42496
s_waitcnt lgkmcnt(3)
v_mfma_f32_16x16x32_bf16 v[144:147], v[176:179], v[60:63], v[144:147]
ds_read_b128 v[160:163], v198 offset:49152
s_waitcnt lgkmcnt(3)
v_mfma_f32_16x16x32_bf16 v[148:151], v[180:183], v[60:63], v[148:151]
ds_read_b128 v[164:167], v198 offset:49664
s_waitcnt lgkmcnt(3)
v_mfma_f32_16x16x32_bf16 v[152:155], v[184:187], v[60:63], v[152:155]
ds_read_b128 v[168:171], v198 offset:50176
s_waitcnt lgkmcnt(3)
v_mfma_f32_16x16x32_bf16 v[156:159], v[188:191], v[60:63], v[156:159]
ds_read_b128 v[172:175], v198 offset:50688
s_waitcnt lgkmcnt(3)
v_mfma_f32_16x16x32_bf16 v[144:147], v[160:163], v[64:67], v[144:147]
ds_read_b128 v[176:179], v199 offset:49152
s_waitcnt lgkmcnt(3)
v_mfma_f32_16x16x32_bf16 v[148:151], v[164:167], v[64:67], v[148:151]
ds_read_b128 v[180:183], v199 offset:49664
s_waitcnt lgkmcnt(3)
v_mfma_f32_16x16x32_bf16 v[152:155], v[168:171], v[64:67], v[152:155]
ds_read_b128 v[184:187], v199 offset:50176
s_waitcnt lgkmcnt(3)
v_mfma_f32_16x16x32_bf16 v[156:159], v[172:175], v[64:67], v[156:159]
ds_read_b128 v[188:191], v199 offset:50688
s_waitcnt lgkmcnt(3)
v_mfma_f32_16x16x32_bf16 v[144:147], v[176:179], v[68:71], v[144:147]
s_waitcnt lgkmcnt(2)
v_mfma_f32_16x16x32_bf16 v[148:151], v[180:183], v[68:71], v[148:151]
s_waitcnt lgkmcnt(1)
v_mfma_f32_16x16x32_bf16 v[152:155], v[184:187], v[68:71], v[152:155]
s_waitcnt lgkmcnt(0)
v_mfma_f32_16x16x32_bf16 v[156:159], v[188:191], v[68:71], v[156:159]
v_and_b32 v6, -17, v11
v_lshlrev_b32 v6, 12, v6
v_bfe_u32 v7, v1, 3, 1
v_lshl_or_b32 v7, v4, 1, v7
v_lshl_add_u32 v6, v7, 4, v6
s_lshl_b32 s13, s4, 7
s_add_u32 s12, s13, 0
s_add_u32 s14, s12, 65536
v_cmp_ne_u32 vcc, 0, v11
s_nop 1
v_cndmask_b32 v8, 0, 1.0, vcc
v_cvt_pk_bf16_f32 v160, v144, v145
v_cvt_pk_bf16_f32 v161, v146, v147
v_cvt_pk_bf16_f32 v162, v148, v149
v_cvt_pk_bf16_f32 v163, v150, v151
v_cvt_pk_bf16_f32 v164, v152, v153
v_cvt_pk_bf16_f32 v165, v154, v155
v_cvt_pk_bf16_f32 v166, v156, v157
v_cvt_pk_bf16_f32 v167, v158, v159
v_mov_b32 v168, v160
v_mov_b32 v169, v161
v_mov_b32 v170, v162
v_mov_b32 v171, v163
v_mov_b32_dpp v160, v164 row_ror:8 row_mask:0xf bank_mask:0xc
v_mov_b32_dpp v161, v165 row_ror:8 row_mask:0xf bank_mask:0xc
v_mov_b32_dpp v162, v166 row_ror:8 row_mask:0xf bank_mask:0xc
v_mov_b32_dpp v163, v167 row_ror:8 row_mask:0xf bank_mask:0xc
v_mov_b32_dpp v164, v168 row_ror:8 row_mask:0xf bank_mask:0x3
v_mov_b32_dpp v165, v169 row_ror:8 row_mask:0xf bank_mask:0x3
v_mov_b32_dpp v166, v170 row_ror:8 row_mask:0xf bank_mask:0x3
v_mov_b32_dpp v167, v171 row_ror:8 row_mask:0xf bank_mask:0x3
buffer_store_dwordx4 v[160:163], v6, s[48:51], s12 offen sc1
buffer_store_dwordx4 v[164:167], v6, s[48:51], s14 offen sc1
v_pk_mul_f32 v[72:73], v[144:145], v[8:9] op_sel:[0,0] op_sel_hi:[1,0]
v_pk_mul_f32 v[74:75], v[146:147], v[8:9] op_sel:[0,0] op_sel_hi:[1,0]
v_pk_mul_f32 v[76:77], v[148:149], v[8:9] op_sel:[0,0] op_sel_hi:[1,0]
v_pk_mul_f32 v[78:79], v[150:151], v[8:9] op_sel:[0,0] op_sel_hi:[1,0]
v_pk_mul_f32 v[80:81], v[152:153], v[8:9] op_sel:[0,0] op_sel_hi:[1,0]
v_pk_mul_f32 v[82:83], v[154:155], v[8:9] op_sel:[0,0] op_sel_hi:[1,0]
v_pk_mul_f32 v[84:85], v[156:157], v[8:9] op_sel:[0,0] op_sel_hi:[1,0]
v_pk_mul_f32 v[86:87], v[158:159], v[8:9] op_sel:[0,0] op_sel_hi:[1,0]
v_pk_mul_f32 v[72:73], v[72:73], v[144:145] op_sel:[0,0] op_sel_hi:[1,1]
v_pk_mul_f32 v[74:75], v[74:75], v[146:147] op_sel:[0,0] op_sel_hi:[1,1]
v_pk_mul_f32 v[76:77], v[76:77], v[148:149] op_sel:[0,0] op_sel_hi:[1,1]
v_pk_mul_f32 v[78:79], v[78:79], v[150:151] op_sel:[0,0] op_sel_hi:[1,1]
v_pk_mul_f32 v[80:81], v[80:81], v[152:153] op_sel:[0,0] op_sel_hi:[1,1]
v_pk_mul_f32 v[82:83], v[82:83], v[154:155] op_sel:[0,0] op_sel_hi:[1,1]
v_pk_mul_f32 v[84:85], v[84:85], v[156:157] op_sel:[0,0] op_sel_hi:[1,1]
v_pk_mul_f32 v[86:87], v[86:87], v[158:159] op_sel:[0,0] op_sel_hi:[1,1]
s_waitcnt lgkmcnt(0)
s_barrier
v_mov_b32 v13, 1.0
v_cmp_gt_u32 vcc, 16, v1
s_add_u32 s12, s5, s7
s_cmp_eq_u32 s12, 0
s_cselect_b64 vcc, vcc, 0
v_cndmask_b32 v13, v13, 0, vcc
v_add_u32 v5, 57344, v2
ds_read_b128 v[160:163], v5 offset:0
ds_read_b128 v[164:167], v5 offset:14336
ds_read_b128 v[168:171], v5 offset:28672
ds_read_b128 v[172:175], v5 offset:43008
s_waitcnt lgkmcnt(3)
v_mfma_f32_16x16x32_bf16 v[144:147], v[16:19], v[160:163], 0
ds_read_b128 v[176:179], v5 offset:1024
v_and_b32 v6, 8, v1
v_cmp_ne_u32 vcc, 0, v6
s_waitcnt lgkmcnt(3)
v_mfma_f32_16x16x32_bf16 v[148:151], v[16:19], v[164:167], 0
ds_read_b128 v[180:183], v5 offset:15360
v_cndmask_b32 v88, v80, v72, vcc
v_cndmask_b32 v72, v72, v80, vcc
s_waitcnt lgkmcnt(3)
v_mfma_f32_16x16x32_bf16 v[152:155], v[16:19], v[168:171], 0
ds_read_b128 v[184:187], v5 offset:29696
v_cndmask_b32 v89, v81, v73, vcc
v_cndmask_b32 v73, v73, v81, vcc
s_waitcnt lgkmcnt(3)
v_mfma_f32_16x16x32_bf16 v[156:159], v[16:19], v[172:175], 0
ds_read_b128 v[188:191], v5 offset:44032
v_cndmask_b32 v90, v82, v74, vcc
v_cndmask_b32 v74, v74, v82, vcc
s_waitcnt lgkmcnt(3)
v_mfma_f32_16x16x32_bf16 v[144:147], v[20:23], v[176:179], v[144:147]
ds_read_b128 v[160:163], v5 offset:2048
v_cndmask_b32 v91, v83, v75, vcc
v_cndmask_b32 v75, v75, v83, vcc
s_waitcnt lgkmcnt(3)
v_mfma_f32_16x16x32_bf16 v[148:151], v[20:23], v[180:183], v[148:151]
ds_read_b128 v[164:167], v5 offset:16384
v_cndmask_b32 v92, v84, v76, vcc
v_cndmask_b32 v76, v76, v84, vcc
s_waitcnt lgkmcnt(3)
v_mfma_f32_16x16x32_bf16 v[152:155], v[20:23], v[184:187], v[152:155]
ds_read_b128 v[168:171], v5 offset:30720
v_cndmask_b32 v93, v85, v77, vcc
v_cndmask_b32 v77, v77, v85, vcc
s_waitcnt lgkmcnt(3)
v_mfma_f32_16x16x32_bf16 v[156:159], v[20:23], v[188:191], v[156:159]
ds_read_b128 v[172:175], v5 offset:45056
v_cndmask_b32 v94, v86, v78, vcc
v_cndmask_b32 v78, v78, v86, vcc
s_waitcnt lgkmcnt(3)
v_mfma_f32_16x16x32_bf16 v[144:147], v[24:27], v[160:163], v[144:147]
ds_read_b128 v[176:179], v5 offset:3072
v_cndmask_b32 v95, v87, v79, vcc
v_cndmask_b32 v79, v79, v87, vcc
s_waitcnt lgkmcnt(3)
v_mfma_f32_16x16x32_bf16 v[148:151], v[24:27], v[164:167], v[148:151]
ds_read_b128 v[180:183], v5 offset:17408
v_add_f32_dpp v72, v88, v72 row_ror:8 row_mask:0xf bank_mask:0xf
v_add_f32_dpp v73, v89, v73 row_ror:8 row_mask:0xf bank_mask:0xf
s_waitcnt lgkmcnt(3)
v_mfma_f32_16x16x32_bf16 v[152:155], v[24:27], v[168:171], v[152:155]
ds_read_b128 v[184:187], v5 offset:31744
v_add_f32_dpp v74, v90, v74 row_ror:8 row_mask:0xf bank_mask:0xf
v_add_f32_dpp v75, v91, v75 row_ror:8 row_mask:0xf bank_mask:0xf
s_waitcnt lgkmcnt(3)
v_mfma_f32_16x16x32_bf16 v[156:159], v[24:27], v[172:175], v[156:159]
ds_read_b128 v[188:191], v5 offset:46080
v_add_f32_dpp v76, v92, v76 row_ror:8 row_mask:0xf bank_mask:0xf
v_add_f32_dpp v77, v93, v77 row_ror:8 row_mask:0xf bank_mask:0xf
s_waitcnt lgkmcnt(3)
v_mfma_f32_16x16x32_bf16 v[144:147], v[28:31], v[176:179], v[144:147]
ds_read_b128 v[160:163], v5 offset:4096
v_add_f32_dpp v78, v94, v78 row_ror:8 row_mask:0xf bank_mask:0xf
v_add_f32_dpp v79, v95, v79 row_ror:8 row_mask:0xf bank_mask:0xf
s_waitcnt lgkmcnt(3)
v_mfma_f32_16x16x32_bf16 v[148:151], v[28:31], v[180:183], v[148:151]
ds_read_b128 v[164:167], v5 offset:18432
v_and_b32 v6, 4, v1
v_cmp_ne_u32 vcc, 0, v6
s_waitcnt lgkmcnt(3)
v_mfma_f32_16x16x32_bf16 v[152:155], v[28:31], v[184:187], v[152:155]
ds_read_b128 v[168:171], v5 offset:32768
v_cndmask_b32 v88, v76, v72, vcc
v_cndmask_b32 v72, v72, v76, vcc
s_waitcnt lgkmcnt(3)
v_mfma_f32_16x16x32_bf16 v[156:159], v[28:31], v[188:191], v[156:159]
ds_read_b128 v[172:175], v5 offset:47104
v_cndmask_b32 v89, v77, v73, vcc
v_cndmask_b32 v73, v73, v77, vcc
s_waitcnt lgkmcnt(3)
v_mfma_f32_16x16x32_bf16 v[144:147], v[32:35], v[160:163], v[144:147]
ds_read_b128 v[176:179], v5 offset:5120
v_cndmask_b32 v90, v78, v74, vcc
v_cndmask_b32 v74, v74, v78, vcc
s_waitcnt lgkmcnt(3)
v_mfma_f32_16x16x32_bf16 v[148:151], v[32:35], v[164:167], v[148:151]
ds_read_b128 v[180:183], v5 offset:19456
v_cndmask_b32 v91, v79, v75, vcc
v_cndmask_b32 v75, v75, v79, vcc
s_waitcnt lgkmcnt(3)
v_mfma_f32_16x16x32_bf16 v[152:155], v[32:35], v[168:171], v[152:155]
ds_read_b128 v[184:187], v5 offset:33792
v_add_f32_dpp v72, v88, v72 row_half_mirror row_mask:0xf bank_mask:0xf
v_add_f32_dpp v73, v89, v73 row_half_mirror row_mask:0xf bank_mask:0xf
s_waitcnt lgkmcnt(3)
v_mfma_f32_16x16x32_bf16 v[156:159], v[32:35], v[172:175], v[156:159]
ds_read_b128 v[188:191], v5 offset:48128
v_add_f32_dpp v74, v90, v74 row_half_mirror row_mask:0xf bank_mask:0xf
v_add_f32_dpp v75, v91, v75 row_half_mirror row_mask:0xf bank_mask:0xf
s_waitcnt lgkmcnt(3)
v_mfma_f32_16x16x32_bf16 v[144:147], v[36:39], v[176:179], v[144:147]
ds_read_b128 v[160:163], v5 offset:6144
v_and_b32 v6, 2, v1
v_cmp_ne_u32 vcc, 0, v6
s_waitcnt lgkmcnt(3)
v_mfma_f32_16x16x32_bf16 v[148:151], v[36:39], v[180:183], v[148:151]
ds_read_b128 v[164:167], v5 offset:20480
v_cndmask_b32 v88, v74, v72, vcc
v_cndmask_b32 v72, v72, v74, vcc
s_waitcnt lgkmcnt(3)
v_mfma_f32_16x16x32_bf16 v[152:155], v[36:39], v[184:187], v[152:155]
ds_read_b128 v[168:171], v5 offset:34816
v_cndmask_b32 v89, v75, v73, vcc
v_cndmask_b32 v73, v73, v75, vcc
s_waitcnt lgkmcnt(3)
v_mfma_f32_16x16x32_bf16 v[156:159], v[36:39], v[188:191], v[156:159]
ds_read_b128 v[172:175], v5 offset:49152
v_add_f32_dpp v72, v88, v72 quad_perm:[2,3,0,1] row_mask:0xf bank_mask:0xf
v_add_f32_dpp v73, v89, v73 quad_perm:[2,3,0,1] row_mask:0xf bank_mask:0xf
s_waitcnt lgkmcnt(3)
v_mfma_f32_16x16x32_bf16 v[144:147], v[40:43], v[160:163], v[144:147]
ds_read_b128 v[176:179], v5 offset:7168
v_and_b32 v6, 1, v1
v_cmp_ne_u32 vcc, 0, v6
s_waitcnt lgkmcnt(3)
v_mfma_f32_16x16x32_bf16 v[148:151], v[40:43], v[164:167], v[148:151]
ds_read_b128 v[180:183], v5 offset:21504
v_cndmask_b32 v88, v73, v72, vcc
v_cndmask_b32 v72, v72, v73, vcc
s_waitcnt lgkmcnt(3)
v_mfma_f32_16x16x32_bf16 v[152:155], v[40:43], v[168:171], v[152:155]
ds_read_b128 v[184:187], v5 offset:35840
v_add_f32_dpp v72, v88, v72 quad_perm:[1,0,3,2] row_mask:0xf bank_mask:0xf
v_lshlrev_b32 v6, 2, v0
s_waitcnt lgkmcnt(3)
v_mfma_f32_16x16x32_bf16 v[156:159], v[40:43], v[172:175], v[156:159]
ds_read_b128 v[188:191], v5 offset:50176
v_add_u32 v6, 114688, v6
ds_write_b32 v6, v72
s_waitcnt lgkmcnt(4)
v_mfma_f32_16x16x32_bf16 v[144:147], v[44:47], v[176:179], v[144:147]
ds_read_b128 v[160:163], v5 offset:8192
v_mov_b32 v128, -1
v_mov_b32 v129, -1
s_waitcnt lgkmcnt(4)
v_mfma_f32_16x16x32_bf16 v[148:151], v[44:47], v[180:183], v[148:151]
ds_read_b128 v[164:167], v5 offset:22528
v_mov_b32 v130, -1
v_mov_b32 v131, -1
s_waitcnt lgkmcnt(4)
v_mfma_f32_16x16x32_bf16 v[152:155], v[44:47], v[184:187], v[152:155]
ds_read_b128 v[168:171], v5 offset:36864
v_lshlrev_b32 v6, 4, v0
s_lshl_b32 s14, s2, 13
s_waitcnt lgkmcnt(4)
v_mfma_f32_16x16x32_bf16 v[156:159], v[44:47], v[188:191], v[156:159]
ds_read_b128 v[172:175], v5 offset:51200
s_add_u32 s14, s14, 2097152
s_add_u32 s15, s14, 4096
s_waitcnt lgkmcnt(3)
v_mfma_f32_16x16x32_bf16 v[144:147], v[48:51], v[160:163], v[144:147]
ds_read_b128 v[176:179], v5 offset:9216
buffer_store_dwordx4 v[128:131], v6, s[48:51], s14 offen sc1
buffer_store_dwordx4 v[128:131], v6, s[48:51], s15 offen sc1
s_waitcnt lgkmcnt(3)
v_mfma_f32_16x16x32_bf16 v[148:151], v[48:51], v[164:167], v[148:151]
ds_read_b128 v[180:183], v5 offset:23552
s_lshl_b32 s14, s2, 12
s_add_u32 s15, s14, 26931200
s_waitcnt lgkmcnt(3)
v_mfma_f32_16x16x32_bf16 v[152:155], v[48:51], v[168:171], v[152:155]
ds_read_b128 v[184:187], v5 offset:37888
s_add_u32 s14, s14, 28311552
s_cmp_lt_u32 s2, 113
s_waitcnt lgkmcnt(3)
v_mfma_f32_16x16x32_bf16 v[156:159], v[48:51], v[172:175], v[156:159]
ds_read_b128 v[188:191], v5 offset:52224
s_cselect_b32 s14, s14, s15
s_cmp_lt_u32 s2, 120
s_waitcnt lgkmcnt(3)
v_mfma_f32_16x16x32_bf16 v[144:147], v[52:55], v[176:179], v[144:147]
ds_read_b128 v[160:163], v5 offset:10240
s_cselect_b32 s62, s50, 0
s_mov_b32 s60, s48
s_waitcnt lgkmcnt(3)
v_mfma_f32_16x16x32_bf16 v[148:151], v[52:55], v[180:183], v[148:151]
ds_read_b128 v[164:167], v5 offset:24576
s_mov_b32 s61, s49
s_mov_b32 s63, s51
s_waitcnt lgkmcnt(3)
v_mfma_f32_16x16x32_bf16 v[152:155], v[52:55], v[184:187], v[152:155]
ds_read_b128 v[168:171], v5 offset:38912
buffer_store_dwordx4 v[128:131], v6, s[60:63], s14 offen sc1
s_waitcnt lgkmcnt(3)
v_mfma_f32_16x16x32_bf16 v[156:159], v[52:55], v[188:191], v[156:159]
ds_read_b128 v[172:175], v5 offset:53248
s_waitcnt lgkmcnt(3)
v_mfma_f32_16x16x32_bf16 v[144:147], v[56:59], v[160:163], v[144:147]
ds_read_b128 v[176:179], v5 offset:11264
s_waitcnt lgkmcnt(3)
v_mfma_f32_16x16x32_bf16 v[148:151], v[56:59], v[164:167], v[148:151]
ds_read_b128 v[180:183], v5 offset:25600
s_waitcnt lgkmcnt(3)
v_mfma_f32_16x16x32_bf16 v[152:155], v[56:59], v[168:171], v[152:155]
ds_read_b128 v[184:187], v5 offset:39936
s_waitcnt lgkmcnt(3)
v_mfma_f32_16x16x32_bf16 v[156:159], v[56:59], v[172:175], v[156:159]
ds_read_b128 v[188:191], v5 offset:54272
s_waitcnt lgkmcnt(3)
v_mfma_f32_16x16x32_bf16 v[144:147], v[60:63], v[176:179], v[144:147]
ds_read_b128 v[160:163], v5 offset:12288
s_waitcnt lgkmcnt(3)
v_mfma_f32_16x16x32_bf16 v[148:151], v[60:63], v[180:183], v[148:151]
ds_read_b128 v[164:167], v5 offset:26624
s_waitcnt lgkmcnt(3)
v_mfma_f32_16x16x32_bf16 v[152:155], v[60:63], v[184:187], v[152:155]
ds_read_b128 v[168:171], v5 offset:40960
s_waitcnt lgkmcnt(3)
v_mfma_f32_16x16x32_bf16 v[156:159], v[60:63], v[188:191], v[156:159]
ds_read_b128 v[172:175], v5 offset:55296
s_waitcnt lgkmcnt(3)
v_mfma_f32_16x16x32_bf16 v[144:147], v[64:67], v[160:163], v[144:147]
ds_read_b128 v[176:179], v5 offset:13312
s_waitcnt lgkmcnt(3)
v_mfma_f32_16x16x32_bf16 v[148:151], v[64:67], v[164:167], v[148:151]
ds_read_b128 v[180:183], v5 offset:27648
s_waitcnt lgkmcnt(3)
v_mfma_f32_16x16x32_bf16 v[152:155], v[64:67], v[168:171], v[152:155]
ds_read_b128 v[184:187], v5 offset:41984
s_waitcnt lgkmcnt(3)
v_mfma_f32_16x16x32_bf16 v[156:159], v[64:67], v[172:175], v[156:159]
ds_read_b128 v[188:191], v5 offset:56320
s_waitcnt lgkmcnt(3)
v_mfma_f32_16x16x32_bf16 v[144:147], v[68:71], v[176:179], v[144:147]
s_waitcnt lgkmcnt(2)
v_mfma_f32_16x16x32_bf16 v[148:151], v[68:71], v[180:183], v[148:151]
s_waitcnt lgkmcnt(1)
v_mfma_f32_16x16x32_bf16 v[152:155], v[68:71], v[184:187], v[152:155]
s_waitcnt lgkmcnt(0)
v_mfma_f32_16x16x32_bf16 v[156:159], v[68:71], v[188:191], v[156:159]
s_lshl_b32 s13, s8, 1
s_and_b32 s14, s7, 1
s_add_u32 s13, s13, s14
s_mul_i32 s13, s13, 28
s_lshl_b32 s14, s5, 1
s_add_u32 s13, s13, s14
s_lshr_b32 s14, s7, 1
s_add_u32 s13, s13, s14
s_lshl_b32 s13, s13, 10
s_add_u32 s13, s13, 24117248
v_mul_f32 v144, v144, v13
v_cvt_pk_bf16_f32 v160, v144, v145
v_cvt_pk_bf16_f32 v161, v146, v147
v_mul_f32 v148, v148, v13
v_cvt_pk_bf16_f32 v162, v148, v149
v_cvt_pk_bf16_f32 v163, v150, v151
v_mul_f32 v152, v152, v13
v_cvt_pk_bf16_f32 v164, v152, v153
v_cvt_pk_bf16_f32 v165, v154, v155
v_mul_f32 v156, v156, v13
v_cvt_pk_bf16_f32 v166, v156, v157
v_cvt_pk_bf16_f32 v167, v158, v159
s_lshl_b32 s12, s7, 10
s_add_u32 s12, s12, 116736
v_add_u32 v6, s12, v2
v_xor_b32 v7, 1024, v6
s_add_u32 s14, s13, 14336
s_bitcmp1_b32 s7, 0
s_cbranch_scc1 L_k1_po7
ds_write_b128 v6, v[164:167]
v_mov_b32 v168, v160
v_mov_b32 v169, v161
v_mov_b32 v172, v162
v_mov_b32 v173, v163
s_waitcnt lgkmcnt(0)
s_barrier
ds_read_b64 v[170:171], v7
ds_read_b64 v[174:175], v7 offset:8
s_branch L_k1_po8
L_k1_po7:
ds_write_b128 v6, v[160:163]
v_mov_b32 v170, v164
v_mov_b32 v171, v165
v_mov_b32 v174, v166
v_mov_b32 v175, v167
s_waitcnt lgkmcnt(0)
s_barrier
ds_read_b64 v[168:169], v7
ds_read_b64 v[172:173], v7 offset:8
L_k1_po8:
s_waitcnt lgkmcnt(0)
buffer_store_dwordx4 v[168:171], v2, s[48:51], s13 offen sc1
buffer_store_dwordx4 v[172:175], v2, s[48:51], s14 offen sc1
v_lshlrev_b32 v7, 5, v1
v_add_u32 v7, 114688, v7
s_mov_b64 exec, 0xff
ds_read_b128 v[72:75], v7 offset:0
ds_read_b128 v[76:79], v7 offset:16
ds_read_b128 v[80:83], v7 offset:256
ds_read_b128 v[84:87], v7 offset:272
ds_read_b128 v[88:91], v7 offset:512
ds_read_b128 v[92:95], v7 offset:528
ds_read_b128 v[96:99], v7 offset:768
ds_read_b128 v[100:103], v7 offset:784
s_lshl_b32 s13, s4, 7
s_lshl_b32 s15, s5, 12
s_add_u32 s13, s13, s15
s_add_u32 s13, s13, 27328512
s_cmp_eq_u32 s7, 0
s_cselect_b32 s62, s50, 0
s_waitcnt lgkmcnt(5)
v_pk_add_f32 v[72:73], v[72:73], v[80:81] op_sel:[0,0] op_sel_hi:[1,1]
v_pk_add_f32 v[74:75], v[74:75], v[82:83] op_sel:[0,0] op_sel_hi:[1,1]
s_waitcnt lgkmcnt(4)
v_pk_add_f32 v[76:77], v[76:77], v[84:85] op_sel:[0,0] op_sel_hi:[1,1]
v_pk_add_f32 v[78:79], v[78:79], v[86:87] op_sel:[0,0] op_sel_hi:[1,1]
s_waitcnt lgkmcnt(1)
v_pk_add_f32 v[88:89], v[88:89], v[96:97] op_sel:[0,0] op_sel_hi:[1,1]
v_pk_add_f32 v[90:91], v[90:91], v[98:99] op_sel:[0,0] op_sel_hi:[1,1]
s_waitcnt lgkmcnt(0)
v_pk_add_f32 v[92:93], v[92:93], v[100:101] op_sel:[0,0] op_sel_hi:[1,1]
v_pk_add_f32 v[94:95], v[94:95], v[102:103] op_sel:[0,0] op_sel_hi:[1,1]
v_pk_add_f32 v[72:73], v[72:73], v[88:89] op_sel:[0,0] op_sel_hi:[1,1]
v_pk_add_f32 v[74:75], v[74:75], v[90:91] op_sel:[0,0] op_sel_hi:[1,1]
v_pk_add_f32 v[76:77], v[76:77], v[92:93] op_sel:[0,0] op_sel_hi:[1,1]
v_pk_add_f32 v[78:79], v[78:79], v[94:95] op_sel:[0,0] op_sel_hi:[1,1]
v_cvt_pk_bf16_f32 v72, v72, v73
v_cvt_pk_bf16_f32 v73, v74, v75
v_cvt_pk_bf16_f32 v74, v76, v77
v_cvt_pk_bf16_f32 v75, v78, v79
buffer_store_dwordx4 v[72:75], v2, s[60:63], s13 offen sc1
s_endpgm
L_k1_w1:
s_sub_u32 s71, s2, 224
s_mul_i32 s9, s71, 28800
s_and_b32 s13, s7, 1
s_lshl_b32 s13, s13, 13
s_add_u32 s9, s9, s13
s_lshr_b32 s14, s7, 1
s_mul_i32 s15, s14, 15360
s_add_u32 s13, s13, s15
s_waitcnt lgkmcnt(0)
s_cmp_eq_u32 s14, 0
s_cselect_b32 s14, s18, s20
s_cselect_b32 s15, s19, s21
s_mov_b32 s56, s14
s_and_b32 s57, s15, 0xffff
s_mov_b32 s58, 0xe1000
s_mov_b32 s59, 0x20000
s_mov_b32 s48, s44
s_and_b32 s49, s45, 0xffff
s_mov_b32 s50, 0x2000000
s_mov_b32 s51, 0x20000
s_mov_b32 s6, s13
s_mov_b32 s52, s38
s_and_b32 s53, s39, 0xffff
s_mov_b32 s54, 0x380
s_mov_b32 s55, 0x20000
buffer_load_dwordx4 v[72:75], v2, s[52:55], 0 offen
s_add_u32 m0, s6, 0
s_add_u32 s10, s9, 0
buffer_load_dwordx4 v2, s[56:59], s10 offen offset:0 lds
buffer_load_dwordx4 v2, s[56:59], s10 offen offset:1024 lds
buffer_load_dwordx4 v2, s[56:59], s10 offen offset:2048 lds
buffer_load_dwordx4 v2, s[56:59], s10 offen offset:3072 lds
s_add_u32 s10, s10, 4096
s_add_u32 m0, m0, 4096
s_nop 0
buffer_load_dwordx4 v2, s[56:59], s10 offen offset:0 lds
buffer_load_dwordx4 v2, s[56:59], s10 offen offset:1024 lds
buffer_load_dwordx4 v2, s[56:59], s10 offen offset:2048 lds
s_and_b32 s12, s7, 1
s_lshl_b32 s12, s12, 10
s_sub_u32 s10, s10, s12
s_sub_u32 m0, m0, s12
s_nop 0
buffer_load_dwordx4 v2, s[56:59], s10 offen offset:3072 lds
s_min_u32 s8, s71, 20
s_mul_i32 s12, s8, 37
s_lshr_b32 s12, s12, 8
s_mul_i32 s13, s12, 7
s_sub_u32 s8, s8, s13
s_add_u32 s4, s8, s12
s_add_u32 s4, s4, 1
s_sub_u32 s13, s4, 7
s_cselect_b32 s4, s4, s13
s_mov_b32 s5, 0
s_movk_i32 s64, 0
s_movk_i32 s65, 128
s_movk_i32 s66, 256
s_movk_i32 s67, 384
s_movk_i32 s68, 512
s_movk_i32 s69, 640
s_movk_i32 s70, 768
s_lshl_b32 s12, s4, 6
s_lshr_b32 s13, s7, 1
s_lshl_b32 s13, s13, 5
s_add_u32 s12, s12, s13
s_and_b32 s13, s7, 1
s_lshl_b32 s13, s13, 2
s_add_u32 s12, s12, s13
v_and_b32 v6, 12, v3
v_add3_u32 v6, v6, v3, s12
v_mov_b32 v11, v6
v_lshrrev_b32 v192, 1, v6
v_and_b32 v194, 1, v6
v_cvt_f32_u32 v194, v194
v_mul_f32 v194, 0x3e800000, v194
v_mov_b32 v15, 0x3d88d677
v_mov_b32 v7, 0x3d41848f
v_cmp_gt_u32 vcc, 2, v6
s_nop 1
v_cndmask_b32 v15, v15, v7, vcc
v_cndmask_b32 v194, v194, 0, vcc
v_mov_b32 v7, 224
v_cmp_eq_u32 vcc, 1, v6
s_nop 1
v_cndmask_b32 v192, v192, v7, vcc
s_lshl_b32 s12, s5, 6
v_lshl_add_u32 v7, v4, 3, s12
v_mul_u32_u24 v193, v192, v7
v_cvt_f32_u32 v192, v192
v_cvt_f32_u32 v193, v193
v_mul_f32 v7, 0x3b124925, v193
v_floor_f32 v7, v7
v_fmac_f32 v193, 0xc3e00000, v7
v_mul_f32 v7, 0x3d924925, v192
v_cos_f32 v14, v7
v_mov_b32 v128, v193
v_add_f32 v129, v193, v192
v_add_f32 v6, v192, v192
v_mul_f32 v8, 0x42000000, v192
v_add_f32 v14, v14, v14
s_mov_b32 s12, 0x3b124925
v_pk_add_f32 v[130:131], v[128:129], v[6:7] op_sel:[0,0] op_sel_hi:[1,0]
v_pk_add_f32 v[132:133], v[130:131], v[6:7] op_sel:[0,0] op_sel_hi:[1,0]
v_pk_add_f32 v[134:135], v[132:133], v[6:7] op_sel:[0,0] op_sel_hi:[1,0]
v_pk_add_f32 v[136:137], v[128:129], v[8:9] op_sel:[0,0] op_sel_hi:[1,0]
v_pk_add_f32 v[138:139], v[130:131], v[8:9] op_sel:[0,0] op_sel_hi:[1,0]
v_pk_add_f32 v[140:141], v[132:133], v[8:9] op_sel:[0,0] op_sel_hi:[1,0]
v_pk_add_f32 v[142:143], v[134:135], v[8:9] op_sel:[0,0] op_sel_hi:[1,0]
v_pk_fma_f32 v[128:129], v[128:129], s[12:13], v[194:195] op_sel:[0,0,0] op_sel_hi:[1,0,0]
v_pk_fma_f32 v[130:131], v[130:131], s[12:13], v[194:195] op_sel:[0,0,0] op_sel_hi:[1,0,0]
v_pk_fma_f32 v[132:133], v[132:133], s[12:13], v[194:195] op_sel:[0,0,0] op_sel_hi:[1,0,0]
v_pk_fma_f32 v[134:135], v[134:135], s[12:13], v[194:195] op_sel:[0,0,0] op_sel_hi:[1,0,0]
v_pk_fma_f32 v[136:137], v[136:137], s[12:13], v[194:195] op_sel:[0,0,0] op_sel_hi:[1,0,0]
v_pk_fma_f32 v[138:139], v[138:139], s[12:13], v[194:195] op_sel:[0,0,0] op_sel_hi:[1,0,0]
v_pk_fma_f32 v[140:141], v[140:141], s[12:13], v[194:195] op_sel:[0,0,0] op_sel_hi:[1,0,0]
v_pk_fma_f32 v[142:143], v[142:143], s[12:13], v[194:195] op_sel:[0,0,0] op_sel_hi:[1,0,0]
v_cos_f32 v128, v128
v_cos_f32 v129, v129
v_cos_f32 v130, v130
v_cos_f32 v131, v131
v_cos_f32 v132, v132
v_cos_f32 v133, v133
v_cos_f32 v134, v134
v_cos_f32 v135, v135
v_cos_f32 v136, v136
v_cos_f32 v137, v137
v_cos_f32 v138, v138
v_cos_f32 v139, v139
v_cos_f32 v140, v140
v_cos_f32 v141, v141
v_cos_f32 v142, v142
v_cos_f32 v143, v143
v_pk_mul_f32 v[128:129], v[128:129], v[14:15] op_sel:[0,1] op_sel_hi:[1,1]
v_pk_mul_f32 v[130:131], v[130:131], v[14:15] op_sel:[0,1] op_sel_hi:[1,1]
v_pk_mul_f32 v[132:133], v[132:133], v[14:15] op_sel:[0,1] op_sel_hi:[1,1]
v_pk_mul_f32 v[134:135], v[134:135], v[14:15] op_sel:[0,1] op_sel_hi:[1,1]
v_pk_mul_f32 v[136:137], v[136:137], v[14:15] op_sel:[0,1] op_sel_hi:[1,1]
v_pk_mul_f32 v[138:139], v[138:139], v[14:15] op_sel:[0,1] op_sel_hi:[1,1]
v_pk_mul_f32 v[140:141], v[140:141], v[14:15] op_sel:[0,1] op_sel_hi:[1,1]
v_pk_mul_f32 v[142:143], v[142:143], v[14:15] op_sel:[0,1] op_sel_hi:[1,1]
v_cvt_pk_bf16_f32 v16, v128, v129
v_cvt_pk_bf16_f32 v17, v130, v131
v_cvt_pk_bf16_f32 v18, v132, v133
v_cvt_pk_bf16_f32 v19, v134, v135
v_cvt_pk_bf16_f32 v20, v136, v137
v_cvt_pk_bf16_f32 v21, v138, v139
v_cvt_pk_bf16_f32 v22, v140, v141
v_cvt_pk_bf16_f32 v23, v142, v143
v_pk_fma_f32 v[128:129], v[14:15], v[136:137], v[128:129] op_sel:[0,0,0] op_sel_hi:[0,1,1] neg_lo:[0,0,1] neg_hi:[0,0,1]
v_pk_fma_f32 v[130:131], v[14:15], v[138:139], v[130:131] op_sel:[0,0,0] op_sel_hi:[0,1,1] neg_lo:[0,0,1] neg_hi:[0,0,1]
v_pk_fma_f32 v[132:133], v[14:15], v[140:141], v[132:133] op_sel:[0,0,0] op_sel_hi:[0,1,1] neg_lo:[0,0,1] neg_hi:[0,0,1]
v_pk_fma_f32 v[134:135], v[14:15], v[142:143], v[134:135] op_sel:[0,0,0] op_sel_hi:[0,1,1] neg_lo:[0,0,1] neg_hi:[0,0,1]
v_cvt_pk_bf16_f32 v24, v128, v129
v_cvt_pk_bf16_f32 v25, v130, v131
v_cvt_pk_bf16_f32 v26, v132, v133
v_cvt_pk_bf16_f32 v27, v134, v135
v_pk_fma_f32 v[136:137], v[14:15], v[128:129], v[136:137] op_sel:[0,0,0] op_sel_hi:[0,1,1] neg_lo:[0,0,1] neg_hi:[0,0,1]
v_pk_fma_f32 v[138:139], v[14:15], v[130:131], v[138:139] op_sel:[0,0,0] op_sel_hi:[0,1,1] neg_lo:[0,0,1] neg_hi:[0,0,1]
v_pk_fma_f32 v[140:141], v[14:15], v[132:133], v[140:141] op_sel:[0,0,0] op_sel_hi:[0,1,1] neg_lo:[0,0,1] neg_hi:[0,0,1]
v_pk_fma_f32 v[142:143], v[14:15], v[134:135], v[142:143] op_sel:[0,0,0] op_sel_hi:[0,1,1] neg_lo:[0,0,1] neg_hi:[0,0,1]
v_cvt_pk_bf16_f32 v28, v136, v137
v_cvt_pk_bf16_f32 v29, v138, v139
v_cvt_pk_bf16_f32 v30, v140, v141
v_cvt_pk_bf16_f32 v31, v142, v143
v_pk_fma_f32 v[128:129], v[14:15], v[136:137], v[128:129] op_sel:[0,0,0] op_sel_hi:[0,1,1] neg_lo:[0,0,1] neg_hi:[0,0,1]
v_pk_fma_f32 v[130:131], v[14:15], v[138:139], v[130:131] op_sel:[0,0,0] op_sel_hi:[0,1,1] neg_lo:[0,0,1] neg_hi:[0,0,1]
v_pk_fma_f32 v[132:133], v[14:15], v[140:141], v[132:133] op_sel:[0,0,0] op_sel_hi:[0,1,1] neg_lo:[0,0,1] neg_hi:[0,0,1]
v_pk_fma_f32 v[134:135], v[14:15], v[142:143], v[134:135] op_sel:[0,0,0] op_sel_hi:[0,1,1] neg_lo:[0,0,1] neg_hi:[0,0,1]
v_cvt_pk_bf16_f32 v32, v128, v129
v_cvt_pk_bf16_f32 v33, v130, v131
v_cvt_pk_bf16_f32 v34, v132, v133
v_cvt_pk_bf16_f32 v35, v134, v135
v_pk_fma_f32 v[136:137], v[14:15], v[128:129], v[136:137] op_sel:[0,0,0] op_sel_hi:[0,1,1] neg_lo:[0,0,1] neg_hi:[0,0,1]
v_pk_fma_f32 v[138:139], v[14:15], v[130:131], v[138:139] op_sel:[0,0,0] op_sel_hi:[0,1,1] neg_lo:[0,0,1] neg_hi:[0,0,1]
v_pk_fma_f32 v[140:141], v[14:15], v[132:133], v[140:141] op_sel:[0,0,0] op_sel_hi:[0,1,1] neg_lo:[0,0,1] neg_hi:[0,0,1]
v_pk_fma_f32 v[142:143], v[14:15], v[134:135], v[142:143] op_sel:[0,0,0] op_sel_hi:[0,1,1] neg_lo:[0,0,1] neg_hi:[0,0,1]
v_cvt_pk_bf16_f32 v36, v136, v137
v_cvt_pk_bf16_f32 v37, v138, v139
v_cvt_pk_bf16_f32 v38, v140, v141
v_cvt_pk_bf16_f32 v39, v142, v143
v_pk_fma_f32 v[128:129], v[14:15], v[136:137], v[128:129] op_sel:[0,0,0] op_sel_hi:[0,1,1] neg_lo:[0,0,1] neg_hi:[0,0,1]
v_pk_fma_f32 v[130:131], v[14:15], v[138:139], v[130:131] op_sel:[0,0,0] op_sel_hi:[0,1,1] neg_lo:[0,0,1] neg_hi:[0,0,1]
v_pk_fma_f32 v[132:133], v[14:15], v[140:141], v[132:133] op_sel:[0,0,0] op_sel_hi:[0,1,1] neg_lo:[0,0,1] neg_hi:[0,0,1]
v_pk_fma_f32 v[134:135], v[14:15], v[142:143], v[134:135] op_sel:[0,0,0] op_sel_hi:[0,1,1] neg_lo:[0,0,1] neg_hi:[0,0,1]
v_cvt_pk_bf16_f32 v40, v128, v129
v_cvt_pk_bf16_f32 v41, v130, v131
v_cvt_pk_bf16_f32 v42, v132, v133
v_cvt_pk_bf16_f32 v43, v134, v135
v_pk_fma_f32 v[136:137], v[14:15], v[128:129], v[136:137] op_sel:[0,0,0] op_sel_hi:[0,1,1] neg_lo:[0,0,1] neg_hi:[0,0,1]
v_pk_fma_f32 v[138:139], v[14:15], v[130:131], v[138:139] op_sel:[0,0,0] op_sel_hi:[0,1,1] neg_lo:[0,0,1] neg_hi:[0,0,1]
v_pk_fma_f32 v[140:141], v[14:15], v[132:133], v[140:141] op_sel:[0,0,0] op_sel_hi:[0,1,1] neg_lo:[0,0,1] neg_hi:[0,0,1]
v_pk_fma_f32 v[142:143], v[14:15], v[134:135], v[142:143] op_sel:[0,0,0] op_sel_hi:[0,1,1] neg_lo:[0,0,1] neg_hi:[0,0,1]
v_cvt_pk_bf16_f32 v44, v136, v137
v_cvt_pk_bf16_f32 v45, v138, v139
v_cvt_pk_bf16_f32 v46, v140, v141
v_cvt_pk_bf16_f32 v47, v142, v143
v_pk_fma_f32 v[128:129], v[14:15], v[136:137], v[128:129] op_sel:[0,0,0] op_sel_hi:[0,1,1] neg_lo:[0,0,1] neg_hi:[0,0,1]
v_pk_fma_f32 v[130:131], v[14:15], v[138:139], v[130:131] op_sel:[0,0,0] op_sel_hi:[0,1,1] neg_lo:[0,0,1] neg_hi:[0,0,1]
v_pk_fma_f32 v[132:133], v[14:15], v[140:141], v[132:133] op_sel:[0,0,0] op_sel_hi:[0,1,1] neg_lo:[0,0,1] neg_hi:[0,0,1]
v_pk_fma_f32 v[134:135], v[14:15], v[142:143], v[134:135] op_sel:[0,0,0] op_sel_hi:[0,1,1] neg_lo:[0,0,1] neg_hi:[0,0,1]
v_cvt_pk_bf16_f32 v48, v128, v129
v_cvt_pk_bf16_f32 v49, v130, v131
v_cvt_pk_bf16_f32 v50, v132, v133
v_cvt_pk_bf16_f32 v51, v134, v135
v_pk_fma_f32 v[136:137], v[14:15], v[128:129], v[136:137] op_sel:[0,0,0] op_sel_hi:[0,1,1] neg_lo:[0,0,1] neg_hi:[0,0,1]
v_pk_fma_f32 v[138:139], v[14:15], v[130:131], v[138:139] op_sel:[0,0,0] op_sel_hi:[0,1,1] neg_lo:[0,0,1] neg_hi:[0,0,1]
v_pk_fma_f32 v[140:141], v[14:15], v[132:133], v[140:141] op_sel:[0,0,0] op_sel_hi:[0,1,1] neg_lo:[0,0,1] neg_hi:[0,0,1]
v_pk_fma_f32 v[142:143], v[14:15], v[134:135], v[142:143] op_sel:[0,0,0] op_sel_hi:[0,1,1] neg_lo:[0,0,1] neg_hi:[0,0,1]
v_cvt_pk_bf16_f32 v52, v136, v137
v_cvt_pk_bf16_f32 v53, v138, v139
v_cvt_pk_bf16_f32 v54, v140, v141
v_cvt_pk_bf16_f32 v55, v142, v143
v_pk_fma_f32 v[128:129], v[14:15], v[136:137], v[128:129] op_sel:[0,0,0] op_sel_hi:[0,1,1] neg_lo:[0,0,1] neg_hi:[0,0,1]
v_pk_fma_f32 v[130:131], v[14:15], v[138:139], v[130:131] op_sel:[0,0,0] op_sel_hi:[0,1,1] neg_lo:[0,0,1] neg_hi:[0,0,1]
v_pk_fma_f32 v[132:133], v[14:15], v[140:141], v[132:133] op_sel:[0,0,0] op_sel_hi:[0,1,1] neg_lo:[0,0,1] neg_hi:[0,0,1]
v_pk_fma_f32 v[134:135], v[14:15], v[142:143], v[134:135] op_sel:[0,0,0] op_sel_hi:[0,1,1] neg_lo:[0,0,1] neg_hi:[0,0,1]
v_cvt_pk_bf16_f32 v56, v128, v129
v_cvt_pk_bf16_f32 v57, v130, v131
v_cvt_pk_bf16_f32 v58, v132, v133
v_cvt_pk_bf16_f32 v59, v134, v135
v_pk_fma_f32 v[136:137], v[14:15], v[128:129], v[136:137] op_sel:[0,0,0] op_sel_hi:[0,1,1] neg_lo:[0,0,1] neg_hi:[0,0,1]
v_pk_fma_f32 v[138:139], v[14:15], v[130:131], v[138:139] op_sel:[0,0,0] op_sel_hi:[0,1,1] neg_lo:[0,0,1] neg_hi:[0,0,1]
v_pk_fma_f32 v[140:141], v[14:15], v[132:133], v[140:141] op_sel:[0,0,0] op_sel_hi:[0,1,1] neg_lo:[0,0,1] neg_hi:[0,0,1]
v_pk_fma_f32 v[142:143], v[14:15], v[134:135], v[142:143] op_sel:[0,0,0] op_sel_hi:[0,1,1] neg_lo:[0,0,1] neg_hi:[0,0,1]
v_cvt_pk_bf16_f32 v60, v136, v137
v_cvt_pk_bf16_f32 v61, v138, v139
v_cvt_pk_bf16_f32 v62, v140, v141
v_cvt_pk_bf16_f32 v63, v142, v143
v_pk_fma_f32 v[128:129], v[14:15], v[136:137], v[128:129] op_sel:[0,0,0] op_sel_hi:[0,1,1] neg_lo:[0,0,1] neg_hi:[0,0,1]
v_pk_fma_f32 v[130:131], v[14:15], v[138:139], v[130:131] op_sel:[0,0,0] op_sel_hi:[0,1,1] neg_lo:[0,0,1] neg_hi:[0,0,1]
v_pk_fma_f32 v[132:133], v[14:15], v[140:141], v[132:133] op_sel:[0,0,0] op_sel_hi:[0,1,1] neg_lo:[0,0,1] neg_hi:[0,0,1]
v_pk_fma_f32 v[134:135], v[14:15], v[142:143], v[134:135] op_sel:[0,0,0] op_sel_hi:[0,1,1] neg_lo:[0,0,1] neg_hi:[0,0,1]
v_cvt_pk_bf16_f32 v64, v128, v129
v_cvt_pk_bf16_f32 v65, v130, v131
v_cvt_pk_bf16_f32 v66, v132, v133
v_cvt_pk_bf16_f32 v67, v134, v135
v_pk_fma_f32 v[136:137], v[14:15], v[128:129], v[136:137] op_sel:[0,0,0] op_sel_hi:[0,1,1] neg_lo:[0,0,1] neg_hi:[0,0,1]
v_pk_fma_f32 v[138:139], v[14:15], v[130:131], v[138:139] op_sel:[0,0,0] op_sel_hi:[0,1,1] neg_lo:[0,0,1] neg_hi:[0,0,1]
v_pk_fma_f32 v[140:141], v[14:15], v[132:133], v[140:141] op_sel:[0,0,0] op_sel_hi:[0,1,1] neg_lo:[0,0,1] neg_hi:[0,0,1]
v_pk_fma_f32 v[142:143], v[14:15], v[134:135], v[142:143] op_sel:[0,0,0] op_sel_hi:[0,1,1] neg_lo:[0,0,1] neg_hi:[0,0,1]
v_cvt_pk_bf16_f32 v68, v136, v137
v_cvt_pk_bf16_f32 v69, v138, v139
v_cvt_pk_bf16_f32 v70, v140, v141
v_cvt_pk_bf16_f32 v71, v142, v143
s_add_u32 m0, s6, 30720
s_add_u32 s10, s9, 14400
buffer_load_dwordx4 v2, s[56:59], s10 offen offset:0 lds
buffer_load_dwordx4 v2, s[56:59], s10 offen offset:1024 lds
buffer_load_dwordx4 v2, s[56:59], s10 offen offset:2048 lds
buffer_load_dwordx4 v2, s[56:59], s10 offen offset:3072 lds
s_add_u32 s10, s10, 4096
s_add_u32 m0, m0, 4096
s_nop 0
buffer_load_dwordx4 v2, s[56:59], s10 offen offset:0 lds
buffer_load_dwordx4 v2, s[56:59], s10 offen offset:1024 lds
buffer_load_dwordx4 v2, s[56:59], s10 offen offset:2048 lds
s_and_b32 s12, s7, 1
s_lshl_b32 s12, s12, 10
s_sub_u32 s10, s10, s12
s_sub_u32 m0, m0, s12
s_nop 0
buffer_load_dwordx4 v2, s[56:59], s10 offen offset:3072 lds
s_lshl_b32 s12, s7, 11
s_add_u32 s12, s12, 120832
v_lshl_add_u32 v6, v1, 5, s12
v_lshl_add_u32 v10, v4, 5, s12
s_waitcnt vmcnt(16)
v_lshlrev_b32 v76, 16, v72
v_and_b32 v77, 0xffff0000, v72
v_lshlrev_b32 v78, 16, v73
v_and_b32 v79, 0xffff0000, v73
v_lshlrev_b32 v80, 16, v74
v_and_b32 v81, 0xffff0000, v74
v_lshlrev_b32 v82, 16, v75
v_and_b32 v83, 0xffff0000, v75
ds_write_b128 v6, v[76:79]
ds_write_b128 v6, v[80:83] offset:16
s_lshl_b32 s13, s64, 1
v_add_u32 v232, s13, v10
s_lshl_b32 s13, s65, 1
v_add_u32 v233, s13, v10
s_lshl_b32 s13, s66, 1
v_add_u32 v234, s13, v10
s_lshl_b32 s13, s67, 1
v_add_u32 v235, s13, v10
s_lshl_b32 s13, s68, 1
v_add_u32 v236, s13, v10
s_lshl_b32 s13, s69, 1
v_add_u32 v237, s13, v10
s_lshl_b32 s13, s70, 1
v_add_u32 v238, s13, v10
s_lshl_b32 s12, s8, 2
s_add_u32 s12, s12, s7
s_lshl_b32 s12, s12, 4
v_add_u32 v6, s12, v3
v_lshrrev_b32 v192, 1, v6
v_and_b32 v194, 1, v6
v_cvt_f32_u32 v194, v194
v_mul_f32 v194, 0x3e800000, v194
v_mov_b32 v15, 0x3d88d677
v_mov_b32 v7, 0x3d41848f
v_cmp_gt_u32 vcc, 2, v6
s_nop 1
v_cndmask_b32 v15, v15, v7, vcc
v_cndmask_b32 v194, v194, 0, vcc
v_mov_b32 v7, 224
v_cmp_eq_u32 vcc, 1, v6
s_nop 1
v_cndmask_b32 v192, v192, v7, vcc
s_lshl_b32 s12, s5, 6
v_lshl_add_u32 v7, v4, 3, s12
v_mul_u32_u24 v193, v192, v7
v_cvt_f32_u32 v192, v192
v_cvt_f32_u32 v193, v193
v_mul_f32 v7, 0x3b124925, v193
v_floor_f32 v7, v7
v_fmac_f32 v193, 0xc3e00000, v7
v_mul_f32 v7, 0x3d924925, v192
v_cos_f32 v14, v7
v_mov_b32 v128, v193
v_add_f32 v129, v193, v192
v_add_f32 v6, v192, v192
v_mul_f32 v8, 0x42000000, v192
v_add_f32 v14, v14, v14
s_mov_b32 s12, 0x3b124925
ds_read_b128 v[240:243], v232 offset:0
ds_read_b128 v[244:247], v232 offset:16
ds_read_b128 v[248:251], v232 offset:128
ds_read_b128 v[252:255], v232 offset:144
v_pk_add_f32 v[130:131], v[128:129], v[6:7] op_sel:[0,0] op_sel_hi:[1,0]
v_pk_add_f32 v[132:133], v[130:131], v[6:7] op_sel:[0,0] op_sel_hi:[1,0]
v_pk_add_f32 v[134:135], v[132:133], v[6:7] op_sel:[0,0] op_sel_hi:[1,0]
v_pk_add_f32 v[136:137], v[128:129], v[8:9] op_sel:[0,0] op_sel_hi:[1,0]
v_pk_add_f32 v[138:139], v[130:131], v[8:9] op_sel:[0,0] op_sel_hi:[1,0]
v_pk_add_f32 v[140:141], v[132:133], v[8:9] op_sel:[0,0] op_sel_hi:[1,0]
v_pk_add_f32 v[142:143], v[134:135], v[8:9] op_sel:[0,0] op_sel_hi:[1,0]
v_pk_fma_f32 v[128:129], v[128:129], s[12:13], v[194:195] op_sel:[0,0,0] op_sel_hi:[1,0,0]
v_pk_fma_f32 v[130:131], v[130:131], s[12:13], v[194:195] op_sel:[0,0,0] op_sel_hi:[1,0,0]
v_pk_fma_f32 v[132:133], v[132:133], s[12:13], v[194:195] op_sel:[0,0,0] op_sel_hi:[1,0,0]
v_pk_fma_f32 v[134:135], v[134:135], s[12:13], v[194:195] op_sel:[0,0,0] op_sel_hi:[1,0,0]
v_pk_fma_f32 v[136:137], v[136:137], s[12:13], v[194:195] op_sel:[0,0,0] op_sel_hi:[1,0,0]
v_pk_fma_f32 v[138:139], v[138:139], s[12:13], v[194:195] op_sel:[0,0,0] op_sel_hi:[1,0,0]
v_pk_fma_f32 v[140:141], v[140:141], s[12:13], v[194:195] op_sel:[0,0,0] op_sel_hi:[1,0,0]
v_pk_fma_f32 v[142:143], v[142:143], s[12:13], v[194:195] op_sel:[0,0,0] op_sel_hi:[1,0,0]
v_cos_f32 v128, v128
v_cos_f32 v129, v129
v_cos_f32 v130, v130
v_cos_f32 v131, v131
v_cos_f32 v132, v132
v_cos_f32 v133, v133
v_cos_f32 v134, v134
v_cos_f32 v135, v135
v_cos_f32 v136, v136
v_cos_f32 v137, v137
v_cos_f32 v138, v138
v_cos_f32 v139, v139
v_cos_f32 v140, v140
v_cos_f32 v141, v141
v_cos_f32 v142, v142
v_cos_f32 v143, v143
v_pk_mul_f32 v[128:129], v[128:129], v[14:15] op_sel:[0,1] op_sel_hi:[1,1]
v_pk_mul_f32 v[130:131], v[130:131], v[14:15] op_sel:[0,1] op_sel_hi:[1,1]
v_pk_mul_f32 v[132:133], v[132:133], v[14:15] op_sel:[0,1] op_sel_hi:[1,1]
v_pk_mul_f32 v[134:135], v[134:135], v[14:15] op_sel:[0,1] op_sel_hi:[1,1]
v_pk_mul_f32 v[136:137], v[136:137], v[14:15] op_sel:[0,1] op_sel_hi:[1,1]
v_pk_mul_f32 v[138:139], v[138:139], v[14:15] op_sel:[0,1] op_sel_hi:[1,1]
v_pk_mul_f32 v[140:141], v[140:141], v[14:15] op_sel:[0,1] op_sel_hi:[1,1]
v_pk_mul_f32 v[142:143], v[142:143], v[14:15] op_sel:[0,1] op_sel_hi:[1,1]
s_mul_i32 s12, s7, 14336
s_add_u32 s12, s12, 61440
v_add_u32 v7, s12, v2
s_waitcnt lgkmcnt(3)
v_pk_mul_f32 v[240:241], v[240:241], v[128:129] op_sel:[0,0] op_sel_hi:[1,1]
v_pk_mul_f32 v[242:243], v[242:243], v[130:131] op_sel:[0,0] op_sel_hi:[1,1]
s_waitcnt lgkmcnt(2)
v_pk_mul_f32 v[244:245], v[244:245], v[132:133] op_sel:[0,0] op_sel_hi:[1,1]
v_pk_mul_f32 v[246:247], v[246:247], v[134:135] op_sel:[0,0] op_sel_hi:[1,1]
v_cvt_pk_bf16_f32 v72, v240, v241
v_cvt_pk_bf16_f32 v73, v242, v243
v_cvt_pk_bf16_f32 v74, v244, v245
v_cvt_pk_bf16_f32 v75, v246, v247
ds_read_b128 v[240:243], v233 offset:0
ds_read_b128 v[244:247], v233 offset:16
ds_write_b128 v7, v[72:75] offset:0
s_waitcnt lgkmcnt(4)
v_pk_mul_f32 v[248:249], v[248:249], v[136:137] op_sel:[0,0] op_sel_hi:[1,1]
v_pk_mul_f32 v[250:251], v[250:251], v[138:139] op_sel:[0,0] op_sel_hi:[1,1]
s_waitcnt lgkmcnt(3)
v_pk_mul_f32 v[252:253], v[252:253], v[140:141] op_sel:[0,0] op_sel_hi:[1,1]
v_pk_mul_f32 v[254:255], v[254:255], v[142:143] op_sel:[0,0] op_sel_hi:[1,1]
v_cvt_pk_bf16_f32 v76, v248, v249
v_cvt_pk_bf16_f32 v77, v250, v251
v_cvt_pk_bf16_f32 v78, v252, v253
v_cvt_pk_bf16_f32 v79, v254, v255
ds_read_b128 v[248:251], v233 offset:128
ds_read_b128 v[252:255], v233 offset:144
ds_write_b128 v7, v[76:79] offset:1024
v_pk_fma_f32 v[128:129], v[14:15], v[136:137], v[128:129] op_sel:[0,0,0] op_sel_hi:[0,1,1] neg_lo:[0,0,1] neg_hi:[0,0,1]
v_pk_fma_f32 v[130:131], v[14:15], v[138:139], v[130:131] op_sel:[0,0,0] op_sel_hi:[0,1,1] neg_lo:[0,0,1] neg_hi:[0,0,1]
v_pk_fma_f32 v[132:133], v[14:15], v[140:141], v[132:133] op_sel:[0,0,0] op_sel_hi:[0,1,1] neg_lo:[0,0,1] neg_hi:[0,0,1]
v_pk_fma_f32 v[134:135], v[14:15], v[142:143], v[134:135] op_sel:[0,0,0] op_sel_hi:[0,1,1] neg_lo:[0,0,1] neg_hi:[0,0,1]
s_waitcnt lgkmcnt(5)
v_pk_mul_f32 v[240:241], v[240:241], v[128:129] op_sel:[0,0] op_sel_hi:[1,1]
v_pk_mul_f32 v[242:243], v[242:243], v[130:131] op_sel:[0,0] op_sel_hi:[1,1]
s_waitcnt lgkmcnt(4)
v_pk_mul_f32 v[244:245], v[244:245], v[132:133] op_sel:[0,0] op_sel_hi:[1,1]
v_pk_mul_f32 v[246:247], v[246:247], v[134:135] op_sel:[0,0] op_sel_hi:[1,1]
v_cvt_pk_bf16_f32 v80, v240, v241
v_cvt_pk_bf16_f32 v81, v242, v243
v_cvt_pk_bf16_f32 v82, v244, v245
v_cvt_pk_bf16_f32 v83, v246, v247
ds_read_b128 v[240:243], v234 offset:0
ds_read_b128 v[244:247], v234 offset:16
ds_write_b128 v7, v[80:83] offset:2048
v_pk_fma_f32 v[136:137], v[14:15], v[128:129], v[136:137] op_sel:[0,0,0] op_sel_hi:[0,1,1] neg_lo:[0,0,1] neg_hi:[0,0,1]
v_pk_fma_f32 v[138:139], v[14:15], v[130:131], v[138:139] op_sel:[0,0,0] op_sel_hi:[0,1,1] neg_lo:[0,0,1] neg_hi:[0,0,1]
v_pk_fma_f32 v[140:141], v[14:15], v[132:133], v[140:141] op_sel:[0,0,0] op_sel_hi:[0,1,1] neg_lo:[0,0,1] neg_hi:[0,0,1]
v_pk_fma_f32 v[142:143], v[14:15], v[134:135], v[142:143] op_sel:[0,0,0] op_sel_hi:[0,1,1] neg_lo:[0,0,1] neg_hi:[0,0,1]
s_waitcnt lgkmcnt(5)
v_pk_mul_f32 v[248:249], v[248:249], v[136:137] op_sel:[0,0] op_sel_hi:[1,1]
v_pk_mul_f32 v[250:251], v[250:251], v[138:139] op_sel:[0,0] op_sel_hi:[1,1]
s_waitcnt lgkmcnt(4)
v_pk_mul_f32 v[252:253], v[252:253], v[140:141] op_sel:[0,0] op_sel_hi:[1,1]
v_pk_mul_f32 v[254:255], v[254:255], v[142:143] op_sel:[0,0] op_sel_hi:[1,1]
v_cvt_pk_bf16_f32 v84, v248, v249
v_cvt_pk_bf16_f32 v85, v250, v251
v_cvt_pk_bf16_f32 v86, v252, v253
v_cvt_pk_bf16_f32 v87, v254, v255
ds_read_b128 v[248:251], v234 offset:128
ds_read_b128 v[252:255], v234 offset:144
ds_write_b128 v7, v[84:87] offset:3072
v_pk_fma_f32 v[128:129], v[14:15], v[136:137], v[128:129] op_sel:[0,0,0] op_sel_hi:[0,1,1] neg_lo:[0,0,1] neg_hi:[0,0,1]
v_pk_fma_f32 v[130:131], v[14:15], v[138:139], v[130:131] op_sel:[0,0,0] op_sel_hi:[0,1,1] neg_lo:[0,0,1] neg_hi:[0,0,1]
v_pk_fma_f32 v[132:133], v[14:15], v[140:141], v[132:133] op_sel:[0,0,0] op_sel_hi:[0,1,1] neg_lo:[0,0,1] neg_hi:[0,0,1]
v_pk_fma_f32 v[134:135], v[14:15], v[142:143], v[134:135] op_sel:[0,0,0] op_sel_hi:[0,1,1] neg_lo:[0,0,1] neg_hi:[0,0,1]
s_waitcnt lgkmcnt(5)
v_pk_mul_f32 v[240:241], v[240:241], v[128:129] op_sel:[0,0] op_sel_hi:[1,1]
v_pk_mul_f32 v[242:243], v[242:243], v[130:131] op_sel:[0,0] op_sel_hi:[1,1]
s_waitcnt lgkmcnt(4)
v_pk_mul_f32 v[244:245], v[244:245], v[132:133] op_sel:[0,0] op_sel_hi:[1,1]
v_pk_mul_f32 v[246:247], v[246:247], v[134:135] op_sel:[0,0] op_sel_hi:[1,1]
v_cvt_pk_bf16_f32 v88, v240, v241
v_cvt_pk_bf16_f32 v89, v242, v243
v_cvt_pk_bf16_f32 v90, v244, v245
v_cvt_pk_bf16_f32 v91, v246, v247
ds_read_b128 v[240:243], v235 offset:0
ds_read_b128 v[244:247], v235 offset:16
ds_write_b128 v7, v[88:91] offset:4096
v_pk_fma_f32 v[136:137], v[14:15], v[128:129], v[136:137] op_sel:[0,0,0] op_sel_hi:[0,1,1] neg_lo:[0,0,1] neg_hi:[0,0,1]
v_pk_fma_f32 v[138:139], v[14:15], v[130:131], v[138:139] op_sel:[0,0,0] op_sel_hi:[0,1,1] neg_lo:[0,0,1] neg_hi:[0,0,1]
v_pk_fma_f32 v[140:141], v[14:15], v[132:133], v[140:141] op_sel:[0,0,0] op_sel_hi:[0,1,1] neg_lo:[0,0,1] neg_hi:[0,0,1]
v_pk_fma_f32 v[142:143], v[14:15], v[134:135], v[142:143] op_sel:[0,0,0] op_sel_hi:[0,1,1] neg_lo:[0,0,1] neg_hi:[0,0,1]
s_waitcnt lgkmcnt(5)
v_pk_mul_f32 v[248:249], v[248:249], v[136:137] op_sel:[0,0] op_sel_hi:[1,1]
v_pk_mul_f32 v[250:251], v[250:251], v[138:139] op_sel:[0,0] op_sel_hi:[1,1]
s_waitcnt lgkmcnt(4)
v_pk_mul_f32 v[252:253], v[252:253], v[140:141] op_sel:[0,0] op_sel_hi:[1,1]
v_pk_mul_f32 v[254:255], v[254:255], v[142:143] op_sel:[0,0] op_sel_hi:[1,1]
v_cvt_pk_bf16_f32 v92, v248, v249
v_cvt_pk_bf16_f32 v93, v250, v251
v_cvt_pk_bf16_f32 v94, v252, v253
v_cvt_pk_bf16_f32 v95, v254, v255
ds_read_b128 v[248:251], v235 offset:128
ds_read_b128 v[252:255], v235 offset:144
ds_write_b128 v7, v[92:95] offset:5120
v_pk_fma_f32 v[128:129], v[14:15], v[136:137], v[128:129] op_sel:[0,0,0] op_sel_hi:[0,1,1] neg_lo:[0,0,1] neg_hi:[0,0,1]
v_pk_fma_f32 v[130:131], v[14:15], v[138:139], v[130:131] op_sel:[0,0,0] op_sel_hi:[0,1,1] neg_lo:[0,0,1] neg_hi:[0,0,1]
v_pk_fma_f32 v[132:133], v[14:15], v[140:141], v[132:133] op_sel:[0,0,0] op_sel_hi:[0,1,1] neg_lo:[0,0,1] neg_hi:[0,0,1]
v_pk_fma_f32 v[134:135], v[14:15], v[142:143], v[134:135] op_sel:[0,0,0] op_sel_hi:[0,1,1] neg_lo:[0,0,1] neg_hi:[0,0,1]
s_waitcnt lgkmcnt(5)
v_pk_mul_f32 v[240:241], v[240:241], v[128:129] op_sel:[0,0] op_sel_hi:[1,1]
v_pk_mul_f32 v[242:243], v[242:243], v[130:131] op_sel:[0,0] op_sel_hi:[1,1]
s_waitcnt lgkmcnt(4)
v_pk_mul_f32 v[244:245], v[244:245], v[132:133] op_sel:[0,0] op_sel_hi:[1,1]
v_pk_mul_f32 v[246:247], v[246:247], v[134:135] op_sel:[0,0] op_sel_hi:[1,1]
v_cvt_pk_bf16_f32 v96, v240, v241
v_cvt_pk_bf16_f32 v97, v242, v243
v_cvt_pk_bf16_f32 v98, v244, v245
v_cvt_pk_bf16_f32 v99, v246, v247
ds_read_b128 v[240:243], v236 offset:0
ds_read_b128 v[244:247], v236 offset:16
ds_write_b128 v7, v[96:99] offset:6144
v_pk_fma_f32 v[136:137], v[14:15], v[128:129], v[136:137] op_sel:[0,0,0] op_sel_hi:[0,1,1] neg_lo:[0,0,1] neg_hi:[0,0,1]
v_pk_fma_f32 v[138:139], v[14:15], v[130:131], v[138:139] op_sel:[0,0,0] op_sel_hi:[0,1,1] neg_lo:[0,0,1] neg_hi:[0,0,1]
v_pk_fma_f32 v[140:141], v[14:15], v[132:133], v[140:141] op_sel:[0,0,0] op_sel_hi:[0,1,1] neg_lo:[0,0,1] neg_hi:[0,0,1]
v_pk_fma_f32 v[142:143], v[14:15], v[134:135], v[142:143] op_sel:[0,0,0] op_sel_hi:[0,1,1] neg_lo:[0,0,1] neg_hi:[0,0,1]
s_waitcnt lgkmcnt(5)
v_pk_mul_f32 v[248:249], v[248:249], v[136:137] op_sel:[0,0] op_sel_hi:[1,1]
v_pk_mul_f32 v[250:251], v[250:251], v[138:139] op_sel:[0,0] op_sel_hi:[1,1]
s_waitcnt lgkmcnt(4)
v_pk_mul_f32 v[252:253], v[252:253], v[140:141] op_sel:[0,0] op_sel_hi:[1,1]
v_pk_mul_f32 v[254:255], v[254:255], v[142:143] op_sel:[0,0] op_sel_hi:[1,1]
v_cvt_pk_bf16_f32 v100, v248, v249
v_cvt_pk_bf16_f32 v101, v250, v251
v_cvt_pk_bf16_f32 v102, v252, v253
v_cvt_pk_bf16_f32 v103, v254, v255
ds_read_b128 v[248:251], v236 offset:128
ds_read_b128 v[252:255], v236 offset:144
ds_write_b128 v7, v[100:103] offset:7168
v_pk_fma_f32 v[128:129], v[14:15], v[136:137], v[128:129] op_sel:[0,0,0] op_sel_hi:[0,1,1] neg_lo:[0,0,1] neg_hi:[0,0,1]
v_pk_fma_f32 v[130:131], v[14:15], v[138:139], v[130:131] op_sel:[0,0,0] op_sel_hi:[0,1,1] neg_lo:[0,0,1] neg_hi:[0,0,1]
v_pk_fma_f32 v[132:133], v[14:15], v[140:141], v[132:133] op_sel:[0,0,0] op_sel_hi:[0,1,1] neg_lo:[0,0,1] neg_hi:[0,0,1]
v_pk_fma_f32 v[134:135], v[14:15], v[142:143], v[134:135] op_sel:[0,0,0] op_sel_hi:[0,1,1] neg_lo:[0,0,1] neg_hi:[0,0,1]
s_waitcnt lgkmcnt(5)
v_pk_mul_f32 v[240:241], v[240:241], v[128:129] op_sel:[0,0] op_sel_hi:[1,1]
v_pk_mul_f32 v[242:243], v[242:243], v[130:131] op_sel:[0,0] op_sel_hi:[1,1]
s_waitcnt lgkmcnt(4)
v_pk_mul_f32 v[244:245], v[244:245], v[132:133] op_sel:[0,0] op_sel_hi:[1,1]
v_pk_mul_f32 v[246:247], v[246:247], v[134:135] op_sel:[0,0] op_sel_hi:[1,1]
v_cvt_pk_bf16_f32 v104, v240, v241
v_cvt_pk_bf16_f32 v105, v242, v243
v_cvt_pk_bf16_f32 v106, v244, v245
v_cvt_pk_bf16_f32 v107, v246, v247
ds_read_b128 v[240:243], v237 offset:0
ds_read_b128 v[244:247], v237 offset:16
ds_write_b128 v7, v[104:107] offset:8192
v_pk_fma_f32 v[136:137], v[14:15], v[128:129], v[136:137] op_sel:[0,0,0] op_sel_hi:[0,1,1] neg_lo:[0,0,1] neg_hi:[0,0,1]
v_pk_fma_f32 v[138:139], v[14:15], v[130:131], v[138:139] op_sel:[0,0,0] op_sel_hi:[0,1,1] neg_lo:[0,0,1] neg_hi:[0,0,1]
v_pk_fma_f32 v[140:141], v[14:15], v[132:133], v[140:141] op_sel:[0,0,0] op_sel_hi:[0,1,1] neg_lo:[0,0,1] neg_hi:[0,0,1]
v_pk_fma_f32 v[142:143], v[14:15], v[134:135], v[142:143] op_sel:[0,0,0] op_sel_hi:[0,1,1] neg_lo:[0,0,1] neg_hi:[0,0,1]
s_waitcnt lgkmcnt(5)
v_pk_mul_f32 v[248:249], v[248:249], v[136:137] op_sel:[0,0] op_sel_hi:[1,1]
v_pk_mul_f32 v[250:251], v[250:251], v[138:139] op_sel:[0,0] op_sel_hi:[1,1]
s_waitcnt lgkmcnt(4)
v_pk_mul_f32 v[252:253], v[252:253], v[140:141] op_sel:[0,0] op_sel_hi:[1,1]
v_pk_mul_f32 v[254:255], v[254:255], v[142:143] op_sel:[0,0] op_sel_hi:[1,1]
v_cvt_pk_bf16_f32 v108, v248, v249
v_cvt_pk_bf16_f32 v109, v250, v251
v_cvt_pk_bf16_f32 v110, v252, v253
v_cvt_pk_bf16_f32 v111, v254, v255
ds_read_b128 v[248:251], v237 offset:128
ds_read_b128 v[252:255], v237 offset:144
ds_write_b128 v7, v[108:111] offset:9216
v_pk_fma_f32 v[128:129], v[14:15], v[136:137], v[128:129] op_sel:[0,0,0] op_sel_hi:[0,1,1] neg_lo:[0,0,1] neg_hi:[0,0,1]
v_pk_fma_f32 v[130:131], v[14:15], v[138:139], v[130:131] op_sel:[0,0,0] op_sel_hi:[0,1,1] neg_lo:[0,0,1] neg_hi:[0,0,1]
v_pk_fma_f32 v[132:133], v[14:15], v[140:141], v[132:133] op_sel:[0,0,0] op_sel_hi:[0,1,1] neg_lo:[0,0,1] neg_hi:[0,0,1]
v_pk_fma_f32 v[134:135], v[14:15], v[142:143], v[134:135] op_sel:[0,0,0] op_sel_hi:[0,1,1] neg_lo:[0,0,1] neg_hi:[0,0,1]
s_waitcnt lgkmcnt(5)
v_pk_mul_f32 v[240:241], v[240:241], v[128:129] op_sel:[0,0] op_sel_hi:[1,1]
v_pk_mul_f32 v[242:243], v[242:243], v[130:131] op_sel:[0,0] op_sel_hi:[1,1]
s_waitcnt lgkmcnt(4)
v_pk_mul_f32 v[244:245], v[244:245], v[132:133] op_sel:[0,0] op_sel_hi:[1,1]
v_pk_mul_f32 v[246:247], v[246:247], v[134:135] op_sel:[0,0] op_sel_hi:[1,1]
v_cvt_pk_bf16_f32 v112, v240, v241
v_cvt_pk_bf16_f32 v113, v242, v243
v_cvt_pk_bf16_f32 v114, v244, v245
v_cvt_pk_bf16_f32 v115, v246, v247
ds_read_b128 v[240:243], v238 offset:0
ds_read_b128 v[244:247], v238 offset:16
ds_write_b128 v7, v[112:115] offset:10240
v_pk_fma_f32 v[136:137], v[14:15], v[128:129], v[136:137] op_sel:[0,0,0] op_sel_hi:[0,1,1] neg_lo:[0,0,1] neg_hi:[0,0,1]
v_pk_fma_f32 v[138:139], v[14:15], v[130:131], v[138:139] op_sel:[0,0,0] op_sel_hi:[0,1,1] neg_lo:[0,0,1] neg_hi:[0,0,1]
v_pk_fma_f32 v[140:141], v[14:15], v[132:133], v[140:141] op_sel:[0,0,0] op_sel_hi:[0,1,1] neg_lo:[0,0,1] neg_hi:[0,0,1]
v_pk_fma_f32 v[142:143], v[14:15], v[134:135], v[142:143] op_sel:[0,0,0] op_sel_hi:[0,1,1] neg_lo:[0,0,1] neg_hi:[0,0,1]
s_waitcnt lgkmcnt(5)
v_pk_mul_f32 v[248:249], v[248:249], v[136:137] op_sel:[0,0] op_sel_hi:[1,1]
v_pk_mul_f32 v[250:251], v[250:251], v[138:139] op_sel:[0,0] op_sel_hi:[1,1]
s_waitcnt lgkmcnt(4)
v_pk_mul_f32 v[252:253], v[252:253], v[140:141] op_sel:[0,0] op_sel_hi:[1,1]
v_pk_mul_f32 v[254:255], v[254:255], v[142:143] op_sel:[0,0] op_sel_hi:[1,1]
v_cvt_pk_bf16_f32 v116, v248, v249
v_cvt_pk_bf16_f32 v117, v250, v251
v_cvt_pk_bf16_f32 v118, v252, v253
v_cvt_pk_bf16_f32 v119, v254, v255
ds_read_b128 v[248:251], v238 offset:128
ds_read_b128 v[252:255], v238 offset:144
ds_write_b128 v7, v[116:119] offset:11264
v_pk_fma_f32 v[128:129], v[14:15], v[136:137], v[128:129] op_sel:[0,0,0] op_sel_hi:[0,1,1] neg_lo:[0,0,1] neg_hi:[0,0,1]
v_pk_fma_f32 v[130:131], v[14:15], v[138:139], v[130:131] op_sel:[0,0,0] op_sel_hi:[0,1,1] neg_lo:[0,0,1] neg_hi:[0,0,1]
v_pk_fma_f32 v[132:133], v[14:15], v[140:141], v[132:133] op_sel:[0,0,0] op_sel_hi:[0,1,1] neg_lo:[0,0,1] neg_hi:[0,0,1]
v_pk_fma_f32 v[134:135], v[14:15], v[142:143], v[134:135] op_sel:[0,0,0] op_sel_hi:[0,1,1] neg_lo:[0,0,1] neg_hi:[0,0,1]
s_waitcnt lgkmcnt(5)
v_pk_mul_f32 v[240:241], v[240:241], v[128:129] op_sel:[0,0] op_sel_hi:[1,1]
v_pk_mul_f32 v[242:243], v[242:243], v[130:131] op_sel:[0,0] op_sel_hi:[1,1]
s_waitcnt lgkmcnt(4)
v_pk_mul_f32 v[244:245], v[244:245], v[132:133] op_sel:[0,0] op_sel_hi:[1,1]
v_pk_mul_f32 v[246:247], v[246:247], v[134:135] op_sel:[0,0] op_sel_hi:[1,1]
v_cvt_pk_bf16_f32 v120, v240, v241
v_cvt_pk_bf16_f32 v121, v242, v243
v_cvt_pk_bf16_f32 v122, v244, v245
v_cvt_pk_bf16_f32 v123, v246, v247
ds_write_b128 v7, v[120:123] offset:12288
v_pk_fma_f32 v[136:137], v[14:15], v[128:129], v[136:137] op_sel:[0,0,0] op_sel_hi:[0,1,1] neg_lo:[0,0,1] neg_hi:[0,0,1]
v_pk_fma_f32 v[138:139], v[14:15], v[130:131], v[138:139] op_sel:[0,0,0] op_sel_hi:[0,1,1] neg_lo:[0,0,1] neg_hi:[0,0,1]
v_pk_fma_f32 v[140:141], v[14:15], v[132:133], v[140:141] op_sel:[0,0,0] op_sel_hi:[0,1,1] neg_lo:[0,0,1] neg_hi:[0,0,1]
v_pk_fma_f32 v[142:143], v[14:15], v[134:135], v[142:143] op_sel:[0,0,0] op_sel_hi:[0,1,1] neg_lo:[0,0,1] neg_hi:[0,0,1]
s_waitcnt lgkmcnt(3)
v_pk_mul_f32 v[248:249], v[248:249], v[136:137] op_sel:[0,0] op_sel_hi:[1,1]
v_pk_mul_f32 v[250:251], v[250:251], v[138:139] op_sel:[0,0] op_sel_hi:[1,1]
s_waitcnt lgkmcnt(2)
v_pk_mul_f32 v[252:253], v[252:253], v[140:141] op_sel:[0,0] op_sel_hi:[1,1]
v_pk_mul_f32 v[254:255], v[254:255], v[142:143] op_sel:[0,0] op_sel_hi:[1,1]
v_cvt_pk_bf16_f32 v124, v248, v249
v_cvt_pk_bf16_f32 v125, v250, v251
v_cvt_pk_bf16_f32 v126, v252, v253
v_cvt_pk_bf16_f32 v127, v254, v255
ds_write_b128 v7, v[124:127] offset:13312
s_getpc_b64 s[10:11]
s_add_u32 s10, s10, kp_kernel@rel32@lo+4
s_addc_u32 s11, s11, kp_kernel@rel32@hi+12
s_mov_b32 s72, s10
s_and_b32 s73, s11, 0xffff
s_mov_b32 s74, 0x0
s_mov_b32 s75, 0x20000
s_mov_b32 s74, L_kp_hx-kp_kernel
s_getpc_b64 s[10:11]
s_add_u32 s10, s10, tab_fft@rel32@lo+4
s_addc_u32 s11, s11, tab_fft@rel32@hi+12
s_mov_b32 s60, s10
s_and_b32 s61, s11, 0xffff
s_mov_b32 s62, 0x9800
s_mov_b32 s63, 0x20000
s_lshr_b32 s12, s71, 3
v_lshlrev_b32 v202, 4, v0
s_mul_i32 s10, s12, 12288
s_mul_i32 s11, s12, 10240
buffer_load_dwordx4 v[144:147], v202, s[72:75], s10 offen
s_add_u32 s10, s10, 4096
buffer_load_dwordx4 v[148:151], v202, s[72:75], s10 offen
s_add_u32 s10, s10, 4096
buffer_load_dwordx4 v[152:155], v202, s[72:75], s10 offen
s_add_u32 s10, s10, 4096
buffer_load_dwordx4 v[128:131], v202, s[60:63], s11 offen
s_add_u32 s11, s11, 4096
buffer_load_dwordx4 v[132:135], v202, s[60:63], s11 offen
s_add_u32 s11, s11, 4096
buffer_load_dwordx4 v[136:139], v202, s[60:63], s11 offen
s_add_u32 s11, s11, 4096
v_and_b32 v6, 7, v1
v_mul_u32_u24 v200, 1800, v6
v_lshrrev_b32 v7, 3, v1
s_mul_i32 s13, s7, 56
v_add_u32 v7, s13, v7
v_lshlrev_b32 v201, 13, v7
v_lshl_add_u32 v201, v6, 4, v201
v_lshl_add_u32 v200, v7, 1, v200
v_mov_b32 v203, v200
v_cmp_eq_u32 vcc, 0, v7
v_add_u32 v7, 448, v200
s_nop 0
v_cndmask_b32 v203, v203, v7, vcc
s_lshl_b32 s13, s71, 8
s_add_u32 s13, s13, 20971520
s_waitcnt vmcnt(14)
s_waitcnt lgkmcnt(0)
s_barrier
ds_read_u16 v204, v203 offset:0
ds_read_u16 v160, v203 offset:15360
ds_read_u16 v205, v203 offset:450
ds_read_u16 v161, v203 offset:15810
ds_read_u16 v206, v203 offset:900
ds_read_u16 v162, v203 offset:16260
ds_read_u16 v207, v203 offset:1350
ds_read_u16 v163, v203 offset:16710
ds_read_u16 v208, v200 offset:16
ds_read_u16 v164, v200 offset:15376
ds_read_u16 v209, v200 offset:466
ds_read_u16 v165, v200 offset:15826
ds_read_u16 v210, v200 offset:916
ds_read_u16 v166, v200 offset:16276
ds_read_u16 v211, v200 offset:1366
ds_read_u16 v167, v200 offset:16726
s_waitcnt lgkmcnt(14)
v_lshl_or_b32 v204, v160, 16, v204
s_waitcnt lgkmcnt(12)
v_lshl_or_b32 v205, v161, 16, v205
s_waitcnt lgkmcnt(10)
v_lshl_or_b32 v206, v162, 16, v206
s_waitcnt lgkmcnt(8)
v_lshl_or_b32 v207, v163, 16, v207
buffer_store_dwordx4 v[204:207], v201, s[48:51], s13 offen sc1
s_add_u32 s13, s13, 0x10000
ds_read_u16 v212, v200 offset:32
ds_read_u16 v168, v200 offset:15392
ds_read_u16 v213, v200 offset:482
ds_read_u16 v169, v200 offset:15842
ds_read_u16 v214, v200 offset:932
ds_read_u16 v170, v200 offset:16292
ds_read_u16 v215, v200 offset:1382
ds_read_u16 v171, v200 offset:16742
s_waitcnt lgkmcnt(14)
v_lshl_or_b32 v208, v164, 16, v208
s_waitcnt lgkmcnt(12)
v_lshl_or_b32 v209, v165, 16, v209
s_waitcnt lgkmcnt(10)
v_lshl_or_b32 v210, v166, 16, v210
s_waitcnt lgkmcnt(8)
v_lshl_or_b32 v211, v167, 16, v211
buffer_store_dwordx4 v[208:211], v201, s[48:51], s13 offen sc1
s_add_u32 s13, s13, 0x10000
ds_read_u16 v216, v200 offset:48
ds_read_u16 v172, v200 offset:15408
ds_read_u16 v217, v200 offset:498
ds_read_u16 v173, v200 offset:15858
ds_read_u16 v218, v200 offset:948
ds_read_u16 v174, v200 offset:16308
ds_read_u16 v219, v200 offset:1398
ds_read_u16 v175, v200 offset:16758
s_waitcnt lgkmcnt(14)
v_lshl_or_b32 v212, v168, 16, v212
s_waitcnt lgkmcnt(12)
v_lshl_or_b32 v213, v169, 16, v213
s_waitcnt lgkmcnt(10)
v_lshl_or_b32 v214, v170, 16, v214
s_waitcnt lgkmcnt(8)
v_lshl_or_b32 v215, v171, 16, v215
buffer_store_dwordx4 v[212:215], v201, s[48:51], s13 offen sc1
s_add_u32 s13, s13, 0x10000
ds_read_u16 v220, v200 offset:64
ds_read_u16 v176, v200 offset:15424
ds_read_u16 v221, v200 offset:514
ds_read_u16 v177, v200 offset:15874
ds_read_u16 v222, v200 offset:964
ds_read_u16 v178, v200 offset:16324
ds_read_u16 v223, v200 offset:1414
ds_read_u16 v179, v200 offset:16774
s_waitcnt lgkmcnt(14)
v_lshl_or_b32 v216, v172, 16, v216
s_waitcnt lgkmcnt(12)
v_lshl_or_b32 v217, v173, 16, v217
s_waitcnt lgkmcnt(10)
v_lshl_or_b32 v218, v174, 16, v218
s_waitcnt lgkmcnt(8)
v_lshl_or_b32 v219, v175, 16, v219
buffer_store_dwordx4 v[216:219], v201, s[48:51], s13 offen sc1
s_add_u32 s13, s13, 0x10000
ds_read_u16 v224, v200 offset:80
ds_read_u16 v180, v200 offset:15440
ds_read_u16 v225, v200 offset:530
ds_read_u16 v181, v200 offset:15890
ds_read_u16 v226, v200 offset:980
ds_read_u16 v182, v200 offset:16340
ds_read_u16 v227, v200 offset:1430
ds_read_u16 v183, v200 offset:16790
s_waitcnt lgkmcnt(14)
v_lshl_or_b32 v220, v176, 16, v220
s_waitcnt lgkmcnt(12)
v_lshl_or_b32 v221, v177, 16, v221
s_waitcnt lgkmcnt(10)
v_lshl_or_b32 v222, v178, 16, v222
s_waitcnt lgkmcnt(8)
v_lshl_or_b32 v223, v179, 16, v223
buffer_store_dwordx4 v[220:223], v201, s[48:51], s13 offen sc1
s_add_u32 s13, s13, 0x10000
ds_read_u16 v228, v200 offset:96
ds_read_u16 v184, v200 offset:15456
ds_read_u16 v229, v200 offset:546
ds_read_u16 v185, v200 offset:15906
ds_read_u16 v230, v200 offset:996
ds_read_u16 v186, v200 offset:16356
ds_read_u16 v231, v200 offset:1446
ds_read_u16 v187, v200 offset:16806
s_waitcnt lgkmcnt(14)
v_lshl_or_b32 v224, v180, 16, v224
s_waitcnt lgkmcnt(12)
v_lshl_or_b32 v225, v181, 16, v225
s_waitcnt lgkmcnt(10)
v_lshl_or_b32 v226, v182, 16, v226
s_waitcnt lgkmcnt(8)
v_lshl_or_b32 v227, v183, 16, v227
buffer_store_dwordx4 v[224:227], v201, s[48:51], s13 offen sc1
s_add_u32 s13, s13, 0x10000
s_waitcnt lgkmcnt(6)
v_lshl_or_b32 v228, v184, 16, v228
s_waitcnt lgkmcnt(4)
v_lshl_or_b32 v229, v185, 16, v229
s_waitcnt lgkmcnt(2)
v_lshl_or_b32 v230, v186, 16, v230
s_waitcnt lgkmcnt(0)
v_lshl_or_b32 v231, v187, 16, v231
buffer_store_dwordx4 v[228:231], v201, s[48:51], s13 offen sc1
s_lshl_b32 s13, s71, 8
s_add_u32 s13, s13, 20971648
s_waitcnt vmcnt(13)
s_waitcnt lgkmcnt(0)
s_barrier
ds_read_u16 v204, v203 offset:30720
ds_read_u16 v160, v203 offset:46080
ds_read_u16 v205, v203 offset:31170
ds_read_u16 v161, v203 offset:46530
ds_read_u16 v206, v203 offset:31620
ds_read_u16 v162, v203 offset:46980
ds_read_u16 v207, v203 offset:32070
ds_read_u16 v163, v203 offset:47430
ds_read_u16 v208, v200 offset:30736
ds_read_u16 v164, v200 offset:46096
ds_read_u16 v209, v200 offset:31186
ds_read_u16 v165, v200 offset:46546
ds_read_u16 v210, v200 offset:31636
ds_read_u16 v166, v200 offset:46996
ds_read_u16 v211, v200 offset:32086
ds_read_u16 v167, v200 offset:47446
s_waitcnt lgkmcnt(14)
v_lshl_or_b32 v204, v160, 16, v204
s_waitcnt lgkmcnt(12)
v_lshl_or_b32 v205, v161, 16, v205
s_waitcnt lgkmcnt(10)
v_lshl_or_b32 v206, v162, 16, v206
s_waitcnt lgkmcnt(8)
v_lshl_or_b32 v207, v163, 16, v207
buffer_store_dwordx4 v[204:207], v201, s[48:51], s13 offen sc1
s_add_u32 s13, s13, 0x10000
ds_read_u16 v212, v200 offset:30752
ds_read_u16 v168, v200 offset:46112
ds_read_u16 v213, v200 offset:31202
ds_read_u16 v169, v200 offset:46562
ds_read_u16 v214, v200 offset:31652
ds_read_u16 v170, v200 offset:47012
ds_read_u16 v215, v200 offset:32102
ds_read_u16 v171, v200 offset:47462
s_waitcnt lgkmcnt(14)
v_lshl_or_b32 v208, v164, 16, v208
s_waitcnt lgkmcnt(12)
v_lshl_or_b32 v209, v165, 16, v209
s_waitcnt lgkmcnt(10)
v_lshl_or_b32 v210, v166, 16, v210
s_waitcnt lgkmcnt(8)
v_lshl_or_b32 v211, v167, 16, v211
buffer_store_dwordx4 v[208:211], v201, s[48:51], s13 offen sc1
s_add_u32 s13, s13, 0x10000
ds_read_u16 v216, v200 offset:30768
ds_read_u16 v172, v200 offset:46128
ds_read_u16 v217, v200 offset:31218
ds_read_u16 v173, v200 offset:46578
ds_read_u16 v218, v200 offset:31668
ds_read_u16 v174, v200 offset:47028
ds_read_u16 v219, v200 offset:32118
ds_read_u16 v175, v200 offset:47478
s_waitcnt lgkmcnt(14)
v_lshl_or_b32 v212, v168, 16, v212
s_waitcnt lgkmcnt(12)
v_lshl_or_b32 v213, v169, 16, v213
s_waitcnt lgkmcnt(10)
v_lshl_or_b32 v214, v170, 16, v214
s_waitcnt lgkmcnt(8)
v_lshl_or_b32 v215, v171, 16, v215
buffer_store_dwordx4 v[212:215], v201, s[48:51], s13 offen sc1
s_add_u32 s13, s13, 0x10000
ds_read_u16 v220, v200 offset:30784
ds_read_u16 v176, v200 offset:46144
ds_read_u16 v221, v200 offset:31234
ds_read_u16 v177, v200 offset:46594
ds_read_u16 v222, v200 offset:31684
ds_read_u16 v178, v200 offset:47044
ds_read_u16 v223, v200 offset:32134
ds_read_u16 v179, v200 offset:47494
s_waitcnt lgkmcnt(14)
v_lshl_or_b32 v216, v172, 16, v216
s_waitcnt lgkmcnt(12)
v_lshl_or_b32 v217, v173, 16, v217
s_waitcnt lgkmcnt(10)
v_lshl_or_b32 v218, v174, 16, v218
s_waitcnt lgkmcnt(8)
v_lshl_or_b32 v219, v175, 16, v219
buffer_store_dwordx4 v[216:219], v201, s[48:51], s13 offen sc1
s_add_u32 s13, s13, 0x10000
ds_read_u16 v224, v200 offset:30800
ds_read_u16 v180, v200 offset:46160
ds_read_u16 v225, v200 offset:31250
ds_read_u16 v181, v200 offset:46610
ds_read_u16 v226, v200 offset:31700
ds_read_u16 v182, v200 offset:47060
ds_read_u16 v227, v200 offset:32150
ds_read_u16 v183, v200 offset:47510
s_waitcnt lgkmcnt(14)
v_lshl_or_b32 v220, v176, 16, v220
s_waitcnt lgkmcnt(12)
v_lshl_or_b32 v221, v177, 16, v221
s_waitcnt lgkmcnt(10)
v_lshl_or_b32 v222, v178, 16, v222
s_waitcnt lgkmcnt(8)
v_lshl_or_b32 v223, v179, 16, v223
buffer_store_dwordx4 v[220:223], v201, s[48:51], s13 offen sc1
s_add_u32 s13, s13, 0x10000
ds_read_u16 v228, v200 offset:30816
ds_read_u16 v184, v200 offset:46176
ds_read_u16 v229, v200 offset:31266
ds_read_u16 v185, v200 offset:46626
ds_read_u16 v230, v200 offset:31716
ds_read_u16 v186, v200 offset:47076
ds_read_u16 v231, v200 offset:32166
ds_read_u16 v187, v200 offset:47526
s_waitcnt lgkmcnt(14)
v_lshl_or_b32 v224, v180, 16, v224
s_waitcnt lgkmcnt(12)
v_lshl_or_b32 v225, v181, 16, v225
s_waitcnt lgkmcnt(10)
v_lshl_or_b32 v226, v182, 16, v226
s_waitcnt lgkmcnt(8)
v_lshl_or_b32 v227, v183, 16, v227
buffer_store_dwordx4 v[224:227], v201, s[48:51], s13 offen sc1
s_add_u32 s13, s13, 0x10000
s_waitcnt lgkmcnt(6)
v_lshl_or_b32 v228, v184, 16, v228
s_waitcnt lgkmcnt(4)
v_lshl_or_b32 v229, v185, 16, v229
s_waitcnt lgkmcnt(2)
v_lshl_or_b32 v230, v186, 16, v230
s_waitcnt lgkmcnt(0)
v_lshl_or_b32 v231, v187, 16, v231
buffer_store_dwordx4 v[228:231], v201, s[48:51], s13 offen sc1
s_cmp_ge_u32 s71, 21
s_cbranch_scc1 L_k1_ex9
v_mov_b32 v13, 1.0
v_cmp_gt_u32 vcc, 16, v1
s_add_u32 s12, s4, s7
s_cmp_eq_u32 s12, 0
s_cselect_b64 vcc, vcc, 0
v_cndmask_b32 v13, v13, 0, vcc
v_add_u32 v5, 61440, v2
ds_read_b128 v[160:163], v5 offset:0
ds_read_b128 v[164:167], v5 offset:14336
ds_read_b128 v[168:171], v5 offset:28672
ds_read_b128 v[172:175], v5 offset:43008
s_waitcnt vmcnt(19) lgkmcnt(3)
v_mfma_f32_16x16x32_bf16 v[144:147], v[16:19], v[160:163], 0
ds_read_b128 v[176:179], v5 offset:1024
s_waitcnt vmcnt(18) lgkmcnt(3)
v_mfma_f32_16x16x32_bf16 v[148:151], v[16:19], v[164:167], 0
ds_read_b128 v[180:183], v5 offset:15360
s_waitcnt vmcnt(17) lgkmcnt(3)
v_mfma_f32_16x16x32_bf16 v[152:155], v[16:19], v[168:171], 0
ds_read_b128 v[184:187], v5 offset:29696
s_waitcnt lgkmcnt(3)
v_mfma_f32_16x16x32_bf16 v[156:159], v[16:19], v[172:175], 0
ds_read_b128 v[188:191], v5 offset:44032
s_waitcnt lgkmcnt(3)
v_mfma_f32_16x16x32_bf16 v[144:147], v[20:23], v[176:179], v[144:147]
ds_read_b128 v[160:163], v5 offset:2048
s_waitcnt lgkmcnt(3)
v_mfma_f32_16x16x32_bf16 v[148:151], v[20:23], v[180:183], v[148:151]
ds_read_b128 v[164:167], v5 offset:16384
s_waitcnt lgkmcnt(3)
v_mfma_f32_16x16x32_bf16 v[152:155], v[20:23], v[184:187], v[152:155]
ds_read_b128 v[168:171], v5 offset:30720
s_waitcnt lgkmcnt(3)
v_mfma_f32_16x16x32_bf16 v[156:159], v[20:23], v[188:191], v[156:159]
ds_read_b128 v[172:175], v5 offset:45056
s_waitcnt lgkmcnt(3)
v_mfma_f32_16x16x32_bf16 v[144:147], v[24:27], v[160:163], v[144:147]
ds_read_b128 v[176:179], v5 offset:3072
s_waitcnt lgkmcnt(3)
v_mfma_f32_16x16x32_bf16 v[148:151], v[24:27], v[164:167], v[148:151]
ds_read_b128 v[180:183], v5 offset:17408
s_waitcnt lgkmcnt(3)
v_mfma_f32_16x16x32_bf16 v[152:155], v[24:27], v[168:171], v[152:155]
ds_read_b128 v[184:187], v5 offset:31744
s_waitcnt lgkmcnt(3)
v_mfma_f32_16x16x32_bf16 v[156:159], v[24:27], v[172:175], v[156:159]
ds_read_b128 v[188:191], v5 offset:46080
s_waitcnt lgkmcnt(3)
v_mfma_f32_16x16x32_bf16 v[144:147], v[28:31], v[176:179], v[144:147]
ds_read_b128 v[160:163], v5 offset:4096
s_waitcnt lgkmcnt(3)
v_mfma_f32_16x16x32_bf16 v[148:151], v[28:31], v[180:183], v[148:151]
ds_read_b128 v[164:167], v5 offset:18432
s_waitcnt lgkmcnt(3)
v_mfma_f32_16x16x32_bf16 v[152:155], v[28:31], v[184:187], v[152:155]
ds_read_b128 v[168:171], v5 offset:32768
s_waitcnt lgkmcnt(3)
v_mfma_f32_16x16x32_bf16 v[156:159], v[28:31], v[188:191], v[156:159]
ds_read_b128 v[172:175], v5 offset:47104
s_waitcnt lgkmcnt(3)
v_mfma_f32_16x16x32_bf16 v[144:147], v[32:35], v[160:163], v[144:147]
ds_read_b128 v[176:179], v5 offset:5120
s_waitcnt lgkmcnt(3)
v_mfma_f32_16x16x32_bf16 v[148:151], v[32:35], v[164:167], v[148:151]
ds_read_b128 v[180:183], v5 offset:19456
s_waitcnt lgkmcnt(3)
v_mfma_f32_16x16x32_bf16 v[152:155], v[32:35], v[168:171], v[152:155]
ds_read_b128 v[184:187], v5 offset:33792
s_waitcnt lgkmcnt(3)
v_mfma_f32_16x16x32_bf16 v[156:159], v[32:35], v[172:175], v[156:159]
ds_read_b128 v[188:191], v5 offset:48128
s_waitcnt lgkmcnt(3)
v_mfma_f32_16x16x32_bf16 v[144:147], v[36:39], v[176:179], v[144:147]
ds_read_b128 v[160:163], v5 offset:6144
s_waitcnt lgkmcnt(3)
v_mfma_f32_16x16x32_bf16 v[148:151], v[36:39], v[180:183], v[148:151]
ds_read_b128 v[164:167], v5 offset:20480
s_waitcnt lgkmcnt(3)
v_mfma_f32_16x16x32_bf16 v[152:155], v[36:39], v[184:187], v[152:155]
ds_read_b128 v[168:171], v5 offset:34816
s_waitcnt lgkmcnt(3)
v_mfma_f32_16x16x32_bf16 v[156:159], v[36:39], v[188:191], v[156:159]
ds_read_b128 v[172:175], v5 offset:49152
s_waitcnt lgkmcnt(3)
v_mfma_f32_16x16x32_bf16 v[144:147], v[40:43], v[160:163], v[144:147]
ds_read_b128 v[176:179], v5 offset:7168
s_waitcnt lgkmcnt(3)
v_mfma_f32_16x16x32_bf16 v[148:151], v[40:43], v[164:167], v[148:151]
ds_read_b128 v[180:183], v5 offset:21504
s_waitcnt lgkmcnt(3)
v_mfma_f32_16x16x32_bf16 v[152:155], v[40:43], v[168:171], v[152:155]
ds_read_b128 v[184:187], v5 offset:35840
s_waitcnt lgkmcnt(3)
v_mfma_f32_16x16x32_bf16 v[156:159], v[40:43], v[172:175], v[156:159]
ds_read_b128 v[188:191], v5 offset:50176
s_waitcnt lgkmcnt(3)
v_mfma_f32_16x16x32_bf16 v[144:147], v[44:47], v[176:179], v[144:147]
ds_read_b128 v[160:163], v5 offset:8192
s_waitcnt lgkmcnt(3)
v_mfma_f32_16x16x32_bf16 v[148:151], v[44:47], v[180:183], v[148:151]
ds_read_b128 v[164:167], v5 offset:22528
s_waitcnt lgkmcnt(3)
v_mfma_f32_16x16x32_bf16 v[152:155], v[44:47], v[184:187], v[152:155]
ds_read_b128 v[168:171], v5 offset:36864
s_waitcnt lgkmcnt(3)
v_mfma_f32_16x16x32_bf16 v[156:159], v[44:47], v[188:191], v[156:159]
ds_read_b128 v[172:175], v5 offset:51200
s_waitcnt lgkmcnt(3)
v_mfma_f32_16x16x32_bf16 v[144:147], v[48:51], v[160:163], v[144:147]
ds_read_b128 v[176:179], v5 offset:9216
s_waitcnt lgkmcnt(3)
v_mfma_f32_16x16x32_bf16 v[148:151], v[48:51], v[164:167], v[148:151]
ds_read_b128 v[180:183], v5 offset:23552
s_waitcnt lgkmcnt(3)
v_mfma_f32_16x16x32_bf16 v[152:155], v[48:51], v[168:171], v[152:155]
ds_read_b128 v[184:187], v5 offset:37888
s_waitcnt lgkmcnt(3)
v_mfma_f32_16x16x32_bf16 v[156:159], v[48:51], v[172:175], v[156:159]
ds_read_b128 v[188:191], v5 offset:52224
s_waitcnt lgkmcnt(3)
v_mfma_f32_16x16x32_bf16 v[144:147], v[52:55], v[176:179], v[144:147]
ds_read_b128 v[160:163], v5 offset:10240
s_waitcnt lgkmcnt(3)
v_mfma_f32_16x16x32_bf16 v[148:151], v[52:55], v[180:183], v[148:151]
ds_read_b128 v[164:167], v5 offset:24576
s_waitcnt lgkmcnt(3)
v_mfma_f32_16x16x32_bf16 v[152:155], v[52:55], v[184:187], v[152:155]
ds_read_b128 v[168:171], v5 offset:38912
s_waitcnt lgkmcnt(3)
v_mfma_f32_16x16x32_bf16 v[156:159], v[52:55], v[188:191], v[156:159]
ds_read_b128 v[172:175], v5 offset:53248
s_waitcnt lgkmcnt(3)
v_mfma_f32_16x16x32_bf16 v[144:147], v[56:59], v[160:163], v[144:147]
ds_read_b128 v[176:179], v5 offset:11264
s_waitcnt lgkmcnt(3)
v_mfma_f32_16x16x32_bf16 v[148:151], v[56:59], v[164:167], v[148:151]
ds_read_b128 v[180:183], v5 offset:25600
s_waitcnt lgkmcnt(3)
v_mfma_f32_16x16x32_bf16 v[152:155], v[56:59], v[168:171], v[152:155]
ds_read_b128 v[184:187], v5 offset:39936
s_waitcnt lgkmcnt(3)
v_mfma_f32_16x16x32_bf16 v[156:159], v[56:59], v[172:175], v[156:159]
ds_read_b128 v[188:191], v5 offset:54272
s_waitcnt lgkmcnt(3)
v_mfma_f32_16x16x32_bf16 v[144:147], v[60:63], v[176:179], v[144:147]
ds_read_b128 v[160:163], v5 offset:12288
s_waitcnt lgkmcnt(3)
v_mfma_f32_16x16x32_bf16 v[148:151], v[60:63], v[180:183], v[148:151]
ds_read_b128 v[164:167], v5 offset:26624
s_waitcnt lgkmcnt(3)
v_mfma_f32_16x16x32_bf16 v[152:155], v[60:63], v[184:187], v[152:155]
ds_read_b128 v[168:171], v5 offset:40960
s_waitcnt lgkmcnt(3)
v_mfma_f32_16x16x32_bf16 v[156:159], v[60:63], v[188:191], v[156:159]
ds_read_b128 v[172:175], v5 offset:55296
s_waitcnt lgkmcnt(3)
v_mfma_f32_16x16x32_bf16 v[144:147], v[64:67], v[160:163], v[144:147]
ds_read_b128 v[176:179], v5 offset:13312
s_waitcnt lgkmcnt(3)
v_mfma_f32_16x16x32_bf16 v[148:151], v[64:67], v[164:167], v[148:151]
ds_read_b128 v[180:183], v5 offset:27648
s_waitcnt lgkmcnt(3)
v_mfma_f32_16x16x32_bf16 v[152:155], v[64:67], v[168:171], v[152:155]
ds_read_b128 v[184:187], v5 offset:41984
s_waitcnt lgkmcnt(3)
v_mfma_f32_16x16x32_bf16 v[156:159], v[64:67], v[172:175], v[156:159]
ds_read_b128 v[188:191], v5 offset:56320
s_waitcnt lgkmcnt(3)
v_mfma_f32_16x16x32_bf16 v[144:147], v[68:71], v[176:179], v[144:147]
s_waitcnt lgkmcnt(2)
v_mfma_f32_16x16x32_bf16 v[148:151], v[68:71], v[180:183], v[148:151]
s_waitcnt lgkmcnt(1)
v_mfma_f32_16x16x32_bf16 v[152:155], v[68:71], v[184:187], v[152:155]
s_waitcnt lgkmcnt(0)
v_mfma_f32_16x16x32_bf16 v[156:159], v[68:71], v[188:191], v[156:159]
s_lshl_b32 s13, s8, 1
s_and_b32 s14, s7, 1
s_add_u32 s13, s13, s14
s_mul_i32 s13, s13, 28
s_lshl_b32 s14, s4, 1
s_add_u32 s13, s13, s14
s_lshr_b32 s14, s7, 1
s_add_u32 s13, s13, s14
s_lshl_b32 s13, s13, 10
s_add_u32 s13, s13, 24117248
v_mul_f32 v144, v144, v13
v_cvt_pk_bf16_f32 v160, v144, v145
v_cvt_pk_bf16_f32 v161, v146, v147
v_mul_f32 v148, v148, v13
v_cvt_pk_bf16_f32 v162, v148, v149
v_cvt_pk_bf16_f32 v163, v150, v151
v_mul_f32 v152, v152, v13
v_cvt_pk_bf16_f32 v164, v152, v153
v_cvt_pk_bf16_f32 v165, v154, v155
v_mul_f32 v156, v156, v13
v_cvt_pk_bf16_f32 v166, v156, v157
v_cvt_pk_bf16_f32 v167, v158, v159
s_lshl_b32 s12, s7, 10
s_add_u32 s12, s12, 0
v_add_u32 v6, s12, v2
v_xor_b32 v7, 1024, v6
s_add_u32 s14, s13, 14336
s_bitcmp1_b32 s7, 0
s_cbranch_scc1 L_k1_po10
ds_write_b128 v6, v[164:167]
v_mov_b32 v168, v160
v_mov_b32 v169, v161
v_mov_b32 v172, v162
v_mov_b32 v173, v163
s_waitcnt lgkmcnt(0)
s_barrier
ds_read_b64 v[170:171], v7
ds_read_b64 v[174:175], v7 offset:8
s_branch L_k1_po11
L_k1_po10:
ds_write_b128 v6, v[160:163]
v_mov_b32 v170, v164
v_mov_b32 v171, v165
v_mov_b32 v174, v166
v_mov_b32 v175, v167
s_waitcnt lgkmcnt(0)
s_barrier
ds_read_b64 v[168:169], v7
ds_read_b64 v[172:173], v7 offset:8
L_k1_po11:
s_waitcnt lgkmcnt(0)
buffer_store_dwordx4 v[168:171], v2, s[48:51], s13 offen sc1
buffer_store_dwordx4 v[172:175], v2, s[48:51], s14 offen sc1
L_k1_ex9:
s_endpgm
L_k1_x2:
L_k1_end:
s_endpgm
.globl kp_kernel
.p2align 8
.type kp_kernel,@function
kp_kernel:
s_load_dwordx2 s[44:45], s[0:1], 112
s_load_dwordx4 s[60:63], s[0:1], 32
s_load_dwordx4 s[64:67], s[0:1], 80
s_load_dwordx4 s[40:43], s[0:1], 96
s_cmp_lt_u32 s2, 32
s_cbranch_scc1 L_kp_help
s_cmp_ge_u32 s2, 256
s_cbranch_scc1 L_kp_hx
s_sub_u32 s19, s2, 32
v_lshrrev_b32 v54, 6, v0
v_and_b32 v1, 63, v0
v_readfirstlane_b32 s7, v54
s_getpc_b64 s[20:21]
s_add_u32 s20, s20, tab_fft@rel32@lo+4
s_addc_u32 s21, s21, tab_fft@rel32@hi+12
s_mov_b32 s52, s20
s_and_b32 s53, s21, 0xffff
s_mov_b32 s54, 0x9800
s_mov_b32 s55, 0x20000
v_lshlrev_b32 v2, 4, v1
s_lshl_b32 s3, s7, 13
s_add_u32 s6, s3, 4096
buffer_load_dwordx4 a[216:219], v2, s[52:55], s3 offen offset:0
buffer_load_dwordx4 a[220:223], v2, s[52:55], s3 offen offset:1024
buffer_load_dwordx4 a[224:227], v2, s[52:55], s3 offen offset:2048
buffer_load_dwordx4 a[228:231], v2, s[52:55], s3 offen offset:3072
s_lshl_b32 s68, s19, 1
s_add_u32 s69, s68, 1
s_cmp_eq_u32 s19, 0
s_cselect_b32 s68, 1, s68
s_cselect_b32 s69, 0, s69
s_cselect_b32 s70, 0, 1.0
s_lshl_b32 s68, s68, 12
s_lshl_b32 s69, s69, 12
v_and_b32 v11, 15, v1
v_lshrrev_b32 v10, 4, v1
s_lshl_b32 s18, s7, 4
v_add_u32 v54, s18, v11
v_lshlrev_b32 v3, 6, v54
v_lshl_add_u32 v3, v10, 4, v3
v_lshrrev_b32 v55, 1, v10
v_and_b32 v56, 1, v10
v_lshl_or_b32 v56, v56, 1, v55
v_lshlrev_b32 v55, 12, v55
v_lshl_add_u32 v55, v56, 9, v55
v_lshl_add_u32 v240, v54, 2, v55
v_xor_b32 v241, 512, v240
s_lshr_b32 s14, s19, 3
s_mul_i32 s12, s14, 37
s_lshr_b32 s12, s12, 8
s_mul_i32 s13, s12, 7
s_sub_u32 s13, s14, s13
s_lshl_b32 s12, s12, 3
s_and_b32 s14, s19, 7
s_add_u32 s12, s12, s14
s_lshl_b32 s21, s19, 13
s_add_u32 s21, s21, 20971520
s_waitcnt lgkmcnt(0)
s_mov_b32 s48, s44
s_and_b32 s49, s45, 0xffff
s_mov_b32 s50, 0x2000000
s_mov_b32 s51, 0x20000
s_add_u32 s17, s68, 0
s_add_u32 s18, s69, 0
s_mov_b32 s14, 27328512
buffer_load_dwordx4 v[112:115], v3, s[48:51], s14 offen
s_add_u32 s14, s14, 4096
buffer_load_dwordx4 v[116:119], v3, s[48:51], s14 offen
s_add_u32 s14, s14, 4096
buffer_load_dwordx4 v[120:123], v3, s[48:51], s14 offen
s_add_u32 s14, s14, 4096
buffer_load_dwordx4 v[124:127], v3, s[48:51], s14 offen
s_add_u32 s14, s14, 4096
buffer_load_dwordx4 v[128:131], v3, s[48:51], s14 offen
s_add_u32 s14, s14, 4096
buffer_load_dwordx4 v[132:135], v3, s[48:51], s14 offen
s_add_u32 s14, s14, 4096
buffer_load_dwordx4 v[136:139], v3, s[48:51], s14 offen
buffer_load_dwordx4 v[104:107], v3, s[48:51], s17 offen
buffer_load_dwordx4 v[108:111], v3, s[48:51], s18 offen
v_bfe_u32 v55, v1, 2, 2
v_lshl_add_u32 v54, v10, 3, v55
v_lshlrev_b32 v4, 6, v54
v_and_b32 v54, 3, v1
v_lshl_add_u32 v4, v54, 4, v4
v_lshl_add_u32 v56, v55, 3, v54
v_mul_u32_u24 v56, 144, v56
v_lshl_add_u32 v6, v10, 4, v56
v_lshl_add_u32 v5, v10, 3, v56
s_lshl_b32 s14, s7, 5
v_add_u32 v5, s14, v5
s_lshr_b32 s15, s7, 1
s_and_b32 s16, s7, 1
v_lshrrev_b32 v54, 7, v3
v_mul_u32_u24 v54, 57344, v54
v_and_b32 v55, 127, v3
v_add_u32 v248, v54, v55
v_lshrrev_b32 v54, 3, v1
v_lshlrev_b32 v54, 7, v54
v_and_b32 v55, 1, v10
v_and_b32 v56, 7, v1
v_xor_b32 v7, v55, v56
s_lshl_b32 s14, s16, 1
v_xor_b32 v7, s14, v7
v_lshl_add_u32 v7, v7, 4, v54
s_lshl_b32 s17, s13, 2
s_add_u32 s17, s17, s7
s_lshl_b32 s14, s17, 4
v_add_u32 v9, s14, v11
v_lshlrev_b32 v20, 1, v9
v_lshlrev_b32 v9, 4, v9
s_lshl_b32 s71, s12, 7
s_mul_i32 s11, s17, 14336
s_lshl_b32 s14, s11, 1
s_add_u32 s14, s14, 23068672
v_add_u32 v252, s14, v2
v_add_u32 v253, 14336, v252
s_add_u32 s14, s11, 24117248
v_add_u32 v254, s14, v2
s_lshr_b32 s46, s12, 3
s_mul_i32 s46, s46, 7
s_add_u32 s46, s46, 1
s_lshr_b32 s46, s46, 1
s_lshl_b32 s14, s13, 1
s_add_u32 s14, s14, s46
s_sub_u32 s17, s14, 14
s_cselect_b32 s14, s14, s17
s_lshl_b32 s24, s14, 10
s_sub_u32 s14, 14, s14
s_cmp_eq_u32 s14, 14
s_cselect_b32 s14, 0, s14
s_lshl_b32 s38, s14, 12
s_add_u32 s25, s24, 1024
s_cmp_eq_u32 s25, 14336
s_cselect_b32 s25, 0, s25
buffer_load_dword a248, v240, s[48:51], s21 offen offset:0
s_add_u32 s26, s25, 1024
s_cmp_eq_u32 s26, 14336
s_cselect_b32 s26, 0, s26
s_add_u32 s27, s26, 1024
s_cmp_eq_u32 s27, 14336
s_cselect_b32 s27, 0, s27
s_add_u32 s28, s27, 1024
buffer_load_dword a249, v240, s[48:51], s21 offen offset:2048
s_cmp_eq_u32 s28, 14336
s_cselect_b32 s28, 0, s28
s_add_u32 s29, s28, 1024
s_cmp_eq_u32 s29, 14336
s_cselect_b32 s29, 0, s29
s_add_u32 s30, s29, 1024
buffer_load_dword a250, v240, s[48:51], s21 offen offset:256
s_cmp_eq_u32 s30, 14336
s_cselect_b32 s30, 0, s30
s_add_u32 s31, s30, 1024
s_cmp_eq_u32 s31, 14336
s_cselect_b32 s31, 0, s31
s_add_u32 s32, s31, 1024
s_cmp_eq_u32 s32, 14336
s_cselect_b32 s32, 0, s32
buffer_load_dword a251, v240, s[48:51], s21 offen offset:2304
s_add_u32 s33, s32, 1024
s_cmp_eq_u32 s33, 14336
s_cselect_b32 s33, 0, s33
s_add_u32 s34, s33, 1024
s_cmp_eq_u32 s34, 14336
s_cselect_b32 s34, 0, s34
buffer_load_dword a252, v241, s[48:51], s21 offen offset:0
s_add_u32 s35, s34, 1024
s_cmp_eq_u32 s35, 14336
s_cselect_b32 s35, 0, s35
s_add_u32 s36, s35, 1024
s_cmp_eq_u32 s36, 14336
s_cselect_b32 s36, 0, s36
buffer_load_dword a253, v241, s[48:51], s21 offen offset:2048
s_add_u32 s37, s36, 1024
s_cmp_eq_u32 s37, 14336
s_cselect_b32 s37, 0, s37
v_lshrrev_b32 v54, 6, v3
v_cvt_f32_u32 v54, v54
v_cvt_f32_u32 v55, v10
v_mul_f32 v54, 0x3c800000, v54
buffer_load_dword a254, v241, s[48:51], s21 offen offset:256
v_mul_f32 v55, 0x41000000, v55
v_mul_f32 v55, v55, v54
v_fmamk_f32 v56, v54, 0x00000000, v55
v_fmamk_f32 v57, v54, 0x3f800000, v55
v_fmamk_f32 v58, v54, 0x40000000, v55
v_fmamk_f32 v59, v54, 0x40400000, v55
v_fmamk_f32 v60, v54, 0x40800000, v55
buffer_load_dword a255, v241, s[48:51], s21 offen offset:2304
v_fmamk_f32 v61, v54, 0x40a00000, v55
v_fmamk_f32 v62, v54, 0x40c00000, v55
v_fmamk_f32 v63, v54, 0x40e00000, v55
v_cos_f32 v64, v56
v_cos_f32 v65, v57
v_cos_f32 v66, v58
v_cos_f32 v67, v59
s_mov_b32 s5, 32768
buffer_load_dwordx4 a[192:195], v2, s[52:55], s5 offen offset:0
v_cos_f32 v68, v60
v_cos_f32 v69, v61
v_cos_f32 v70, v62
v_cos_f32 v71, v63
v_sin_f32 v72, v56
v_sin_f32 v73, v57
buffer_load_dwordx4 a[196:199], v2, s[52:55], s5 offen offset:1024
v_sin_f32 v74, v58
v_sin_f32 v75, v59
v_sin_f32 v76, v60
v_sin_f32 v77, v61
v_sin_f32 v78, v62
v_sin_f32 v79, v63
v_cvt_pk_bf16_f32 v80, v64, v65
buffer_load_dwordx4 a[200:203], v2, s[52:55], s5 offen offset:2048
v_cvt_pk_bf16_f32 v81, v66, v67
v_cvt_pk_bf16_f32 v82, v68, v69
v_cvt_pk_bf16_f32 v83, v70, v71
v_cvt_pk_bf16_f32 v84, v72, v73
v_cvt_pk_bf16_f32 v85, v74, v75
v_cvt_pk_bf16_f32 v86, v76, v77
v_cvt_pk_bf16_f32 v87, v78, v79
buffer_load_dwordx4 a[204:207], v2, s[52:55], s5 offen offset:3072
v_accvgpr_write_b32 a168, v80
v_accvgpr_write_b32 a169, v81
v_accvgpr_write_b32 a170, v82
v_accvgpr_write_b32 a171, v83
v_xor_b32 v88, 0x80008000, v84
v_xor_b32 v89, 0x80008000, v85
v_xor_b32 v90, 0x80008000, v86
s_mov_b32 s5, 36864
buffer_load_dwordx4 a[208:211], v2, s[52:55], s5 offen offset:0
v_xor_b32 v91, 0x80008000, v87
v_accvgpr_write_b32 a176, v84
v_accvgpr_write_b32 a177, v85
v_accvgpr_write_b32 a178, v86
v_accvgpr_write_b32 a179, v87
v_accvgpr_write_b32 a184, v88
buffer_load_dwordx4 a[212:215], v2, s[52:55], s5 offen offset:1024
v_accvgpr_write_b32 a185, v89
v_accvgpr_write_b32 a186, v90
v_accvgpr_write_b32 a187, v91
v_and_b32 v92, 1, v1
v_mul_u32_u24 v92, 0x8000, v92
v_lshl_or_b32 v92, v92, 16, v92
v_xor_b32 v80, v92, v80
buffer_load_dwordx4 a[232:235], v2, s[52:55], s6 offen offset:0
v_xor_b32 v81, v92, v81
v_xor_b32 v82, v92, v82
v_xor_b32 v83, v92, v83
v_xor_b32 v84, v92, v84
v_xor_b32 v85, v92, v85
v_xor_b32 v86, v92, v86
v_xor_b32 v87, v92, v87
buffer_load_dwordx4 a[236:239], v2, s[52:55], s6 offen offset:1024
v_xor_b32 v88, v92, v88
v_xor_b32 v89, v92, v89
v_xor_b32 v90, v92, v90
v_xor_b32 v91, v92, v91
v_accvgpr_write_b32 a172, v80
v_accvgpr_write_b32 a173, v81
buffer_load_dwordx4 a[240:243], v2, s[52:55], s6 offen offset:2048
v_accvgpr_write_b32 a174, v82
v_accvgpr_write_b32 a175, v83
v_accvgpr_write_b32 a180, v84
v_accvgpr_write_b32 a181, v85
v_accvgpr_write_b32 a182, v86
v_accvgpr_write_b32 a183, v87
v_accvgpr_write_b32 a188, v88
buffer_load_dwordx4 a[244:247], v2, s[52:55], s6 offen offset:3072
v_accvgpr_write_b32 a189, v89
v_accvgpr_write_b32 a190, v90
v_accvgpr_write_b32 a191, v91
s_mov_b32 s17, 0x00003f80
s_mov_b32 s18, 0x3f800000
s_mov_b32 s4, 0x3b124925
s_mov_b32 s5, 0x3727c5ac
v_mov_b32 v164, s5
s_waitcnt vmcnt(26)
v_dot2_f32_bf16 v140, v112, s17, 0
v_dot2_f32_bf16 v141, v112, s18, 0
v_dot2_f32_bf16 v142, v113, s17, 0
v_dot2_f32_bf16 v143, v113, s18, 0
v_dot2_f32_bf16 v144, v114, s17, 0
v_dot2_f32_bf16 v145, v114, s18, 0
v_dot2_f32_bf16 v146, v115, s17, 0
v_dot2_f32_bf16 v147, v115, s18, 0
s_waitcnt vmcnt(25)
v_dot2_f32_bf16 v140, v116, s17, v140
v_dot2_f32_bf16 v141, v116, s18, v141
v_dot2_f32_bf16 v142, v117, s17, v142
v_dot2_f32_bf16 v143, v117, s18, v143
v_dot2_f32_bf16 v144, v118, s17, v144
v_dot2_f32_bf16 v145, v118, s18, v145
v_dot2_f32_bf16 v146, v119, s17, v146
v_dot2_f32_bf16 v147, v119, s18, v147
s_waitcnt vmcnt(24)
v_dot2_f32_bf16 v140, v120, s17, v140
v_dot2_f32_bf16 v141, v120, s18, v141
v_dot2_f32_bf16 v142, v121, s17, v142
v_dot2_f32_bf16 v143, v121, s18, v143
v_dot2_f32_bf16 v144, v122, s17, v144
v_dot2_f32_bf16 v145, v122, s18, v145
v_dot2_f32_bf16 v146, v123, s17, v146
v_dot2_f32_bf16 v147, v123, s18, v147
s_waitcnt vmcnt(23)
v_dot2_f32_bf16 v140, v124, s17, v140
v_dot2_f32_bf16 v141, v124, s18, v141
v_dot2_f32_bf16 v142, v125, s17, v142
v_dot2_f32_bf16 v143, v125, s18, v143
v_dot2_f32_bf16 v144, v126, s17, v144
v_dot2_f32_bf16 v145, v126, s18, v145
v_dot2_f32_bf16 v146, v127, s17, v146
v_dot2_f32_bf16 v147, v127, s18, v147
s_waitcnt vmcnt(22)
v_dot2_f32_bf16 v140, v128, s17, v140
v_dot2_f32_bf16 v141, v128, s18, v141
v_dot2_f32_bf16 v142, v129, s17, v142
v_dot2_f32_bf16 v143, v129, s18, v143
v_dot2_f32_bf16 v144, v130, s17, v144
v_dot2_f32_bf16 v145, v130, s18, v145
v_dot2_f32_bf16 v146, v131, s17, v146
v_dot2_f32_bf16 v147, v131, s18, v147
s_waitcnt vmcnt(21)
v_dot2_f32_bf16 v140, v132, s17, v140
v_dot2_f32_bf16 v141, v132, s18, v141
v_dot2_f32_bf16 v142, v133, s17, v142
v_dot2_f32_bf16 v143, v133, s18, v143
v_dot2_f32_bf16 v144, v134, s17, v144
v_dot2_f32_bf16 v145, v134, s18, v145
v_dot2_f32_bf16 v146, v135, s17, v146
v_dot2_f32_bf16 v147, v135, s18, v147
s_waitcnt vmcnt(20)
v_dot2_f32_bf16 v140, v136, s17, v140
v_dot2_f32_bf16 v141, v136, s18, v141
v_dot2_f32_bf16 v142, v137, s17, v142
v_dot2_f32_bf16 v143, v137, s18, v143
v_dot2_f32_bf16 v144, v138, s17, v144
v_dot2_f32_bf16 v145, v138, s18, v145
v_dot2_f32_bf16 v146, v139, s17, v146
v_dot2_f32_bf16 v147, v139, s18, v147
s_waitcnt vmcnt(19)
v_lshlrev_b32 v148, 16, v104
v_and_b32 v149, 0xffff0000, v104
v_lshlrev_b32 v150, 16, v105
v_and_b32 v151, 0xffff0000, v105
v_lshlrev_b32 v152, 16, v106
v_and_b32 v153, 0xffff0000, v106
v_lshlrev_b32 v154, 16, v107
v_and_b32 v155, 0xffff0000, v107
v_pk_fma_f32 v[140:141], v[140:141], s[4:5], v[164:165] op_sel:[0,0,0] op_sel_hi:[1,0,0]
v_pk_fma_f32 v[142:143], v[142:143], s[4:5], v[164:165] op_sel:[0,0,0] op_sel_hi:[1,0,0]
v_pk_fma_f32 v[144:145], v[144:145], s[4:5], v[164:165] op_sel:[0,0,0] op_sel_hi:[1,0,0]
v_pk_fma_f32 v[146:147], v[146:147], s[4:5], v[164:165] op_sel:[0,0,0] op_sel_hi:[1,0,0]
v_rsq_f32 v140, v140
v_rsq_f32 v141, v141
v_rsq_f32 v142, v142
v_rsq_f32 v143, v143
v_rsq_f32 v144, v144
v_rsq_f32 v145, v145
v_rsq_f32 v146, v146
v_rsq_f32 v147, v147
s_waitcnt vmcnt(18)
v_lshlrev_b32 v156, 16, v108
v_and_b32 v157, 0xffff0000, v108
v_lshlrev_b32 v158, 16, v109
v_and_b32 v159, 0xffff0000, v109
buffer_load_dwordx4 a[0:3], v252, s[48:51], s24 offen
v_lshlrev_b32 v160, 16, v110
v_and_b32 v161, 0xffff0000, v110
v_lshlrev_b32 v162, 16, v111
v_and_b32 v163, 0xffff0000, v111
v_pk_mul_f32 v[164:165], v[148:149], v[140:141] op_sel:[0,0] op_sel_hi:[1,1]
v_pk_mul_f32 v[166:167], v[150:151], v[142:143] op_sel:[0,0] op_sel_hi:[1,1]
v_pk_mul_f32 v[168:169], v[152:153], v[144:145] op_sel:[0,0] op_sel_hi:[1,1]
v_pk_mul_f32 v[170:171], v[154:155], v[146:147] op_sel:[0,0] op_sel_hi:[1,1]
v_cvt_pk_bf16_f32 v180, v164, v165
v_cvt_pk_bf16_f32 v181, v166, v167
v_cvt_pk_bf16_f32 v182, v168, v169
v_cvt_pk_bf16_f32 v183, v170, v171
ds_write_b128 v3, v[180:183]
v_pk_mul_f32 v[140:141], s[70:71], v[140:141] op_sel:[0,0] op_sel_hi:[0,1]
v_pk_mul_f32 v[142:143], s[70:71], v[142:143] op_sel:[0,0] op_sel_hi:[0,1]
v_pk_mul_f32 v[144:145], s[70:71], v[144:145] op_sel:[0,0] op_sel_hi:[0,1]
v_pk_mul_f32 v[146:147], s[70:71], v[146:147] op_sel:[0,0] op_sel_hi:[0,1]
v_pk_mul_f32 v[172:173], v[156:157], v[140:141] op_sel:[0,0] op_sel_hi:[1,1]
buffer_load_dwordx4 a[4:7], v253, s[48:51], s24 offen
v_pk_mul_f32 v[174:175], v[158:159], v[142:143] op_sel:[0,0] op_sel_hi:[1,1]
v_pk_mul_f32 v[176:177], v[160:161], v[144:145] op_sel:[0,0] op_sel_hi:[1,1]
v_pk_mul_f32 v[178:179], v[162:163], v[146:147] op_sel:[0,0] op_sel_hi:[1,1]
v_cvt_pk_bf16_f32 v184, v172, v173
v_cvt_pk_bf16_f32 v185, v174, v175
v_cvt_pk_bf16_f32 v186, v176, v177
v_cvt_pk_bf16_f32 v187, v178, v179
ds_write_b128 v3, v[184:187] offset:4096
s_waitcnt lgkmcnt(0)
s_barrier
ds_read_b64_tr_b16 v[56:57], v4 offset:0
ds_read_b64_tr_b16 v[58:59], v4 offset:256
ds_read_b64_tr_b16 v[72:73], v4 offset:4096
ds_read_b64_tr_b16 v[74:75], v4 offset:4352
ds_read_b64_tr_b16 v[64:65], v4 offset:8
ds_read_b64_tr_b16 v[66:67], v4 offset:264
ds_read_b64_tr_b16 v[80:81], v4 offset:4104
ds_read_b64_tr_b16 v[82:83], v4 offset:4360
ds_read_b64_tr_b16 v[60:61], v4 offset:2048
ds_read_b64_tr_b16 v[62:63], v4 offset:2304
ds_read_b64_tr_b16 v[76:77], v4 offset:6144
ds_read_b64_tr_b16 v[78:79], v4 offset:6400
ds_read_b64_tr_b16 v[68:69], v4 offset:2056
ds_read_b64_tr_b16 v[70:71], v4 offset:2312
ds_read_b64_tr_b16 v[84:85], v4 offset:6152
ds_read_b64_tr_b16 v[86:87], v4 offset:6408
s_waitcnt lgkmcnt(14)
v_mfma_f32_16x16x32_bf16 v[88:91], v[56:59], a[168:171], 0
v_accvgpr_read_b32 v188, a216
v_accvgpr_read_b32 v189, a217
s_waitcnt lgkmcnt(12)
v_mfma_f32_16x16x32_bf16 v[96:99], v[72:75], a[168:171], 0
v_accvgpr_read_b32 v190, a218
v_accvgpr_read_b32 v191, a219
v_mfma_f32_16x16x32_bf16 v[88:91], v[72:75], a[176:179], v[88:91]
buffer_load_dwordx4 a[8:11], v252, s[48:51], s25 offen
v_accvgpr_read_b32 v192, a220
v_mfma_f32_16x16x32_bf16 v[96:99], v[56:59], a[184:187], v[96:99]
v_accvgpr_read_b32 v193, a221
v_accvgpr_read_b32 v194, a222
s_waitcnt lgkmcnt(10)
v_mfma_f32_16x16x32_bf16 v[92:95], v[64:67], a[168:171], 0
v_accvgpr_read_b32 v195, a223
v_accvgpr_read_b32 v196, a224
s_waitcnt lgkmcnt(8)
v_mfma_f32_16x16x32_bf16 v[100:103], v[80:83], a[168:171], 0
buffer_load_dwordx4 a[12:15], v253, s[48:51], s25 offen
v_accvgpr_read_b32 v197, a225
v_mfma_f32_16x16x32_bf16 v[92:95], v[80:83], a[176:179], v[92:95]
v_accvgpr_read_b32 v198, a226
v_accvgpr_read_b32 v199, a227
v_mfma_f32_16x16x32_bf16 v[100:103], v[64:67], a[184:187], v[100:103]
v_accvgpr_read_b32 v200, a228
v_accvgpr_read_b32 v201, a229
s_waitcnt lgkmcnt(6)
v_mfma_f32_16x16x32_bf16 v[88:91], v[60:63], a[172:175], v[88:91]
buffer_load_dwordx4 a[16:19], v252, s[48:51], s26 offen
v_accvgpr_read_b32 v202, a230
s_waitcnt lgkmcnt(4)
v_mfma_f32_16x16x32_bf16 v[96:99], v[76:79], a[172:175], v[96:99]
v_accvgpr_read_b32 v203, a231
s_waitcnt vmcnt(22)
v_accvgpr_read_b32 v221, a248
v_mfma_f32_16x16x32_bf16 v[88:91], v[76:79], a[180:183], v[88:91]
s_waitcnt vmcnt(21)
v_accvgpr_read_b32 v223, a249
s_waitcnt vmcnt(20)
v_accvgpr_read_b32 v225, a250
v_mfma_f32_16x16x32_bf16 v[96:99], v[60:63], a[188:191], v[96:99]
buffer_load_dwordx4 a[20:23], v253, s[48:51], s26 offen
s_waitcnt vmcnt(20)
v_accvgpr_read_b32 v227, a251
s_waitcnt lgkmcnt(2)
v_mfma_f32_16x16x32_bf16 v[92:95], v[68:71], a[172:175], v[92:95]
s_waitcnt vmcnt(19)
v_accvgpr_read_b32 v229, a252
s_waitcnt vmcnt(18)
v_accvgpr_read_b32 v231, a253
s_waitcnt lgkmcnt(0)
v_mfma_f32_16x16x32_bf16 v[100:103], v[84:87], a[172:175], v[100:103]
s_waitcnt vmcnt(17)
v_accvgpr_read_b32 v233, a254
s_waitcnt vmcnt(16)
v_accvgpr_read_b32 v235, a255
v_mfma_f32_16x16x32_bf16 v[92:95], v[84:87], a[180:183], v[92:95]
buffer_load_dwordx4 a[24:27], v252, s[48:51], s27 offen
v_mfma_f32_16x16x32_bf16 v[100:103], v[68:71], a[188:191], v[100:103]
v_pk_mul_f32 v[164:165], v[88:89], v[188:189] op_sel:[0,0] op_sel_hi:[0,1]
v_pk_fma_f32 v[164:165], v[96:97], v[188:189], v[164:165] op_sel:[0,1,0] op_sel_hi:[0,0,1] neg_lo:[0,1,0]
v_pk_mul_f32 v[166:167], v[88:89], v[190:191] op_sel:[1,0] op_sel_hi:[1,1]
v_pk_fma_f32 v[166:167], v[96:97], v[190:191], v[166:167] op_sel:[1,1,0] op_sel_hi:[1,0,1] neg_lo:[0,1,0]
v_cvt_pk_bf16_f32 v180, v164, v166
v_cvt_pk_bf16_f32 v184, v165, v167
v_pk_mul_f32 v[168:169], v[90:91], v[192:193] op_sel:[0,0] op_sel_hi:[0,1]
v_pk_fma_f32 v[168:169], v[98:99], v[192:193], v[168:169] op_sel:[0,1,0] op_sel_hi:[0,0,1] neg_lo:[0,1,0]
v_pk_mul_f32 v[170:171], v[90:91], v[194:195] op_sel:[1,0] op_sel_hi:[1,1]
v_pk_fma_f32 v[170:171], v[98:99], v[194:195], v[170:171] op_sel:[1,1,0] op_sel_hi:[1,0,1] neg_lo:[0,1,0]
v_cvt_pk_bf16_f32 v181, v168, v170
v_cvt_pk_bf16_f32 v185, v169, v171
v_pk_mul_f32 v[172:173], v[92:93], v[196:197] op_sel:[0,0] op_sel_hi:[0,1]
v_pk_fma_f32 v[172:173], v[100:101], v[196:197], v[172:173] op_sel:[0,1,0] op_sel_hi:[0,0,1] neg_lo:[0,1,0]
v_pk_mul_f32 v[174:175], v[92:93], v[198:199] op_sel:[1,0] op_sel_hi:[1,1]
v_pk_fma_f32 v[174:175], v[100:101], v[198:199], v[174:175] op_sel:[1,1,0] op_sel_hi:[1,0,1] neg_lo:[0,1,0]
v_cvt_pk_bf16_f32 v182, v172, v174
v_cvt_pk_bf16_f32 v186, v173, v175
v_pk_mul_f32 v[176:177], v[94:95], v[200:201] op_sel:[0,0] op_sel_hi:[0,1]
v_pk_fma_f32 v[176:177], v[102:103], v[200:201], v[176:177] op_sel:[0,1,0] op_sel_hi:[0,0,1] neg_lo:[0,1,0]
v_pk_mul_f32 v[178:179], v[94:95], v[202:203] op_sel:[1,0] op_sel_hi:[1,1]
v_pk_fma_f32 v[178:179], v[102:103], v[202:203], v[178:179] op_sel:[1,1,0] op_sel_hi:[1,0,1] neg_lo:[0,1,0]
v_cvt_pk_bf16_f32 v183, v176, v178
v_cvt_pk_bf16_f32 v187, v177, v179
s_waitcnt vmcnt(16)
v_mfma_f32_16x16x32_bf16 v[88:91], a[192:195], v[180:183], 0
v_lshlrev_b32 v220, 16, v221
v_and_b32 v221, 0xffff0000, v221
v_mfma_f32_16x16x32_bf16 v[96:99], a[192:195], v[184:187], 0
v_lshlrev_b32 v222, 16, v223
v_and_b32 v223, 0xffff0000, v223
s_waitcnt vmcnt(14)
v_mfma_f32_16x16x32_bf16 v[88:91], a[200:203], v[184:187], v[88:91]
v_lshlrev_b32 v224, 16, v225
v_and_b32 v225, 0xffff0000, v225
s_waitcnt vmcnt(12)
v_mfma_f32_16x16x32_bf16 v[96:99], a[208:211], v[180:183], v[96:99]
buffer_load_dwordx4 a[28:31], v253, s[48:51], s27 offen
v_lshlrev_b32 v226, 16, v227
v_mfma_f32_16x16x32_bf16 v[92:95], a[196:199], v[180:183], 0
v_and_b32 v227, 0xffff0000, v227
v_lshlrev_b32 v228, 16, v229
v_mfma_f32_16x16x32_bf16 v[100:103], a[196:199], v[184:187], 0
v_and_b32 v229, 0xffff0000, v229
v_lshlrev_b32 v230, 16, v231
v_mfma_f32_16x16x32_bf16 v[92:95], a[204:207], v[184:187], v[92:95]
v_and_b32 v231, 0xffff0000, v231
v_lshlrev_b32 v232, 16, v233
s_waitcnt vmcnt(12)
v_mfma_f32_16x16x32_bf16 v[100:103], a[212:215], v[180:183], v[100:103]
buffer_load_dwordx4 a[32:35], v252, s[48:51], s28 offen
v_and_b32 v233, 0xffff0000, v233
v_lshlrev_b32 v234, 16, v235
v_and_b32 v235, 0xffff0000, v235
v_pk_mul_f32 v[164:165], v[88:89], v[220:221] op_sel:[0,0] op_sel_hi:[0,1]
v_pk_fma_f32 v[164:165], v[96:97], v[220:221], v[164:165] op_sel:[0,1,0] op_sel_hi:[0,0,1] neg_lo:[0,1,0]
v_pk_mul_f32 v[166:167], v[88:89], v[222:223] op_sel:[1,0] op_sel_hi:[1,1]
v_pk_fma_f32 v[166:167], v[96:97], v[222:223], v[166:167] op_sel:[1,1,0] op_sel_hi:[1,0,1] neg_lo:[0,1,0]
v_cvt_pk_bf16_f32 v180, v164, v166
v_cvt_pk_bf16_f32 v184, v165, v167
v_pk_mul_f32 v[168:169], v[90:91], v[224:225] op_sel:[0,0] op_sel_hi:[0,1]
v_pk_fma_f32 v[168:169], v[98:99], v[224:225], v[168:169] op_sel:[0,1,0] op_sel_hi:[0,0,1] neg_lo:[0,1,0]
v_pk_mul_f32 v[170:171], v[90:91], v[226:227] op_sel:[1,0] op_sel_hi:[1,1]
v_pk_fma_f32 v[170:171], v[98:99], v[226:227], v[170:171] op_sel:[1,1,0] op_sel_hi:[1,0,1] neg_lo:[0,1,0]
v_cvt_pk_bf16_f32 v181, v168, v170
v_cvt_pk_bf16_f32 v185, v169, v171
v_pk_mul_f32 v[172:173], v[92:93], v[228:229] op_sel:[0,0] op_sel_hi:[0,1]
v_pk_fma_f32 v[172:173], v[100:101], v[228:229], v[172:173] op_sel:[0,1,0] op_sel_hi:[0,0,1] neg_lo:[0,1,0]
v_pk_mul_f32 v[174:175], v[92:93], v[230:231] op_sel:[1,0] op_sel_hi:[1,1]
v_pk_fma_f32 v[174:175], v[100:101], v[230:231], v[174:175] op_sel:[1,1,0] op_sel_hi:[1,0,1] neg_lo:[0,1,0]
v_cvt_pk_bf16_f32 v182, v172, v174
v_cvt_pk_bf16_f32 v186, v173, v175
v_pk_mul_f32 v[176:177], v[94:95], v[232:233] op_sel:[0,0] op_sel_hi:[0,1]
v_pk_fma_f32 v[176:177], v[102:103], v[232:233], v[176:177] op_sel:[0,1,0] op_sel_hi:[0,0,1] neg_lo:[0,1,0]
v_pk_mul_f32 v[178:179], v[94:95], v[234:235] op_sel:[1,0] op_sel_hi:[1,1]
v_pk_fma_f32 v[178:179], v[102:103], v[234:235], v[178:179] op_sel:[1,1,0] op_sel_hi:[1,0,1] neg_lo:[0,1,0]
v_cvt_pk_bf16_f32 v183, v176, v178
v_cvt_pk_bf16_f32 v187, v177, v179
s_nop 0
v_mfma_f32_16x16x32_bf16 v[88:91], v[180:183], a[192:195], 0
s_waitcnt vmcnt(12)
v_accvgpr_read_b32 v204, a232
v_accvgpr_read_b32 v205, a233
v_mfma_f32_16x16x32_bf16 v[96:99], v[184:187], a[192:195], 0
v_accvgpr_read_b32 v206, a234
v_accvgpr_read_b32 v207, a235
v_mfma_f32_16x16x32_bf16 v[88:91], v[184:187], a[208:211], v[88:91]
s_waitcnt vmcnt(11)
v_accvgpr_read_b32 v208, a236
v_accvgpr_read_b32 v209, a237
v_mfma_f32_16x16x32_bf16 v[96:99], v[180:183], a[200:203], v[96:99]
buffer_load_dwordx4 a[36:39], v253, s[48:51], s28 offen
v_accvgpr_read_b32 v210, a238
v_mfma_f32_16x16x32_bf16 v[92:95], v[180:183], a[196:199], 0
v_accvgpr_read_b32 v211, a239
s_waitcnt vmcnt(11)
v_accvgpr_read_b32 v212, a240
v_mfma_f32_16x16x32_bf16 v[100:103], v[184:187], a[196:199], 0
v_accvgpr_read_b32 v213, a241
v_accvgpr_read_b32 v214, a242
v_mfma_f32_16x16x32_bf16 v[92:95], v[184:187], a[212:215], v[92:95]
v_accvgpr_read_b32 v215, a243
s_waitcnt vmcnt(10)
v_accvgpr_read_b32 v216, a244
v_mfma_f32_16x16x32_bf16 v[100:103], v[180:183], a[204:207], v[100:103]
buffer_load_dwordx4 a[40:43], v252, s[48:51], s29 offen
v_accvgpr_read_b32 v217, a245
v_accvgpr_read_b32 v218, a246
v_accvgpr_read_b32 v219, a247
v_pk_mul_f32 v[164:165], v[88:89], v[204:205] op_sel:[0,0] op_sel_hi:[0,1]
v_pk_fma_f32 v[164:165], v[96:97], v[204:205], v[164:165] op_sel:[0,1,0] op_sel_hi:[0,0,1] neg_lo:[0,1,0]
v_pk_mul_f32 v[166:167], v[88:89], v[206:207] op_sel:[1,0] op_sel_hi:[1,1]
v_pk_fma_f32 v[166:167], v[96:97], v[206:207], v[166:167] op_sel:[1,1,0] op_sel_hi:[1,0,1] neg_lo:[0,1,0]
v_cvt_pk_bf16_f32 v180, v164, v166
v_cvt_pk_bf16_f32 v184, v165, v167
v_pk_mul_f32 v[168:169], v[90:91], v[208:209] op_sel:[0,0] op_sel_hi:[0,1]
v_pk_fma_f32 v[168:169], v[98:99], v[208:209], v[168:169] op_sel:[0,1,0] op_sel_hi:[0,0,1] neg_lo:[0,1,0]
v_pk_mul_f32 v[170:171], v[90:91], v[210:211] op_sel:[1,0] op_sel_hi:[1,1]
v_pk_fma_f32 v[170:171], v[98:99], v[210:211], v[170:171] op_sel:[1,1,0] op_sel_hi:[1,0,1] neg_lo:[0,1,0]
v_cvt_pk_bf16_f32 v181, v168, v170
v_cvt_pk_bf16_f32 v185, v169, v171
v_pk_mul_f32 v[172:173], v[92:93], v[212:213] op_sel:[0,0] op_sel_hi:[0,1]
v_pk_fma_f32 v[172:173], v[100:101], v[212:213], v[172:173] op_sel:[0,1,0] op_sel_hi:[0,0,1] neg_lo:[0,1,0]
v_pk_mul_f32 v[174:175], v[92:93], v[214:215] op_sel:[1,0] op_sel_hi:[1,1]
v_pk_fma_f32 v[174:175], v[100:101], v[214:215], v[174:175] op_sel:[1,1,0] op_sel_hi:[1,0,1] neg_lo:[0,1,0]
v_cvt_pk_bf16_f32 v182, v172, v174
v_cvt_pk_bf16_f32 v186, v173, v175
v_pk_mul_f32 v[176:177], v[94:95], v[216:217] op_sel:[0,0] op_sel_hi:[0,1]
v_pk_fma_f32 v[176:177], v[102:103], v[216:217], v[176:177] op_sel:[0,1,0] op_sel_hi:[0,0,1] neg_lo:[0,1,0]
v_pk_mul_f32 v[178:179], v[94:95], v[218:219] op_sel:[1,0] op_sel_hi:[1,1]
v_pk_fma_f32 v[178:179], v[102:103], v[218:219], v[178:179] op_sel:[1,1,0] op_sel_hi:[1,0,1] neg_lo:[0,1,0]
v_cvt_pk_bf16_f32 v183, v176, v178
v_cvt_pk_bf16_f32 v187, v177, v179
ds_write_b64 v5, v[180:181] offset:8192
ds_write_b64 v5, v[184:185] offset:12800
ds_write_b64 v5, v[182:183] offset:8768
ds_write_b64 v5, v[186:187] offset:13376
s_waitcnt lgkmcnt(0)
s_barrier
ds_read_b128 v[56:59], v6 offset:8192
ds_read_b128 v[72:75], v6 offset:12800
ds_read_b128 v[64:67], v6 offset:8768
ds_read_b128 v[80:83], v6 offset:13376
ds_read_b128 v[60:63], v6 offset:8256
ds_read_b128 v[76:79], v6 offset:12864
ds_read_b128 v[68:71], v6 offset:8832
ds_read_b128 v[84:87], v6 offset:13440
s_waitcnt lgkmcnt(7)
v_mfma_f32_16x16x32_bf16 v[88:91], v[56:59], a[168:171], 0
s_lshr_b32 s17, s68, 5
s_lshr_b32 s18, s69, 5
s_waitcnt lgkmcnt(6)
v_mfma_f32_16x16x32_bf16 v[96:99], v[72:75], a[168:171], 0
s_add_u32 s17, s17, 2097152
s_add_u32 s18, s18, 2097152
v_mfma_f32_16x16x32_bf16 v[88:91], v[72:75], a[184:187], v[88:91]
buffer_load_dwordx4 a[44:47], v253, s[48:51], s29 offen
v_mfma_f32_16x16x32_bf16 v[96:99], v[56:59], a[176:179], v[96:99]
s_waitcnt lgkmcnt(5)
v_mfma_f32_16x16x32_bf16 v[92:95], v[64:67], a[168:171], 0
s_waitcnt lgkmcnt(4)
v_mfma_f32_16x16x32_bf16 v[100:103], v[80:83], a[168:171], 0
buffer_load_dwordx4 a[48:51], v252, s[48:51], s30 offen
v_mfma_f32_16x16x32_bf16 v[92:95], v[80:83], a[184:187], v[92:95]
v_mfma_f32_16x16x32_bf16 v[100:103], v[64:67], a[176:179], v[100:103]
s_waitcnt lgkmcnt(3)
v_mfma_f32_16x16x32_bf16 v[88:91], v[60:63], a[172:175], v[88:91]
buffer_load_dwordx4 a[52:55], v253, s[48:51], s30 offen
s_waitcnt lgkmcnt(2)
v_mfma_f32_16x16x32_bf16 v[96:99], v[76:79], a[172:175], v[96:99]
v_mfma_f32_16x16x32_bf16 v[88:91], v[76:79], a[188:191], v[88:91]
v_mfma_f32_16x16x32_bf16 v[96:99], v[60:63], a[180:183], v[96:99]
buffer_load_dwordx4 a[56:59], v252, s[48:51], s31 offen
s_waitcnt lgkmcnt(1)
v_mfma_f32_16x16x32_bf16 v[92:95], v[68:71], a[172:175], v[92:95]
s_waitcnt lgkmcnt(0)
v_mfma_f32_16x16x32_bf16 v[100:103], v[84:87], a[172:175], v[100:103]
v_mfma_f32_16x16x32_bf16 v[92:95], v[84:87], a[188:191], v[92:95]
buffer_load_dwordx4 a[60:63], v253, s[48:51], s31 offen
v_mfma_f32_16x16x32_bf16 v[100:103], v[68:71], a[180:183], v[100:103]
v_pk_add_f32 v[148:149], v[148:149], v[88:89] op_sel:[0,0] op_sel_hi:[1,1]
v_pk_add_f32 v[150:151], v[150:151], v[90:91] op_sel:[0,0] op_sel_hi:[1,1]
s_nop 3
v_pk_add_f32 v[152:153], v[152:153], v[92:93] op_sel:[0,0] op_sel_hi:[1,1]
v_pk_add_f32 v[154:155], v[154:155], v[94:95] op_sel:[0,0] op_sel_hi:[1,1]
v_cvt_pk_bf16_f32 v180, v148, v149
v_cvt_pk_bf16_f32 v181, v150, v151
v_cvt_pk_bf16_f32 v182, v152, v153
v_cvt_pk_bf16_f32 v183, v154, v155
buffer_store_dwordx4 v[180:183], v248, s[48:51], s17 offen sc1
v_pk_fma_f32 v[156:157], s[70:71], v[96:97], v[156:157] op_sel:[0,0,0] op_sel_hi:[0,1,1]
v_pk_fma_f32 v[158:159], s[70:71], v[98:99], v[158:159] op_sel:[0,0,0] op_sel_hi:[0,1,1]
v_pk_fma_f32 v[160:161], s[70:71], v[100:101], v[160:161] op_sel:[0,0,0] op_sel_hi:[0,1,1]
v_pk_fma_f32 v[162:163], s[70:71], v[102:103], v[162:163] op_sel:[0,0,0] op_sel_hi:[0,1,1]
v_cvt_pk_bf16_f32 v184, v156, v157
v_cvt_pk_bf16_f32 v185, v158, v159
v_cvt_pk_bf16_f32 v186, v160, v161
v_cvt_pk_bf16_f32 v187, v162, v163
buffer_store_dwordx4 v[184:187], v248, s[48:51], s18 offen sc1
global_load_ushort v236, v20, s[60:61]
global_load_ushort v237, v20, s[62:63]
global_load_ushort v238, v20, s[64:65]
global_load_ushort v44, v20, s[66:67]
s_mov_b32 s73, 30000
s_getreg_b32 s14, hwreg(HW_REG_XCC_ID)
v_mov_b32 v54, s14
s_lshl_b32 s14, s13, 4
s_add_u32 s14, s14, s71
s_add_u32 s14, s14, 28770304
s_mov_b32 s52, s48
s_mov_b32 s53, s49
s_cmp_eq_u32 s7, 0
s_cselect_b32 s54, s50, 0
s_mov_b64 exec, 1
buffer_store_dword v54, v2, s[52:55], s14 offen sc1
s_mov_b64 exec, -1
buffer_load_dwordx4 a[64:67], v252, s[48:51], s32 offen
buffer_load_dwordx4 a[68:71], v253, s[48:51], s32 offen
buffer_load_dwordx4 a[72:75], v252, s[48:51], s33 offen
buffer_load_dwordx4 a[76:79], v253, s[48:51], s33 offen
buffer_load_dwordx4 a[80:83], v252, s[48:51], s34 offen
buffer_load_dwordx4 a[84:87], v253, s[48:51], s34 offen
buffer_load_dwordx4 a[88:91], v252, s[48:51], s35 offen
buffer_load_dwordx4 a[92:95], v253, s[48:51], s35 offen
s_mov_b32 s64, s40
s_and_b32 s65, s41, 0xffff
s_mov_b32 s66, 0x380000
s_mov_b32 s67, 0x20000
s_mov_b32 s62, 229376
s_mov_b32 s63, 0x20000
v_lshrrev_b32 v57, 4, v9
s_lshl_b32 s14, s13, 2
s_add_u32 s14, s14, s7
s_lshl_b32 s14, s14, 11
s_lshl_b32 s17, s15, 10
s_add_u32 s14, s14, s17
v_add_u32 v12, s14, v2
v_add_u32 v249, 28672, v2
v_bfe_u32 v55, v1, 2, 2
v_lshl_add_u32 v54, v10, 3, v55
v_lshlrev_b32 v49, 7, v54
v_and_b32 v54, 3, v1
v_cmp_eq_u32 s[20:21], 1, v54
v_cmp_eq_u32 s[22:23], 2, v54
v_cmp_eq_u32 s[40:41], 3, v54
v_lshlrev_b32 v54, 1, v54
v_bfe_u32 v55, v1, 3, 2
v_xor_b32 v54, v54, v55
v_lshl_add_u32 v49, v54, 4, v49
v_and_b32 v54, 1, v1
v_lshl_add_u32 v49, v54, 3, v49
v_xor_b32 v50, 8, v49
v_xor_b32 v51, 16, v49
v_xor_b32 v52, 24, v49
s_lshl_b32 s14, s7, 3
v_xor_b32 v8, s14, v49
v_lshrrev_b32 v54, 2, v1
v_and_b32 v55, 3, v1
v_lshl_add_u32 v54, v54, 4, v55
s_lshl_b32 s14, s7, 2
v_add_u32 v54, s14, v54
v_lshlrev_b32 v54, 8, v54
v_add_u32 v13, 252, v54
v_bfe_u32 v55, v57, 1, 1
v_bfe_u32 v56, v57, 3, 1
v_lshl_or_b32 v55, v56, 1, v55
v_lshlrev_b32 v56, 1, v10
v_xor_b32 v55, v55, v56
v_lshlrev_b32 v55, 4, v55
v_and_b32 v56, 31, v57
v_lshl_add_u32 v19, v56, 7, v55
v_and_b32 v55, 1, v10
v_lshl_add_u32 v19, v55, 3, v19
s_sub_u32 s14, s15, s46
s_cselect_b32 s17, 14, 0
s_add_u32 s14, s14, s17
s_lshl_b32 s14, s14, 12
v_add_u32 v19, s14, v19
v_bfe_u32 v55, v1, 1, 1
v_lshlrev_b32 v55, 6, v55
v_and_b32 v56, 63, v57
v_lshlrev_b32 v56, 7, v56
v_lshl_add_u32 v56, v10, 5, v56
v_xor_b32 v255, v55, v56
v_add_u32 v255, 114688, v255
s_sub_u32 s14, s12, 1
s_mul_i32 s14, s14, 7168
v_mul_u32_u24 v54, 57344, v10
v_sub_u32 v55, v9, v54
v_add_u32 v24, s14, v55
v_subrev_u32 v25, 7168, v24
v_subrev_u32 v26, 7168, v25
v_subrev_u32 v27, 7168, v26
v_subrev_u32 v28, 7168, v27
v_subrev_u32 v29, 7168, v28
v_subrev_u32 v30, 7168, v29
v_subrev_u32 v31, 7168, v30
v_and_b32 v54, 3, v1
v_lshrrev_b32 v55, 2, v11
v_lshlrev_b32 v56, 1, v54
v_lshl_add_u32 v56, v55, 5, v56
v_and_b32 v22, 1, v55
v_xor_b32 v22, s16, v22
v_lshl_add_u32 v22, v22, 3, v56
s_lshl_b32 s14, s15, 4
s_add_u32 s14, s14, s38
v_add_u32 v22, s14, v22
v_lshl_add_u32 v56, v55, 4, v54
s_lshl_b32 s14, s7, 2
v_add_u32 v56, s14, v56
v_lshlrev_b32 v56, 2, v56
v_add_u32 v23, 147456, v56
v_cmp_eq_u32 s[8:9], v55, v10
s_lshl_b32 s14, s7, 8
s_add_u32 s14, s14, 131072
v_lshlrev_b32 v54, 10, v10
v_lshl_add_u32 v54, v11, 4, v54
v_add_u32 v45, s14, v54
v_lshrrev_b32 v54, 5, v1
v_and_b32 v55, 31, v1
v_lshlrev_b32 v56, 10, v54
v_lshl_add_u32 v56, v55, 4, v56
s_lshl_b32 s14, s15, 11
s_lshl_b32 s17, s16, 9
s_add_u32 s14, s14, s17
s_add_u32 s14, s14, 131072
v_add_u32 v56, s14, v56
v_lshl_add_u32 v46, v54, 12, v56
v_lshlrev_b32 v47, 12, v54
v_sub_u32 v47, v56, v47
s_lshl_b32 s14, s13, 1
s_add_u32 s14, s14, s16
s_lshl_b32 s17, s14, 5
v_add_u32 v55, s17, v55
v_cmp_ne_u32 vcc, 0, v55
s_nop 1
v_cndmask_b32 v21, 0, 1.0, vcc
v_mul_u32_u24 v56, 28672, v54
v_lshl_add_u32 v48, v55, 2, v56
s_mul_i32 s10, s14, 57344
s_lshl_b32 s74, s7, 10
s_add_u32 s10, s10, s74
s_xor_b32 s11, s14, 1
s_mul_i32 s11, s11, 57344
s_add_u32 s11, s11, s74
v_add_u32 v55, s17, v11
v_lshlrev_b32 v17, 12, v55
v_lshl_add_u32 v17, v10, 4, v17
s_lshl_b32 s14, s15, 6
v_add_u32 v17, s14, v17
v_bfe_u32 v55, v1, 2, 2
v_lshl_add_u32 v54, v54, 3, v55
v_lshlrev_b32 v15, 7, v54
v_and_b32 v54, 1, v1
v_bfe_u32 v56, v1, 1, 1
v_xor_b32 v56, v56, v54
v_lshl_add_u32 v15, v56, 3, v15
v_lshlrev_b32 v54, 1, v54
v_and_b32 v55, 1, v10
v_add_u32 v54, v54, v55
v_bfe_u32 v55, v1, 3, 1
v_lshl_add_u32 v54, v55, 2, v54
v_lshl_add_u32 v15, v54, 4, v15
v_xor_b32 v15, s14, v15
s_lshl_b32 s14, s7, 11
v_add_u32 v15, s14, v15
v_add_u32 v15, 114688, v15
v_xor_b32 v16, 64, v15
s_lshl_b32 s17, s15, 10
s_add_u32 s14, s14, s17
v_add_u32 v14, s14, v2
v_xor_b32 v18, 1024, v14
s_mul_i32 s75, s12, 57344
v_bfe_u32 v54, v1, 1, 4
v_lshrrev_b32 v55, 5, v1
v_lshl_add_u32 v54, v55, 4, v54
s_lshl_b32 s14, s15, 7
s_lshl_b32 s17, s16, 8
s_add_u32 s14, s14, s17
s_add_u32 s14, s14, 147712
v_lshl_add_u32 v20, v54, 2, s14
v_lshlrev_b32 v11, 2, v11
s_add_u32 s60, s44, 28311552
s_addc_u32 s61, s45, 0
s_and_b32 s61, s61, 0xffff
s_add_u32 s6, s75, 2097152
s_lshl_b32 s4, s7, 10
s_add_u32 s5, s4, s6
v_add_u32 v53, s5, v7
s_mov_b32 s72, 400
s_barrier
s_waitcnt vmcnt(13)
v_min_u32 v70, 6, v1
v_lshlrev_b32 v70, 4, v70
s_add_u32 s17, s71, 28770304
v_mov_b32 v68, 0
buffer_load_dword v69, v70, s[48:51], s17 offen sc1
s_mov_b32 exec_lo, 0xffffffff
s_mov_b32 exec_hi, 0xffffff
buffer_load_dword v68, v13, s[48:51], s6 offen sc1
s_mov_b64 exec, -1
s_mov_b32 m0, s4
s_lshl_b32 s5, s24, 2
buffer_load_dwordx4 v53, s[48:51], s5 offen sc1 lds
s_add_u32 m0, m0, 4096
s_lshl_b32 s5, s25, 2
buffer_load_dwordx4 v53, s[48:51], s5 offen sc1 lds
s_waitcnt vmcnt(16)
v_lshlrev_b32 v236, 16, v236
s_waitcnt vmcnt(15)
v_lshlrev_b32 v237, 16, v237
s_waitcnt vmcnt(14)
v_lshlrev_b32 v238, 16, v238
v_mul_f32 v54, 0x3fb8aa3b, v238
v_exp_f32 v54, v54
s_nop 0
v_cvt_pk_bf16_f32 v54, v54, v54
v_and_b32 v54, 0xffff0000, v54
v_mul_f32 v55, v54, v236
v_mul_f32 v55, 0x3fb8aa3b, v55
v_exp_f32 v55, v55
v_mul_f32 v54, v54, v237
v_mul_f32 v54, 0x3e22f983, v54
v_fract_f32 v54, v54
v_cos_f32 v32, v54
v_sin_f32 v33, v54
v_mul_f32 v32, v32, v55
v_mul_f32 v33, v33, v55
s_waitcnt vmcnt(13)
v_lshlrev_b32 v44, 16, v44
v_mul_f32 v56, v32, v32
v_mul_f32 v57, v32, v33
v_fma_f32 v56, -v33, v33, v56
v_add_f32 v57, v57, v57
v_mul_f32 v58, v56, v56
v_mul_f32 v59, v56, v57
v_fma_f32 v58, -v57, v57, v58
v_add_f32 v59, v59, v59
v_mul_f32 v42, v58, v58
v_mul_f32 v43, v58, v59
v_fma_f32 v42, -v59, v59, v42
v_add_f32 v43, v43, v43
v_mul_f32 v34, v42, v42
v_mul_f32 v35, v42, v43
v_fma_f32 v34, -v43, v43, v34
v_add_f32 v35, v35, v35
v_mul_f32 v56, v34, v34
v_mul_f32 v57, v34, v35
v_fma_f32 v56, -v35, v35, v56
v_add_f32 v57, v57, v57
v_mul_f32 v58, v56, v34
v_mul_f32 v59, v56, v35
v_fma_f32 v58, -v57, v35, v58
v_fmac_f32 v59, v57, v34
v_mul_f32 v36, v56, v56
v_mul_f32 v37, v56, v57
v_fma_f32 v36, -v57, v57, v36
v_add_f32 v37, v37, v37
v_mov_b32 v38, 1.0
v_mov_b32 v39, 0
v_cmp_eq_u32 vcc, 1, v10
s_nop 1
v_cndmask_b32 v38, v38, v34, vcc
v_cndmask_b32 v39, v39, v35, vcc
v_cmp_eq_u32 vcc, 2, v10
s_nop 1
v_cndmask_b32 v38, v38, v56, vcc
v_cndmask_b32 v39, v39, v57, vcc
v_cmp_eq_u32 vcc, 3, v10
s_nop 1
v_cndmask_b32 v38, v38, v58, vcc
v_cndmask_b32 v39, v39, v59, vcc
v_mul_f32 v56, v36, v36
v_mul_f32 v57, v36, v37
v_fma_f32 v56, -v37, v37, v56
v_add_f32 v57, v57, v57
v_mul_f32 v58, v56, v56
v_mul_f32 v59, v56, v57
v_fma_f32 v58, -v57, v57, v58
v_add_f32 v59, v59, v59
v_mul_f32 v56, v58, v58
v_mul_f32 v57, v58, v59
v_fma_f32 v56, -v59, v59, v56
v_add_f32 v57, v57, v57
v_mul_f32 v58, v56, v56
v_mul_f32 v59, v56, v57
v_fma_f32 v58, -v57, v57, v58
v_add_f32 v59, v59, v59
v_mul_f32 v60, v56, v58
v_mul_f32 v61, v56, v59
v_fma_f32 v60, -v57, v59, v60
v_fmac_f32 v61, v57, v58
v_mov_b32 v40, 1.0
v_mov_b32 v41, 0
v_cmp_eq_u32 vcc, 1, v10
s_nop 1
v_cndmask_b32 v40, v40, v56, vcc
v_cndmask_b32 v41, v41, v57, vcc
v_cmp_eq_u32 vcc, 2, v10
s_nop 1
v_cndmask_b32 v40, v40, v58, vcc
v_cndmask_b32 v41, v41, v59, vcc
v_cmp_eq_u32 vcc, 3, v10
s_nop 1
v_cndmask_b32 v40, v40, v60, vcc
v_cndmask_b32 v41, v41, v61, vcc
s_waitcnt vmcnt(3)
v_cmp_eq_u32 s[18:19], -1, v69
s_waitcnt vmcnt(2)
v_cmp_eq_u32 vcc, -1, v68
s_nop 0
s_or_b64 vcc, vcc, s[18:19]
s_cbranch_scc1 L_kp_poll2
L_kp_pollx3:
s_getreg_b32 s17, hwreg(HW_REG_XCC_ID)
v_cmp_ne_u32 vcc, s17, v69
s_nop 0
s_cmp_eq_u64 vcc, 0
s_cselect_b32 s3, 1, 0
s_add_u32 m0, m0, 4096
s_lshl_b32 s5, s26, 2
buffer_load_dwordx4 v53, s[48:51], s5 offen sc1 lds
s_add_u32 m0, m0, 4096
s_lshl_b32 s5, s27, 2
buffer_load_dwordx4 v53, s[48:51], s5 offen sc1 lds
s_add_u32 m0, m0, 4096
s_lshl_b32 s5, s28, 2
buffer_load_dwordx4 v53, s[48:51], s5 offen sc1 lds
s_add_u32 m0, m0, 4096
s_lshl_b32 s5, s29, 2
buffer_load_dwordx4 v53, s[48:51], s5 offen sc1 lds
s_add_u32 m0, m0, 4096
s_lshl_b32 s5, s30, 2
buffer_load_dwordx4 v53, s[48:51], s5 offen sc1 lds
s_waitcnt vmcnt(5)
s_barrier
ds_read_b64_tr_b16 v[124:125], v49 offset:0
ds_read_b64_tr_b16 v[126:127], v49 offset:512
ds_read_b64_tr_b16 v[128:129], v50 offset:0
ds_read_b64_tr_b16 v[130:131], v50 offset:512
ds_read_b64_tr_b16 v[132:133], v51 offset:0
ds_read_b64_tr_b16 v[134:135], v51 offset:512
ds_read_b64_tr_b16 v[136:137], v52 offset:0
ds_read_b64_tr_b16 v[138:139], v52 offset:512
ds_read_b64_tr_b16 v[140:141], v8 offset:0
ds_read_b64_tr_b16 v[142:143], v8 offset:512
s_waitcnt lgkmcnt(8)
v_mfma_f32_16x16x32_bf16 v[72:75], v[124:127], a[0:3], 0
ds_read_b64_tr_b16 v[144:145], v49 offset:4096
ds_read_b64_tr_b16 v[146:147], v49 offset:4608
v_mfma_f32_16x16x32_bf16 v[88:91], v[124:127], a[4:7], 0
ds_read_b64_tr_b16 v[148:149], v50 offset:4096
ds_read_b64_tr_b16 v[150:151], v50 offset:4608
s_waitcnt lgkmcnt(10)
v_mfma_f32_16x16x32_bf16 v[76:79], v[128:131], a[0:3], 0
ds_read_b64_tr_b16 v[152:153], v51 offset:4096
v_mfma_f32_16x16x32_bf16 v[92:95], v[128:131], a[4:7], 0
ds_read_b64_tr_b16 v[154:155], v51 offset:4608
s_add_u32 m0, m0, 4096
s_lshl_b32 s5, s31, 2
buffer_load_dwordx4 v53, s[48:51], s5 offen sc1 lds
s_waitcnt lgkmcnt(10)
v_mfma_f32_16x16x32_bf16 v[80:83], v[132:135], a[0:3], 0
ds_read_b64_tr_b16 v[156:157], v52 offset:4096
v_mfma_f32_16x16x32_bf16 v[96:99], v[132:135], a[4:7], 0
ds_read_b64_tr_b16 v[158:159], v52 offset:4608
s_waitcnt lgkmcnt(10)
v_mfma_f32_16x16x32_bf16 v[84:87], v[136:139], a[0:3], 0
ds_read_b64_tr_b16 v[160:161], v8 offset:4096
v_mfma_f32_16x16x32_bf16 v[100:103], v[136:139], a[4:7], 0
ds_read_b64_tr_b16 v[162:163], v8 offset:4608
s_add_u32 m0, m0, 4096
s_lshl_b32 s5, s32, 2
buffer_load_dwordx4 v53, s[48:51], s5 offen sc1 lds
s_waitcnt lgkmcnt(10)
v_mfma_f32_16x16x32_bf16 v[120:123], v[140:143], v[140:143], 0
s_waitcnt lgkmcnt(8)
v_mfma_f32_16x16x32_bf16 v[72:75], v[144:147], a[8:11], v[72:75]
s_waitcnt vmcnt(5)
s_barrier
v_mfma_f32_16x16x32_bf16 v[88:91], v[144:147], a[12:15], v[88:91]
ds_read_b64_tr_b16 v[124:125], v49 offset:8192
ds_read_b64_tr_b16 v[126:127], v49 offset:8704
s_waitcnt lgkmcnt(8)
v_mfma_f32_16x16x32_bf16 v[76:79], v[148:151], a[8:11], v[76:79]
ds_read_b64_tr_b16 v[128:129], v50 offset:8192
ds_read_b64_tr_b16 v[130:131], v50 offset:8704
v_mfma_f32_16x16x32_bf16 v[92:95], v[148:151], a[12:15], v[92:95]
ds_read_b64_tr_b16 v[132:133], v51 offset:8192
s_add_u32 m0, m0, 4096
s_lshl_b32 s5, s33, 2
buffer_load_dwordx4 v53, s[48:51], s5 offen sc1 lds
s_waitcnt lgkmcnt(9)
v_mfma_f32_16x16x32_bf16 v[80:83], v[152:155], a[8:11], v[80:83]
ds_read_b64_tr_b16 v[134:135], v51 offset:8704
v_mfma_f32_16x16x32_bf16 v[96:99], v[152:155], a[12:15], v[96:99]
ds_read_b64_tr_b16 v[136:137], v52 offset:8192
s_waitcnt lgkmcnt(9)
v_mfma_f32_16x16x32_bf16 v[84:87], v[156:159], a[8:11], v[84:87]
ds_read_b64_tr_b16 v[138:139], v52 offset:8704
v_mfma_f32_16x16x32_bf16 v[100:103], v[156:159], a[12:15], v[100:103]
ds_read_b64_tr_b16 v[140:141], v8 offset:8192
s_add_u32 m0, m0, 4096
s_lshl_b32 s5, s34, 2
buffer_load_dwordx4 v53, s[48:51], s5 offen sc1 lds
s_waitcnt lgkmcnt(9)
v_mfma_f32_16x16x32_bf16 v[120:123], v[160:163], v[160:163], v[120:123]
ds_read_b64_tr_b16 v[142:143], v8 offset:8704
s_waitcnt lgkmcnt(8)
v_mfma_f32_16x16x32_bf16 v[72:75], v[124:127], a[16:19], v[72:75]
ds_read_b64_tr_b16 v[144:145], v49 offset:12288
ds_read_b64_tr_b16 v[146:147], v49 offset:12800
v_mfma_f32_16x16x32_bf16 v[88:91], v[124:127], a[20:23], v[88:91]
ds_read_b64_tr_b16 v[148:149], v50 offset:12288
ds_read_b64_tr_b16 v[150:151], v50 offset:12800
s_waitcnt lgkmcnt(10)
v_mfma_f32_16x16x32_bf16 v[76:79], v[128:131], a[16:19], v[76:79]
ds_read_b64_tr_b16 v[152:153], v51 offset:12288
v_mfma_f32_16x16x32_bf16 v[92:95], v[128:131], a[20:23], v[92:95]
ds_read_b64_tr_b16 v[154:155], v51 offset:12800
s_add_u32 m0, m0, 4096
s_lshl_b32 s5, s35, 2
buffer_load_dwordx4 v53, s[48:51], s5 offen sc1 lds
s_waitcnt lgkmcnt(10)
v_mfma_f32_16x16x32_bf16 v[80:83], v[132:135], a[16:19], v[80:83]
ds_read_b64_tr_b16 v[156:157], v52 offset:12288
v_mfma_f32_16x16x32_bf16 v[96:99], v[132:135], a[20:23], v[96:99]
ds_read_b64_tr_b16 v[158:159], v52 offset:12800
s_waitcnt lgkmcnt(10)
v_mfma_f32_16x16x32_bf16 v[84:87], v[136:139], a[16:19], v[84:87]
ds_read_b64_tr_b16 v[160:161], v8 offset:12288
v_mfma_f32_16x16x32_bf16 v[100:103], v[136:139], a[20:23], v[100:103]
ds_read_b64_tr_b16 v[162:163], v8 offset:12800
s_add_u32 m0, m0, 4096
s_lshl_b32 s5, s36, 2
buffer_load_dwordx4 v53, s[48:51], s5 offen sc1 lds
s_waitcnt lgkmcnt(10)
v_mfma_f32_16x16x32_bf16 v[120:123], v[140:143], v[140:143], v[120:123]
s_waitcnt lgkmcnt(8)
v_mfma_f32_16x16x32_bf16 v[72:75], v[144:147], a[24:27], v[72:75]
s_waitcnt vmcnt(6)
s_barrier
v_mfma_f32_16x16x32_bf16 v[88:91], v[144:147], a[28:31], v[88:91]
ds_read_b64_tr_b16 v[124:125], v49 offset:16384
ds_read_b64_tr_b16 v[126:127], v49 offset:16896
s_waitcnt lgkmcnt(8)
v_mfma_f32_16x16x32_bf16 v[76:79], v[148:151], a[24:27], v[76:79]
ds_read_b64_tr_b16 v[128:129], v50 offset:16384
ds_read_b64_tr_b16 v[130:131], v50 offset:16896
v_mfma_f32_16x16x32_bf16 v[92:95], v[148:151], a[28:31], v[92:95]
ds_read_b64_tr_b16 v[132:133], v51 offset:16384
s_add_u32 m0, m0, 4096
s_lshl_b32 s5, s37, 2
buffer_load_dwordx4 v53, s[48:51], s5 offen sc1 lds
s_waitcnt lgkmcnt(9)
v_mfma_f32_16x16x32_bf16 v[80:83], v[152:155], a[24:27], v[80:83]
ds_read_b64_tr_b16 v[134:135], v51 offset:16896
v_mfma_f32_16x16x32_bf16 v[96:99], v[152:155], a[28:31], v[96:99]
ds_read_b64_tr_b16 v[136:137], v52 offset:16384
s_waitcnt lgkmcnt(9)
v_mfma_f32_16x16x32_bf16 v[84:87], v[156:159], a[24:27], v[84:87]
ds_read_b64_tr_b16 v[138:139], v52 offset:16896
v_mfma_f32_16x16x32_bf16 v[100:103], v[156:159], a[28:31], v[100:103]
ds_read_b64_tr_b16 v[140:141], v8 offset:16384
buffer_load_dwordx4 a[96:99], v252, s[48:51], s36 offen
s_waitcnt lgkmcnt(9)
v_mfma_f32_16x16x32_bf16 v[120:123], v[160:163], v[160:163], v[120:123]
ds_read_b64_tr_b16 v[142:143], v8 offset:16896
s_waitcnt lgkmcnt(8)
v_mfma_f32_16x16x32_bf16 v[72:75], v[124:127], a[32:35], v[72:75]
ds_read_b64_tr_b16 v[144:145], v49 offset:20480
ds_read_b64_tr_b16 v[146:147], v49 offset:20992
v_mfma_f32_16x16x32_bf16 v[88:91], v[124:127], a[36:39], v[88:91]
ds_read_b64_tr_b16 v[148:149], v50 offset:20480
ds_read_b64_tr_b16 v[150:151], v50 offset:20992
s_waitcnt lgkmcnt(10)
v_mfma_f32_16x16x32_bf16 v[76:79], v[128:131], a[32:35], v[76:79]
ds_read_b64_tr_b16 v[152:153], v51 offset:20480
v_mfma_f32_16x16x32_bf16 v[92:95], v[128:131], a[36:39], v[92:95]
ds_read_b64_tr_b16 v[154:155], v51 offset:20992
buffer_load_dwordx4 a[100:103], v253, s[48:51], s36 offen
s_waitcnt lgkmcnt(10)
v_mfma_f32_16x16x32_bf16 v[80:83], v[132:135], a[32:35], v[80:83]
ds_read_b64_tr_b16 v[156:157], v52 offset:20480
v_mfma_f32_16x16x32_bf16 v[96:99], v[132:135], a[36:39], v[96:99]
ds_read_b64_tr_b16 v[158:159], v52 offset:20992
s_waitcnt lgkmcnt(10)
v_mfma_f32_16x16x32_bf16 v[84:87], v[136:139], a[32:35], v[84:87]
ds_read_b64_tr_b16 v[160:161], v8 offset:20480
v_mfma_f32_16x16x32_bf16 v[100:103], v[136:139], a[36:39], v[100:103]
ds_read_b64_tr_b16 v[162:163], v8 offset:20992
buffer_load_dwordx4 a[104:107], v252, s[48:51], s37 offen
s_waitcnt lgkmcnt(10)
v_mfma_f32_16x16x32_bf16 v[120:123], v[140:143], v[140:143], v[120:123]
s_waitcnt lgkmcnt(8)
v_mfma_f32_16x16x32_bf16 v[72:75], v[144:147], a[40:43], v[72:75]
ds_read_b64_tr_b16 v[124:125], v49 offset:24576
ds_read_b64_tr_b16 v[126:127], v49 offset:25088
v_mfma_f32_16x16x32_bf16 v[88:91], v[144:147], a[44:47], v[88:91]
ds_read_b64_tr_b16 v[128:129], v50 offset:24576
ds_read_b64_tr_b16 v[130:131], v50 offset:25088
s_waitcnt lgkmcnt(10)
v_mfma_f32_16x16x32_bf16 v[76:79], v[148:151], a[40:43], v[76:79]
ds_read_b64_tr_b16 v[132:133], v51 offset:24576
v_mfma_f32_16x16x32_bf16 v[92:95], v[148:151], a[44:47], v[92:95]
ds_read_b64_tr_b16 v[134:135], v51 offset:25088
buffer_load_dwordx4 a[108:111], v253, s[48:51], s37 offen
s_waitcnt lgkmcnt(10)
v_mfma_f32_16x16x32_bf16 v[80:83], v[152:155], a[40:43], v[80:83]
ds_read_b64_tr_b16 v[136:137], v52 offset:24576
v_mfma_f32_16x16x32_bf16 v[96:99], v[152:155], a[44:47], v[96:99]
ds_read_b64_tr_b16 v[138:139], v52 offset:25088
s_waitcnt lgkmcnt(10)
v_mfma_f32_16x16x32_bf16 v[84:87], v[156:159], a[40:43], v[84:87]
ds_read_b64_tr_b16 v[140:141], v8 offset:24576
v_mfma_f32_16x16x32_bf16 v[100:103], v[156:159], a[44:47], v[100:103]
ds_read_b64_tr_b16 v[142:143], v8 offset:25088
buffer_load_dwordx4 a[112:115], v254, s[48:51], s24 offen
s_waitcnt lgkmcnt(10)
v_mfma_f32_16x16x32_bf16 v[120:123], v[160:163], v[160:163], v[120:123]
s_waitcnt lgkmcnt(8)
v_mfma_f32_16x16x32_bf16 v[72:75], v[124:127], a[48:51], v[72:75]
s_waitcnt vmcnt(9)
s_barrier
v_mfma_f32_16x16x32_bf16 v[88:91], v[124:127], a[52:55], v[88:91]
ds_read_b64_tr_b16 v[144:145], v49 offset:28672
ds_read_b64_tr_b16 v[146:147], v49 offset:29184
s_waitcnt lgkmcnt(8)
v_mfma_f32_16x16x32_bf16 v[76:79], v[128:131], a[48:51], v[76:79]
ds_read_b64_tr_b16 v[148:149], v50 offset:28672
ds_read_b64_tr_b16 v[150:151], v50 offset:29184
v_mfma_f32_16x16x32_bf16 v[92:95], v[128:131], a[52:55], v[92:95]
ds_read_b64_tr_b16 v[152:153], v51 offset:28672
buffer_load_dwordx4 a[116:119], v254, s[48:51], s25 offen
s_waitcnt lgkmcnt(9)
v_mfma_f32_16x16x32_bf16 v[80:83], v[132:135], a[48:51], v[80:83]
ds_read_b64_tr_b16 v[154:155], v51 offset:29184
v_mfma_f32_16x16x32_bf16 v[96:99], v[132:135], a[52:55], v[96:99]
ds_read_b64_tr_b16 v[156:157], v52 offset:28672
s_waitcnt lgkmcnt(9)
v_mfma_f32_16x16x32_bf16 v[84:87], v[136:139], a[48:51], v[84:87]
ds_read_b64_tr_b16 v[158:159], v52 offset:29184
v_mfma_f32_16x16x32_bf16 v[100:103], v[136:139], a[52:55], v[100:103]
ds_read_b64_tr_b16 v[160:161], v8 offset:28672
buffer_load_dwordx4 a[120:123], v254, s[48:51], s26 offen
s_waitcnt lgkmcnt(9)
v_mfma_f32_16x16x32_bf16 v[120:123], v[140:143], v[140:143], v[120:123]
ds_read_b64_tr_b16 v[162:163], v8 offset:29184
s_waitcnt lgkmcnt(8)
v_mfma_f32_16x16x32_bf16 v[72:75], v[144:147], a[56:59], v[72:75]
ds_read_b64_tr_b16 v[124:125], v49 offset:32768
ds_read_b64_tr_b16 v[126:127], v49 offset:33280
v_mfma_f32_16x16x32_bf16 v[88:91], v[144:147], a[60:63], v[88:91]
ds_read_b64_tr_b16 v[128:129], v50 offset:32768
ds_read_b64_tr_b16 v[130:131], v50 offset:33280
s_waitcnt lgkmcnt(10)
v_mfma_f32_16x16x32_bf16 v[76:79], v[148:151], a[56:59], v[76:79]
ds_read_b64_tr_b16 v[132:133], v51 offset:32768
v_mfma_f32_16x16x32_bf16 v[92:95], v[148:151], a[60:63], v[92:95]
ds_read_b64_tr_b16 v[134:135], v51 offset:33280
buffer_load_dwordx4 a[124:127], v254, s[48:51], s27 offen
s_waitcnt lgkmcnt(10)
v_mfma_f32_16x16x32_bf16 v[80:83], v[152:155], a[56:59], v[80:83]
ds_read_b64_tr_b16 v[136:137], v52 offset:32768
v_mfma_f32_16x16x32_bf16 v[96:99], v[152:155], a[60:63], v[96:99]
ds_read_b64_tr_b16 v[138:139], v52 offset:33280
s_waitcnt lgkmcnt(10)
v_mfma_f32_16x16x32_bf16 v[84:87], v[156:159], a[56:59], v[84:87]
ds_read_b64_tr_b16 v[140:141], v8 offset:32768
v_mfma_f32_16x16x32_bf16 v[100:103], v[156:159], a[60:63], v[100:103]
ds_read_b64_tr_b16 v[142:143], v8 offset:33280
buffer_load_dwordx4 a[128:131], v254, s[48:51], s28 offen
s_waitcnt lgkmcnt(10)
v_mfma_f32_16x16x32_bf16 v[120:123], v[160:163], v[160:163], v[120:123]
s_waitcnt lgkmcnt(8)
v_mfma_f32_16x16x32_bf16 v[72:75], v[124:127], a[64:67], v[72:75]
ds_read_b64_tr_b16 v[144:145], v49 offset:36864
ds_read_b64_tr_b16 v[146:147], v49 offset:37376
v_mfma_f32_16x16x32_bf16 v[88:91], v[124:127], a[68:71], v[88:91]
ds_read_b64_tr_b16 v[148:149], v50 offset:36864
ds_read_b64_tr_b16 v[150:151], v50 offset:37376
s_waitcnt lgkmcnt(10)
v_mfma_f32_16x16x32_bf16 v[76:79], v[128:131], a[64:67], v[76:79]
ds_read_b64_tr_b16 v[152:153], v51 offset:36864
v_mfma_f32_16x16x32_bf16 v[92:95], v[128:131], a[68:71], v[92:95]
ds_read_b64_tr_b16 v[154:155], v51 offset:37376
buffer_load_dwordx4 a[132:135], v254, s[48:51], s29 offen
s_waitcnt lgkmcnt(10)
v_mfma_f32_16x16x32_bf16 v[80:83], v[132:135], a[64:67], v[80:83]
ds_read_b64_tr_b16 v[156:157], v52 offset:36864
v_mfma_f32_16x16x32_bf16 v[96:99], v[132:135], a[68:71], v[96:99]
ds_read_b64_tr_b16 v[158:159], v52 offset:37376
s_waitcnt lgkmcnt(10)
v_mfma_f32_16x16x32_bf16 v[84:87], v[136:139], a[64:67], v[84:87]
ds_read_b64_tr_b16 v[160:161], v8 offset:36864
v_mfma_f32_16x16x32_bf16 v[100:103], v[136:139], a[68:71], v[100:103]
ds_read_b64_tr_b16 v[162:163], v8 offset:37376
buffer_load_dwordx4 a[136:139], v254, s[48:51], s30 offen
s_waitcnt lgkmcnt(10)
v_mfma_f32_16x16x32_bf16 v[120:123], v[140:143], v[140:143], v[120:123]
s_waitcnt lgkmcnt(8)
v_mfma_f32_16x16x32_bf16 v[72:75], v[144:147], a[72:75], v[72:75]
s_waitcnt vmcnt(11)
s_barrier
v_mfma_f32_16x16x32_bf16 v[88:91], v[144:147], a[76:79], v[88:91]
ds_read_b64_tr_b16 v[124:125], v49 offset:40960
ds_read_b64_tr_b16 v[126:127], v49 offset:41472
s_waitcnt lgkmcnt(8)
v_mfma_f32_16x16x32_bf16 v[76:79], v[148:151], a[72:75], v[76:79]
ds_read_b64_tr_b16 v[128:129], v50 offset:40960
ds_read_b64_tr_b16 v[130:131], v50 offset:41472
v_mfma_f32_16x16x32_bf16 v[92:95], v[148:151], a[76:79], v[92:95]
ds_read_b64_tr_b16 v[132:133], v51 offset:40960
buffer_load_dwordx4 a[140:143], v254, s[48:51], s31 offen
s_waitcnt lgkmcnt(9)
v_mfma_f32_16x16x32_bf16 v[80:83], v[152:155], a[72:75], v[80:83]
ds_read_b64_tr_b16 v[134:135], v51 offset:41472
v_mfma_f32_16x16x32_bf16 v[96:99], v[152:155], a[76:79], v[96:99]
ds_read_b64_tr_b16 v[136:137], v52 offset:40960
s_waitcnt lgkmcnt(9)
v_mfma_f32_16x16x32_bf16 v[84:87], v[156:159], a[72:75], v[84:87]
ds_read_b64_tr_b16 v[138:139], v52 offset:41472
v_mfma_f32_16x16x32_bf16 v[100:103], v[156:159], a[76:79], v[100:103]
ds_read_b64_tr_b16 v[140:141], v8 offset:40960
buffer_load_dwordx4 a[144:147], v254, s[48:51], s32 offen
s_waitcnt lgkmcnt(9)
v_mfma_f32_16x16x32_bf16 v[120:123], v[160:163], v[160:163], v[120:123]
ds_read_b64_tr_b16 v[142:143], v8 offset:41472
s_waitcnt lgkmcnt(8)
v_mfma_f32_16x16x32_bf16 v[72:75], v[124:127], a[80:83], v[72:75]
ds_read_b64_tr_b16 v[144:145], v49 offset:45056
ds_read_b64_tr_b16 v[146:147], v49 offset:45568
v_mfma_f32_16x16x32_bf16 v[88:91], v[124:127], a[84:87], v[88:91]
ds_read_b64_tr_b16 v[148:149], v50 offset:45056
ds_read_b64_tr_b16 v[150:151], v50 offset:45568
s_waitcnt lgkmcnt(10)
v_mfma_f32_16x16x32_bf16 v[76:79], v[128:131], a[80:83], v[76:79]
ds_read_b64_tr_b16 v[152:153], v51 offset:45056
v_mfma_f32_16x16x32_bf16 v[92:95], v[128:131], a[84:87], v[92:95]
ds_read_b64_tr_b16 v[154:155], v51 offset:45568
buffer_load_dwordx4 a[148:151], v254, s[48:51], s33 offen
s_waitcnt lgkmcnt(10)
v_mfma_f32_16x16x32_bf16 v[80:83], v[132:135], a[80:83], v[80:83]
ds_read_b64_tr_b16 v[156:157], v52 offset:45056
v_mfma_f32_16x16x32_bf16 v[96:99], v[132:135], a[84:87], v[96:99]
ds_read_b64_tr_b16 v[158:159], v52 offset:45568
s_waitcnt lgkmcnt(10)
v_mfma_f32_16x16x32_bf16 v[84:87], v[136:139], a[80:83], v[84:87]
ds_read_b64_tr_b16 v[160:161], v8 offset:45056
v_mfma_f32_16x16x32_bf16 v[100:103], v[136:139], a[84:87], v[100:103]
ds_read_b64_tr_b16 v[162:163], v8 offset:45568
buffer_load_dwordx4 a[152:155], v254, s[48:51], s34 offen
s_waitcnt lgkmcnt(10)
v_mfma_f32_16x16x32_bf16 v[120:123], v[140:143], v[140:143], v[120:123]
s_waitcnt lgkmcnt(8)
v_mfma_f32_16x16x32_bf16 v[72:75], v[144:147], a[88:91], v[72:75]
ds_read_b64_tr_b16 v[124:125], v49 offset:49152
ds_read_b64_tr_b16 v[126:127], v49 offset:49664
v_mfma_f32_16x16x32_bf16 v[88:91], v[144:147], a[92:95], v[88:91]
ds_read_b64_tr_b16 v[128:129], v50 offset:49152
ds_read_b64_tr_b16 v[130:131], v50 offset:49664
s_waitcnt lgkmcnt(10)
v_mfma_f32_16x16x32_bf16 v[76:79], v[148:151], a[88:91], v[76:79]
ds_read_b64_tr_b16 v[132:133], v51 offset:49152
v_mfma_f32_16x16x32_bf16 v[92:95], v[148:151], a[92:95], v[92:95]
ds_read_b64_tr_b16 v[134:135], v51 offset:49664
buffer_load_dwordx4 a[156:159], v254, s[48:51], s35 offen
s_waitcnt lgkmcnt(10)
v_mfma_f32_16x16x32_bf16 v[80:83], v[152:155], a[88:91], v[80:83]
ds_read_b64_tr_b16 v[136:137], v52 offset:49152
v_mfma_f32_16x16x32_bf16 v[96:99], v[152:155], a[92:95], v[96:99]
ds_read_b64_tr_b16 v[138:139], v52 offset:49664
s_waitcnt lgkmcnt(10)
v_mfma_f32_16x16x32_bf16 v[84:87], v[156:159], a[88:91], v[84:87]
ds_read_b64_tr_b16 v[140:141], v8 offset:49152
v_mfma_f32_16x16x32_bf16 v[100:103], v[156:159], a[92:95], v[100:103]
ds_read_b64_tr_b16 v[142:143], v8 offset:49664
buffer_load_dwordx4 a[160:163], v254, s[48:51], s36 offen
s_waitcnt lgkmcnt(10)
v_mfma_f32_16x16x32_bf16 v[120:123], v[160:163], v[160:163], v[120:123]
s_waitcnt vmcnt(16) lgkmcnt(8)
v_mfma_f32_16x16x32_bf16 v[72:75], v[124:127], a[96:99], v[72:75]
ds_read_b64_tr_b16 v[144:145], v49 offset:53248
ds_read_b64_tr_b16 v[146:147], v49 offset:53760
s_waitcnt vmcnt(15)
v_mfma_f32_16x16x32_bf16 v[88:91], v[124:127], a[100:103], v[88:91]
ds_read_b64_tr_b16 v[148:149], v50 offset:53248
ds_read_b64_tr_b16 v[150:151], v50 offset:53760
s_waitcnt lgkmcnt(10)
v_mfma_f32_16x16x32_bf16 v[76:79], v[128:131], a[96:99], v[76:79]
ds_read_b64_tr_b16 v[152:153], v51 offset:53248
v_mfma_f32_16x16x32_bf16 v[92:95], v[128:131], a[100:103], v[92:95]
ds_read_b64_tr_b16 v[154:155], v51 offset:53760
buffer_load_dwordx4 a[164:167], v254, s[48:51], s37 offen
s_waitcnt lgkmcnt(10)
v_mfma_f32_16x16x32_bf16 v[80:83], v[132:135], a[96:99], v[80:83]
ds_read_b64_tr_b16 v[156:157], v52 offset:53248
v_mfma_f32_16x16x32_bf16 v[96:99], v[132:135], a[100:103], v[96:99]
ds_read_b64_tr_b16 v[158:159], v52 offset:53760
s_waitcnt lgkmcnt(10)
v_mfma_f32_16x16x32_bf16 v[84:87], v[136:139], a[96:99], v[84:87]
ds_read_b64_tr_b16 v[160:161], v8 offset:53248
v_mfma_f32_16x16x32_bf16 v[100:103], v[136:139], a[100:103], v[100:103]
ds_read_b64_tr_b16 v[162:163], v8 offset:53760
s_waitcnt lgkmcnt(10)
v_mfma_f32_16x16x32_bf16 v[120:123], v[140:143], v[140:143], v[120:123]
s_waitcnt vmcnt(15) lgkmcnt(8)
v_mfma_f32_16x16x32_bf16 v[72:75], v[144:147], a[104:107], v[72:75]
ds_read_u16 v70, v22
s_waitcnt vmcnt(14)
v_mfma_f32_16x16x32_bf16 v[88:91], v[144:147], a[108:111], v[88:91]
v_mov_b32 v69, 0x3727c5ac
s_waitcnt lgkmcnt(7)
v_mfma_f32_16x16x32_bf16 v[76:79], v[148:151], a[104:107], v[76:79]
s_mov_b32 s14, 0x3b124925
v_mfma_f32_16x16x32_bf16 v[92:95], v[148:151], a[108:111], v[92:95]
v_lshlrev_b32 v68, 6, v10
s_waitcnt lgkmcnt(5)
v_mfma_f32_16x16x32_bf16 v[80:83], v[152:155], a[104:107], v[80:83]
v_add_u32 v68, 147456, v68
v_mfma_f32_16x16x32_bf16 v[96:99], v[152:155], a[108:111], v[96:99]
s_waitcnt lgkmcnt(0)
v_lshlrev_b32 v70, 16, v70
v_mfma_f32_16x16x32_bf16 v[84:87], v[156:159], a[104:107], v[84:87]
v_mfma_f32_16x16x32_bf16 v[100:103], v[156:159], a[108:111], v[100:103]
v_mfma_f32_16x16x32_bf16 v[120:123], v[160:163], v[160:163], v[120:123]
s_nop 7
v_cndmask_b32 v120, v120, v121, s[20:21]
v_cndmask_b32 v120, v120, v122, s[22:23]
v_cndmask_b32 v120, v120, v123, s[40:41]
v_fma_f32 v120, -v70, v70, v120
v_fma_f32 v69, |v120|, s14, v69
v_rsq_f32 v69, v69
s_mov_b64 exec, s[8:9]
ds_write_b32 v23, v69
s_mov_b64 exec, -1
s_waitcnt lgkmcnt(0)
s_barrier
ds_read_b128 v[164:167], v68 offset:0
ds_read_b128 v[168:171], v68 offset:16
ds_read_b128 v[172:175], v68 offset:32
ds_read_b128 v[176:179], v68 offset:48
ds_read_b64_tr_b16 v[140:141], v49 offset:0
ds_read_b64_tr_b16 v[142:143], v49 offset:512
ds_read_b64_tr_b16 v[160:161], v50 offset:0
ds_read_b64_tr_b16 v[162:163], v50 offset:512
ds_read_b64_tr_b16 v[180:181], v51 offset:0
ds_read_b64_tr_b16 v[182:183], v51 offset:512
ds_read_b64_tr_b16 v[184:185], v52 offset:0
ds_read_b64_tr_b16 v[186:187], v52 offset:512
s_waitcnt lgkmcnt(11)
v_pk_mul_f32 v[72:73], v[72:73], v[164:165] op_sel:[0,0] op_sel_hi:[1,1]
v_pk_mul_f32 v[88:89], v[88:89], v[164:165] op_sel:[0,0] op_sel_hi:[1,1]
v_pk_mul_f32 v[74:75], v[74:75], v[166:167] op_sel:[0,0] op_sel_hi:[1,1]
v_pk_mul_f32 v[90:91], v[90:91], v[166:167] op_sel:[0,0] op_sel_hi:[1,1]
v_pk_add_f32 v[54:55], v[164:165], v[166:167] op_sel:[0,0] op_sel_hi:[1,1]
s_waitcnt lgkmcnt(10)
v_pk_mul_f32 v[76:77], v[76:77], v[168:169] op_sel:[0,0] op_sel_hi:[1,1]
v_pk_mul_f32 v[92:93], v[92:93], v[168:169] op_sel:[0,0] op_sel_hi:[1,1]
v_pk_mul_f32 v[78:79], v[78:79], v[170:171] op_sel:[0,0] op_sel_hi:[1,1]
v_pk_mul_f32 v[94:95], v[94:95], v[170:171] op_sel:[0,0] op_sel_hi:[1,1]
v_pk_add_f32 v[56:57], v[168:169], v[170:171] op_sel:[0,0] op_sel_hi:[1,1]
s_waitcnt lgkmcnt(9)
v_pk_mul_f32 v[80:81], v[80:81], v[172:173] op_sel:[0,0] op_sel_hi:[1,1]
v_pk_mul_f32 v[96:97], v[96:97], v[172:173] op_sel:[0,0] op_sel_hi:[1,1]
v_pk_mul_f32 v[82:83], v[82:83], v[174:175] op_sel:[0,0] op_sel_hi:[1,1]
v_pk_mul_f32 v[98:99], v[98:99], v[174:175] op_sel:[0,0] op_sel_hi:[1,1]
v_pk_add_f32 v[58:59], v[172:173], v[174:175] op_sel:[0,0] op_sel_hi:[1,1]
s_waitcnt lgkmcnt(8)
v_pk_mul_f32 v[84:85], v[84:85], v[176:177] op_sel:[0,0] op_sel_hi:[1,1]
v_pk_mul_f32 v[100:101], v[100:101], v[176:177] op_sel:[0,0] op_sel_hi:[1,1]
v_pk_mul_f32 v[86:87], v[86:87], v[178:179] op_sel:[0,0] op_sel_hi:[1,1]
v_pk_mul_f32 v[102:103], v[102:103], v[178:179] op_sel:[0,0] op_sel_hi:[1,1]
v_pk_add_f32 v[60:61], v[176:177], v[178:179] op_sel:[0,0] op_sel_hi:[1,1]
v_pk_add_f32 v[54:55], v[54:55], v[56:57] op_sel:[0,0] op_sel_hi:[1,1]
v_pk_add_f32 v[58:59], v[58:59], v[60:61] op_sel:[0,0] op_sel_hi:[1,1]
v_pk_add_f32 v[54:55], v[54:55], v[58:59] op_sel:[0,0] op_sel_hi:[1,1]
v_cmp_u_f32 vcc, v54, v55
s_sub_u32 s72, s72, 1
s_cselect_b64 vcc, 0, vcc
s_cbranch_vccz L_kp_r31ok
s_waitcnt vmcnt(0) lgkmcnt(0)
s_branch L_kp_r31
L_kp_r31ok:
v_pk_fma_f32 v[58:59], v[32:33], v[72:73], v[74:75] op_sel:[0,0,0] op_sel_hi:[0,1,1]
v_pk_fma_f32 v[60:61], v[32:33], v[88:89], v[90:91] op_sel:[0,0,0] op_sel_hi:[0,1,1]
v_pk_fma_f32 v[58:59], v[32:33], v[88:89], v[58:59] op_sel:[1,0,0] op_sel_hi:[1,1,1] neg_lo:[1,0,0] neg_hi:[1,0,0]
s_add_u32 s10, s10, 25165824
s_add_u32 s11, s11, 25165824
s_lshl_b32 s39, s13, 12
s_add_u32 s4, s10, s39
buffer_load_dwordx4 a[0:3], v2, s[48:51], s4 offen
v_pk_fma_f32 v[60:61], v[32:33], v[72:73], v[60:61] op_sel:[1,0,0] op_sel_hi:[1,1,1]
v_pk_fma_f32 v[54:55], v[32:33], v[58:59], v[76:77] op_sel:[0,0,0] op_sel_hi:[0,1,1]
v_pk_fma_f32 v[56:57], v[32:33], v[60:61], v[92:93] op_sel:[0,0,0] op_sel_hi:[0,1,1]
v_pk_fma_f32 v[54:55], v[32:33], v[60:61], v[54:55] op_sel:[1,0,0] op_sel_hi:[1,1,1] neg_lo:[1,0,0] neg_hi:[1,0,0]
v_pk_fma_f32 v[56:57], v[32:33], v[58:59], v[56:57] op_sel:[1,0,0] op_sel_hi:[1,1,1]
s_add_u32 s47, s11, s39
buffer_load_dwordx4 a[4:7], v2, s[48:51], s47 offen
v_pk_fma_f32 v[58:59], v[32:33], v[54:55], v[78:79] op_sel:[0,0,0] op_sel_hi:[0,1,1]
v_pk_fma_f32 v[60:61], v[32:33], v[56:57], v[94:95] op_sel:[0,0,0] op_sel_hi:[0,1,1]
v_pk_fma_f32 v[58:59], v[32:33], v[56:57], v[58:59] op_sel:[1,0,0] op_sel_hi:[1,1,1] neg_lo:[1,0,0] neg_hi:[1,0,0]
v_pk_fma_f32 v[60:61], v[32:33], v[54:55], v[60:61] op_sel:[1,0,0] op_sel_hi:[1,1,1]
v_pk_fma_f32 v[54:55], v[32:33], v[58:59], v[80:81] op_sel:[0,0,0] op_sel_hi:[0,1,1]
buffer_load_dwordx4 a[8:11], v249, s[48:51], s4 offen
v_pk_fma_f32 v[56:57], v[32:33], v[60:61], v[96:97] op_sel:[0,0,0] op_sel_hi:[0,1,1]
v_pk_fma_f32 v[54:55], v[32:33], v[60:61], v[54:55] op_sel:[1,0,0] op_sel_hi:[1,1,1] neg_lo:[1,0,0] neg_hi:[1,0,0]
v_pk_fma_f32 v[56:57], v[32:33], v[58:59], v[56:57] op_sel:[1,0,0] op_sel_hi:[1,1,1]
v_pk_fma_f32 v[58:59], v[32:33], v[54:55], v[82:83] op_sel:[0,0,0] op_sel_hi:[0,1,1]
v_pk_fma_f32 v[60:61], v[32:33], v[56:57], v[98:99] op_sel:[0,0,0] op_sel_hi:[0,1,1]
buffer_load_dwordx4 a[12:15], v249, s[48:51], s47 offen
v_pk_fma_f32 v[58:59], v[32:33], v[56:57], v[58:59] op_sel:[1,0,0] op_sel_hi:[1,1,1] neg_lo:[1,0,0] neg_hi:[1,0,0]
v_pk_fma_f32 v[60:61], v[32:33], v[54:55], v[60:61] op_sel:[1,0,0] op_sel_hi:[1,1,1]
v_pk_fma_f32 v[54:55], v[32:33], v[58:59], v[84:85] op_sel:[0,0,0] op_sel_hi:[0,1,1]
v_pk_fma_f32 v[56:57], v[32:33], v[60:61], v[100:101] op_sel:[0,0,0] op_sel_hi:[0,1,1]
v_pk_fma_f32 v[54:55], v[32:33], v[60:61], v[54:55] op_sel:[1,0,0] op_sel_hi:[1,1,1] neg_lo:[1,0,0] neg_hi:[1,0,0]
v_pk_fma_f32 v[56:57], v[32:33], v[58:59], v[56:57] op_sel:[1,0,0] op_sel_hi:[1,1,1]
s_add_u32 s39, s39, 4096
s_cmp_eq_u32 s39, 28672
s_cselect_b32 s39, 0, s39
s_add_u32 s4, s10, s39
buffer_load_dwordx4 a[16:19], v2, s[48:51], s4 offen
v_pk_fma_f32 v[58:59], v[32:33], v[54:55], v[86:87] op_sel:[0,0,0] op_sel_hi:[0,1,1]
v_pk_fma_f32 v[60:61], v[32:33], v[56:57], v[102:103] op_sel:[0,0,0] op_sel_hi:[0,1,1]
v_pk_fma_f32 v[58:59], v[32:33], v[56:57], v[58:59] op_sel:[1,0,0] op_sel_hi:[1,1,1] neg_lo:[1,0,0] neg_hi:[1,0,0]
v_pk_fma_f32 v[60:61], v[32:33], v[54:55], v[60:61] op_sel:[1,0,0] op_sel_hi:[1,1,1]
v_fma_f32 v54, v42, v58, v59
s_add_u32 s47, s11, s39
buffer_load_dwordx4 a[20:23], v2, s[48:51], s47 offen
v_fma_f32 v55, v42, v60, v61
v_fma_f32 v54, -v43, v60, v54
v_fmac_f32 v55, v43, v58
ds_bpermute_b32 v188, v11, v54 offset:0
ds_bpermute_b32 v189, v11, v55 offset:0
buffer_load_dwordx4 a[24:27], v249, s[48:51], s4 offen
ds_bpermute_b32 v190, v11, v54 offset:64
ds_bpermute_b32 v191, v11, v55 offset:64
ds_bpermute_b32 v192, v11, v54 offset:128
ds_bpermute_b32 v193, v11, v55 offset:128
ds_bpermute_b32 v194, v11, v54 offset:192
ds_bpermute_b32 v195, v11, v55 offset:192
v_mov_b32 v66, 0
v_mov_b32 v67, 0
s_mul_i32 s14, s12, 7168
s_waitcnt lgkmcnt(4)
v_pk_fma_f32 v[56:57], v[34:35], v[188:189], v[190:191] op_sel:[0,0,0] op_sel_hi:[0,1,1]
v_pk_fma_f32 v[56:57], v[34:35], v[188:189], v[56:57] op_sel:[1,1,0] op_sel_hi:[1,0,1] neg_lo:[0,1,0]
s_waitcnt lgkmcnt(2)
v_pk_fma_f32 v[62:63], v[34:35], v[56:57], v[192:193] op_sel:[0,0,0] op_sel_hi:[0,1,1]
v_pk_fma_f32 v[62:63], v[34:35], v[56:57], v[62:63] op_sel:[1,1,0] op_sel_hi:[1,0,1] neg_lo:[0,1,0]
s_waitcnt lgkmcnt(0)
v_pk_fma_f32 v[64:65], v[34:35], v[62:63], v[194:195] op_sel:[0,0,0] op_sel_hi:[0,1,1]
v_pk_fma_f32 v[64:65], v[34:35], v[62:63], v[64:65] op_sel:[1,1,0] op_sel_hi:[1,0,1] neg_lo:[0,1,0]
s_mov_b64 exec, 0xffff
buffer_store_dwordx4 v[64:67], v9, s[60:63], s14 offen sc1
s_mov_b64 exec, -1
v_mov_b32 v196, 0
v_mov_b32 v197, 0
v_cmp_eq_u32 vcc, 1, v10
s_nop 1
v_cndmask_b32 v196, v196, v188, vcc
v_cndmask_b32 v197, v197, v189, vcc
v_cmp_eq_u32 vcc, 2, v10
s_nop 1
v_cndmask_b32 v196, v196, v56, vcc
v_cndmask_b32 v197, v197, v57, vcc
v_cmp_eq_u32 vcc, 3, v10
s_nop 1
v_cndmask_b32 v196, v196, v62, vcc
v_cndmask_b32 v197, v197, v63, vcc
v_mov_b32 v233, 0
v_xor_b32 v70, 16, v19
v_xor_b32 v68, 8, v19
ds_read_b64 v[234:235], v19
ds_read_b64 v[236:237], v68
v_xor_b32 v68, 8, v70
ds_read_b64 v[238:239], v70
ds_read_b64 v[240:241], v68
s_waitcnt vmcnt(9)
v_mfma_f32_16x16x32_bf16 v[104:107], v[124:127], a[160:163], 0
v_mfma_f32_16x16x32_bf16 v[108:111], v[128:131], a[160:163], 0
buffer_load_dwordx4 a[28:31], v249, s[48:51], s47 offen
v_mfma_f32_16x16x32_bf16 v[112:115], v[132:135], a[160:163], 0
v_mfma_f32_16x16x32_bf16 v[116:119], v[136:139], a[160:163], 0
s_waitcnt vmcnt(9)
v_mfma_f32_16x16x32_bf16 v[104:107], v[144:147], a[164:167], v[104:107]
ds_read_b64_tr_b16 v[124:125], v49 offset:4096
ds_read_b64_tr_b16 v[126:127], v49 offset:4608
v_mfma_f32_16x16x32_bf16 v[108:111], v[148:151], a[164:167], v[108:111]
ds_read_b64_tr_b16 v[128:129], v50 offset:4096
ds_read_b64_tr_b16 v[130:131], v50 offset:4608
s_add_u32 s39, s39, 4096
s_cmp_eq_u32 s39, 28672
s_cselect_b32 s39, 0, s39
s_add_u32 s4, s10, s39
buffer_load_dwordx4 a[32:35], v2, s[48:51], s4 offen
v_mfma_f32_16x16x32_bf16 v[112:115], v[152:155], a[164:167], v[112:115]
ds_read_b64_tr_b16 v[132:133], v51 offset:4096
ds_read_b64_tr_b16 v[134:135], v51 offset:4608
v_mfma_f32_16x16x32_bf16 v[116:119], v[156:159], a[164:167], v[116:119]
ds_read_b64_tr_b16 v[136:137], v52 offset:4096
ds_read_b64_tr_b16 v[138:139], v52 offset:4608
v_mfma_f32_16x16x32_bf16 v[104:107], v[140:143], a[112:115], v[104:107]
ds_read_b64_tr_b16 v[144:145], v49 offset:8192
ds_read_b64_tr_b16 v[146:147], v49 offset:8704
v_mfma_f32_16x16x32_bf16 v[108:111], v[160:163], a[112:115], v[108:111]
ds_read_b64_tr_b16 v[148:149], v50 offset:8192
ds_read_b64_tr_b16 v[150:151], v50 offset:8704
s_add_u32 s47, s11, s39
buffer_load_dwordx4 a[36:39], v2, s[48:51], s47 offen
v_mfma_f32_16x16x32_bf16 v[112:115], v[180:183], a[112:115], v[112:115]
ds_read_b64_tr_b16 v[152:153], v51 offset:8192
ds_read_b64_tr_b16 v[154:155], v51 offset:8704
v_mfma_f32_16x16x32_bf16 v[116:119], v[184:187], a[112:115], v[116:119]
ds_read_b64_tr_b16 v[156:157], v52 offset:8192
ds_read_b64_tr_b16 v[158:159], v52 offset:8704
s_waitcnt lgkmcnt(14)
v_mfma_f32_16x16x32_bf16 v[104:107], v[124:127], a[116:119], v[104:107]
ds_read_b64_tr_b16 v[140:141], v49 offset:12288
ds_read_b64_tr_b16 v[142:143], v49 offset:12800
s_waitcnt lgkmcnt(14)
v_mfma_f32_16x16x32_bf16 v[108:111], v[128:131], a[116:119], v[108:111]
ds_read_b64_tr_b16 v[160:161], v50 offset:12288
ds_read_b64_tr_b16 v[162:163], v50 offset:12800
buffer_load_dwordx4 a[40:43], v249, s[48:51], s4 offen
s_waitcnt lgkmcnt(14)
v_mfma_f32_16x16x32_bf16 v[112:115], v[132:135], a[116:119], v[112:115]
ds_read_b64_tr_b16 v[180:181], v51 offset:12288
ds_read_b64_tr_b16 v[182:183], v51 offset:12800
s_waitcnt lgkmcnt(14)
v_mfma_f32_16x16x32_bf16 v[116:119], v[136:139], a[116:119], v[116:119]
ds_read_b64_tr_b16 v[184:185], v52 offset:12288
ds_read_b64_tr_b16 v[186:187], v52 offset:12800
s_waitcnt lgkmcnt(14)
v_mfma_f32_16x16x32_bf16 v[104:107], v[144:147], a[120:123], v[104:107]
ds_read_b64_tr_b16 v[124:125], v49 offset:16384
ds_read_b64_tr_b16 v[126:127], v49 offset:16896
s_waitcnt lgkmcnt(14)
v_mfma_f32_16x16x32_bf16 v[108:111], v[148:151], a[120:123], v[108:111]
ds_read_b64_tr_b16 v[128:129], v50 offset:16384
ds_read_b64_tr_b16 v[130:131], v50 offset:16896
buffer_load_dwordx4 a[44:47], v249, s[48:51], s47 offen
s_waitcnt lgkmcnt(14)
v_mfma_f32_16x16x32_bf16 v[112:115], v[152:155], a[120:123], v[112:115]
ds_read_b64_tr_b16 v[132:133], v51 offset:16384
ds_read_b64_tr_b16 v[134:135], v51 offset:16896
s_waitcnt lgkmcnt(14)
v_mfma_f32_16x16x32_bf16 v[116:119], v[156:159], a[120:123], v[116:119]
ds_read_b64_tr_b16 v[136:137], v52 offset:16384
ds_read_b64_tr_b16 v[138:139], v52 offset:16896
s_waitcnt lgkmcnt(14)
v_mfma_f32_16x16x32_bf16 v[104:107], v[140:143], a[124:127], v[104:107]
ds_read_b64_tr_b16 v[144:145], v49 offset:20480
ds_read_b64_tr_b16 v[146:147], v49 offset:20992
s_waitcnt lgkmcnt(14)
v_mfma_f32_16x16x32_bf16 v[108:111], v[160:163], a[124:127], v[108:111]
ds_read_b64_tr_b16 v[148:149], v50 offset:20480
ds_read_b64_tr_b16 v[150:151], v50 offset:20992
s_add_u32 s39, s39, 4096
s_cmp_eq_u32 s39, 28672
s_cselect_b32 s39, 0, s39
s_add_u32 s4, s10, s39
buffer_load_dwordx4 a[48:51], v2, s[48:51], s4 offen
s_waitcnt lgkmcnt(14)
v_mfma_f32_16x16x32_bf16 v[112:115], v[180:183], a[124:127], v[112:115]
ds_read_b64_tr_b16 v[152:153], v51 offset:20480
ds_read_b64_tr_b16 v[154:155], v51 offset:20992
s_waitcnt lgkmcnt(14)
v_mfma_f32_16x16x32_bf16 v[116:119], v[184:187], a[124:127], v[116:119]
ds_read_b64_tr_b16 v[156:157], v52 offset:20480
ds_read_b64_tr_b16 v[158:159], v52 offset:20992
s_waitcnt lgkmcnt(14)
v_mfma_f32_16x16x32_bf16 v[104:107], v[124:127], a[128:131], v[104:107]
ds_read_b64_tr_b16 v[140:141], v49 offset:24576
ds_read_b64_tr_b16 v[142:143], v49 offset:25088
s_waitcnt lgkmcnt(14)
v_mfma_f32_16x16x32_bf16 v[108:111], v[128:131], a[128:131], v[108:111]
ds_read_b64_tr_b16 v[160:161], v50 offset:24576
ds_read_b64_tr_b16 v[162:163], v50 offset:25088
s_add_u32 s47, s11, s39
buffer_load_dwordx4 a[52:55], v2, s[48:51], s47 offen
s_waitcnt lgkmcnt(14)
v_mfma_f32_16x16x32_bf16 v[112:115], v[132:135], a[128:131], v[112:115]
ds_read_b64_tr_b16 v[180:181], v51 offset:24576
ds_read_b64_tr_b16 v[182:183], v51 offset:25088
s_waitcnt lgkmcnt(14)
v_mfma_f32_16x16x32_bf16 v[116:119], v[136:139], a[128:131], v[116:119]
ds_read_b64_tr_b16 v[184:185], v52 offset:24576
ds_read_b64_tr_b16 v[186:187], v52 offset:25088
s_waitcnt lgkmcnt(14)
v_mfma_f32_16x16x32_bf16 v[104:107], v[144:147], a[132:135], v[104:107]
ds_read_b64_tr_b16 v[124:125], v49 offset:28672
ds_read_b64_tr_b16 v[126:127], v49 offset:29184
s_waitcnt lgkmcnt(14)
v_mfma_f32_16x16x32_bf16 v[108:111], v[148:151], a[132:135], v[108:111]
ds_read_b64_tr_b16 v[128:129], v50 offset:28672
ds_read_b64_tr_b16 v[130:131], v50 offset:29184
buffer_load_dwordx4 a[56:59], v249, s[48:51], s4 offen
s_waitcnt lgkmcnt(14)
v_mfma_f32_16x16x32_bf16 v[112:115], v[152:155], a[132:135], v[112:115]
ds_read_b64_tr_b16 v[132:133], v51 offset:28672
ds_read_b64_tr_b16 v[134:135], v51 offset:29184
s_waitcnt lgkmcnt(14)
v_mfma_f32_16x16x32_bf16 v[116:119], v[156:159], a[132:135], v[116:119]
ds_read_b64_tr_b16 v[136:137], v52 offset:28672
ds_read_b64_tr_b16 v[138:139], v52 offset:29184
s_waitcnt lgkmcnt(14)
v_mfma_f32_16x16x32_bf16 v[104:107], v[140:143], a[136:139], v[104:107]
ds_read_b64_tr_b16 v[144:145], v49 offset:32768
ds_read_b64_tr_b16 v[146:147], v49 offset:33280
s_waitcnt lgkmcnt(14)
v_mfma_f32_16x16x32_bf16 v[108:111], v[160:163], a[136:139], v[108:111]
ds_read_b64_tr_b16 v[148:149], v50 offset:32768
ds_read_b64_tr_b16 v[150:151], v50 offset:33280
buffer_load_dwordx4 a[60:63], v249, s[48:51], s47 offen
s_waitcnt lgkmcnt(14)
v_mfma_f32_16x16x32_bf16 v[112:115], v[180:183], a[136:139], v[112:115]
ds_read_b64_tr_b16 v[152:153], v51 offset:32768
ds_read_b64_tr_b16 v[154:155], v51 offset:33280
s_waitcnt lgkmcnt(14)
v_mfma_f32_16x16x32_bf16 v[116:119], v[184:187], a[136:139], v[116:119]
ds_read_b64_tr_b16 v[156:157], v52 offset:32768
ds_read_b64_tr_b16 v[158:159], v52 offset:33280
s_waitcnt lgkmcnt(14)
v_mfma_f32_16x16x32_bf16 v[104:107], v[124:127], a[140:143], v[104:107]
ds_read_b64_tr_b16 v[140:141], v49 offset:36864
ds_read_b64_tr_b16 v[142:143], v49 offset:37376
s_waitcnt lgkmcnt(14)
v_mfma_f32_16x16x32_bf16 v[108:111], v[128:131], a[140:143], v[108:111]
ds_read_b64_tr_b16 v[160:161], v50 offset:36864
ds_read_b64_tr_b16 v[162:163], v50 offset:37376
s_add_u32 s39, s39, 4096
s_cmp_eq_u32 s39, 28672
s_cselect_b32 s39, 0, s39
s_add_u32 s4, s10, s39
buffer_load_dwordx4 a[64:67], v2, s[48:51], s4 offen
s_waitcnt lgkmcnt(14)
v_mfma_f32_16x16x32_bf16 v[112:115], v[132:135], a[140:143], v[112:115]
ds_read_b64_tr_b16 v[180:181], v51 offset:36864
ds_read_b64_tr_b16 v[182:183], v51 offset:37376
s_waitcnt lgkmcnt(14)
v_mfma_f32_16x16x32_bf16 v[116:119], v[136:139], a[140:143], v[116:119]
ds_read_b64_tr_b16 v[184:185], v52 offset:36864
ds_read_b64_tr_b16 v[186:187], v52 offset:37376
s_waitcnt lgkmcnt(14)
v_mfma_f32_16x16x32_bf16 v[104:107], v[144:147], a[144:147], v[104:107]
ds_read_b64_tr_b16 v[124:125], v49 offset:40960
ds_read_b64_tr_b16 v[126:127], v49 offset:41472
s_waitcnt lgkmcnt(14)
v_mfma_f32_16x16x32_bf16 v[108:111], v[148:151], a[144:147], v[108:111]
ds_read_b64_tr_b16 v[128:129], v50 offset:40960
ds_read_b64_tr_b16 v[130:131], v50 offset:41472
s_add_u32 s47, s11, s39
buffer_load_dwordx4 a[68:71], v2, s[48:51], s47 offen
s_waitcnt lgkmcnt(14)
v_mfma_f32_16x16x32_bf16 v[112:115], v[152:155], a[144:147], v[112:115]
ds_read_b64_tr_b16 v[132:133], v51 offset:40960
ds_read_b64_tr_b16 v[134:135], v51 offset:41472
s_waitcnt lgkmcnt(14)
v_mfma_f32_16x16x32_bf16 v[116:119], v[156:159], a[144:147], v[116:119]
ds_read_b64_tr_b16 v[136:137], v52 offset:40960
ds_read_b64_tr_b16 v[138:139], v52 offset:41472
s_waitcnt lgkmcnt(14)
v_mfma_f32_16x16x32_bf16 v[104:107], v[140:143], a[148:151], v[104:107]
ds_read_b64_tr_b16 v[144:145], v49 offset:45056
ds_read_b64_tr_b16 v[146:147], v49 offset:45568
s_waitcnt lgkmcnt(14)
v_mfma_f32_16x16x32_bf16 v[108:111], v[160:163], a[148:151], v[108:111]
ds_read_b64_tr_b16 v[148:149], v50 offset:45056
ds_read_b64_tr_b16 v[150:151], v50 offset:45568
global_load_dword v232, v233, s[42:43] offset:132 sc1
s_waitcnt lgkmcnt(14)
v_mfma_f32_16x16x32_bf16 v[112:115], v[180:183], a[148:151], v[112:115]
ds_read_b64_tr_b16 v[152:153], v51 offset:45056
ds_read_b64_tr_b16 v[154:155], v51 offset:45568
s_waitcnt lgkmcnt(14)
v_mfma_f32_16x16x32_bf16 v[116:119], v[184:187], a[148:151], v[116:119]
ds_read_b64_tr_b16 v[156:157], v52 offset:45056
ds_read_b64_tr_b16 v[158:159], v52 offset:45568
buffer_load_dwordx4 v[200:203], v24, s[60:63], 0 offen sc1
buffer_load_dwordx4 v[204:207], v25, s[60:63], 0 offen sc1
buffer_load_dwordx4 v[208:211], v26, s[60:63], 0 offen sc1
buffer_load_dwordx4 v[212:215], v27, s[60:63], 0 offen sc1
buffer_load_dwordx4 v[216:219], v28, s[60:63], 0 offen sc1
buffer_load_dwordx4 v[220:223], v29, s[60:63], 0 offen sc1
buffer_load_dwordx4 v[224:227], v30, s[60:63], 0 offen sc1
buffer_load_dwordx4 v[228:231], v31, s[60:63], 0 offen sc1
s_waitcnt lgkmcnt(14)
v_mfma_f32_16x16x32_bf16 v[104:107], v[124:127], a[152:155], v[104:107]
s_waitcnt lgkmcnt(12)
v_mfma_f32_16x16x32_bf16 v[108:111], v[128:131], a[152:155], v[108:111]
s_waitcnt lgkmcnt(10)
v_mfma_f32_16x16x32_bf16 v[112:115], v[132:135], a[152:155], v[112:115]
s_waitcnt lgkmcnt(8)
v_mfma_f32_16x16x32_bf16 v[116:119], v[136:139], a[152:155], v[116:119]
s_waitcnt lgkmcnt(6)
v_mfma_f32_16x16x32_bf16 v[104:107], v[144:147], a[156:159], v[104:107]
s_waitcnt lgkmcnt(4)
v_mfma_f32_16x16x32_bf16 v[108:111], v[148:151], a[156:159], v[108:111]
s_waitcnt lgkmcnt(2)
v_mfma_f32_16x16x32_bf16 v[112:115], v[152:155], a[156:159], v[112:115]
s_waitcnt lgkmcnt(0)
v_mfma_f32_16x16x32_bf16 v[116:119], v[156:159], a[156:159], v[116:119]
v_lshlrev_b32 v124, 16, v234
v_and_b32 v125, 0xffff0000, v234
v_lshlrev_b32 v126, 16, v235
v_and_b32 v127, 0xffff0000, v235
buffer_load_dwordx4 a[72:75], v249, s[48:51], s4 offen
v_lshlrev_b32 v128, 16, v236
v_and_b32 v129, 0xffff0000, v236
v_lshlrev_b32 v130, 16, v237
v_and_b32 v131, 0xffff0000, v237
v_lshlrev_b32 v132, 16, v238
v_and_b32 v133, 0xffff0000, v238
v_lshlrev_b32 v134, 16, v239
buffer_load_dwordx4 a[76:79], v249, s[48:51], s47 offen
v_and_b32 v135, 0xffff0000, v239
v_lshlrev_b32 v136, 16, v240
v_and_b32 v137, 0xffff0000, v240
v_lshlrev_b32 v138, 16, v241
v_and_b32 v139, 0xffff0000, v241
v_pk_fma_f32 v[104:105], v[104:105], v[164:165], v[124:125] op_sel:[0,0,0] op_sel_hi:[1,1,1]
v_pk_fma_f32 v[106:107], v[106:107], v[166:167], v[126:127] op_sel:[0,0,0] op_sel_hi:[1,1,1]
s_add_u32 s39, s39, 4096
s_cmp_eq_u32 s39, 28672
s_cselect_b32 s39, 0, s39
s_add_u32 s4, s10, s39
buffer_load_dwordx4 a[80:83], v2, s[48:51], s4 offen
v_pk_fma_f32 v[108:109], v[108:109], v[168:169], v[128:129] op_sel:[0,0,0] op_sel_hi:[1,1,1]
v_pk_fma_f32 v[110:111], v[110:111], v[170:171], v[130:131] op_sel:[0,0,0] op_sel_hi:[1,1,1]
v_pk_fma_f32 v[112:113], v[112:113], v[172:173], v[132:133] op_sel:[0,0,0] op_sel_hi:[1,1,1]
v_pk_fma_f32 v[114:115], v[114:115], v[174:175], v[134:135] op_sel:[0,0,0] op_sel_hi:[1,1,1]
v_pk_fma_f32 v[116:117], v[116:117], v[176:177], v[136:137] op_sel:[0,0,0] op_sel_hi:[1,1,1]
v_pk_fma_f32 v[118:119], v[118:119], v[178:179], v[138:139] op_sel:[0,0,0] op_sel_hi:[1,1,1]
ds_write_b128 v45, v[104:107] offset:0
s_add_u32 s47, s11, s39
buffer_load_dwordx4 a[84:87], v2, s[48:51], s47 offen
ds_write_b128 v45, v[108:111] offset:4096
ds_write_b128 v45, v[112:115] offset:8192
ds_write_b128 v45, v[116:119] offset:12288
s_waitcnt lgkmcnt(0)
s_barrier
L_kp_lb4:
s_waitcnt vmcnt(9)
v_or3_b32 v68, v202, v206, v210
s_waitcnt vmcnt(6)
v_or3_b32 v69, v214, v218, v222
s_waitcnt vmcnt(4)
v_or3_b32 v68, v68, v226, v230
v_or_b32 v68, v68, v69
v_cmp_eq_u32 s[18:19], 0, v232
v_cmp_ne_u32 vcc, 0, v68
s_nop 0
s_or_b64 vcc, vcc, s[18:19]
s_cbranch_scc0 L_kp_lbx5
s_sub_i32 s73, s73, 1
s_cmp_gt_i32 s73, 0
s_cbranch_scc0 L_kp_lbx5
global_load_dword v232, v233, s[42:43] offset:132 sc1
buffer_load_dwordx4 v[200:203], v24, s[60:63], 0 offen sc1
buffer_load_dwordx4 v[204:207], v25, s[60:63], 0 offen sc1
buffer_load_dwordx4 v[208:211], v26, s[60:63], 0 offen sc1
buffer_load_dwordx4 v[212:215], v27, s[60:63], 0 offen sc1
buffer_load_dwordx4 v[216:219], v28, s[60:63], 0 offen sc1
buffer_load_dwordx4 v[220:223], v29, s[60:63], 0 offen sc1
buffer_load_dwordx4 v[224:227], v30, s[60:63], 0 offen sc1
buffer_load_dwordx4 v[228:231], v31, s[60:63], 0 offen sc1
s_waitcnt vmcnt(0)
s_branch L_kp_lb4
L_kp_lbx5:
v_pk_fma_f32 v[54:55], v[36:37], v[228:229], v[224:225] op_sel:[0,0,0] op_sel_hi:[0,1,1]
v_pk_fma_f32 v[54:55], v[36:37], v[228:229], v[54:55] op_sel:[1,1,0] op_sel_hi:[1,0,1] neg_lo:[0,1,0]
v_pk_fma_f32 v[56:57], v[36:37], v[54:55], v[220:221] op_sel:[0,0,0] op_sel_hi:[0,1,1]
v_pk_fma_f32 v[56:57], v[36:37], v[54:55], v[56:57] op_sel:[1,1,0] op_sel_hi:[1,0,1] neg_lo:[0,1,0]
v_pk_fma_f32 v[54:55], v[36:37], v[56:57], v[216:217] op_sel:[0,0,0] op_sel_hi:[0,1,1]
v_pk_fma_f32 v[54:55], v[36:37], v[56:57], v[54:55] op_sel:[1,1,0] op_sel_hi:[1,0,1] neg_lo:[0,1,0]
buffer_load_dwordx4 a[88:91], v249, s[48:51], s4 offen
v_pk_fma_f32 v[56:57], v[36:37], v[54:55], v[212:213] op_sel:[0,0,0] op_sel_hi:[0,1,1]
v_pk_fma_f32 v[56:57], v[36:37], v[54:55], v[56:57] op_sel:[1,1,0] op_sel_hi:[1,0,1] neg_lo:[0,1,0]
v_pk_fma_f32 v[54:55], v[36:37], v[56:57], v[208:209] op_sel:[0,0,0] op_sel_hi:[0,1,1]
v_pk_fma_f32 v[54:55], v[36:37], v[56:57], v[54:55] op_sel:[1,1,0] op_sel_hi:[1,0,1] neg_lo:[0,1,0]
v_pk_fma_f32 v[56:57], v[36:37], v[54:55], v[204:205] op_sel:[0,0,0] op_sel_hi:[0,1,1]
v_pk_fma_f32 v[56:57], v[36:37], v[54:55], v[56:57] op_sel:[1,1,0] op_sel_hi:[1,0,1] neg_lo:[0,1,0]
v_pk_fma_f32 v[54:55], v[36:37], v[56:57], v[200:201] op_sel:[0,0,0] op_sel_hi:[0,1,1]
v_pk_fma_f32 v[54:55], v[36:37], v[56:57], v[54:55] op_sel:[1,1,0] op_sel_hi:[1,0,1] neg_lo:[0,1,0]
v_pk_mul_f32 v[56:57], v[40:41], v[54:55] op_sel:[0,0] op_sel_hi:[0,1]
v_pk_fma_f32 v[56:57], v[40:41], v[54:55], v[56:57] op_sel:[1,1,0] op_sel_hi:[1,0,1] neg_lo:[0,1,0]
v_mov_b32 v54, v56
v_mov_b32 v55, v57
buffer_load_dwordx4 a[92:95], v249, s[48:51], s47 offen
v_permlane16_swap_b32 v56, v54
v_permlane16_swap_b32 v57, v55
v_pk_add_f32 v[56:57], v[56:57], v[54:55] op_sel:[0,0] op_sel_hi:[1,1]
v_mov_b32 v54, v56
v_mov_b32 v55, v57
s_nop 0
v_permlane32_swap_b32 v56, v54
v_permlane32_swap_b32 v57, v55
v_pk_add_f32 v[56:57], v[56:57], v[54:55] op_sel:[0,0] op_sel_hi:[1,1]
v_fma_f32 v62, v38, v56, v196
v_fma_f32 v64, v38, v57, v197
v_fma_f32 v62, -v39, v57, v62
s_add_u32 s39, s39, 4096
s_cmp_eq_u32 s39, 28672
s_cselect_b32 s39, 0, s39
s_add_u32 s4, s10, s39
buffer_load_dwordx4 a[96:99], v2, s[48:51], s4 offen
v_fmac_f32 v64, v39, v56
v_fma_f32 v63, v42, v62, v58
v_fma_f32 v65, v42, v64, v60
v_fma_f32 v63, -v43, v64, v63
v_fmac_f32 v65, v43, v62
s_lshl_b32 s6, s75, 1
s_add_u32 s6, s6, 12582912
s_add_u32 s5, s6, 57344
v_pk_fma_f32 v[72:73], v[32:33], v[62:63], v[72:73] op_sel:[0,0,0] op_sel_hi:[0,1,1]
v_pk_fma_f32 v[88:89], v[32:33], v[64:65], v[88:89] op_sel:[0,0,0] op_sel_hi:[0,1,1]
v_pk_fma_f32 v[72:73], v[32:33], v[64:65], v[72:73] op_sel:[1,0,0] op_sel_hi:[1,1,1] neg_lo:[1,0,0] neg_hi:[1,0,0]
v_pk_fma_f32 v[88:89], v[32:33], v[62:63], v[88:89] op_sel:[1,0,0] op_sel_hi:[1,1,1]
s_add_u32 s47, s11, s39
buffer_load_dwordx4 a[100:103], v2, s[48:51], s47 offen
v_pk_fma_f32 v[74:75], v[32:33], v[72:73], v[74:75] op_sel:[0,0,0] op_sel_hi:[0,1,1]
v_pk_fma_f32 v[90:91], v[32:33], v[88:89], v[90:91] op_sel:[0,0,0] op_sel_hi:[0,1,1]
v_pk_fma_f32 v[74:75], v[32:33], v[88:89], v[74:75] op_sel:[1,0,0] op_sel_hi:[1,1,1] neg_lo:[1,0,0] neg_hi:[1,0,0]
v_pk_fma_f32 v[90:91], v[32:33], v[72:73], v[90:91] op_sel:[1,0,0] op_sel_hi:[1,1,1]
v_pk_fma_f32 v[76:77], v[32:33], v[74:75], v[76:77] op_sel:[0,0,0] op_sel_hi:[0,1,1]
v_pk_fma_f32 v[92:93], v[32:33], v[90:91], v[92:93] op_sel:[0,0,0] op_sel_hi:[0,1,1]
v_pk_fma_f32 v[76:77], v[32:33], v[90:91], v[76:77] op_sel:[1,0,0] op_sel_hi:[1,1,1] neg_lo:[1,0,0] neg_hi:[1,0,0]
v_pk_fma_f32 v[92:93], v[32:33], v[74:75], v[92:93] op_sel:[1,0,0] op_sel_hi:[1,1,1]
v_pk_fma_f32 v[78:79], v[32:33], v[76:77], v[78:79] op_sel:[0,0,0] op_sel_hi:[0,1,1]
v_pk_fma_f32 v[94:95], v[32:33], v[92:93], v[94:95] op_sel:[0,0,0] op_sel_hi:[0,1,1]
v_pk_fma_f32 v[78:79], v[32:33], v[92:93], v[78:79] op_sel:[1,0,0] op_sel_hi:[1,1,1] neg_lo:[1,0,0] neg_hi:[1,0,0]
buffer_load_dwordx4 a[104:107], v249, s[48:51], s4 offen
v_pk_fma_f32 v[94:95], v[32:33], v[76:77], v[94:95] op_sel:[1,0,0] op_sel_hi:[1,1,1]
v_pk_fma_f32 v[80:81], v[32:33], v[78:79], v[80:81] op_sel:[0,0,0] op_sel_hi:[0,1,1]
v_pk_fma_f32 v[96:97], v[32:33], v[94:95], v[96:97] op_sel:[0,0,0] op_sel_hi:[0,1,1]
v_pk_fma_f32 v[80:81], v[32:33], v[94:95], v[80:81] op_sel:[1,0,0] op_sel_hi:[1,1,1] neg_lo:[1,0,0] neg_hi:[1,0,0]
v_pk_fma_f32 v[96:97], v[32:33], v[78:79], v[96:97] op_sel:[1,0,0] op_sel_hi:[1,1,1]
v_pk_fma_f32 v[82:83], v[32:33], v[80:81], v[82:83] op_sel:[0,0,0] op_sel_hi:[0,1,1]
v_pk_fma_f32 v[98:99], v[32:33], v[96:97], v[98:99] op_sel:[0,0,0] op_sel_hi:[0,1,1]
v_pk_fma_f32 v[82:83], v[32:33], v[96:97], v[82:83] op_sel:[1,0,0] op_sel_hi:[1,1,1] neg_lo:[1,0,0] neg_hi:[1,0,0]
v_pk_fma_f32 v[98:99], v[32:33], v[80:81], v[98:99] op_sel:[1,0,0] op_sel_hi:[1,1,1]
v_pk_fma_f32 v[84:85], v[32:33], v[82:83], v[84:85] op_sel:[0,0,0] op_sel_hi:[0,1,1]
v_pk_fma_f32 v[100:101], v[32:33], v[98:99], v[100:101] op_sel:[0,0,0] op_sel_hi:[0,1,1]
v_pk_fma_f32 v[84:85], v[32:33], v[98:99], v[84:85] op_sel:[1,0,0] op_sel_hi:[1,1,1] neg_lo:[1,0,0] neg_hi:[1,0,0]
buffer_load_dwordx4 a[108:111], v249, s[48:51], s47 offen
v_pk_fma_f32 v[100:101], v[32:33], v[82:83], v[100:101] op_sel:[1,0,0] op_sel_hi:[1,1,1]
v_pk_fma_f32 v[86:87], v[32:33], v[84:85], v[86:87] op_sel:[0,0,0] op_sel_hi:[0,1,1]
v_pk_fma_f32 v[102:103], v[32:33], v[100:101], v[102:103] op_sel:[0,0,0] op_sel_hi:[0,1,1]
v_pk_fma_f32 v[86:87], v[32:33], v[100:101], v[86:87] op_sel:[1,0,0] op_sel_hi:[1,1,1] neg_lo:[1,0,0] neg_hi:[1,0,0]
v_pk_fma_f32 v[102:103], v[32:33], v[84:85], v[102:103] op_sel:[1,0,0] op_sel_hi:[1,1,1]
v_add_u32 v69, 16, v255
v_xor_b32 v70, 1024, v12
v_cvt_pk_bf16_f32 v232, v72, v73
v_cvt_pk_bf16_f32 v233, v74, v75
v_cvt_pk_bf16_f32 v234, v76, v77
v_cvt_pk_bf16_f32 v235, v78, v79
v_cvt_pk_bf16_f32 v236, v80, v81
v_cvt_pk_bf16_f32 v237, v82, v83
v_cvt_pk_bf16_f32 v238, v84, v85
v_cvt_pk_bf16_f32 v239, v86, v87
ds_write_b128 v255, v[232:235] offset:0
ds_write_b128 v69, v[236:239] offset:0
ds_read_b64_tr_b16 v[136:137], v15 offset:0
ds_read_b64_tr_b16 v[138:139], v15 offset:512
ds_read_b64_tr_b16 v[140:141], v16 offset:0
ds_read_b64_tr_b16 v[142:143], v16 offset:512
v_cvt_pk_bf16_f32 v240, -v88, -v89
v_cvt_pk_bf16_f32 v241, -v90, -v91
v_cvt_pk_bf16_f32 v242, -v92, -v93
v_cvt_pk_bf16_f32 v243, -v94, -v95
v_cvt_pk_bf16_f32 v244, -v96, -v97
v_cvt_pk_bf16_f32 v245, -v98, -v99
v_cvt_pk_bf16_f32 v246, -v100, -v101
v_cvt_pk_bf16_f32 v247, -v102, -v103
ds_write_b128 v255, v[240:243] offset:8192
ds_write_b128 v69, v[244:247] offset:8192
ds_read_b64_tr_b16 v[144:145], v15 offset:8192
ds_read_b64_tr_b16 v[146:147], v15 offset:8704
ds_read_b64_tr_b16 v[148:149], v16 offset:8192
ds_read_b64_tr_b16 v[150:151], v16 offset:8704
s_waitcnt lgkmcnt(0)
s_cmp_eq_u32 s3, 0
s_cbranch_scc1 L_kp_st6
buffer_store_dwordx4 v[136:139], v12, s[48:51], s6 offen
buffer_store_dwordx4 v[140:143], v70, s[48:51], s6 offen
buffer_store_dwordx4 v[144:147], v12, s[48:51], s5 offen
buffer_store_dwordx4 v[148:151], v70, s[48:51], s5 offen
s_branch L_kp_st7
L_kp_st6:
buffer_store_dwordx4 v[136:139], v12, s[48:51], s6 offen sc1
buffer_store_dwordx4 v[140:143], v70, s[48:51], s6 offen sc1
buffer_store_dwordx4 v[144:147], v12, s[48:51], s5 offen sc1
buffer_store_dwordx4 v[148:151], v70, s[48:51], s5 offen sc1
s_waitcnt vmcnt(0)
L_kp_st7:
v_add_u32 v62, 57344, v14
v_add_u32 v63, 57344, v18
s_add_u32 s47, s6, 57344
s_lshl_b32 s72, s13, 13
s_add_u32 s72, s72, s6
v_mov_b32 v61, 0
ds_read_b128 v[72:75], v46 offset:0
ds_read_b128 v[76:79], v47 offset:4096
ds_read_b128 v[80:83], v46 offset:8192
ds_read_b128 v[84:87], v47 offset:12288
s_xor_b32 s14, s7, 1
s_mul_i32 s14, s14, 12288
s_add_u32 s14, s14, 0
v_add_u32 v55, s14, v2
s_xor_b32 s14, s7, 2
s_mul_i32 s14, s14, 12288
s_add_u32 s14, s14, 4096
v_add_u32 v56, s14, v2
s_xor_b32 s14, s7, 3
s_mul_i32 s14, s14, 12288
s_add_u32 s14, s14, 8192
v_add_u32 v57, s14, v2
s_mul_i32 s14, s7, 12288
s_add_u32 s14, s14, 0
v_add_u32 v58, s14, v2
s_waitcnt lgkmcnt(0)
v_mfma_f32_32x32x16_bf16 v[72:87], v[136:139], a[0:3], v[72:87]
s_add_u32 s4, s72, 8192
s_cmp_eq_u32 s4, s47
s_cselect_b32 s4, s6, s4
buffer_load_dwordx4 v[152:155], v14, s[48:51], s4 offen sc1
v_mfma_f32_32x32x16_bf16 v[88:103], v[136:139], a[4:7], 0
buffer_load_dwordx4 v[156:159], v18, s[48:51], s4 offen sc1
v_mfma_f32_32x32x16_bf16 v[104:119], v[140:143], a[0:3], 0
buffer_load_dwordx4 v[160:163], v62, s[48:51], s4 offen sc1
v_mfma_f32_32x32x16_bf16 v[120:135], v[140:143], a[4:7], 0
v_mfma_f32_32x32x16_bf16 v[72:87], v[144:147], a[8:11], v[72:87]
buffer_load_dwordx4 v[164:167], v63, s[48:51], s4 offen sc1
v_mfma_f32_32x32x16_bf16 v[88:103], v[144:147], a[12:15], v[88:103]
s_add_u32 s5, s4, 8192
s_cmp_eq_u32 s5, s47
s_cselect_b32 s5, s6, s5
buffer_load_dwordx4 v[168:171], v14, s[48:51], s5 offen sc1
v_mfma_f32_32x32x16_bf16 v[104:119], v[148:151], a[8:11], v[104:119]
buffer_load_dwordx4 v[172:175], v18, s[48:51], s5 offen sc1
v_mfma_f32_32x32x16_bf16 v[120:135], v[148:151], a[12:15], v[120:135]
s_waitcnt vmcnt(4)
v_max_u32 v54, v155, v159
v_cmp_eq_u32 vcc, -1, v54
s_nop 0
s_cbranch_vccnz L_kp_redo8
L_kp_back9:
v_mfma_f32_32x32x16_bf16 v[72:87], v[152:155], a[16:19], v[72:87]
buffer_load_dwordx4 v[176:179], v62, s[48:51], s5 offen sc1
v_mfma_f32_32x32x16_bf16 v[88:103], v[152:155], a[20:23], v[88:103]
buffer_load_dwordx4 v[180:183], v63, s[48:51], s5 offen sc1
v_mfma_f32_32x32x16_bf16 v[104:119], v[156:159], a[16:19], v[104:119]
s_add_u32 s17, s5, 8192
s_cmp_eq_u32 s17, s47
s_cselect_b32 s17, s6, s17
buffer_load_dwordx4 v[184:187], v14, s[48:51], s17 offen sc1
v_mfma_f32_32x32x16_bf16 v[120:135], v[156:159], a[20:23], v[120:135]
s_waitcnt vmcnt(5)
v_max_u32 v54, v163, v167
v_cmp_eq_u32 vcc, -1, v54
s_nop 0
s_cbranch_vccnz L_kp_redo10
L_kp_back11:
v_mfma_f32_32x32x16_bf16 v[72:87], v[160:163], a[24:27], v[72:87]
buffer_load_dwordx4 v[188:191], v18, s[48:51], s17 offen sc1
v_mfma_f32_32x32x16_bf16 v[88:103], v[160:163], a[28:31], v[88:103]
buffer_load_dwordx4 v[192:195], v62, s[48:51], s17 offen sc1
v_mfma_f32_32x32x16_bf16 v[104:119], v[164:167], a[24:27], v[104:119]
buffer_load_dwordx4 v[196:199], v63, s[48:51], s17 offen sc1
v_mfma_f32_32x32x16_bf16 v[120:135], v[164:167], a[28:31], v[120:135]
s_waitcnt vmcnt(6)
v_max_u32 v54, v171, v175
v_cmp_eq_u32 vcc, -1, v54
s_nop 0
s_cbranch_vccnz L_kp_redo12
L_kp_back13:
v_mfma_f32_32x32x16_bf16 v[72:87], v[168:171], a[32:35], v[72:87]
s_add_u32 s18, s17, 8192
s_cmp_eq_u32 s18, s47
s_cselect_b32 s18, s6, s18
buffer_load_dwordx4 v[200:203], v14, s[48:51], s18 offen sc1
v_mfma_f32_32x32x16_bf16 v[88:103], v[168:171], a[36:39], v[88:103]
buffer_load_dwordx4 v[204:207], v18, s[48:51], s18 offen sc1
v_mfma_f32_32x32x16_bf16 v[104:119], v[172:175], a[32:35], v[104:119]
buffer_load_dwordx4 v[208:211], v62, s[48:51], s18 offen sc1
v_mfma_f32_32x32x16_bf16 v[120:135], v[172:175], a[36:39], v[120:135]
s_waitcnt vmcnt(7)
v_max_u32 v54, v179, v183
v_cmp_eq_u32 vcc, -1, v54
s_nop 0
s_cbranch_vccnz L_kp_redo14
L_kp_back15:
v_mfma_f32_32x32x16_bf16 v[72:87], v[176:179], a[40:43], v[72:87]
buffer_load_dwordx4 v[212:215], v63, s[48:51], s18 offen sc1
v_mfma_f32_32x32x16_bf16 v[88:103], v[176:179], a[44:47], v[88:103]
s_add_u32 s19, s18, 8192
s_cmp_eq_u32 s19, s47
s_cselect_b32 s19, s6, s19
buffer_load_dwordx4 v[216:219], v14, s[48:51], s19 offen sc1
v_mfma_f32_32x32x16_bf16 v[104:119], v[180:183], a[40:43], v[104:119]
buffer_load_dwordx4 v[220:223], v18, s[48:51], s19 offen sc1
v_mfma_f32_32x32x16_bf16 v[120:135], v[180:183], a[44:47], v[120:135]
s_waitcnt vmcnt(8)
v_max_u32 v54, v187, v191
v_cmp_eq_u32 vcc, -1, v54
s_nop 0
s_cbranch_vccnz L_kp_redo16
L_kp_back17:
v_mfma_f32_32x32x16_bf16 v[72:87], v[184:187], a[48:51], v[72:87]
buffer_load_dwordx4 v[224:227], v62, s[48:51], s19 offen sc1
v_mfma_f32_32x32x16_bf16 v[88:103], v[184:187], a[52:55], v[88:103]
buffer_load_dwordx4 v[228:231], v63, s[48:51], s19 offen sc1
v_mfma_f32_32x32x16_bf16 v[104:119], v[188:191], a[48:51], v[104:119]
s_add_u32 s39, s19, 8192
s_cmp_eq_u32 s39, s47
s_cselect_b32 s39, s6, s39
buffer_load_dwordx4 v[232:235], v14, s[48:51], s39 offen sc1
v_mfma_f32_32x32x16_bf16 v[120:135], v[188:191], a[52:55], v[120:135]
s_waitcnt vmcnt(9)
v_max_u32 v54, v195, v199
v_cmp_eq_u32 vcc, -1, v54
s_nop 0
s_cbranch_vccnz L_kp_redo18
L_kp_back19:
v_mfma_f32_32x32x16_bf16 v[72:87], v[192:195], a[56:59], v[72:87]
buffer_load_dwordx4 v[236:239], v18, s[48:51], s39 offen sc1
v_mfma_f32_32x32x16_bf16 v[88:103], v[192:195], a[60:63], v[88:103]
buffer_load_dwordx4 v[240:243], v62, s[48:51], s39 offen sc1
v_mfma_f32_32x32x16_bf16 v[104:119], v[196:199], a[56:59], v[104:119]
buffer_load_dwordx4 v[244:247], v63, s[48:51], s39 offen sc1
v_mfma_f32_32x32x16_bf16 v[120:135], v[196:199], a[60:63], v[120:135]
s_waitcnt vmcnt(10)
v_max_u32 v54, v203, v207
v_cmp_eq_u32 vcc, -1, v54
s_nop 0
s_cbranch_vccnz L_kp_redo20
L_kp_back21:
v_mfma_f32_32x32x16_bf16 v[72:87], v[200:203], a[64:67], v[72:87]
global_load_dword v60, v61, s[42:43] offset:136 sc1
v_mfma_f32_32x32x16_bf16 v[88:103], v[200:203], a[68:71], v[88:103]
v_mfma_f32_32x32x16_bf16 v[104:119], v[204:207], a[64:67], v[104:119]
v_mfma_f32_32x32x16_bf16 v[120:135], v[204:207], a[68:71], v[120:135]
s_waitcnt vmcnt(9)
v_max_u32 v54, v211, v215
v_cmp_eq_u32 vcc, -1, v54
s_nop 0
s_cbranch_vccnz L_kp_redo22
L_kp_back23:
v_mfma_f32_32x32x16_bf16 v[88:103], v[208:211], a[76:79], v[88:103]
s_waitcnt vmcnt(7)
v_max_u32 v54, v219, v223
v_cmp_eq_u32 vcc, -1, v54
s_nop 0
s_cbranch_vccnz L_kp_redo24
L_kp_back25:
v_mfma_f32_32x32x16_bf16 v[88:103], v[216:219], a[84:87], v[88:103]
s_waitcnt vmcnt(5)
v_max_u32 v54, v227, v231
v_cmp_eq_u32 vcc, -1, v54
s_nop 0
s_cbranch_vccnz L_kp_redo26
L_kp_back27:
v_mfma_f32_32x32x16_bf16 v[88:103], v[224:227], a[92:95], v[88:103]
s_waitcnt vmcnt(3)
v_max_u32 v54, v235, v239
v_cmp_eq_u32 vcc, -1, v54
s_nop 0
s_cbranch_vccnz L_kp_redo28
L_kp_back29:
v_mfma_f32_32x32x16_bf16 v[88:103], v[232:235], a[100:103], v[88:103]
s_waitcnt vmcnt(1)
v_max_u32 v54, v243, v247
v_cmp_eq_u32 vcc, -1, v54
s_nop 0
s_cbranch_vccnz L_kp_redo30
L_kp_back31:
v_mfma_f32_32x32x16_bf16 v[88:103], v[240:243], a[108:111], v[88:103]
v_mfma_f32_32x32x16_bf16 v[104:119], v[212:215], a[72:75], v[104:119]
v_mfma_f32_32x32x16_bf16 v[104:119], v[220:223], a[80:83], v[104:119]
s_nop 9
ds_write_b128 v55, v[88:91] offset:0
v_mfma_f32_32x32x16_bf16 v[104:119], v[228:231], a[88:91], v[104:119]
ds_write_b128 v55, v[92:95] offset:1024
v_mfma_f32_32x32x16_bf16 v[104:119], v[236:239], a[96:99], v[104:119]
ds_write_b128 v55, v[96:99] offset:2048
v_mfma_f32_32x32x16_bf16 v[104:119], v[244:247], a[104:107], v[104:119]
ds_write_b128 v55, v[100:103] offset:3072
v_mfma_f32_32x32x16_bf16 v[120:135], v[212:215], a[76:79], v[120:135]
v_mfma_f32_32x32x16_bf16 v[120:135], v[220:223], a[84:87], v[120:135]
s_nop 8
ds_write_b128 v56, v[104:107] offset:0
v_mfma_f32_32x32x16_bf16 v[120:135], v[228:231], a[92:95], v[120:135]
ds_write_b128 v56, v[108:111] offset:1024
v_mfma_f32_32x32x16_bf16 v[120:135], v[236:239], a[100:103], v[120:135]
ds_write_b128 v56, v[112:115] offset:2048
v_mfma_f32_32x32x16_bf16 v[120:135], v[244:247], a[108:111], v[120:135]
ds_write_b128 v56, v[116:119] offset:3072
v_mfma_f32_32x32x16_bf16 v[72:87], v[208:211], a[72:75], v[72:87]
v_mfma_f32_32x32x16_bf16 v[72:87], v[216:219], a[80:83], v[72:87]
s_nop 8
ds_write_b128 v57, v[120:123] offset:0
v_mfma_f32_32x32x16_bf16 v[72:87], v[224:227], a[88:91], v[72:87]
ds_write_b128 v57, v[124:127] offset:1024
v_mfma_f32_32x32x16_bf16 v[72:87], v[232:235], a[96:99], v[72:87]
ds_write_b128 v57, v[128:131] offset:2048
v_mfma_f32_32x32x16_bf16 v[72:87], v[240:243], a[104:107], v[72:87]
ds_write_b128 v57, v[132:135] offset:3072
s_waitcnt vmcnt(0)
v_cmp_eq_u32 vcc, 0, v60
s_nop 0
s_cbranch_vccnz L_kp_redo32
L_kp_back33:
s_waitcnt lgkmcnt(0)
s_barrier
ds_read_b128 v[88:91], v58 offset:0
ds_read_b128 v[92:95], v58 offset:1024
ds_read_b128 v[96:99], v58 offset:2048
ds_read_b128 v[100:103], v58 offset:3072
ds_read_b128 v[104:107], v58 offset:4096
ds_read_b128 v[108:111], v58 offset:5120
ds_read_b128 v[112:115], v58 offset:6144
ds_read_b128 v[116:119], v58 offset:7168
ds_read_b128 v[120:123], v58 offset:8192
ds_read_b128 v[124:127], v58 offset:9216
ds_read_b128 v[128:131], v58 offset:10240
ds_read_b128 v[132:135], v58 offset:11264
s_waitcnt lgkmcnt(11)
v_pk_add_f32 v[72:73], v[72:73], v[88:89] op_sel:[0,0] op_sel_hi:[1,1]
v_pk_add_f32 v[74:75], v[74:75], v[90:91] op_sel:[0,0] op_sel_hi:[1,1]
s_waitcnt lgkmcnt(10)
v_pk_add_f32 v[76:77], v[76:77], v[92:93] op_sel:[0,0] op_sel_hi:[1,1]
v_pk_add_f32 v[78:79], v[78:79], v[94:95] op_sel:[0,0] op_sel_hi:[1,1]
s_waitcnt lgkmcnt(9)
v_pk_add_f32 v[80:81], v[80:81], v[96:97] op_sel:[0,0] op_sel_hi:[1,1]
v_pk_add_f32 v[82:83], v[82:83], v[98:99] op_sel:[0,0] op_sel_hi:[1,1]
s_waitcnt lgkmcnt(8)
v_pk_add_f32 v[84:85], v[84:85], v[100:101] op_sel:[0,0] op_sel_hi:[1,1]
v_pk_add_f32 v[86:87], v[86:87], v[102:103] op_sel:[0,0] op_sel_hi:[1,1]
s_waitcnt lgkmcnt(3)
v_pk_add_f32 v[104:105], v[104:105], v[120:121] op_sel:[0,0] op_sel_hi:[1,1]
v_pk_add_f32 v[106:107], v[106:107], v[122:123] op_sel:[0,0] op_sel_hi:[1,1]
s_waitcnt lgkmcnt(2)
v_pk_add_f32 v[108:109], v[108:109], v[124:125] op_sel:[0,0] op_sel_hi:[1,1]
v_pk_add_f32 v[110:111], v[110:111], v[126:127] op_sel:[0,0] op_sel_hi:[1,1]
s_waitcnt lgkmcnt(1)
v_pk_add_f32 v[112:113], v[112:113], v[128:129] op_sel:[0,0] op_sel_hi:[1,1]
v_pk_add_f32 v[114:115], v[114:115], v[130:131] op_sel:[0,0] op_sel_hi:[1,1]
s_waitcnt lgkmcnt(0)
v_pk_add_f32 v[116:117], v[116:117], v[132:133] op_sel:[0,0] op_sel_hi:[1,1]
v_pk_add_f32 v[118:119], v[118:119], v[134:135] op_sel:[0,0] op_sel_hi:[1,1]
v_pk_add_f32 v[72:73], v[72:73], v[104:105] op_sel:[0,0] op_sel_hi:[1,1]
v_pk_add_f32 v[74:75], v[74:75], v[106:107] op_sel:[0,0] op_sel_hi:[1,1]
v_pk_add_f32 v[76:77], v[76:77], v[108:109] op_sel:[0,0] op_sel_hi:[1,1]
v_pk_add_f32 v[78:79], v[78:79], v[110:111] op_sel:[0,0] op_sel_hi:[1,1]
v_pk_add_f32 v[80:81], v[80:81], v[112:113] op_sel:[0,0] op_sel_hi:[1,1]
v_pk_add_f32 v[82:83], v[82:83], v[114:115] op_sel:[0,0] op_sel_hi:[1,1]
v_pk_add_f32 v[84:85], v[84:85], v[116:117] op_sel:[0,0] op_sel_hi:[1,1]
v_pk_add_f32 v[86:87], v[86:87], v[118:119] op_sel:[0,0] op_sel_hi:[1,1]
s_add_u32 s14, s71, 6291456
s_add_u32 s17, s14, 65536
v_cvt_pk_bf16_f32 v136, v72, v73
v_cvt_pk_bf16_f32 v137, v74, v75
v_cvt_pk_bf16_f32 v138, v76, v77
v_cvt_pk_bf16_f32 v139, v78, v79
v_cvt_pk_bf16_f32 v140, v80, v81
v_cvt_pk_bf16_f32 v141, v82, v83
v_cvt_pk_bf16_f32 v142, v84, v85
v_cvt_pk_bf16_f32 v143, v86, v87
v_permlane16_swap_b32 v136, v140
v_permlane16_swap_b32 v137, v141
v_permlane16_swap_b32 v138, v142
v_permlane16_swap_b32 v139, v143
buffer_store_dwordx4 v[136:139], v17, s[48:51], s14 offen sc1
buffer_store_dwordx4 v[140:143], v17, s[48:51], s17 offen sc1
v_pk_mul_f32 v[120:121], v[72:73], v[72:73] op_sel:[0,0] op_sel_hi:[1,1]
v_pk_mul_f32 v[122:123], v[74:75], v[74:75] op_sel:[0,0] op_sel_hi:[1,1]
v_pk_mul_f32 v[124:125], v[76:77], v[76:77] op_sel:[0,0] op_sel_hi:[1,1]
v_pk_mul_f32 v[126:127], v[78:79], v[78:79] op_sel:[0,0] op_sel_hi:[1,1]
v_pk_mul_f32 v[128:129], v[80:81], v[80:81] op_sel:[0,0] op_sel_hi:[1,1]
v_pk_mul_f32 v[130:131], v[82:83], v[82:83] op_sel:[0,0] op_sel_hi:[1,1]
v_pk_mul_f32 v[132:133], v[84:85], v[84:85] op_sel:[0,0] op_sel_hi:[1,1]
v_pk_mul_f32 v[134:135], v[86:87], v[86:87] op_sel:[0,0] op_sel_hi:[1,1]
s_add_u32 s14, s13, s16
s_cmp_lg_u32 s14, 0
s_cbranch_scc1 L_kp_nm34
v_pk_mul_f32 v[120:121], v[120:121], v[20:21] op_sel:[0,1] op_sel_hi:[1,1]
v_pk_mul_f32 v[122:123], v[122:123], v[20:21] op_sel:[0,1] op_sel_hi:[1,1]
v_pk_mul_f32 v[124:125], v[124:125], v[20:21] op_sel:[0,1] op_sel_hi:[1,1]
v_pk_mul_f32 v[126:127], v[126:127], v[20:21] op_sel:[0,1] op_sel_hi:[1,1]
v_pk_mul_f32 v[128:129], v[128:129], v[20:21] op_sel:[0,1] op_sel_hi:[1,1]
v_pk_mul_f32 v[130:131], v[130:131], v[20:21] op_sel:[0,1] op_sel_hi:[1,1]
v_pk_mul_f32 v[132:133], v[132:133], v[20:21] op_sel:[0,1] op_sel_hi:[1,1]
v_pk_mul_f32 v[134:135], v[134:135], v[20:21] op_sel:[0,1] op_sel_hi:[1,1]
L_kp_nm34:
v_permlane16_swap_b32 v120, v128
v_permlane16_swap_b32 v121, v129
v_permlane16_swap_b32 v122, v130
v_permlane16_swap_b32 v123, v131
v_permlane16_swap_b32 v124, v132
v_permlane16_swap_b32 v125, v133
v_permlane16_swap_b32 v126, v134
v_permlane16_swap_b32 v127, v135
v_pk_add_f32 v[120:121], v[120:121], v[128:129] op_sel:[0,0] op_sel_hi:[1,1]
v_pk_add_f32 v[122:123], v[122:123], v[130:131] op_sel:[0,0] op_sel_hi:[1,1]
v_pk_add_f32 v[124:125], v[124:125], v[132:133] op_sel:[0,0] op_sel_hi:[1,1]
v_pk_add_f32 v[126:127], v[126:127], v[134:135] op_sel:[0,0] op_sel_hi:[1,1]
buffer_load_dwordx4 a[0:3], v252, s[48:51], s24 offen
v_and_b32 v54, 8, v1
v_cmp_ne_u32 vcc, 0, v54
s_nop 1
v_cndmask_b32 v128, v124, v120, vcc
v_cndmask_b32 v120, v120, v124, vcc
v_cndmask_b32 v129, v125, v121, vcc
v_cndmask_b32 v121, v121, v125, vcc
v_cndmask_b32 v130, v126, v122, vcc
v_cndmask_b32 v122, v122, v126, vcc
v_cndmask_b32 v131, v127, v123, vcc
v_cndmask_b32 v123, v123, v127, vcc
v_add_f32_dpp v120, v128, v120 row_ror:8 row_mask:0xf bank_mask:0xf
v_add_f32_dpp v121, v129, v121 row_ror:8 row_mask:0xf bank_mask:0xf
v_add_f32_dpp v122, v130, v122 row_ror:8 row_mask:0xf bank_mask:0xf
v_add_f32_dpp v123, v131, v123 row_ror:8 row_mask:0xf bank_mask:0xf
v_and_b32 v54, 4, v1
v_cmp_ne_u32 vcc, 0, v54
s_nop 1
v_cndmask_b32 v128, v122, v120, vcc
v_cndmask_b32 v120, v120, v122, vcc
v_cndmask_b32 v129, v123, v121, vcc
v_cndmask_b32 v121, v121, v123, vcc
v_add_f32_dpp v120, v128, v120 row_half_mirror row_mask:0xf bank_mask:0xf
s_nop 0
v_add_f32_dpp v121, v129, v121 row_half_mirror row_mask:0xf bank_mask:0xf
v_and_b32 v54, 2, v1
buffer_load_dwordx4 a[4:7], v253, s[48:51], s24 offen
v_cmp_ne_u32 vcc, 0, v54
s_nop 1
v_cndmask_b32 v128, v121, v120, vcc
v_cndmask_b32 v120, v120, v121, vcc
s_nop 1
v_add_f32_dpp v120, v128, v120 quad_perm:[2,3,0,1] row_mask:0xf bank_mask:0xf
s_nop 1
v_add_f32_dpp v120, v120, v120 quad_perm:[1,0,3,2] row_mask:0xf bank_mask:0xf
ds_write_b32 v20, v120
v_lshlrev_b32 v54, 5, v1
v_add_u32 v54, 147712, v54
s_lshl_b32 s14, s13, 12
s_add_u32 s14, s14, s71
s_add_u32 s14, s14, 27394048
s_waitcnt lgkmcnt(0)
s_barrier
s_mov_b64 exec, 0xff
ds_read_b128 v[120:123], v54
ds_read_b128 v[128:131], v54 offset:256
ds_read_b128 v[124:127], v54 offset:16
ds_read_b128 v[132:135], v54 offset:272
s_waitcnt lgkmcnt(2)
v_pk_add_f32 v[120:121], v[120:121], v[128:129] op_sel:[0,0] op_sel_hi:[1,1]
v_pk_add_f32 v[122:123], v[122:123], v[130:131] op_sel:[0,0] op_sel_hi:[1,1]
s_waitcnt lgkmcnt(0)
v_pk_add_f32 v[124:125], v[124:125], v[132:133] op_sel:[0,0] op_sel_hi:[1,1]
v_pk_add_f32 v[126:127], v[126:127], v[134:135] op_sel:[0,0] op_sel_hi:[1,1]
v_cvt_pk_bf16_f32 v120, v120, v121
v_cvt_pk_bf16_f32 v121, v122, v123
v_cvt_pk_bf16_f32 v122, v124, v125
v_cvt_pk_bf16_f32 v123, v126, v127
buffer_store_dwordx4 v[120:123], v2, s[52:55], s14 offen sc1
s_mov_b64 exec, -1
buffer_load_dwordx4 a[8:11], v252, s[48:51], s25 offen
buffer_load_dwordx4 a[12:15], v253, s[48:51], s25 offen
buffer_load_dwordx4 a[16:19], v252, s[48:51], s26 offen
buffer_load_dwordx4 a[20:23], v253, s[48:51], s26 offen
v_lshrrev_b32 v54, 4, v9
s_lshr_b32 s14, s24, 6
v_lshl_add_u32 v64, v10, 2, s14
v_mul_u32_u24 v55, v64, v54
v_and_b32 v64, 1, v54
v_lshlrev_b32 v63, 31, v64
v_or_b32 v58, 1.0, v63
v_or_b32 v63, 0x3d423d42, v63
v_cvt_f32_u32 v54, v54
v_cvt_f32_u32 v55, v55
v_mul_f32 v64, 0x3b124925, v55
v_floor_f32 v64, v64
v_fmac_f32 v55, 0xc3e00000, v64
v_mul_f32 v64, 0x3d124925, v54
v_cos_f32 v56, v64
v_mov_b32 v60, 0
v_mov_b32 v61, 0x3e800000
v_mov_b32 v62, 0x3d88d677
s_mov_b32 s14, 0x3b124925
v_add_f32 v56, v56, v56
v_cmp_gt_u32 s[18:19], 16, v1
v_fmamk_f32 v66, v54, 0x00000000, v55
v_fmamk_f32 v68, v54, 0x3f800000, v55
v_fmamk_f32 v70, v54, 0x40000000, v55
v_fmamk_f32 v72, v54, 0x40400000, v55
v_fmamk_f32 v74, v54, 0x41800000, v55
v_fmamk_f32 v76, v54, 0x41880000, v55
v_fmamk_f32 v78, v54, 0x41900000, v55
v_fmamk_f32 v80, v54, 0x41980000, v55
v_pk_fma_f32 v[66:67], v[66:67], s[14:15], v[60:61] op_sel:[0,0,0] op_sel_hi:[0,0,1]
v_pk_fma_f32 v[68:69], v[68:69], s[14:15], v[60:61] op_sel:[0,0,0] op_sel_hi:[0,0,1]
v_pk_fma_f32 v[70:71], v[70:71], s[14:15], v[60:61] op_sel:[0,0,0] op_sel_hi:[0,0,1]
v_pk_fma_f32 v[72:73], v[72:73], s[14:15], v[60:61] op_sel:[0,0,0] op_sel_hi:[0,0,1]
v_pk_fma_f32 v[74:75], v[74:75], s[14:15], v[60:61] op_sel:[0,0,0] op_sel_hi:[0,0,1]
v_pk_fma_f32 v[76:77], v[76:77], s[14:15], v[60:61] op_sel:[0,0,0] op_sel_hi:[0,0,1]
v_pk_fma_f32 v[78:79], v[78:79], s[14:15], v[60:61] op_sel:[0,0,0] op_sel_hi:[0,0,1]
v_pk_fma_f32 v[80:81], v[80:81], s[14:15], v[60:61] op_sel:[0,0,0] op_sel_hi:[0,0,1]
v_cos_f32 v66, v66
v_cos_f32 v67, v67
v_cos_f32 v68, v68
v_cos_f32 v69, v69
v_cos_f32 v70, v70
v_cos_f32 v71, v71
v_cos_f32 v72, v72
v_cos_f32 v73, v73
v_cos_f32 v74, v74
v_cos_f32 v75, v75
v_cos_f32 v76, v76
v_cos_f32 v77, v77
v_cos_f32 v78, v78
v_cos_f32 v79, v79
v_cos_f32 v80, v80
v_cos_f32 v81, v81
v_pk_mul_f32 v[66:67], v[66:67], v[62:63] op_sel:[0,0] op_sel_hi:[1,0]
v_pk_mul_f32 v[68:69], v[68:69], v[62:63] op_sel:[0,0] op_sel_hi:[1,0]
v_pk_mul_f32 v[70:71], v[70:71], v[62:63] op_sel:[0,0] op_sel_hi:[1,0]
v_pk_mul_f32 v[72:73], v[72:73], v[62:63] op_sel:[0,0] op_sel_hi:[1,0]
v_pk_mul_f32 v[74:75], v[74:75], v[62:63] op_sel:[0,0] op_sel_hi:[1,0]
v_pk_mul_f32 v[76:77], v[76:77], v[62:63] op_sel:[0,0] op_sel_hi:[1,0]
v_pk_mul_f32 v[78:79], v[78:79], v[62:63] op_sel:[0,0] op_sel_hi:[1,0]
v_pk_mul_f32 v[80:81], v[80:81], v[62:63] op_sel:[0,0] op_sel_hi:[1,0]
s_cmp_eq_u32 s24, 0
s_cbranch_scc1 L_kp_qw35
v_cvt_pk_bf16_f32 v82, v66, v67
v_cvt_pk_bf16_f32 v83, v68, v69
v_cvt_pk_bf16_f32 v84, v70, v71
v_cvt_pk_bf16_f32 v85, v72, v73
L_kp_qb36:
v_accvgpr_write_b32 a112, v82
v_accvgpr_write_b32 a113, v83
v_accvgpr_write_b32 a114, v84
v_accvgpr_write_b32 a115, v85
s_cmp_eq_u32 s25, 0
s_cbranch_scc1 L_kp_qw37
v_cvt_pk_bf16_f32 v82, v74, v75
v_cvt_pk_bf16_f32 v83, v76, v77
v_cvt_pk_bf16_f32 v84, v78, v79
v_cvt_pk_bf16_f32 v85, v80, v81
L_kp_qb38:
v_accvgpr_write_b32 a116, v82
v_accvgpr_write_b32 a117, v83
v_accvgpr_write_b32 a118, v84
v_accvgpr_write_b32 a119, v85
v_pk_fma_f32 v[66:67], v[56:57], v[74:75], v[66:67] op_sel:[0,0,0] op_sel_hi:[0,1,1] neg_lo:[0,0,1] neg_hi:[0,0,1]
v_pk_fma_f32 v[68:69], v[56:57], v[76:77], v[68:69] op_sel:[0,0,0] op_sel_hi:[0,1,1] neg_lo:[0,0,1] neg_hi:[0,0,1]
v_pk_fma_f32 v[70:71], v[56:57], v[78:79], v[70:71] op_sel:[0,0,0] op_sel_hi:[0,1,1] neg_lo:[0,0,1] neg_hi:[0,0,1]
v_pk_fma_f32 v[72:73], v[56:57], v[80:81], v[72:73] op_sel:[0,0,0] op_sel_hi:[0,1,1] neg_lo:[0,0,1] neg_hi:[0,0,1]
s_cmp_eq_u32 s26, 0
s_cbranch_scc1 L_kp_qw39
v_cvt_pk_bf16_f32 v82, v66, v67
v_cvt_pk_bf16_f32 v83, v68, v69
v_cvt_pk_bf16_f32 v84, v70, v71
v_cvt_pk_bf16_f32 v85, v72, v73
L_kp_qb40:
v_accvgpr_write_b32 a120, v82
v_accvgpr_write_b32 a121, v83
v_accvgpr_write_b32 a122, v84
v_accvgpr_write_b32 a123, v85
v_pk_fma_f32 v[74:75], v[56:57], v[66:67], v[74:75] op_sel:[0,0,0] op_sel_hi:[0,1,1] neg_lo:[0,0,1] neg_hi:[0,0,1]
v_pk_fma_f32 v[76:77], v[56:57], v[68:69], v[76:77] op_sel:[0,0,0] op_sel_hi:[0,1,1] neg_lo:[0,0,1] neg_hi:[0,0,1]
v_pk_fma_f32 v[78:79], v[56:57], v[70:71], v[78:79] op_sel:[0,0,0] op_sel_hi:[0,1,1] neg_lo:[0,0,1] neg_hi:[0,0,1]
v_pk_fma_f32 v[80:81], v[56:57], v[72:73], v[80:81] op_sel:[0,0,0] op_sel_hi:[0,1,1] neg_lo:[0,0,1] neg_hi:[0,0,1]
s_cmp_eq_u32 s27, 0
s_cbranch_scc1 L_kp_qw41
v_cvt_pk_bf16_f32 v82, v74, v75
v_cvt_pk_bf16_f32 v83, v76, v77
v_cvt_pk_bf16_f32 v84, v78, v79
v_cvt_pk_bf16_f32 v85, v80, v81
L_kp_qb42:
v_accvgpr_write_b32 a124, v82
v_accvgpr_write_b32 a125, v83
v_accvgpr_write_b32 a126, v84
v_accvgpr_write_b32 a127, v85
v_pk_fma_f32 v[66:67], v[56:57], v[74:75], v[66:67] op_sel:[0,0,0] op_sel_hi:[0,1,1] neg_lo:[0,0,1] neg_hi:[0,0,1]
v_pk_fma_f32 v[68:69], v[56:57], v[76:77], v[68:69] op_sel:[0,0,0] op_sel_hi:[0,1,1] neg_lo:[0,0,1] neg_hi:[0,0,1]
v_pk_fma_f32 v[70:71], v[56:57], v[78:79], v[70:71] op_sel:[0,0,0] op_sel_hi:[0,1,1] neg_lo:[0,0,1] neg_hi:[0,0,1]
v_pk_fma_f32 v[72:73], v[56:57], v[80:81], v[72:73] op_sel:[0,0,0] op_sel_hi:[0,1,1] neg_lo:[0,0,1] neg_hi:[0,0,1]
s_cmp_eq_u32 s28, 0
s_cbranch_scc1 L_kp_qw43
v_cvt_pk_bf16_f32 v82, v66, v67
v_cvt_pk_bf16_f32 v83, v68, v69
v_cvt_pk_bf16_f32 v84, v70, v71
v_cvt_pk_bf16_f32 v85, v72, v73
L_kp_qb44:
v_accvgpr_write_b32 a128, v82
v_accvgpr_write_b32 a129, v83
v_accvgpr_write_b32 a130, v84
v_accvgpr_write_b32 a131, v85
v_pk_fma_f32 v[74:75], v[56:57], v[66:67], v[74:75] op_sel:[0,0,0] op_sel_hi:[0,1,1] neg_lo:[0,0,1] neg_hi:[0,0,1]
v_pk_fma_f32 v[76:77], v[56:57], v[68:69], v[76:77] op_sel:[0,0,0] op_sel_hi:[0,1,1] neg_lo:[0,0,1] neg_hi:[0,0,1]
v_pk_fma_f32 v[78:79], v[56:57], v[70:71], v[78:79] op_sel:[0,0,0] op_sel_hi:[0,1,1] neg_lo:[0,0,1] neg_hi:[0,0,1]
v_pk_fma_f32 v[80:81], v[56:57], v[72:73], v[80:81] op_sel:[0,0,0] op_sel_hi:[0,1,1] neg_lo:[0,0,1] neg_hi:[0,0,1]
s_cmp_eq_u32 s29, 0
s_cbranch_scc1 L_kp_qw45
v_cvt_pk_bf16_f32 v82, v74, v75
v_cvt_pk_bf16_f32 v83, v76, v77
v_cvt_pk_bf16_f32 v84, v78, v79
v_cvt_pk_bf16_f32 v85, v80, v81
L_kp_qb46:
v_accvgpr_write_b32 a132, v82
v_accvgpr_write_b32 a133, v83
v_accvgpr_write_b32 a134, v84
v_accvgpr_write_b32 a135, v85
v_pk_fma_f32 v[66:67], v[56:57], v[74:75], v[66:67] op_sel:[0,0,0] op_sel_hi:[0,1,1] neg_lo:[0,0,1] neg_hi:[0,0,1]
v_pk_fma_f32 v[68:69], v[56:57], v[76:77], v[68:69] op_sel:[0,0,0] op_sel_hi:[0,1,1] neg_lo:[0,0,1] neg_hi:[0,0,1]
v_pk_fma_f32 v[70:71], v[56:57], v[78:79], v[70:71] op_sel:[0,0,0] op_sel_hi:[0,1,1] neg_lo:[0,0,1] neg_hi:[0,0,1]
v_pk_fma_f32 v[72:73], v[56:57], v[80:81], v[72:73] op_sel:[0,0,0] op_sel_hi:[0,1,1] neg_lo:[0,0,1] neg_hi:[0,0,1]
s_cmp_eq_u32 s30, 0
s_cbranch_scc1 L_kp_qw47
v_cvt_pk_bf16_f32 v82, v66, v67
v_cvt_pk_bf16_f32 v83, v68, v69
v_cvt_pk_bf16_f32 v84, v70, v71
v_cvt_pk_bf16_f32 v85, v72, v73
L_kp_qb48:
v_accvgpr_write_b32 a136, v82
v_accvgpr_write_b32 a137, v83
v_accvgpr_write_b32 a138, v84
v_accvgpr_write_b32 a139, v85
v_pk_fma_f32 v[74:75], v[56:57], v[66:67], v[74:75] op_sel:[0,0,0] op_sel_hi:[0,1,1] neg_lo:[0,0,1] neg_hi:[0,0,1]
v_pk_fma_f32 v[76:77], v[56:57], v[68:69], v[76:77] op_sel:[0,0,0] op_sel_hi:[0,1,1] neg_lo:[0,0,1] neg_hi:[0,0,1]
v_pk_fma_f32 v[78:79], v[56:57], v[70:71], v[78:79] op_sel:[0,0,0] op_sel_hi:[0,1,1] neg_lo:[0,0,1] neg_hi:[0,0,1]
v_pk_fma_f32 v[80:81], v[56:57], v[72:73], v[80:81] op_sel:[0,0,0] op_sel_hi:[0,1,1] neg_lo:[0,0,1] neg_hi:[0,0,1]
s_cmp_eq_u32 s31, 0
s_cbranch_scc1 L_kp_qw49
v_cvt_pk_bf16_f32 v82, v74, v75
v_cvt_pk_bf16_f32 v83, v76, v77
v_cvt_pk_bf16_f32 v84, v78, v79
v_cvt_pk_bf16_f32 v85, v80, v81
L_kp_qb50:
v_accvgpr_write_b32 a140, v82
v_accvgpr_write_b32 a141, v83
v_accvgpr_write_b32 a142, v84
v_accvgpr_write_b32 a143, v85
v_pk_fma_f32 v[66:67], v[56:57], v[74:75], v[66:67] op_sel:[0,0,0] op_sel_hi:[0,1,1] neg_lo:[0,0,1] neg_hi:[0,0,1]
v_pk_fma_f32 v[68:69], v[56:57], v[76:77], v[68:69] op_sel:[0,0,0] op_sel_hi:[0,1,1] neg_lo:[0,0,1] neg_hi:[0,0,1]
v_pk_fma_f32 v[70:71], v[56:57], v[78:79], v[70:71] op_sel:[0,0,0] op_sel_hi:[0,1,1] neg_lo:[0,0,1] neg_hi:[0,0,1]
v_pk_fma_f32 v[72:73], v[56:57], v[80:81], v[72:73] op_sel:[0,0,0] op_sel_hi:[0,1,1] neg_lo:[0,0,1] neg_hi:[0,0,1]
s_cmp_eq_u32 s32, 0
s_cbranch_scc1 L_kp_qw51
v_cvt_pk_bf16_f32 v82, v66, v67
v_cvt_pk_bf16_f32 v83, v68, v69
v_cvt_pk_bf16_f32 v84, v70, v71
v_cvt_pk_bf16_f32 v85, v72, v73
L_kp_qb52:
v_accvgpr_write_b32 a144, v82
v_accvgpr_write_b32 a145, v83
v_accvgpr_write_b32 a146, v84
v_accvgpr_write_b32 a147, v85
v_pk_fma_f32 v[74:75], v[56:57], v[66:67], v[74:75] op_sel:[0,0,0] op_sel_hi:[0,1,1] neg_lo:[0,0,1] neg_hi:[0,0,1]
v_pk_fma_f32 v[76:77], v[56:57], v[68:69], v[76:77] op_sel:[0,0,0] op_sel_hi:[0,1,1] neg_lo:[0,0,1] neg_hi:[0,0,1]
v_pk_fma_f32 v[78:79], v[56:57], v[70:71], v[78:79] op_sel:[0,0,0] op_sel_hi:[0,1,1] neg_lo:[0,0,1] neg_hi:[0,0,1]
v_pk_fma_f32 v[80:81], v[56:57], v[72:73], v[80:81] op_sel:[0,0,0] op_sel_hi:[0,1,1] neg_lo:[0,0,1] neg_hi:[0,0,1]
s_cmp_eq_u32 s33, 0
s_cbranch_scc1 L_kp_qw53
v_cvt_pk_bf16_f32 v82, v74, v75
v_cvt_pk_bf16_f32 v83, v76, v77
v_cvt_pk_bf16_f32 v84, v78, v79
v_cvt_pk_bf16_f32 v85, v80, v81
L_kp_qb54:
v_accvgpr_write_b32 a148, v82
v_accvgpr_write_b32 a149, v83
v_accvgpr_write_b32 a150, v84
v_accvgpr_write_b32 a151, v85
v_pk_fma_f32 v[66:67], v[56:57], v[74:75], v[66:67] op_sel:[0,0,0] op_sel_hi:[0,1,1] neg_lo:[0,0,1] neg_hi:[0,0,1]
v_pk_fma_f32 v[68:69], v[56:57], v[76:77], v[68:69] op_sel:[0,0,0] op_sel_hi:[0,1,1] neg_lo:[0,0,1] neg_hi:[0,0,1]
v_pk_fma_f32 v[70:71], v[56:57], v[78:79], v[70:71] op_sel:[0,0,0] op_sel_hi:[0,1,1] neg_lo:[0,0,1] neg_hi:[0,0,1]
v_pk_fma_f32 v[72:73], v[56:57], v[80:81], v[72:73] op_sel:[0,0,0] op_sel_hi:[0,1,1] neg_lo:[0,0,1] neg_hi:[0,0,1]
s_cmp_eq_u32 s34, 0
s_cbranch_scc1 L_kp_qw55
v_cvt_pk_bf16_f32 v82, v66, v67
v_cvt_pk_bf16_f32 v83, v68, v69
v_cvt_pk_bf16_f32 v84, v70, v71
v_cvt_pk_bf16_f32 v85, v72, v73
L_kp_qb56:
v_accvgpr_write_b32 a152, v82
v_accvgpr_write_b32 a153, v83
v_accvgpr_write_b32 a154, v84
v_accvgpr_write_b32 a155, v85
v_pk_fma_f32 v[74:75], v[56:57], v[66:67], v[74:75] op_sel:[0,0,0] op_sel_hi:[0,1,1] neg_lo:[0,0,1] neg_hi:[0,0,1]
v_pk_fma_f32 v[76:77], v[56:57], v[68:69], v[76:77] op_sel:[0,0,0] op_sel_hi:[0,1,1] neg_lo:[0,0,1] neg_hi:[0,0,1]
v_pk_fma_f32 v[78:79], v[56:57], v[70:71], v[78:79] op_sel:[0,0,0] op_sel_hi:[0,1,1] neg_lo:[0,0,1] neg_hi:[0,0,1]
v_pk_fma_f32 v[80:81], v[56:57], v[72:73], v[80:81] op_sel:[0,0,0] op_sel_hi:[0,1,1] neg_lo:[0,0,1] neg_hi:[0,0,1]
s_cmp_eq_u32 s35, 0
s_cbranch_scc1 L_kp_qw57
v_cvt_pk_bf16_f32 v82, v74, v75
v_cvt_pk_bf16_f32 v83, v76, v77
v_cvt_pk_bf16_f32 v84, v78, v79
v_cvt_pk_bf16_f32 v85, v80, v81
L_kp_qb58:
v_accvgpr_write_b32 a156, v82
v_accvgpr_write_b32 a157, v83
v_accvgpr_write_b32 a158, v84
v_accvgpr_write_b32 a159, v85
v_pk_fma_f32 v[66:67], v[56:57], v[74:75], v[66:67] op_sel:[0,0,0] op_sel_hi:[0,1,1] neg_lo:[0,0,1] neg_hi:[0,0,1]
v_pk_fma_f32 v[68:69], v[56:57], v[76:77], v[68:69] op_sel:[0,0,0] op_sel_hi:[0,1,1] neg_lo:[0,0,1] neg_hi:[0,0,1]
v_pk_fma_f32 v[70:71], v[56:57], v[78:79], v[70:71] op_sel:[0,0,0] op_sel_hi:[0,1,1] neg_lo:[0,0,1] neg_hi:[0,0,1]
v_pk_fma_f32 v[72:73], v[56:57], v[80:81], v[72:73] op_sel:[0,0,0] op_sel_hi:[0,1,1] neg_lo:[0,0,1] neg_hi:[0,0,1]
s_cmp_eq_u32 s36, 0
s_cbranch_scc1 L_kp_qw59
v_cvt_pk_bf16_f32 v82, v66, v67
v_cvt_pk_bf16_f32 v83, v68, v69
v_cvt_pk_bf16_f32 v84, v70, v71
v_cvt_pk_bf16_f32 v85, v72, v73
L_kp_qb60:
v_accvgpr_write_b32 a160, v82
v_accvgpr_write_b32 a161, v83
v_accvgpr_write_b32 a162, v84
v_accvgpr_write_b32 a163, v85
v_pk_fma_f32 v[74:75], v[56:57], v[66:67], v[74:75] op_sel:[0,0,0] op_sel_hi:[0,1,1] neg_lo:[0,0,1] neg_hi:[0,0,1]
v_pk_fma_f32 v[76:77], v[56:57], v[68:69], v[76:77] op_sel:[0,0,0] op_sel_hi:[0,1,1] neg_lo:[0,0,1] neg_hi:[0,0,1]
v_pk_fma_f32 v[78:79], v[56:57], v[70:71], v[78:79] op_sel:[0,0,0] op_sel_hi:[0,1,1] neg_lo:[0,0,1] neg_hi:[0,0,1]
v_pk_fma_f32 v[80:81], v[56:57], v[72:73], v[80:81] op_sel:[0,0,0] op_sel_hi:[0,1,1] neg_lo:[0,0,1] neg_hi:[0,0,1]
s_cmp_eq_u32 s37, 0
s_cbranch_scc1 L_kp_qw61
v_cvt_pk_bf16_f32 v82, v74, v75
v_cvt_pk_bf16_f32 v83, v76, v77
v_cvt_pk_bf16_f32 v84, v78, v79
v_cvt_pk_bf16_f32 v85, v80, v81
L_kp_qb62:
v_accvgpr_write_b32 a164, v82
v_accvgpr_write_b32 a165, v83
v_accvgpr_write_b32 a166, v84
v_accvgpr_write_b32 a167, v85
s_waitcnt vmcnt(4)
s_add_u32 s17, s68, 6291456
s_add_u32 s18, s69, 6291456
s_mov_b32 s14, 27394048
buffer_load_dwordx4 v[112:115], v3, s[48:51], s14 offen sc1
s_add_u32 s14, s14, 4096
buffer_load_dwordx4 v[116:119], v3, s[48:51], s14 offen sc1
s_add_u32 s14, s14, 4096
buffer_load_dwordx4 v[120:123], v3, s[48:51], s14 offen sc1
s_add_u32 s14, s14, 4096
buffer_load_dwordx4 v[124:127], v3, s[48:51], s14 offen sc1
s_add_u32 s14, s14, 4096
buffer_load_dwordx4 v[128:131], v3, s[48:51], s14 offen sc1
s_add_u32 s14, s14, 4096
buffer_load_dwordx4 v[132:135], v3, s[48:51], s14 offen sc1
s_add_u32 s14, s14, 4096
buffer_load_dwordx4 v[136:139], v3, s[48:51], s14 offen sc1
buffer_load_dwordx4 v[104:107], v3, s[48:51], s17 offen sc1
buffer_load_dwordx4 v[108:111], v3, s[48:51], s18 offen sc1
L_kp_h563:
s_waitcnt vmcnt(0)
v_max3_u32 v140, v104, v105, v106
v_max3_u32 v141, v107, v108, v109
v_max3_u32 v140, v140, v110, v111
v_max3_u32 v141, v141, v112, v113
v_max3_u32 v140, v140, v114, v115
v_max3_u32 v141, v141, v116, v117
v_max3_u32 v140, v140, v118, v119
v_max3_u32 v141, v141, v120, v121
v_max3_u32 v140, v140, v122, v123
v_max3_u32 v141, v141, v124, v125
v_max3_u32 v140, v140, v126, v127
v_max3_u32 v141, v141, v128, v129
v_max3_u32 v140, v140, v130, v131
v_max3_u32 v141, v141, v132, v133
v_max3_u32 v140, v140, v134, v135
v_max3_u32 v141, v141, v136, v137
v_max3_u32 v140, v140, v138, v139
v_max_u32 v140, v140, v141
v_cmp_eq_u32 vcc, -1, v140
s_nop 0
s_cbranch_vccnz L_kp_h5r65
L_kp_h5x64:
s_mov_b32 s17, 0x00003f80
s_mov_b32 s18, 0x3f800000
s_mov_b32 s4, 0x3b124925
s_mov_b32 s5, 0x3727c5ac
v_mov_b32 v164, s5
v_dot2_f32_bf16 v140, v112, s17, 0
v_dot2_f32_bf16 v141, v112, s18, 0
v_dot2_f32_bf16 v142, v113, s17, 0
v_dot2_f32_bf16 v143, v113, s18, 0
v_dot2_f32_bf16 v144, v114, s17, 0
v_dot2_f32_bf16 v145, v114, s18, 0
v_dot2_f32_bf16 v146, v115, s17, 0
v_dot2_f32_bf16 v147, v115, s18, 0
v_dot2_f32_bf16 v140, v116, s17, v140
v_dot2_f32_bf16 v141, v116, s18, v141
v_dot2_f32_bf16 v142, v117, s17, v142
v_dot2_f32_bf16 v143, v117, s18, v143
v_dot2_f32_bf16 v144, v118, s17, v144
v_dot2_f32_bf16 v145, v118, s18, v145
v_dot2_f32_bf16 v146, v119, s17, v146
v_dot2_f32_bf16 v147, v119, s18, v147
v_dot2_f32_bf16 v140, v120, s17, v140
v_dot2_f32_bf16 v141, v120, s18, v141
v_dot2_f32_bf16 v142, v121, s17, v142
v_dot2_f32_bf16 v143, v121, s18, v143
v_dot2_f32_bf16 v144, v122, s17, v144
v_dot2_f32_bf16 v145, v122, s18, v145
v_dot2_f32_bf16 v146, v123, s17, v146
v_dot2_f32_bf16 v147, v123, s18, v147
v_dot2_f32_bf16 v140, v124, s17, v140
v_dot2_f32_bf16 v141, v124, s18, v141
v_dot2_f32_bf16 v142, v125, s17, v142
v_dot2_f32_bf16 v143, v125, s18, v143
v_dot2_f32_bf16 v144, v126, s17, v144
v_dot2_f32_bf16 v145, v126, s18, v145
v_dot2_f32_bf16 v146, v127, s17, v146
v_dot2_f32_bf16 v147, v127, s18, v147
v_dot2_f32_bf16 v140, v128, s17, v140
v_dot2_f32_bf16 v141, v128, s18, v141
v_dot2_f32_bf16 v142, v129, s17, v142
v_dot2_f32_bf16 v143, v129, s18, v143
v_dot2_f32_bf16 v144, v130, s17, v144
v_dot2_f32_bf16 v145, v130, s18, v145
v_dot2_f32_bf16 v146, v131, s17, v146
v_dot2_f32_bf16 v147, v131, s18, v147
v_dot2_f32_bf16 v140, v132, s17, v140
v_dot2_f32_bf16 v141, v132, s18, v141
v_dot2_f32_bf16 v142, v133, s17, v142
v_dot2_f32_bf16 v143, v133, s18, v143
v_dot2_f32_bf16 v144, v134, s17, v144
v_dot2_f32_bf16 v145, v134, s18, v145
v_dot2_f32_bf16 v146, v135, s17, v146
v_dot2_f32_bf16 v147, v135, s18, v147
v_dot2_f32_bf16 v140, v136, s17, v140
v_dot2_f32_bf16 v141, v136, s18, v141
v_dot2_f32_bf16 v142, v137, s17, v142
v_dot2_f32_bf16 v143, v137, s18, v143
v_dot2_f32_bf16 v144, v138, s17, v144
v_dot2_f32_bf16 v145, v138, s18, v145
v_dot2_f32_bf16 v146, v139, s17, v146
v_dot2_f32_bf16 v147, v139, s18, v147
v_lshlrev_b32 v148, 16, v104
v_and_b32 v149, 0xffff0000, v104
v_lshlrev_b32 v150, 16, v105
v_and_b32 v151, 0xffff0000, v105
v_lshlrev_b32 v152, 16, v106
v_and_b32 v153, 0xffff0000, v106
v_lshlrev_b32 v154, 16, v107
v_and_b32 v155, 0xffff0000, v107
v_pk_fma_f32 v[140:141], v[140:141], s[4:5], v[164:165] op_sel:[0,0,0] op_sel_hi:[1,0,0]
v_pk_fma_f32 v[142:143], v[142:143], s[4:5], v[164:165] op_sel:[0,0,0] op_sel_hi:[1,0,0]
v_pk_fma_f32 v[144:145], v[144:145], s[4:5], v[164:165] op_sel:[0,0,0] op_sel_hi:[1,0,0]
v_pk_fma_f32 v[146:147], v[146:147], s[4:5], v[164:165] op_sel:[0,0,0] op_sel_hi:[1,0,0]
v_rsq_f32 v140, v140
v_rsq_f32 v141, v141
v_rsq_f32 v142, v142
v_rsq_f32 v143, v143
v_rsq_f32 v144, v144
v_rsq_f32 v145, v145
v_rsq_f32 v146, v146
v_rsq_f32 v147, v147
buffer_load_dwordx4 a[24:27], v252, s[48:51], s27 offen
v_lshlrev_b32 v156, 16, v108
v_and_b32 v157, 0xffff0000, v108
v_lshlrev_b32 v158, 16, v109
v_and_b32 v159, 0xffff0000, v109
v_lshlrev_b32 v160, 16, v110
v_and_b32 v161, 0xffff0000, v110
v_lshlrev_b32 v162, 16, v111
v_and_b32 v163, 0xffff0000, v111
v_pk_mul_f32 v[164:165], v[148:149], v[140:141] op_sel:[0,0] op_sel_hi:[1,1]
buffer_load_dwordx4 a[28:31], v253, s[48:51], s27 offen
v_pk_mul_f32 v[166:167], v[150:151], v[142:143] op_sel:[0,0] op_sel_hi:[1,1]
v_pk_mul_f32 v[168:169], v[152:153], v[144:145] op_sel:[0,0] op_sel_hi:[1,1]
v_pk_mul_f32 v[170:171], v[154:155], v[146:147] op_sel:[0,0] op_sel_hi:[1,1]
v_cvt_pk_bf16_f32 v180, v164, v165
v_cvt_pk_bf16_f32 v181, v166, v167
v_cvt_pk_bf16_f32 v182, v168, v169
v_cvt_pk_bf16_f32 v183, v170, v171
ds_write_b128 v3, v[180:183]
buffer_load_dwordx4 a[32:35], v252, s[48:51], s28 offen
v_pk_mul_f32 v[140:141], s[70:71], v[140:141] op_sel:[0,0] op_sel_hi:[0,1]
v_pk_mul_f32 v[142:143], s[70:71], v[142:143] op_sel:[0,0] op_sel_hi:[0,1]
v_pk_mul_f32 v[144:145], s[70:71], v[144:145] op_sel:[0,0] op_sel_hi:[0,1]
v_pk_mul_f32 v[146:147], s[70:71], v[146:147] op_sel:[0,0] op_sel_hi:[0,1]
v_pk_mul_f32 v[172:173], v[156:157], v[140:141] op_sel:[0,0] op_sel_hi:[1,1]
v_pk_mul_f32 v[174:175], v[158:159], v[142:143] op_sel:[0,0] op_sel_hi:[1,1]
v_pk_mul_f32 v[176:177], v[160:161], v[144:145] op_sel:[0,0] op_sel_hi:[1,1]
v_pk_mul_f32 v[178:179], v[162:163], v[146:147] op_sel:[0,0] op_sel_hi:[1,1]
v_cvt_pk_bf16_f32 v184, v172, v173
buffer_load_dwordx4 a[36:39], v253, s[48:51], s28 offen
v_cvt_pk_bf16_f32 v185, v174, v175
v_cvt_pk_bf16_f32 v186, v176, v177
v_cvt_pk_bf16_f32 v187, v178, v179
ds_write_b128 v3, v[184:187] offset:4096
s_waitcnt lgkmcnt(0)
s_barrier
ds_read_b64_tr_b16 v[56:57], v4 offset:0
ds_read_b64_tr_b16 v[58:59], v4 offset:256
ds_read_b64_tr_b16 v[72:73], v4 offset:4096
ds_read_b64_tr_b16 v[74:75], v4 offset:4352
ds_read_b64_tr_b16 v[64:65], v4 offset:8
ds_read_b64_tr_b16 v[66:67], v4 offset:264
ds_read_b64_tr_b16 v[80:81], v4 offset:4104
ds_read_b64_tr_b16 v[82:83], v4 offset:4360
ds_read_b64_tr_b16 v[60:61], v4 offset:2048
ds_read_b64_tr_b16 v[62:63], v4 offset:2304
ds_read_b64_tr_b16 v[76:77], v4 offset:6144
ds_read_b64_tr_b16 v[78:79], v4 offset:6400
ds_read_b64_tr_b16 v[68:69], v4 offset:2056
ds_read_b64_tr_b16 v[70:71], v4 offset:2312
ds_read_b64_tr_b16 v[84:85], v4 offset:6152
ds_read_b64_tr_b16 v[86:87], v4 offset:6408
s_waitcnt lgkmcnt(14)
v_mfma_f32_16x16x32_bf16 v[88:91], v[56:59], a[168:171], 0
v_accvgpr_read_b32 v188, a216
v_accvgpr_read_b32 v189, a217
s_waitcnt lgkmcnt(12)
v_mfma_f32_16x16x32_bf16 v[96:99], v[72:75], a[168:171], 0
buffer_load_dwordx4 a[40:43], v252, s[48:51], s29 offen
v_accvgpr_read_b32 v190, a218
v_mfma_f32_16x16x32_bf16 v[88:91], v[72:75], a[176:179], v[88:91]
v_accvgpr_read_b32 v191, a219
v_accvgpr_read_b32 v192, a220
v_mfma_f32_16x16x32_bf16 v[96:99], v[56:59], a[184:187], v[96:99]
buffer_load_dwordx4 a[44:47], v253, s[48:51], s29 offen
v_accvgpr_read_b32 v193, a221
s_waitcnt lgkmcnt(10)
v_mfma_f32_16x16x32_bf16 v[92:95], v[64:67], a[168:171], 0
v_accvgpr_read_b32 v194, a222
v_accvgpr_read_b32 v195, a223
s_waitcnt lgkmcnt(8)
v_mfma_f32_16x16x32_bf16 v[100:103], v[80:83], a[168:171], 0
buffer_load_dwordx4 a[48:51], v252, s[48:51], s30 offen
v_accvgpr_read_b32 v196, a224
v_mfma_f32_16x16x32_bf16 v[92:95], v[80:83], a[176:179], v[92:95]
v_accvgpr_read_b32 v197, a225
v_accvgpr_read_b32 v198, a226
v_mfma_f32_16x16x32_bf16 v[100:103], v[64:67], a[184:187], v[100:103]
buffer_load_dwordx4 a[52:55], v253, s[48:51], s30 offen
v_accvgpr_read_b32 v199, a227
s_waitcnt lgkmcnt(6)
v_mfma_f32_16x16x32_bf16 v[88:91], v[60:63], a[172:175], v[88:91]
v_accvgpr_read_b32 v200, a228
v_accvgpr_read_b32 v201, a229
s_waitcnt lgkmcnt(4)
v_mfma_f32_16x16x32_bf16 v[96:99], v[76:79], a[172:175], v[96:99]
buffer_load_dwordx4 a[56:59], v252, s[48:51], s31 offen
v_accvgpr_read_b32 v202, a230
v_mfma_f32_16x16x32_bf16 v[88:91], v[76:79], a[180:183], v[88:91]
v_accvgpr_read_b32 v203, a231
v_accvgpr_read_b32 v221, a248
v_mfma_f32_16x16x32_bf16 v[96:99], v[60:63], a[188:191], v[96:99]
buffer_load_dwordx4 a[60:63], v253, s[48:51], s31 offen
v_accvgpr_read_b32 v223, a249
s_waitcnt lgkmcnt(2)
v_mfma_f32_16x16x32_bf16 v[92:95], v[68:71], a[172:175], v[92:95]
v_accvgpr_read_b32 v225, a250
v_accvgpr_read_b32 v227, a251
s_waitcnt lgkmcnt(0)
v_mfma_f32_16x16x32_bf16 v[100:103], v[84:87], a[172:175], v[100:103]
buffer_load_dwordx4 a[64:67], v252, s[48:51], s32 offen
v_accvgpr_read_b32 v229, a252
v_mfma_f32_16x16x32_bf16 v[92:95], v[84:87], a[180:183], v[92:95]
v_accvgpr_read_b32 v231, a253
v_accvgpr_read_b32 v233, a254
v_mfma_f32_16x16x32_bf16 v[100:103], v[68:71], a[188:191], v[100:103]
v_accvgpr_read_b32 v235, a255
v_pk_mul_f32 v[164:165], v[88:89], v[188:189] op_sel:[0,0] op_sel_hi:[0,1]
v_pk_fma_f32 v[164:165], v[96:97], v[188:189], v[164:165] op_sel:[0,1,0] op_sel_hi:[0,0,1] neg_lo:[0,1,0]
v_pk_mul_f32 v[166:167], v[88:89], v[190:191] op_sel:[1,0] op_sel_hi:[1,1]
v_pk_fma_f32 v[166:167], v[96:97], v[190:191], v[166:167] op_sel:[1,1,0] op_sel_hi:[1,0,1] neg_lo:[0,1,0]
v_cvt_pk_bf16_f32 v180, v164, v166
v_cvt_pk_bf16_f32 v184, v165, v167
v_pk_mul_f32 v[168:169], v[90:91], v[192:193] op_sel:[0,0] op_sel_hi:[0,1]
v_pk_fma_f32 v[168:169], v[98:99], v[192:193], v[168:169] op_sel:[0,1,0] op_sel_hi:[0,0,1] neg_lo:[0,1,0]
v_pk_mul_f32 v[170:171], v[90:91], v[194:195] op_sel:[1,0] op_sel_hi:[1,1]
v_pk_fma_f32 v[170:171], v[98:99], v[194:195], v[170:171] op_sel:[1,1,0] op_sel_hi:[1,0,1] neg_lo:[0,1,0]
v_cvt_pk_bf16_f32 v181, v168, v170
v_cvt_pk_bf16_f32 v185, v169, v171
v_pk_mul_f32 v[172:173], v[92:93], v[196:197] op_sel:[0,0] op_sel_hi:[0,1]
v_pk_fma_f32 v[172:173], v[100:101], v[196:197], v[172:173] op_sel:[0,1,0] op_sel_hi:[0,0,1] neg_lo:[0,1,0]
v_pk_mul_f32 v[174:175], v[92:93], v[198:199] op_sel:[1,0] op_sel_hi:[1,1]
v_pk_fma_f32 v[174:175], v[100:101], v[198:199], v[174:175] op_sel:[1,1,0] op_sel_hi:[1,0,1] neg_lo:[0,1,0]
v_cvt_pk_bf16_f32 v182, v172, v174
v_cvt_pk_bf16_f32 v186, v173, v175
v_pk_mul_f32 v[176:177], v[94:95], v[200:201] op_sel:[0,0] op_sel_hi:[0,1]
v_pk_fma_f32 v[176:177], v[102:103], v[200:201], v[176:177] op_sel:[0,1,0] op_sel_hi:[0,0,1] neg_lo:[0,1,0]
v_pk_mul_f32 v[178:179], v[94:95], v[202:203] op_sel:[1,0] op_sel_hi:[1,1]
v_pk_fma_f32 v[178:179], v[102:103], v[202:203], v[178:179] op_sel:[1,1,0] op_sel_hi:[1,0,1] neg_lo:[0,1,0]
v_cvt_pk_bf16_f32 v183, v176, v178
v_cvt_pk_bf16_f32 v187, v177, v179
s_nop 0
v_mfma_f32_16x16x32_bf16 v[88:91], a[192:195], v[180:183], 0
v_lshlrev_b32 v220, 16, v221
v_and_b32 v221, 0xffff0000, v221
v_mfma_f32_16x16x32_bf16 v[96:99], a[192:195], v[184:187], 0
buffer_load_dwordx4 a[68:71], v253, s[48:51], s32 offen
v_lshlrev_b32 v222, 16, v223
v_mfma_f32_16x16x32_bf16 v[88:91], a[200:203], v[184:187], v[88:91]
v_and_b32 v223, 0xffff0000, v223
v_lshlrev_b32 v224, 16, v225
v_mfma_f32_16x16x32_bf16 v[96:99], a[208:211], v[180:183], v[96:99]
buffer_load_dwordx4 a[72:75], v252, s[48:51], s33 offen
v_and_b32 v225, 0xffff0000, v225
v_mfma_f32_16x16x32_bf16 v[92:95], a[196:199], v[180:183], 0
v_lshlrev_b32 v226, 16, v227
v_and_b32 v227, 0xffff0000, v227
v_mfma_f32_16x16x32_bf16 v[100:103], a[196:199], v[184:187], 0
buffer_load_dwordx4 a[76:79], v253, s[48:51], s33 offen
v_lshlrev_b32 v228, 16, v229
v_mfma_f32_16x16x32_bf16 v[92:95], a[204:207], v[184:187], v[92:95]
v_and_b32 v229, 0xffff0000, v229
v_lshlrev_b32 v230, 16, v231
v_mfma_f32_16x16x32_bf16 v[100:103], a[212:215], v[180:183], v[100:103]
v_and_b32 v231, 0xffff0000, v231
v_lshlrev_b32 v232, 16, v233
v_and_b32 v233, 0xffff0000, v233
v_lshlrev_b32 v234, 16, v235
v_and_b32 v235, 0xffff0000, v235
v_pk_mul_f32 v[164:165], v[88:89], v[220:221] op_sel:[0,0] op_sel_hi:[0,1]
v_pk_fma_f32 v[164:165], v[96:97], v[220:221], v[164:165] op_sel:[0,1,0] op_sel_hi:[0,0,1] neg_lo:[0,1,0]
v_pk_mul_f32 v[166:167], v[88:89], v[222:223] op_sel:[1,0] op_sel_hi:[1,1]
v_pk_fma_f32 v[166:167], v[96:97], v[222:223], v[166:167] op_sel:[1,1,0] op_sel_hi:[1,0,1] neg_lo:[0,1,0]
v_cvt_pk_bf16_f32 v180, v164, v166
v_cvt_pk_bf16_f32 v184, v165, v167
v_pk_mul_f32 v[168:169], v[90:91], v[224:225] op_sel:[0,0] op_sel_hi:[0,1]
v_pk_fma_f32 v[168:169], v[98:99], v[224:225], v[168:169] op_sel:[0,1,0] op_sel_hi:[0,0,1] neg_lo:[0,1,0]
v_pk_mul_f32 v[170:171], v[90:91], v[226:227] op_sel:[1,0] op_sel_hi:[1,1]
v_pk_fma_f32 v[170:171], v[98:99], v[226:227], v[170:171] op_sel:[1,1,0] op_sel_hi:[1,0,1] neg_lo:[0,1,0]
v_cvt_pk_bf16_f32 v181, v168, v170
v_cvt_pk_bf16_f32 v185, v169, v171
v_pk_mul_f32 v[172:173], v[92:93], v[228:229] op_sel:[0,0] op_sel_hi:[0,1]
v_pk_fma_f32 v[172:173], v[100:101], v[228:229], v[172:173] op_sel:[0,1,0] op_sel_hi:[0,0,1] neg_lo:[0,1,0]
v_pk_mul_f32 v[174:175], v[92:93], v[230:231] op_sel:[1,0] op_sel_hi:[1,1]
v_pk_fma_f32 v[174:175], v[100:101], v[230:231], v[174:175] op_sel:[1,1,0] op_sel_hi:[1,0,1] neg_lo:[0,1,0]
v_cvt_pk_bf16_f32 v182, v172, v174
v_cvt_pk_bf16_f32 v186, v173, v175
v_pk_mul_f32 v[176:177], v[94:95], v[232:233] op_sel:[0,0] op_sel_hi:[0,1]
v_pk_fma_f32 v[176:177], v[102:103], v[232:233], v[176:177] op_sel:[0,1,0] op_sel_hi:[0,0,1] neg_lo:[0,1,0]
v_pk_mul_f32 v[178:179], v[94:95], v[234:235] op_sel:[1,0] op_sel_hi:[1,1]
v_pk_fma_f32 v[178:179], v[102:103], v[234:235], v[178:179] op_sel:[1,1,0] op_sel_hi:[1,0,1] neg_lo:[0,1,0]
v_cvt_pk_bf16_f32 v183, v176, v178
v_cvt_pk_bf16_f32 v187, v177, v179
s_nop 0
v_mfma_f32_16x16x32_bf16 v[88:91], v[180:183], a[192:195], 0
v_accvgpr_read_b32 v204, a232
v_accvgpr_read_b32 v205, a233
v_mfma_f32_16x16x32_bf16 v[96:99], v[184:187], a[192:195], 0
buffer_load_dwordx4 a[80:83], v252, s[48:51], s34 offen
v_accvgpr_read_b32 v206, a234
v_mfma_f32_16x16x32_bf16 v[88:91], v[184:187], a[208:211], v[88:91]
v_accvgpr_read_b32 v207, a235
v_accvgpr_read_b32 v208, a236
v_mfma_f32_16x16x32_bf16 v[96:99], v[180:183], a[200:203], v[96:99]
buffer_load_dwordx4 a[84:87], v253, s[48:51], s34 offen
v_accvgpr_read_b32 v209, a237
v_mfma_f32_16x16x32_bf16 v[92:95], v[180:183], a[196:199], 0
v_accvgpr_read_b32 v210, a238
v_accvgpr_read_b32 v211, a239
v_mfma_f32_16x16x32_bf16 v[100:103], v[184:187], a[196:199], 0
buffer_load_dwordx4 a[88:91], v252, s[48:51], s35 offen
v_accvgpr_read_b32 v212, a240
v_mfma_f32_16x16x32_bf16 v[92:95], v[184:187], a[212:215], v[92:95]
v_accvgpr_read_b32 v213, a241
v_accvgpr_read_b32 v214, a242
v_mfma_f32_16x16x32_bf16 v[100:103], v[180:183], a[204:207], v[100:103]
v_accvgpr_read_b32 v215, a243
v_accvgpr_read_b32 v216, a244
v_accvgpr_read_b32 v217, a245
v_accvgpr_read_b32 v218, a246
v_accvgpr_read_b32 v219, a247
v_pk_mul_f32 v[164:165], v[88:89], v[204:205] op_sel:[0,0] op_sel_hi:[0,1]
v_pk_fma_f32 v[164:165], v[96:97], v[204:205], v[164:165] op_sel:[0,1,0] op_sel_hi:[0,0,1] neg_lo:[0,1,0]
v_pk_mul_f32 v[166:167], v[88:89], v[206:207] op_sel:[1,0] op_sel_hi:[1,1]
v_pk_fma_f32 v[166:167], v[96:97], v[206:207], v[166:167] op_sel:[1,1,0] op_sel_hi:[1,0,1] neg_lo:[0,1,0]
v_cvt_pk_bf16_f32 v180, v164, v166
v_cvt_pk_bf16_f32 v184, v165, v167
v_pk_mul_f32 v[168:169], v[90:91], v[208:209] op_sel:[0,0] op_sel_hi:[0,1]
v_pk_fma_f32 v[168:169], v[98:99], v[208:209], v[168:169] op_sel:[0,1,0] op_sel_hi:[0,0,1] neg_lo:[0,1,0]
v_pk_mul_f32 v[170:171], v[90:91], v[210:211] op_sel:[1,0] op_sel_hi:[1,1]
v_pk_fma_f32 v[170:171], v[98:99], v[210:211], v[170:171] op_sel:[1,1,0] op_sel_hi:[1,0,1] neg_lo:[0,1,0]
v_cvt_pk_bf16_f32 v181, v168, v170
v_cvt_pk_bf16_f32 v185, v169, v171
v_pk_mul_f32 v[172:173], v[92:93], v[212:213] op_sel:[0,0] op_sel_hi:[0,1]
v_pk_fma_f32 v[172:173], v[100:101], v[212:213], v[172:173] op_sel:[0,1,0] op_sel_hi:[0,0,1] neg_lo:[0,1,0]
v_pk_mul_f32 v[174:175], v[92:93], v[214:215] op_sel:[1,0] op_sel_hi:[1,1]
v_pk_fma_f32 v[174:175], v[100:101], v[214:215], v[174:175] op_sel:[1,1,0] op_sel_hi:[1,0,1] neg_lo:[0,1,0]
v_cvt_pk_bf16_f32 v182, v172, v174
v_cvt_pk_bf16_f32 v186, v173, v175
v_pk_mul_f32 v[176:177], v[94:95], v[216:217] op_sel:[0,0] op_sel_hi:[0,1]
v_pk_fma_f32 v[176:177], v[102:103], v[216:217], v[176:177] op_sel:[0,1,0] op_sel_hi:[0,0,1] neg_lo:[0,1,0]
v_pk_mul_f32 v[178:179], v[94:95], v[218:219] op_sel:[1,0] op_sel_hi:[1,1]
v_pk_fma_f32 v[178:179], v[102:103], v[218:219], v[178:179] op_sel:[1,1,0] op_sel_hi:[1,0,1] neg_lo:[0,1,0]
v_cvt_pk_bf16_f32 v183, v176, v178
v_cvt_pk_bf16_f32 v187, v177, v179
ds_write_b64 v5, v[180:181] offset:8192
ds_write_b64 v5, v[184:185] offset:12800
ds_write_b64 v5, v[182:183] offset:8768
ds_write_b64 v5, v[186:187] offset:13376
s_waitcnt lgkmcnt(0)
s_barrier
ds_read_b128 v[56:59], v6 offset:8192
ds_read_b128 v[72:75], v6 offset:12800
ds_read_b128 v[64:67], v6 offset:8768
ds_read_b128 v[80:83], v6 offset:13376
ds_read_b128 v[60:63], v6 offset:8256
ds_read_b128 v[76:79], v6 offset:12864
ds_read_b128 v[68:71], v6 offset:8832
ds_read_b128 v[84:87], v6 offset:13440
s_waitcnt lgkmcnt(7)
v_mfma_f32_16x16x32_bf16 v[88:91], v[56:59], a[168:171], 0
s_lshr_b32 s17, s68, 5
s_lshr_b32 s18, s69, 5
s_waitcnt lgkmcnt(6)
v_mfma_f32_16x16x32_bf16 v[96:99], v[72:75], a[168:171], 0
s_add_u32 s17, s17, 8388608
s_add_u32 s18, s18, 8388608
v_mfma_f32_16x16x32_bf16 v[88:91], v[72:75], a[184:187], v[88:91]
buffer_load_dwordx4 a[92:95], v253, s[48:51], s35 offen
v_mfma_f32_16x16x32_bf16 v[96:99], v[56:59], a[176:179], v[96:99]
s_waitcnt lgkmcnt(5)
v_mfma_f32_16x16x32_bf16 v[92:95], v[64:67], a[168:171], 0
s_waitcnt lgkmcnt(4)
v_mfma_f32_16x16x32_bf16 v[100:103], v[80:83], a[168:171], 0
buffer_load_dwordx4 a[96:99], v252, s[48:51], s36 offen
v_mfma_f32_16x16x32_bf16 v[92:95], v[80:83], a[184:187], v[92:95]
v_mfma_f32_16x16x32_bf16 v[100:103], v[64:67], a[176:179], v[100:103]
s_waitcnt lgkmcnt(3)
v_mfma_f32_16x16x32_bf16 v[88:91], v[60:63], a[172:175], v[88:91]
buffer_load_dwordx4 a[100:103], v253, s[48:51], s36 offen
s_waitcnt lgkmcnt(2)
v_mfma_f32_16x16x32_bf16 v[96:99], v[76:79], a[172:175], v[96:99]
v_mfma_f32_16x16x32_bf16 v[88:91], v[76:79], a[188:191], v[88:91]
v_mfma_f32_16x16x32_bf16 v[96:99], v[60:63], a[180:183], v[96:99]
buffer_load_dwordx4 a[104:107], v252, s[48:51], s37 offen
s_waitcnt lgkmcnt(1)
v_mfma_f32_16x16x32_bf16 v[92:95], v[68:71], a[172:175], v[92:95]
s_waitcnt lgkmcnt(0)
v_mfma_f32_16x16x32_bf16 v[100:103], v[84:87], a[172:175], v[100:103]
v_mfma_f32_16x16x32_bf16 v[92:95], v[84:87], a[188:191], v[92:95]
buffer_load_dwordx4 a[108:111], v253, s[48:51], s37 offen
v_mfma_f32_16x16x32_bf16 v[100:103], v[68:71], a[180:183], v[100:103]
v_pk_add_f32 v[148:149], v[148:149], v[88:89] op_sel:[0,0] op_sel_hi:[1,1]
v_pk_add_f32 v[150:151], v[150:151], v[90:91] op_sel:[0,0] op_sel_hi:[1,1]
s_nop 3
v_pk_add_f32 v[152:153], v[152:153], v[92:93] op_sel:[0,0] op_sel_hi:[1,1]
v_pk_add_f32 v[154:155], v[154:155], v[94:95] op_sel:[0,0] op_sel_hi:[1,1]
v_cvt_pk_bf16_f32 v180, v148, v149
v_cvt_pk_bf16_f32 v181, v150, v151
v_cvt_pk_bf16_f32 v182, v152, v153
v_cvt_pk_bf16_f32 v183, v154, v155
buffer_store_dwordx4 v[180:183], v248, s[48:51], s17 offen sc1
v_pk_fma_f32 v[156:157], s[70:71], v[96:97], v[156:157] op_sel:[0,0,0] op_sel_hi:[0,1,1]
v_pk_fma_f32 v[158:159], s[70:71], v[98:99], v[158:159] op_sel:[0,0,0] op_sel_hi:[0,1,1]
v_pk_fma_f32 v[160:161], s[70:71], v[100:101], v[160:161] op_sel:[0,0,0] op_sel_hi:[0,1,1]
v_pk_fma_f32 v[162:163], s[70:71], v[102:103], v[162:163] op_sel:[0,0,0] op_sel_hi:[0,1,1]
v_cvt_pk_bf16_f32 v184, v156, v157
v_cvt_pk_bf16_f32 v185, v158, v159
v_cvt_pk_bf16_f32 v186, v160, v161
v_cvt_pk_bf16_f32 v187, v162, v163
buffer_store_dwordx4 v[184:187], v248, s[48:51], s18 offen sc1
s_add_u32 s60, s44, 28540928
s_addc_u32 s61, s45, 0
s_and_b32 s61, s61, 0xffff
s_add_u32 s6, s75, 8388608
s_lshl_b32 s4, s7, 10
s_add_u32 s5, s4, s6
v_add_u32 v53, s5, v7
s_mov_b32 s72, 400
s_barrier
s_waitcnt vmcnt(0)
v_mov_b32 v70, 0
v_mov_b32 v68, 0
global_load_dword v69, v70, s[42:43] offset:140 sc1
s_mov_b32 exec_lo, 0xffffffff
s_mov_b32 exec_hi, 0xffffff
buffer_load_dword v68, v13, s[48:51], s6 offen sc1
s_mov_b64 exec, -1
s_mov_b32 m0, s4
s_lshl_b32 s5, s24, 2
buffer_load_dwordx4 v53, s[48:51], s5 offen sc1 lds
s_add_u32 m0, m0, 4096
s_lshl_b32 s5, s25, 2
buffer_load_dwordx4 v53, s[48:51], s5 offen sc1 lds
s_waitcnt vmcnt(3)
v_cmp_eq_u32 s[18:19], 0, v69
s_waitcnt vmcnt(2)
v_cmp_eq_u32 vcc, -1, v68
s_nop 0
s_or_b64 vcc, vcc, s[18:19]
s_cbranch_scc1 L_kp_poll76
L_kp_pollx77:
s_add_u32 m0, m0, 4096
s_lshl_b32 s5, s26, 2
buffer_load_dwordx4 v53, s[48:51], s5 offen sc1 lds
s_add_u32 m0, m0, 4096
s_lshl_b32 s5, s27, 2
buffer_load_dwordx4 v53, s[48:51], s5 offen sc1 lds
s_add_u32 m0, m0, 4096
s_lshl_b32 s5, s28, 2
buffer_load_dwordx4 v53, s[48:51], s5 offen sc1 lds
s_add_u32 m0, m0, 4096
s_lshl_b32 s5, s29, 2
buffer_load_dwordx4 v53, s[48:51], s5 offen sc1 lds
s_add_u32 m0, m0, 4096
s_lshl_b32 s5, s30, 2
buffer_load_dwordx4 v53, s[48:51], s5 offen sc1 lds
s_waitcnt vmcnt(5)
s_barrier
ds_read_b64_tr_b16 v[124:125], v49 offset:0
ds_read_b64_tr_b16 v[126:127], v49 offset:512
ds_read_b64_tr_b16 v[128:129], v50 offset:0
ds_read_b64_tr_b16 v[130:131], v50 offset:512
ds_read_b64_tr_b16 v[132:133], v51 offset:0
ds_read_b64_tr_b16 v[134:135], v51 offset:512
ds_read_b64_tr_b16 v[136:137], v52 offset:0
ds_read_b64_tr_b16 v[138:139], v52 offset:512
ds_read_b64_tr_b16 v[140:141], v8 offset:0
ds_read_b64_tr_b16 v[142:143], v8 offset:512
s_waitcnt lgkmcnt(8)
v_mfma_f32_16x16x32_bf16 v[72:75], v[124:127], a[0:3], 0
ds_read_b64_tr_b16 v[144:145], v49 offset:4096
ds_read_b64_tr_b16 v[146:147], v49 offset:4608
v_mfma_f32_16x16x32_bf16 v[88:91], v[124:127], a[4:7], 0
ds_read_b64_tr_b16 v[148:149], v50 offset:4096
ds_read_b64_tr_b16 v[150:151], v50 offset:4608
s_waitcnt lgkmcnt(10)
v_mfma_f32_16x16x32_bf16 v[76:79], v[128:131], a[0:3], 0
ds_read_b64_tr_b16 v[152:153], v51 offset:4096
v_mfma_f32_16x16x32_bf16 v[92:95], v[128:131], a[4:7], 0
ds_read_b64_tr_b16 v[154:155], v51 offset:4608
s_add_u32 m0, m0, 4096
s_lshl_b32 s5, s31, 2
buffer_load_dwordx4 v53, s[48:51], s5 offen sc1 lds
s_waitcnt lgkmcnt(10)
v_mfma_f32_16x16x32_bf16 v[80:83], v[132:135], a[0:3], 0
ds_read_b64_tr_b16 v[156:157], v52 offset:4096
v_mfma_f32_16x16x32_bf16 v[96:99], v[132:135], a[4:7], 0
ds_read_b64_tr_b16 v[158:159], v52 offset:4608
s_waitcnt lgkmcnt(10)
v_mfma_f32_16x16x32_bf16 v[84:87], v[136:139], a[0:3], 0
ds_read_b64_tr_b16 v[160:161], v8 offset:4096
v_mfma_f32_16x16x32_bf16 v[100:103], v[136:139], a[4:7], 0
ds_read_b64_tr_b16 v[162:163], v8 offset:4608
s_waitcnt lgkmcnt(10)
v_mfma_f32_16x16x32_bf16 v[120:123], v[140:143], v[140:143], 0
s_waitcnt lgkmcnt(8)
v_mfma_f32_16x16x32_bf16 v[72:75], v[144:147], a[8:11], v[72:75]
s_waitcnt vmcnt(4)
s_barrier
v_mfma_f32_16x16x32_bf16 v[88:91], v[144:147], a[12:15], v[88:91]
ds_read_b64_tr_b16 v[124:125], v49 offset:8192
ds_read_b64_tr_b16 v[126:127], v49 offset:8704
s_waitcnt lgkmcnt(8)
v_mfma_f32_16x16x32_bf16 v[76:79], v[148:151], a[8:11], v[76:79]
ds_read_b64_tr_b16 v[128:129], v50 offset:8192
ds_read_b64_tr_b16 v[130:131], v50 offset:8704
v_mfma_f32_16x16x32_bf16 v[92:95], v[148:151], a[12:15], v[92:95]
ds_read_b64_tr_b16 v[132:133], v51 offset:8192
s_add_u32 m0, m0, 4096
s_lshl_b32 s5, s32, 2
buffer_load_dwordx4 v53, s[48:51], s5 offen sc1 lds
s_waitcnt lgkmcnt(9)
v_mfma_f32_16x16x32_bf16 v[80:83], v[152:155], a[8:11], v[80:83]
ds_read_b64_tr_b16 v[134:135], v51 offset:8704
v_mfma_f32_16x16x32_bf16 v[96:99], v[152:155], a[12:15], v[96:99]
ds_read_b64_tr_b16 v[136:137], v52 offset:8192
s_waitcnt lgkmcnt(9)
v_mfma_f32_16x16x32_bf16 v[84:87], v[156:159], a[8:11], v[84:87]
ds_read_b64_tr_b16 v[138:139], v52 offset:8704
v_mfma_f32_16x16x32_bf16 v[100:103], v[156:159], a[12:15], v[100:103]
ds_read_b64_tr_b16 v[140:141], v8 offset:8192
s_waitcnt lgkmcnt(9)
v_mfma_f32_16x16x32_bf16 v[120:123], v[160:163], v[160:163], v[120:123]
ds_read_b64_tr_b16 v[142:143], v8 offset:8704
s_waitcnt lgkmcnt(8)
v_mfma_f32_16x16x32_bf16 v[72:75], v[124:127], a[16:19], v[72:75]
ds_read_b64_tr_b16 v[144:145], v49 offset:12288
ds_read_b64_tr_b16 v[146:147], v49 offset:12800
v_mfma_f32_16x16x32_bf16 v[88:91], v[124:127], a[20:23], v[88:91]
ds_read_b64_tr_b16 v[148:149], v50 offset:12288
ds_read_b64_tr_b16 v[150:151], v50 offset:12800
s_waitcnt lgkmcnt(10)
v_mfma_f32_16x16x32_bf16 v[76:79], v[128:131], a[16:19], v[76:79]
ds_read_b64_tr_b16 v[152:153], v51 offset:12288
v_mfma_f32_16x16x32_bf16 v[92:95], v[128:131], a[20:23], v[92:95]
ds_read_b64_tr_b16 v[154:155], v51 offset:12800
s_add_u32 m0, m0, 4096
s_lshl_b32 s5, s33, 2
buffer_load_dwordx4 v53, s[48:51], s5 offen sc1 lds
s_waitcnt lgkmcnt(10)
v_mfma_f32_16x16x32_bf16 v[80:83], v[132:135], a[16:19], v[80:83]
ds_read_b64_tr_b16 v[156:157], v52 offset:12288
v_mfma_f32_16x16x32_bf16 v[96:99], v[132:135], a[20:23], v[96:99]
ds_read_b64_tr_b16 v[158:159], v52 offset:12800
s_waitcnt lgkmcnt(10)
v_mfma_f32_16x16x32_bf16 v[84:87], v[136:139], a[16:19], v[84:87]
ds_read_b64_tr_b16 v[160:161], v8 offset:12288
v_mfma_f32_16x16x32_bf16 v[100:103], v[136:139], a[20:23], v[100:103]
ds_read_b64_tr_b16 v[162:163], v8 offset:12800
s_waitcnt lgkmcnt(10)
v_mfma_f32_16x16x32_bf16 v[120:123], v[140:143], v[140:143], v[120:123]
s_waitcnt lgkmcnt(8)
v_mfma_f32_16x16x32_bf16 v[72:75], v[144:147], a[24:27], v[72:75]
s_waitcnt vmcnt(3)
s_barrier
v_mfma_f32_16x16x32_bf16 v[88:91], v[144:147], a[28:31], v[88:91]
ds_read_b64_tr_b16 v[124:125], v49 offset:16384
ds_read_b64_tr_b16 v[126:127], v49 offset:16896
s_waitcnt lgkmcnt(8)
v_mfma_f32_16x16x32_bf16 v[76:79], v[148:151], a[24:27], v[76:79]
ds_read_b64_tr_b16 v[128:129], v50 offset:16384
ds_read_b64_tr_b16 v[130:131], v50 offset:16896
v_mfma_f32_16x16x32_bf16 v[92:95], v[148:151], a[28:31], v[92:95]
ds_read_b64_tr_b16 v[132:133], v51 offset:16384
s_add_u32 m0, m0, 4096
s_lshl_b32 s5, s34, 2
buffer_load_dwordx4 v53, s[48:51], s5 offen sc1 lds
s_waitcnt lgkmcnt(9)
v_mfma_f32_16x16x32_bf16 v[80:83], v[152:155], a[24:27], v[80:83]
ds_read_b64_tr_b16 v[134:135], v51 offset:16896
v_mfma_f32_16x16x32_bf16 v[96:99], v[152:155], a[28:31], v[96:99]
ds_read_b64_tr_b16 v[136:137], v52 offset:16384
s_waitcnt lgkmcnt(9)
v_mfma_f32_16x16x32_bf16 v[84:87], v[156:159], a[24:27], v[84:87]
ds_read_b64_tr_b16 v[138:139], v52 offset:16896
v_mfma_f32_16x16x32_bf16 v[100:103], v[156:159], a[28:31], v[100:103]
ds_read_b64_tr_b16 v[140:141], v8 offset:16384
s_waitcnt lgkmcnt(9)
v_mfma_f32_16x16x32_bf16 v[120:123], v[160:163], v[160:163], v[120:123]
ds_read_b64_tr_b16 v[142:143], v8 offset:16896
s_waitcnt lgkmcnt(8)
v_mfma_f32_16x16x32_bf16 v[72:75], v[124:127], a[32:35], v[72:75]
ds_read_b64_tr_b16 v[144:145], v49 offset:20480
ds_read_b64_tr_b16 v[146:147], v49 offset:20992
v_mfma_f32_16x16x32_bf16 v[88:91], v[124:127], a[36:39], v[88:91]
ds_read_b64_tr_b16 v[148:149], v50 offset:20480
ds_read_b64_tr_b16 v[150:151], v50 offset:20992
s_waitcnt lgkmcnt(10)
v_mfma_f32_16x16x32_bf16 v[76:79], v[128:131], a[32:35], v[76:79]
ds_read_b64_tr_b16 v[152:153], v51 offset:20480
v_mfma_f32_16x16x32_bf16 v[92:95], v[128:131], a[36:39], v[92:95]
ds_read_b64_tr_b16 v[154:155], v51 offset:20992
s_add_u32 m0, m0, 4096
s_lshl_b32 s5, s35, 2
buffer_load_dwordx4 v53, s[48:51], s5 offen sc1 lds
s_waitcnt lgkmcnt(10)
v_mfma_f32_16x16x32_bf16 v[80:83], v[132:135], a[32:35], v[80:83]
ds_read_b64_tr_b16 v[156:157], v52 offset:20480
v_mfma_f32_16x16x32_bf16 v[96:99], v[132:135], a[36:39], v[96:99]
ds_read_b64_tr_b16 v[158:159], v52 offset:20992
s_waitcnt lgkmcnt(10)
v_mfma_f32_16x16x32_bf16 v[84:87], v[136:139], a[32:35], v[84:87]
ds_read_b64_tr_b16 v[160:161], v8 offset:20480
v_mfma_f32_16x16x32_bf16 v[100:103], v[136:139], a[36:39], v[100:103]
ds_read_b64_tr_b16 v[162:163], v8 offset:20992
s_waitcnt lgkmcnt(10)
v_mfma_f32_16x16x32_bf16 v[120:123], v[140:143], v[140:143], v[120:123]
s_waitcnt lgkmcnt(8)
v_mfma_f32_16x16x32_bf16 v[72:75], v[144:147], a[40:43], v[72:75]
ds_read_b64_tr_b16 v[124:125], v49 offset:24576
ds_read_b64_tr_b16 v[126:127], v49 offset:25088
v_mfma_f32_16x16x32_bf16 v[88:91], v[144:147], a[44:47], v[88:91]
ds_read_b64_tr_b16 v[128:129], v50 offset:24576
ds_read_b64_tr_b16 v[130:131], v50 offset:25088
s_waitcnt lgkmcnt(10)
v_mfma_f32_16x16x32_bf16 v[76:79], v[148:151], a[40:43], v[76:79]
ds_read_b64_tr_b16 v[132:133], v51 offset:24576
v_mfma_f32_16x16x32_bf16 v[92:95], v[148:151], a[44:47], v[92:95]
ds_read_b64_tr_b16 v[134:135], v51 offset:25088
s_add_u32 m0, m0, 4096
s_lshl_b32 s5, s36, 2
buffer_load_dwordx4 v53, s[48:51], s5 offen sc1 lds
s_waitcnt lgkmcnt(10)
v_mfma_f32_16x16x32_bf16 v[80:83], v[152:155], a[40:43], v[80:83]
ds_read_b64_tr_b16 v[136:137], v52 offset:24576
v_mfma_f32_16x16x32_bf16 v[96:99], v[152:155], a[44:47], v[96:99]
ds_read_b64_tr_b16 v[138:139], v52 offset:25088
s_waitcnt lgkmcnt(10)
v_mfma_f32_16x16x32_bf16 v[84:87], v[156:159], a[40:43], v[84:87]
ds_read_b64_tr_b16 v[140:141], v8 offset:24576
v_mfma_f32_16x16x32_bf16 v[100:103], v[156:159], a[44:47], v[100:103]
ds_read_b64_tr_b16 v[142:143], v8 offset:25088
s_waitcnt lgkmcnt(10)
v_mfma_f32_16x16x32_bf16 v[120:123], v[160:163], v[160:163], v[120:123]
s_waitcnt lgkmcnt(8)
v_mfma_f32_16x16x32_bf16 v[72:75], v[124:127], a[48:51], v[72:75]
s_waitcnt vmcnt(3)
s_barrier
v_mfma_f32_16x16x32_bf16 v[88:91], v[124:127], a[52:55], v[88:91]
ds_read_b64_tr_b16 v[144:145], v49 offset:28672
ds_read_b64_tr_b16 v[146:147], v49 offset:29184
s_waitcnt lgkmcnt(8)
v_mfma_f32_16x16x32_bf16 v[76:79], v[128:131], a[48:51], v[76:79]
ds_read_b64_tr_b16 v[148:149], v50 offset:28672
ds_read_b64_tr_b16 v[150:151], v50 offset:29184
v_mfma_f32_16x16x32_bf16 v[92:95], v[128:131], a[52:55], v[92:95]
ds_read_b64_tr_b16 v[152:153], v51 offset:28672
s_add_u32 m0, m0, 4096
s_lshl_b32 s5, s37, 2
buffer_load_dwordx4 v53, s[48:51], s5 offen sc1 lds
s_waitcnt lgkmcnt(9)
v_mfma_f32_16x16x32_bf16 v[80:83], v[132:135], a[48:51], v[80:83]
ds_read_b64_tr_b16 v[154:155], v51 offset:29184
v_mfma_f32_16x16x32_bf16 v[96:99], v[132:135], a[52:55], v[96:99]
ds_read_b64_tr_b16 v[156:157], v52 offset:28672
s_waitcnt lgkmcnt(9)
v_mfma_f32_16x16x32_bf16 v[84:87], v[136:139], a[48:51], v[84:87]
ds_read_b64_tr_b16 v[158:159], v52 offset:29184
v_mfma_f32_16x16x32_bf16 v[100:103], v[136:139], a[52:55], v[100:103]
ds_read_b64_tr_b16 v[160:161], v8 offset:28672
s_waitcnt lgkmcnt(9)
v_mfma_f32_16x16x32_bf16 v[120:123], v[140:143], v[140:143], v[120:123]
ds_read_b64_tr_b16 v[162:163], v8 offset:29184
s_waitcnt lgkmcnt(8)
v_mfma_f32_16x16x32_bf16 v[72:75], v[144:147], a[56:59], v[72:75]
ds_read_b64_tr_b16 v[124:125], v49 offset:32768
ds_read_b64_tr_b16 v[126:127], v49 offset:33280
v_mfma_f32_16x16x32_bf16 v[88:91], v[144:147], a[60:63], v[88:91]
ds_read_b64_tr_b16 v[128:129], v50 offset:32768
ds_read_b64_tr_b16 v[130:131], v50 offset:33280
s_waitcnt lgkmcnt(10)
v_mfma_f32_16x16x32_bf16 v[76:79], v[148:151], a[56:59], v[76:79]
ds_read_b64_tr_b16 v[132:133], v51 offset:32768
v_mfma_f32_16x16x32_bf16 v[92:95], v[148:151], a[60:63], v[92:95]
ds_read_b64_tr_b16 v[134:135], v51 offset:33280
s_waitcnt lgkmcnt(10)
v_mfma_f32_16x16x32_bf16 v[80:83], v[152:155], a[56:59], v[80:83]
ds_read_b64_tr_b16 v[136:137], v52 offset:32768
v_mfma_f32_16x16x32_bf16 v[96:99], v[152:155], a[60:63], v[96:99]
ds_read_b64_tr_b16 v[138:139], v52 offset:33280
s_waitcnt lgkmcnt(10)
v_mfma_f32_16x16x32_bf16 v[84:87], v[156:159], a[56:59], v[84:87]
ds_read_b64_tr_b16 v[140:141], v8 offset:32768
v_mfma_f32_16x16x32_bf16 v[100:103], v[156:159], a[60:63], v[100:103]
ds_read_b64_tr_b16 v[142:143], v8 offset:33280
s_waitcnt lgkmcnt(10)
v_mfma_f32_16x16x32_bf16 v[120:123], v[160:163], v[160:163], v[120:123]
s_waitcnt lgkmcnt(8)
v_mfma_f32_16x16x32_bf16 v[72:75], v[124:127], a[64:67], v[72:75]
ds_read_b64_tr_b16 v[144:145], v49 offset:36864
ds_read_b64_tr_b16 v[146:147], v49 offset:37376
v_mfma_f32_16x16x32_bf16 v[88:91], v[124:127], a[68:71], v[88:91]
ds_read_b64_tr_b16 v[148:149], v50 offset:36864
ds_read_b64_tr_b16 v[150:151], v50 offset:37376
s_waitcnt lgkmcnt(10)
v_mfma_f32_16x16x32_bf16 v[76:79], v[128:131], a[64:67], v[76:79]
ds_read_b64_tr_b16 v[152:153], v51 offset:36864
v_mfma_f32_16x16x32_bf16 v[92:95], v[128:131], a[68:71], v[92:95]
ds_read_b64_tr_b16 v[154:155], v51 offset:37376
s_waitcnt lgkmcnt(10)
v_mfma_f32_16x16x32_bf16 v[80:83], v[132:135], a[64:67], v[80:83]
ds_read_b64_tr_b16 v[156:157], v52 offset:36864
v_mfma_f32_16x16x32_bf16 v[96:99], v[132:135], a[68:71], v[96:99]
ds_read_b64_tr_b16 v[158:159], v52 offset:37376
s_waitcnt lgkmcnt(10)
v_mfma_f32_16x16x32_bf16 v[84:87], v[136:139], a[64:67], v[84:87]
ds_read_b64_tr_b16 v[160:161], v8 offset:36864
v_mfma_f32_16x16x32_bf16 v[100:103], v[136:139], a[68:71], v[100:103]
ds_read_b64_tr_b16 v[162:163], v8 offset:37376
s_waitcnt lgkmcnt(10)
v_mfma_f32_16x16x32_bf16 v[120:123], v[140:143], v[140:143], v[120:123]
s_waitcnt lgkmcnt(8)
v_mfma_f32_16x16x32_bf16 v[72:75], v[144:147], a[72:75], v[72:75]
s_waitcnt vmcnt(0)
s_barrier
v_mfma_f32_16x16x32_bf16 v[88:91], v[144:147], a[76:79], v[88:91]
ds_read_b64_tr_b16 v[124:125], v49 offset:40960
ds_read_b64_tr_b16 v[126:127], v49 offset:41472
s_waitcnt lgkmcnt(8)
v_mfma_f32_16x16x32_bf16 v[76:79], v[148:151], a[72:75], v[76:79]
ds_read_b64_tr_b16 v[128:129], v50 offset:40960
ds_read_b64_tr_b16 v[130:131], v50 offset:41472
v_mfma_f32_16x16x32_bf16 v[92:95], v[148:151], a[76:79], v[92:95]
ds_read_b64_tr_b16 v[132:133], v51 offset:40960
s_waitcnt lgkmcnt(9)
v_mfma_f32_16x16x32_bf16 v[80:83], v[152:155], a[72:75], v[80:83]
ds_read_b64_tr_b16 v[134:135], v51 offset:41472
v_mfma_f32_16x16x32_bf16 v[96:99], v[152:155], a[76:79], v[96:99]
ds_read_b64_tr_b16 v[136:137], v52 offset:40960
s_waitcnt lgkmcnt(9)
v_mfma_f32_16x16x32_bf16 v[84:87], v[156:159], a[72:75], v[84:87]
ds_read_b64_tr_b16 v[138:139], v52 offset:41472
v_mfma_f32_16x16x32_bf16 v[100:103], v[156:159], a[76:79], v[100:103]
ds_read_b64_tr_b16 v[140:141], v8 offset:40960
s_waitcnt lgkmcnt(9)
v_mfma_f32_16x16x32_bf16 v[120:123], v[160:163], v[160:163], v[120:123]
ds_read_b64_tr_b16 v[142:143], v8 offset:41472
s_waitcnt lgkmcnt(8)
v_mfma_f32_16x16x32_bf16 v[72:75], v[124:127], a[80:83], v[72:75]
ds_read_b64_tr_b16 v[144:145], v49 offset:45056
ds_read_b64_tr_b16 v[146:147], v49 offset:45568
v_mfma_f32_16x16x32_bf16 v[88:91], v[124:127], a[84:87], v[88:91]
ds_read_b64_tr_b16 v[148:149], v50 offset:45056
ds_read_b64_tr_b16 v[150:151], v50 offset:45568
s_waitcnt lgkmcnt(10)
v_mfma_f32_16x16x32_bf16 v[76:79], v[128:131], a[80:83], v[76:79]
ds_read_b64_tr_b16 v[152:153], v51 offset:45056
v_mfma_f32_16x16x32_bf16 v[92:95], v[128:131], a[84:87], v[92:95]
ds_read_b64_tr_b16 v[154:155], v51 offset:45568
s_waitcnt lgkmcnt(10)
v_mfma_f32_16x16x32_bf16 v[80:83], v[132:135], a[80:83], v[80:83]
ds_read_b64_tr_b16 v[156:157], v52 offset:45056
v_mfma_f32_16x16x32_bf16 v[96:99], v[132:135], a[84:87], v[96:99]
ds_read_b64_tr_b16 v[158:159], v52 offset:45568
s_waitcnt lgkmcnt(10)
v_mfma_f32_16x16x32_bf16 v[84:87], v[136:139], a[80:83], v[84:87]
ds_read_b64_tr_b16 v[160:161], v8 offset:45056
v_mfma_f32_16x16x32_bf16 v[100:103], v[136:139], a[84:87], v[100:103]
ds_read_b64_tr_b16 v[162:163], v8 offset:45568
s_waitcnt lgkmcnt(10)
v_mfma_f32_16x16x32_bf16 v[120:123], v[140:143], v[140:143], v[120:123]
s_waitcnt lgkmcnt(8)
v_mfma_f32_16x16x32_bf16 v[72:75], v[144:147], a[88:91], v[72:75]
ds_read_b64_tr_b16 v[124:125], v49 offset:49152
ds_read_b64_tr_b16 v[126:127], v49 offset:49664
v_mfma_f32_16x16x32_bf16 v[88:91], v[144:147], a[92:95], v[88:91]
ds_read_b64_tr_b16 v[128:129], v50 offset:49152
ds_read_b64_tr_b16 v[130:131], v50 offset:49664
s_waitcnt lgkmcnt(10)
v_mfma_f32_16x16x32_bf16 v[76:79], v[148:151], a[88:91], v[76:79]
ds_read_b64_tr_b16 v[132:133], v51 offset:49152
v_mfma_f32_16x16x32_bf16 v[92:95], v[148:151], a[92:95], v[92:95]
ds_read_b64_tr_b16 v[134:135], v51 offset:49664
s_waitcnt lgkmcnt(10)
v_mfma_f32_16x16x32_bf16 v[80:83], v[152:155], a[88:91], v[80:83]
ds_read_b64_tr_b16 v[136:137], v52 offset:49152
v_mfma_f32_16x16x32_bf16 v[96:99], v[152:155], a[92:95], v[96:99]
ds_read_b64_tr_b16 v[138:139], v52 offset:49664
s_waitcnt lgkmcnt(10)
v_mfma_f32_16x16x32_bf16 v[84:87], v[156:159], a[88:91], v[84:87]
ds_read_b64_tr_b16 v[140:141], v8 offset:49152
v_mfma_f32_16x16x32_bf16 v[100:103], v[156:159], a[92:95], v[100:103]
ds_read_b64_tr_b16 v[142:143], v8 offset:49664
s_waitcnt lgkmcnt(10)
v_mfma_f32_16x16x32_bf16 v[120:123], v[160:163], v[160:163], v[120:123]
s_waitcnt lgkmcnt(8)
v_mfma_f32_16x16x32_bf16 v[72:75], v[124:127], a[96:99], v[72:75]
ds_read_b64_tr_b16 v[144:145], v49 offset:53248
ds_read_b64_tr_b16 v[146:147], v49 offset:53760
v_mfma_f32_16x16x32_bf16 v[88:91], v[124:127], a[100:103], v[88:91]
ds_read_b64_tr_b16 v[148:149], v50 offset:53248
ds_read_b64_tr_b16 v[150:151], v50 offset:53760
s_waitcnt lgkmcnt(10)
v_mfma_f32_16x16x32_bf16 v[76:79], v[128:131], a[96:99], v[76:79]
ds_read_b64_tr_b16 v[152:153], v51 offset:53248
v_mfma_f32_16x16x32_bf16 v[92:95], v[128:131], a[100:103], v[92:95]
ds_read_b64_tr_b16 v[154:155], v51 offset:53760
s_waitcnt lgkmcnt(10)
v_mfma_f32_16x16x32_bf16 v[80:83], v[132:135], a[96:99], v[80:83]
ds_read_b64_tr_b16 v[156:157], v52 offset:53248
v_mfma_f32_16x16x32_bf16 v[96:99], v[132:135], a[100:103], v[96:99]
ds_read_b64_tr_b16 v[158:159], v52 offset:53760
s_waitcnt lgkmcnt(10)
v_mfma_f32_16x16x32_bf16 v[84:87], v[136:139], a[96:99], v[84:87]
ds_read_b64_tr_b16 v[160:161], v8 offset:53248
v_mfma_f32_16x16x32_bf16 v[100:103], v[136:139], a[100:103], v[100:103]
ds_read_b64_tr_b16 v[162:163], v8 offset:53760
s_waitcnt lgkmcnt(10)
v_mfma_f32_16x16x32_bf16 v[120:123], v[140:143], v[140:143], v[120:123]
s_waitcnt lgkmcnt(8)
v_mfma_f32_16x16x32_bf16 v[72:75], v[144:147], a[104:107], v[72:75]
ds_read_u16 v70, v22
v_mfma_f32_16x16x32_bf16 v[88:91], v[144:147], a[108:111], v[88:91]
v_mov_b32 v69, 0x3727c5ac
s_waitcnt lgkmcnt(7)
v_mfma_f32_16x16x32_bf16 v[76:79], v[148:151], a[104:107], v[76:79]
s_mov_b32 s14, 0x3b124925
v_mfma_f32_16x16x32_bf16 v[92:95], v[148:151], a[108:111], v[92:95]
v_lshlrev_b32 v68, 6, v10
s_waitcnt lgkmcnt(5)
v_mfma_f32_16x16x32_bf16 v[80:83], v[152:155], a[104:107], v[80:83]
v_add_u32 v68, 147456, v68
v_mfma_f32_16x16x32_bf16 v[96:99], v[152:155], a[108:111], v[96:99]
s_waitcnt lgkmcnt(0)
v_lshlrev_b32 v70, 16, v70
v_mfma_f32_16x16x32_bf16 v[84:87], v[156:159], a[104:107], v[84:87]
v_mfma_f32_16x16x32_bf16 v[100:103], v[156:159], a[108:111], v[100:103]
v_mfma_f32_16x16x32_bf16 v[120:123], v[160:163], v[160:163], v[120:123]
s_nop 7
v_cndmask_b32 v120, v120, v121, s[20:21]
v_cndmask_b32 v120, v120, v122, s[22:23]
v_cndmask_b32 v120, v120, v123, s[40:41]
v_fma_f32 v120, -v70, v70, v120
v_fma_f32 v69, |v120|, s14, v69
v_rsq_f32 v69, v69
s_mov_b64 exec, s[8:9]
ds_write_b32 v23, v69
s_mov_b64 exec, -1
s_waitcnt lgkmcnt(0)
s_barrier
ds_read_b128 v[164:167], v68 offset:0
ds_read_b128 v[168:171], v68 offset:16
ds_read_b128 v[172:175], v68 offset:32
ds_read_b128 v[176:179], v68 offset:48
ds_read_b64_tr_b16 v[140:141], v49 offset:0
ds_read_b64_tr_b16 v[142:143], v49 offset:512
ds_read_b64_tr_b16 v[160:161], v50 offset:0
ds_read_b64_tr_b16 v[162:163], v50 offset:512
ds_read_b64_tr_b16 v[180:181], v51 offset:0
ds_read_b64_tr_b16 v[182:183], v51 offset:512
ds_read_b64_tr_b16 v[184:185], v52 offset:0
ds_read_b64_tr_b16 v[186:187], v52 offset:512
s_waitcnt lgkmcnt(11)
v_pk_mul_f32 v[72:73], v[72:73], v[164:165] op_sel:[0,0] op_sel_hi:[1,1]
v_pk_mul_f32 v[88:89], v[88:89], v[164:165] op_sel:[0,0] op_sel_hi:[1,1]
v_pk_mul_f32 v[74:75], v[74:75], v[166:167] op_sel:[0,0] op_sel_hi:[1,1]
v_pk_mul_f32 v[90:91], v[90:91], v[166:167] op_sel:[0,0] op_sel_hi:[1,1]
v_pk_add_f32 v[54:55], v[164:165], v[166:167] op_sel:[0,0] op_sel_hi:[1,1]
s_waitcnt lgkmcnt(10)
v_pk_mul_f32 v[76:77], v[76:77], v[168:169] op_sel:[0,0] op_sel_hi:[1,1]
v_pk_mul_f32 v[92:93], v[92:93], v[168:169] op_sel:[0,0] op_sel_hi:[1,1]
v_pk_mul_f32 v[78:79], v[78:79], v[170:171] op_sel:[0,0] op_sel_hi:[1,1]
v_pk_mul_f32 v[94:95], v[94:95], v[170:171] op_sel:[0,0] op_sel_hi:[1,1]
v_pk_add_f32 v[56:57], v[168:169], v[170:171] op_sel:[0,0] op_sel_hi:[1,1]
s_waitcnt lgkmcnt(9)
v_pk_mul_f32 v[80:81], v[80:81], v[172:173] op_sel:[0,0] op_sel_hi:[1,1]
v_pk_mul_f32 v[96:97], v[96:97], v[172:173] op_sel:[0,0] op_sel_hi:[1,1]
v_pk_mul_f32 v[82:83], v[82:83], v[174:175] op_sel:[0,0] op_sel_hi:[1,1]
v_pk_mul_f32 v[98:99], v[98:99], v[174:175] op_sel:[0,0] op_sel_hi:[1,1]
v_pk_add_f32 v[58:59], v[172:173], v[174:175] op_sel:[0,0] op_sel_hi:[1,1]
s_waitcnt lgkmcnt(8)
v_pk_mul_f32 v[84:85], v[84:85], v[176:177] op_sel:[0,0] op_sel_hi:[1,1]
v_pk_mul_f32 v[100:101], v[100:101], v[176:177] op_sel:[0,0] op_sel_hi:[1,1]
v_pk_mul_f32 v[86:87], v[86:87], v[178:179] op_sel:[0,0] op_sel_hi:[1,1]
v_pk_mul_f32 v[102:103], v[102:103], v[178:179] op_sel:[0,0] op_sel_hi:[1,1]
v_pk_add_f32 v[60:61], v[176:177], v[178:179] op_sel:[0,0] op_sel_hi:[1,1]
v_pk_add_f32 v[54:55], v[54:55], v[56:57] op_sel:[0,0] op_sel_hi:[1,1]
v_pk_add_f32 v[58:59], v[58:59], v[60:61] op_sel:[0,0] op_sel_hi:[1,1]
v_pk_add_f32 v[54:55], v[54:55], v[58:59] op_sel:[0,0] op_sel_hi:[1,1]
v_cmp_u_f32 vcc, v54, v55
s_sub_u32 s72, s72, 1
s_cselect_b64 vcc, 0, vcc
s_cbranch_vccz L_kp_r375ok
s_waitcnt vmcnt(0) lgkmcnt(0)
s_branch L_kp_r375
L_kp_r375ok:
v_pk_fma_f32 v[58:59], v[32:33], v[72:73], v[74:75] op_sel:[0,0,0] op_sel_hi:[0,1,1]
v_pk_fma_f32 v[60:61], v[32:33], v[88:89], v[90:91] op_sel:[0,0,0] op_sel_hi:[0,1,1]
v_pk_fma_f32 v[58:59], v[32:33], v[88:89], v[58:59] op_sel:[1,0,0] op_sel_hi:[1,1,1] neg_lo:[1,0,0] neg_hi:[1,0,0]
s_add_u32 s10, s10, 1048576
s_add_u32 s11, s11, 1048576
s_lshl_b32 s39, s13, 12
s_add_u32 s4, s10, s39
buffer_load_dwordx4 a[0:3], v2, s[48:51], s4 offen sc1
v_pk_fma_f32 v[60:61], v[32:33], v[72:73], v[60:61] op_sel:[1,0,0] op_sel_hi:[1,1,1]
v_pk_fma_f32 v[54:55], v[32:33], v[58:59], v[76:77] op_sel:[0,0,0] op_sel_hi:[0,1,1]
v_pk_fma_f32 v[56:57], v[32:33], v[60:61], v[92:93] op_sel:[0,0,0] op_sel_hi:[0,1,1]
v_pk_fma_f32 v[54:55], v[32:33], v[60:61], v[54:55] op_sel:[1,0,0] op_sel_hi:[1,1,1] neg_lo:[1,0,0] neg_hi:[1,0,0]
v_pk_fma_f32 v[56:57], v[32:33], v[58:59], v[56:57] op_sel:[1,0,0] op_sel_hi:[1,1,1]
s_add_u32 s47, s11, s39
buffer_load_dwordx4 a[4:7], v2, s[48:51], s47 offen sc1
v_pk_fma_f32 v[58:59], v[32:33], v[54:55], v[78:79] op_sel:[0,0,0] op_sel_hi:[0,1,1]
v_pk_fma_f32 v[60:61], v[32:33], v[56:57], v[94:95] op_sel:[0,0,0] op_sel_hi:[0,1,1]
v_pk_fma_f32 v[58:59], v[32:33], v[56:57], v[58:59] op_sel:[1,0,0] op_sel_hi:[1,1,1] neg_lo:[1,0,0] neg_hi:[1,0,0]
v_pk_fma_f32 v[60:61], v[32:33], v[54:55], v[60:61] op_sel:[1,0,0] op_sel_hi:[1,1,1]
v_pk_fma_f32 v[54:55], v[32:33], v[58:59], v[80:81] op_sel:[0,0,0] op_sel_hi:[0,1,1]
buffer_load_dwordx4 a[8:11], v249, s[48:51], s4 offen sc1
v_pk_fma_f32 v[56:57], v[32:33], v[60:61], v[96:97] op_sel:[0,0,0] op_sel_hi:[0,1,1]
v_pk_fma_f32 v[54:55], v[32:33], v[60:61], v[54:55] op_sel:[1,0,0] op_sel_hi:[1,1,1] neg_lo:[1,0,0] neg_hi:[1,0,0]
v_pk_fma_f32 v[56:57], v[32:33], v[58:59], v[56:57] op_sel:[1,0,0] op_sel_hi:[1,1,1]
v_pk_fma_f32 v[58:59], v[32:33], v[54:55], v[82:83] op_sel:[0,0,0] op_sel_hi:[0,1,1]
v_pk_fma_f32 v[60:61], v[32:33], v[56:57], v[98:99] op_sel:[0,0,0] op_sel_hi:[0,1,1]
buffer_load_dwordx4 a[12:15], v249, s[48:51], s47 offen sc1
v_pk_fma_f32 v[58:59], v[32:33], v[56:57], v[58:59] op_sel:[1,0,0] op_sel_hi:[1,1,1] neg_lo:[1,0,0] neg_hi:[1,0,0]
v_pk_fma_f32 v[60:61], v[32:33], v[54:55], v[60:61] op_sel:[1,0,0] op_sel_hi:[1,1,1]
v_pk_fma_f32 v[54:55], v[32:33], v[58:59], v[84:85] op_sel:[0,0,0] op_sel_hi:[0,1,1]
v_pk_fma_f32 v[56:57], v[32:33], v[60:61], v[100:101] op_sel:[0,0,0] op_sel_hi:[0,1,1]
v_pk_fma_f32 v[54:55], v[32:33], v[60:61], v[54:55] op_sel:[1,0,0] op_sel_hi:[1,1,1] neg_lo:[1,0,0] neg_hi:[1,0,0]
v_pk_fma_f32 v[56:57], v[32:33], v[58:59], v[56:57] op_sel:[1,0,0] op_sel_hi:[1,1,1]
s_add_u32 s39, s39, 4096
s_cmp_eq_u32 s39, 28672
s_cselect_b32 s39, 0, s39
s_add_u32 s4, s10, s39
buffer_load_dwordx4 a[16:19], v2, s[48:51], s4 offen sc1
v_pk_fma_f32 v[58:59], v[32:33], v[54:55], v[86:87] op_sel:[0,0,0] op_sel_hi:[0,1,1]
v_pk_fma_f32 v[60:61], v[32:33], v[56:57], v[102:103] op_sel:[0,0,0] op_sel_hi:[0,1,1]
v_pk_fma_f32 v[58:59], v[32:33], v[56:57], v[58:59] op_sel:[1,0,0] op_sel_hi:[1,1,1] neg_lo:[1,0,0] neg_hi:[1,0,0]
v_pk_fma_f32 v[60:61], v[32:33], v[54:55], v[60:61] op_sel:[1,0,0] op_sel_hi:[1,1,1]
v_fma_f32 v54, v42, v58, v59
s_add_u32 s47, s11, s39
buffer_load_dwordx4 a[20:23], v2, s[48:51], s47 offen sc1
v_fma_f32 v55, v42, v60, v61
v_fma_f32 v54, -v43, v60, v54
v_fmac_f32 v55, v43, v58
ds_bpermute_b32 v188, v11, v54 offset:0
ds_bpermute_b32 v189, v11, v55 offset:0
buffer_load_dwordx4 a[24:27], v249, s[48:51], s4 offen sc1
ds_bpermute_b32 v190, v11, v54 offset:64
ds_bpermute_b32 v191, v11, v55 offset:64
ds_bpermute_b32 v192, v11, v54 offset:128
ds_bpermute_b32 v193, v11, v55 offset:128
ds_bpermute_b32 v194, v11, v54 offset:192
ds_bpermute_b32 v195, v11, v55 offset:192
v_mov_b32 v66, 0
v_mov_b32 v67, 0
s_mul_i32 s14, s12, 7168
s_waitcnt lgkmcnt(4)
v_pk_fma_f32 v[56:57], v[34:35], v[188:189], v[190:191] op_sel:[0,0,0] op_sel_hi:[0,1,1]
v_pk_fma_f32 v[56:57], v[34:35], v[188:189], v[56:57] op_sel:[1,1,0] op_sel_hi:[1,0,1] neg_lo:[0,1,0]
s_waitcnt lgkmcnt(2)
v_pk_fma_f32 v[62:63], v[34:35], v[56:57], v[192:193] op_sel:[0,0,0] op_sel_hi:[0,1,1]
v_pk_fma_f32 v[62:63], v[34:35], v[56:57], v[62:63] op_sel:[1,1,0] op_sel_hi:[1,0,1] neg_lo:[0,1,0]
s_waitcnt lgkmcnt(0)
v_pk_fma_f32 v[64:65], v[34:35], v[62:63], v[194:195] op_sel:[0,0,0] op_sel_hi:[0,1,1]
v_pk_fma_f32 v[64:65], v[34:35], v[62:63], v[64:65] op_sel:[1,1,0] op_sel_hi:[1,0,1] neg_lo:[0,1,0]
s_mov_b64 exec, 0xffff
buffer_store_dwordx4 v[64:67], v9, s[60:63], s14 offen sc1
s_mov_b64 exec, -1
v_mov_b32 v196, 0
v_mov_b32 v197, 0
v_cmp_eq_u32 vcc, 1, v10
s_nop 1
v_cndmask_b32 v196, v196, v188, vcc
v_cndmask_b32 v197, v197, v189, vcc
v_cmp_eq_u32 vcc, 2, v10
s_nop 1
v_cndmask_b32 v196, v196, v56, vcc
v_cndmask_b32 v197, v197, v57, vcc
v_cmp_eq_u32 vcc, 3, v10
s_nop 1
v_cndmask_b32 v196, v196, v62, vcc
v_cndmask_b32 v197, v197, v63, vcc
v_mov_b32 v233, 0
v_and_b32 v69, 1, v10
v_lshl_add_u32 v70, v10, 5, s38
v_lshl_add_u32 v69, v69, 3, v70
v_xor_b32 v70, 16, v69
v_xor_b32 v68, 8, v69
ds_read_b64 v[234:235], v69
ds_read_b64 v[236:237], v68
v_xor_b32 v68, 8, v70
ds_read_b64 v[238:239], v70
ds_read_b64 v[240:241], v68
v_mfma_f32_16x16x32_bf16 v[104:107], v[124:127], a[160:163], 0
v_mfma_f32_16x16x32_bf16 v[108:111], v[128:131], a[160:163], 0
buffer_load_dwordx4 a[28:31], v249, s[48:51], s47 offen sc1
v_mfma_f32_16x16x32_bf16 v[112:115], v[132:135], a[160:163], 0
v_mfma_f32_16x16x32_bf16 v[116:119], v[136:139], a[160:163], 0
v_mfma_f32_16x16x32_bf16 v[104:107], v[144:147], a[164:167], v[104:107]
ds_read_b64_tr_b16 v[124:125], v49 offset:4096
ds_read_b64_tr_b16 v[126:127], v49 offset:4608
v_mfma_f32_16x16x32_bf16 v[108:111], v[148:151], a[164:167], v[108:111]
ds_read_b64_tr_b16 v[128:129], v50 offset:4096
ds_read_b64_tr_b16 v[130:131], v50 offset:4608
s_add_u32 s39, s39, 4096
s_cmp_eq_u32 s39, 28672
s_cselect_b32 s39, 0, s39
s_add_u32 s4, s10, s39
buffer_load_dwordx4 a[32:35], v2, s[48:51], s4 offen sc1
v_mfma_f32_16x16x32_bf16 v[112:115], v[152:155], a[164:167], v[112:115]
ds_read_b64_tr_b16 v[132:133], v51 offset:4096
ds_read_b64_tr_b16 v[134:135], v51 offset:4608
v_mfma_f32_16x16x32_bf16 v[116:119], v[156:159], a[164:167], v[116:119]
ds_read_b64_tr_b16 v[136:137], v52 offset:4096
ds_read_b64_tr_b16 v[138:139], v52 offset:4608
v_mfma_f32_16x16x32_bf16 v[104:107], v[140:143], a[112:115], v[104:107]
ds_read_b64_tr_b16 v[144:145], v49 offset:8192
ds_read_b64_tr_b16 v[146:147], v49 offset:8704
v_mfma_f32_16x16x32_bf16 v[108:111], v[160:163], a[112:115], v[108:111]
ds_read_b64_tr_b16 v[148:149], v50 offset:8192
ds_read_b64_tr_b16 v[150:151], v50 offset:8704
s_add_u32 s47, s11, s39
buffer_load_dwordx4 a[36:39], v2, s[48:51], s47 offen sc1
v_mfma_f32_16x16x32_bf16 v[112:115], v[180:183], a[112:115], v[112:115]
ds_read_b64_tr_b16 v[152:153], v51 offset:8192
ds_read_b64_tr_b16 v[154:155], v51 offset:8704
v_mfma_f32_16x16x32_bf16 v[116:119], v[184:187], a[112:115], v[116:119]
ds_read_b64_tr_b16 v[156:157], v52 offset:8192
ds_read_b64_tr_b16 v[158:159], v52 offset:8704
s_waitcnt lgkmcnt(14)
v_mfma_f32_16x16x32_bf16 v[104:107], v[124:127], a[116:119], v[104:107]
ds_read_b64_tr_b16 v[140:141], v49 offset:12288
ds_read_b64_tr_b16 v[142:143], v49 offset:12800
s_waitcnt lgkmcnt(14)
v_mfma_f32_16x16x32_bf16 v[108:111], v[128:131], a[116:119], v[108:111]
ds_read_b64_tr_b16 v[160:161], v50 offset:12288
ds_read_b64_tr_b16 v[162:163], v50 offset:12800
buffer_load_dwordx4 a[40:43], v249, s[48:51], s4 offen sc1
s_waitcnt lgkmcnt(14)
v_mfma_f32_16x16x32_bf16 v[112:115], v[132:135], a[116:119], v[112:115]
ds_read_b64_tr_b16 v[180:181], v51 offset:12288
ds_read_b64_tr_b16 v[182:183], v51 offset:12800
s_waitcnt lgkmcnt(14)
v_mfma_f32_16x16x32_bf16 v[116:119], v[136:139], a[116:119], v[116:119]
ds_read_b64_tr_b16 v[184:185], v52 offset:12288
ds_read_b64_tr_b16 v[186:187], v52 offset:12800
s_waitcnt lgkmcnt(14)
v_mfma_f32_16x16x32_bf16 v[104:107], v[144:147], a[120:123], v[104:107]
ds_read_b64_tr_b16 v[124:125], v49 offset:16384
ds_read_b64_tr_b16 v[126:127], v49 offset:16896
s_waitcnt lgkmcnt(14)
v_mfma_f32_16x16x32_bf16 v[108:111], v[148:151], a[120:123], v[108:111]
ds_read_b64_tr_b16 v[128:129], v50 offset:16384
ds_read_b64_tr_b16 v[130:131], v50 offset:16896
buffer_load_dwordx4 a[44:47], v249, s[48:51], s47 offen sc1
s_waitcnt lgkmcnt(14)
v_mfma_f32_16x16x32_bf16 v[112:115], v[152:155], a[120:123], v[112:115]
ds_read_b64_tr_b16 v[132:133], v51 offset:16384
ds_read_b64_tr_b16 v[134:135], v51 offset:16896
s_waitcnt lgkmcnt(14)
v_mfma_f32_16x16x32_bf16 v[116:119], v[156:159], a[120:123], v[116:119]
ds_read_b64_tr_b16 v[136:137], v52 offset:16384
ds_read_b64_tr_b16 v[138:139], v52 offset:16896
s_waitcnt lgkmcnt(14)
v_mfma_f32_16x16x32_bf16 v[104:107], v[140:143], a[124:127], v[104:107]
ds_read_b64_tr_b16 v[144:145], v49 offset:20480
ds_read_b64_tr_b16 v[146:147], v49 offset:20992
s_waitcnt lgkmcnt(14)
v_mfma_f32_16x16x32_bf16 v[108:111], v[160:163], a[124:127], v[108:111]
ds_read_b64_tr_b16 v[148:149], v50 offset:20480
ds_read_b64_tr_b16 v[150:151], v50 offset:20992
s_add_u32 s39, s39, 4096
s_cmp_eq_u32 s39, 28672
s_cselect_b32 s39, 0, s39
s_add_u32 s4, s10, s39
buffer_load_dwordx4 a[48:51], v2, s[48:51], s4 offen sc1
s_waitcnt lgkmcnt(14)
v_mfma_f32_16x16x32_bf16 v[112:115], v[180:183], a[124:127], v[112:115]
ds_read_b64_tr_b16 v[152:153], v51 offset:20480
ds_read_b64_tr_b16 v[154:155], v51 offset:20992
s_waitcnt lgkmcnt(14)
v_mfma_f32_16x16x32_bf16 v[116:119], v[184:187], a[124:127], v[116:119]
ds_read_b64_tr_b16 v[156:157], v52 offset:20480
ds_read_b64_tr_b16 v[158:159], v52 offset:20992
s_waitcnt lgkmcnt(14)
v_mfma_f32_16x16x32_bf16 v[104:107], v[124:127], a[128:131], v[104:107]
ds_read_b64_tr_b16 v[140:141], v49 offset:24576
ds_read_b64_tr_b16 v[142:143], v49 offset:25088
s_waitcnt lgkmcnt(14)
v_mfma_f32_16x16x32_bf16 v[108:111], v[128:131], a[128:131], v[108:111]
ds_read_b64_tr_b16 v[160:161], v50 offset:24576
ds_read_b64_tr_b16 v[162:163], v50 offset:25088
s_add_u32 s47, s11, s39
buffer_load_dwordx4 a[52:55], v2, s[48:51], s47 offen sc1
s_waitcnt lgkmcnt(14)
v_mfma_f32_16x16x32_bf16 v[112:115], v[132:135], a[128:131], v[112:115]
ds_read_b64_tr_b16 v[180:181], v51 offset:24576
ds_read_b64_tr_b16 v[182:183], v51 offset:25088
s_waitcnt lgkmcnt(14)
v_mfma_f32_16x16x32_bf16 v[116:119], v[136:139], a[128:131], v[116:119]
ds_read_b64_tr_b16 v[184:185], v52 offset:24576
ds_read_b64_tr_b16 v[186:187], v52 offset:25088
s_waitcnt lgkmcnt(14)
v_mfma_f32_16x16x32_bf16 v[104:107], v[144:147], a[132:135], v[104:107]
ds_read_b64_tr_b16 v[124:125], v49 offset:28672
ds_read_b64_tr_b16 v[126:127], v49 offset:29184
s_waitcnt lgkmcnt(14)
v_mfma_f32_16x16x32_bf16 v[108:111], v[148:151], a[132:135], v[108:111]
ds_read_b64_tr_b16 v[128:129], v50 offset:28672
ds_read_b64_tr_b16 v[130:131], v50 offset:29184
buffer_load_dwordx4 a[56:59], v249, s[48:51], s4 offen sc1
s_waitcnt lgkmcnt(14)
v_mfma_f32_16x16x32_bf16 v[112:115], v[152:155], a[132:135], v[112:115]
ds_read_b64_tr_b16 v[132:133], v51 offset:28672
ds_read_b64_tr_b16 v[134:135], v51 offset:29184
s_waitcnt lgkmcnt(14)
v_mfma_f32_16x16x32_bf16 v[116:119], v[156:159], a[132:135], v[116:119]
ds_read_b64_tr_b16 v[136:137], v52 offset:28672
ds_read_b64_tr_b16 v[138:139], v52 offset:29184
s_waitcnt lgkmcnt(14)
v_mfma_f32_16x16x32_bf16 v[104:107], v[140:143], a[136:139], v[104:107]
ds_read_b64_tr_b16 v[144:145], v49 offset:32768
ds_read_b64_tr_b16 v[146:147], v49 offset:33280
s_waitcnt lgkmcnt(14)
v_mfma_f32_16x16x32_bf16 v[108:111], v[160:163], a[136:139], v[108:111]
ds_read_b64_tr_b16 v[148:149], v50 offset:32768
ds_read_b64_tr_b16 v[150:151], v50 offset:33280
buffer_load_dwordx4 a[60:63], v249, s[48:51], s47 offen sc1
s_waitcnt lgkmcnt(14)
v_mfma_f32_16x16x32_bf16 v[112:115], v[180:183], a[136:139], v[112:115]
ds_read_b64_tr_b16 v[152:153], v51 offset:32768
ds_read_b64_tr_b16 v[154:155], v51 offset:33280
s_waitcnt lgkmcnt(14)
v_mfma_f32_16x16x32_bf16 v[116:119], v[184:187], a[136:139], v[116:119]
ds_read_b64_tr_b16 v[156:157], v52 offset:32768
ds_read_b64_tr_b16 v[158:159], v52 offset:33280
s_waitcnt lgkmcnt(14)
v_mfma_f32_16x16x32_bf16 v[104:107], v[124:127], a[140:143], v[104:107]
ds_read_b64_tr_b16 v[140:141], v49 offset:36864
ds_read_b64_tr_b16 v[142:143], v49 offset:37376
s_waitcnt lgkmcnt(14)
v_mfma_f32_16x16x32_bf16 v[108:111], v[128:131], a[140:143], v[108:111]
ds_read_b64_tr_b16 v[160:161], v50 offset:36864
ds_read_b64_tr_b16 v[162:163], v50 offset:37376
s_add_u32 s39, s39, 4096
s_cmp_eq_u32 s39, 28672
s_cselect_b32 s39, 0, s39
s_add_u32 s4, s10, s39
buffer_load_dwordx4 a[64:67], v2, s[48:51], s4 offen sc1
s_waitcnt lgkmcnt(14)
v_mfma_f32_16x16x32_bf16 v[112:115], v[132:135], a[140:143], v[112:115]
ds_read_b64_tr_b16 v[180:181], v51 offset:36864
ds_read_b64_tr_b16 v[182:183], v51 offset:37376
s_waitcnt lgkmcnt(14)
v_mfma_f32_16x16x32_bf16 v[116:119], v[136:139], a[140:143], v[116:119]
ds_read_b64_tr_b16 v[184:185], v52 offset:36864
ds_read_b64_tr_b16 v[186:187], v52 offset:37376
s_waitcnt lgkmcnt(14)
v_mfma_f32_16x16x32_bf16 v[104:107], v[144:147], a[144:147], v[104:107]
ds_read_b64_tr_b16 v[124:125], v49 offset:40960
ds_read_b64_tr_b16 v[126:127], v49 offset:41472
s_waitcnt lgkmcnt(14)
v_mfma_f32_16x16x32_bf16 v[108:111], v[148:151], a[144:147], v[108:111]
ds_read_b64_tr_b16 v[128:129], v50 offset:40960
ds_read_b64_tr_b16 v[130:131], v50 offset:41472
s_add_u32 s47, s11, s39
buffer_load_dwordx4 a[68:71], v2, s[48:51], s47 offen sc1
s_waitcnt lgkmcnt(14)
v_mfma_f32_16x16x32_bf16 v[112:115], v[152:155], a[144:147], v[112:115]
ds_read_b64_tr_b16 v[132:133], v51 offset:40960
ds_read_b64_tr_b16 v[134:135], v51 offset:41472
s_waitcnt lgkmcnt(14)
v_mfma_f32_16x16x32_bf16 v[116:119], v[156:159], a[144:147], v[116:119]
ds_read_b64_tr_b16 v[136:137], v52 offset:40960
ds_read_b64_tr_b16 v[138:139], v52 offset:41472
s_waitcnt lgkmcnt(14)
v_mfma_f32_16x16x32_bf16 v[104:107], v[140:143], a[148:151], v[104:107]
ds_read_b64_tr_b16 v[144:145], v49 offset:45056
ds_read_b64_tr_b16 v[146:147], v49 offset:45568
s_waitcnt lgkmcnt(14)
v_mfma_f32_16x16x32_bf16 v[108:111], v[160:163], a[148:151], v[108:111]
ds_read_b64_tr_b16 v[148:149], v50 offset:45056
ds_read_b64_tr_b16 v[150:151], v50 offset:45568
buffer_load_dwordx4 v[200:203], v24, s[60:63], 0 offen sc1
s_waitcnt lgkmcnt(14)
v_mfma_f32_16x16x32_bf16 v[112:115], v[180:183], a[148:151], v[112:115]
ds_read_b64_tr_b16 v[152:153], v51 offset:45056
ds_read_b64_tr_b16 v[154:155], v51 offset:45568
s_waitcnt lgkmcnt(14)
v_mfma_f32_16x16x32_bf16 v[116:119], v[184:187], a[148:151], v[116:119]
ds_read_b64_tr_b16 v[156:157], v52 offset:45056
ds_read_b64_tr_b16 v[158:159], v52 offset:45568
buffer_load_dwordx4 v[204:207], v25, s[60:63], 0 offen sc1
buffer_load_dwordx4 v[208:211], v26, s[60:63], 0 offen sc1
buffer_load_dwordx4 v[212:215], v27, s[60:63], 0 offen sc1
buffer_load_dwordx4 v[216:219], v28, s[60:63], 0 offen sc1
buffer_load_dwordx4 v[220:223], v29, s[60:63], 0 offen sc1
buffer_load_dwordx4 v[224:227], v30, s[60:63], 0 offen sc1
buffer_load_dwordx4 v[228:231], v31, s[60:63], 0 offen sc1
s_waitcnt lgkmcnt(14)
v_mfma_f32_16x16x32_bf16 v[104:107], v[124:127], a[152:155], v[104:107]
s_waitcnt lgkmcnt(12)
v_mfma_f32_16x16x32_bf16 v[108:111], v[128:131], a[152:155], v[108:111]
s_waitcnt lgkmcnt(10)
v_mfma_f32_16x16x32_bf16 v[112:115], v[132:135], a[152:155], v[112:115]
s_waitcnt lgkmcnt(8)
v_mfma_f32_16x16x32_bf16 v[116:119], v[136:139], a[152:155], v[116:119]
s_waitcnt lgkmcnt(6)
v_mfma_f32_16x16x32_bf16 v[104:107], v[144:147], a[156:159], v[104:107]
s_waitcnt lgkmcnt(4)
v_mfma_f32_16x16x32_bf16 v[108:111], v[148:151], a[156:159], v[108:111]
s_waitcnt lgkmcnt(2)
v_mfma_f32_16x16x32_bf16 v[112:115], v[152:155], a[156:159], v[112:115]
s_waitcnt lgkmcnt(0)
v_mfma_f32_16x16x32_bf16 v[116:119], v[156:159], a[156:159], v[116:119]
s_mov_b32 s14, 0xbd41848f
v_pk_mul_f32 v[164:165], v[164:165], v[44:45] op_sel:[0,0] op_sel_hi:[1,0]
v_pk_mul_f32 v[166:167], v[166:167], v[44:45] op_sel:[0,0] op_sel_hi:[1,0]
v_pk_mul_f32 v[168:169], v[168:169], v[44:45] op_sel:[0,0] op_sel_hi:[1,0]
v_pk_mul_f32 v[170:171], v[170:171], v[44:45] op_sel:[0,0] op_sel_hi:[1,0]
v_pk_mul_f32 v[172:173], v[172:173], v[44:45] op_sel:[0,0] op_sel_hi:[1,0]
buffer_load_dwordx4 a[72:75], v249, s[48:51], s4 offen sc1
v_pk_mul_f32 v[174:175], v[174:175], v[44:45] op_sel:[0,0] op_sel_hi:[1,0]
v_pk_mul_f32 v[176:177], v[176:177], v[44:45] op_sel:[0,0] op_sel_hi:[1,0]
v_pk_mul_f32 v[178:179], v[178:179], v[44:45] op_sel:[0,0] op_sel_hi:[1,0]
v_lshlrev_b32 v124, 16, v234
v_and_b32 v125, 0xffff0000, v234
v_lshlrev_b32 v126, 16, v235
v_and_b32 v127, 0xffff0000, v235
v_lshlrev_b32 v128, 16, v236
v_and_b32 v129, 0xffff0000, v236
v_lshlrev_b32 v130, 16, v237
v_and_b32 v131, 0xffff0000, v237
buffer_load_dwordx4 a[76:79], v249, s[48:51], s47 offen sc1
v_lshlrev_b32 v132, 16, v238
v_and_b32 v133, 0xffff0000, v238
v_lshlrev_b32 v134, 16, v239
v_and_b32 v135, 0xffff0000, v239
v_lshlrev_b32 v136, 16, v240
v_and_b32 v137, 0xffff0000, v240
v_lshlrev_b32 v138, 16, v241
v_and_b32 v139, 0xffff0000, v241
v_pk_fma_f32 v[124:125], v[124:125], s[14:15], v[104:105] op_sel:[0,0,0] op_sel_hi:[1,0,1]
v_pk_fma_f32 v[126:127], v[126:127], s[14:15], v[106:107] op_sel:[0,0,0] op_sel_hi:[1,0,1]
v_pk_fma_f32 v[128:129], v[128:129], s[14:15], v[108:109] op_sel:[0,0,0] op_sel_hi:[1,0,1]
v_pk_fma_f32 v[130:131], v[130:131], s[14:15], v[110:111] op_sel:[0,0,0] op_sel_hi:[1,0,1]
s_add_u32 s39, s39, 4096
s_cmp_eq_u32 s39, 28672
s_cselect_b32 s39, 0, s39
s_add_u32 s4, s10, s39
buffer_load_dwordx4 a[80:83], v2, s[48:51], s4 offen sc1
v_pk_fma_f32 v[132:133], v[132:133], s[14:15], v[112:113] op_sel:[0,0,0] op_sel_hi:[1,0,1]
v_pk_fma_f32 v[134:135], v[134:135], s[14:15], v[114:115] op_sel:[0,0,0] op_sel_hi:[1,0,1]
v_pk_fma_f32 v[136:137], v[136:137], s[14:15], v[116:117] op_sel:[0,0,0] op_sel_hi:[1,0,1]
v_pk_fma_f32 v[138:139], v[138:139], s[14:15], v[118:119] op_sel:[0,0,0] op_sel_hi:[1,0,1]
v_pk_fma_f32 v[104:105], v[124:125], v[164:165], v[104:105] op_sel:[0,0,0] op_sel_hi:[1,1,1]
v_pk_fma_f32 v[106:107], v[126:127], v[166:167], v[106:107] op_sel:[0,0,0] op_sel_hi:[1,1,1]
v_pk_fma_f32 v[108:109], v[128:129], v[168:169], v[108:109] op_sel:[0,0,0] op_sel_hi:[1,1,1]
v_pk_fma_f32 v[110:111], v[130:131], v[170:171], v[110:111] op_sel:[0,0,0] op_sel_hi:[1,1,1]
v_pk_fma_f32 v[112:113], v[132:133], v[172:173], v[112:113] op_sel:[0,0,0] op_sel_hi:[1,1,1]
v_pk_fma_f32 v[114:115], v[134:135], v[174:175], v[114:115] op_sel:[0,0,0] op_sel_hi:[1,1,1]
v_pk_fma_f32 v[116:117], v[136:137], v[176:177], v[116:117] op_sel:[0,0,0] op_sel_hi:[1,1,1]
s_add_u32 s47, s11, s39
buffer_load_dwordx4 a[84:87], v2, s[48:51], s47 offen sc1
v_pk_fma_f32 v[118:119], v[138:139], v[178:179], v[118:119] op_sel:[0,0,0] op_sel_hi:[1,1,1]
ds_write_b128 v45, v[104:107] offset:0
ds_write_b128 v45, v[108:111] offset:4096
ds_write_b128 v45, v[112:115] offset:8192
ds_write_b128 v45, v[116:119] offset:12288
s_waitcnt lgkmcnt(0)
s_barrier
L_kp_lb78:
s_waitcnt vmcnt(9)
v_or3_b32 v68, v202, v206, v210
s_waitcnt vmcnt(6)
v_or3_b32 v69, v214, v218, v222
s_waitcnt vmcnt(4)
v_or3_b32 v68, v68, v226, v230
v_or_b32 v68, v68, v69
s_mov_b64 s[18:19], 0
v_cmp_ne_u32 vcc, 0, v68
s_nop 0
s_or_b64 vcc, vcc, s[18:19]
s_cbranch_scc0 L_kp_lbx79
s_sub_i32 s73, s73, 1
s_cmp_gt_i32 s73, 0
s_cbranch_scc0 L_kp_lbx79
buffer_load_dwordx4 v[200:203], v24, s[60:63], 0 offen sc1
buffer_load_dwordx4 v[204:207], v25, s[60:63], 0 offen sc1
buffer_load_dwordx4 v[208:211], v26, s[60:63], 0 offen sc1
buffer_load_dwordx4 v[212:215], v27, s[60:63], 0 offen sc1
buffer_load_dwordx4 v[216:219], v28, s[60:63], 0 offen sc1
buffer_load_dwordx4 v[220:223], v29, s[60:63], 0 offen sc1
buffer_load_dwordx4 v[224:227], v30, s[60:63], 0 offen sc1
buffer_load_dwordx4 v[228:231], v31, s[60:63], 0 offen sc1
s_waitcnt vmcnt(0)
s_branch L_kp_lb78
L_kp_lbx79:
v_pk_fma_f32 v[54:55], v[36:37], v[228:229], v[224:225] op_sel:[0,0,0] op_sel_hi:[0,1,1]
v_pk_fma_f32 v[54:55], v[36:37], v[228:229], v[54:55] op_sel:[1,1,0] op_sel_hi:[1,0,1] neg_lo:[0,1,0]
v_pk_fma_f32 v[56:57], v[36:37], v[54:55], v[220:221] op_sel:[0,0,0] op_sel_hi:[0,1,1]
v_pk_fma_f32 v[56:57], v[36:37], v[54:55], v[56:57] op_sel:[1,1,0] op_sel_hi:[1,0,1] neg_lo:[0,1,0]
v_pk_fma_f32 v[54:55], v[36:37], v[56:57], v[216:217] op_sel:[0,0,0] op_sel_hi:[0,1,1]
v_pk_fma_f32 v[54:55], v[36:37], v[56:57], v[54:55] op_sel:[1,1,0] op_sel_hi:[1,0,1] neg_lo:[0,1,0]
buffer_load_dwordx4 a[88:91], v249, s[48:51], s4 offen sc1
v_pk_fma_f32 v[56:57], v[36:37], v[54:55], v[212:213] op_sel:[0,0,0] op_sel_hi:[0,1,1]
v_pk_fma_f32 v[56:57], v[36:37], v[54:55], v[56:57] op_sel:[1,1,0] op_sel_hi:[1,0,1] neg_lo:[0,1,0]
v_pk_fma_f32 v[54:55], v[36:37], v[56:57], v[208:209] op_sel:[0,0,0] op_sel_hi:[0,1,1]
v_pk_fma_f32 v[54:55], v[36:37], v[56:57], v[54:55] op_sel:[1,1,0] op_sel_hi:[1,0,1] neg_lo:[0,1,0]
v_pk_fma_f32 v[56:57], v[36:37], v[54:55], v[204:205] op_sel:[0,0,0] op_sel_hi:[0,1,1]
v_pk_fma_f32 v[56:57], v[36:37], v[54:55], v[56:57] op_sel:[1,1,0] op_sel_hi:[1,0,1] neg_lo:[0,1,0]
v_pk_fma_f32 v[54:55], v[36:37], v[56:57], v[200:201] op_sel:[0,0,0] op_sel_hi:[0,1,1]
v_pk_fma_f32 v[54:55], v[36:37], v[56:57], v[54:55] op_sel:[1,1,0] op_sel_hi:[1,0,1] neg_lo:[0,1,0]
v_pk_mul_f32 v[56:57], v[40:41], v[54:55] op_sel:[0,0] op_sel_hi:[0,1]
v_pk_fma_f32 v[56:57], v[40:41], v[54:55], v[56:57] op_sel:[1,1,0] op_sel_hi:[1,0,1] neg_lo:[0,1,0]
v_mov_b32 v54, v56
v_mov_b32 v55, v57
buffer_load_dwordx4 a[92:95], v249, s[48:51], s47 offen sc1
v_permlane16_swap_b32 v56, v54
v_permlane16_swap_b32 v57, v55
v_pk_add_f32 v[56:57], v[56:57], v[54:55] op_sel:[0,0] op_sel_hi:[1,1]
v_mov_b32 v54, v56
v_mov_b32 v55, v57
s_nop 0
v_permlane32_swap_b32 v56, v54
v_permlane32_swap_b32 v57, v55
v_pk_add_f32 v[56:57], v[56:57], v[54:55] op_sel:[0,0] op_sel_hi:[1,1]
v_fma_f32 v62, v38, v56, v196
v_fma_f32 v64, v38, v57, v197
v_fma_f32 v62, -v39, v57, v62
s_add_u32 s39, s39, 4096
s_cmp_eq_u32 s39, 28672
s_cselect_b32 s39, 0, s39
s_add_u32 s4, s10, s39
buffer_load_dwordx4 a[96:99], v2, s[48:51], s4 offen sc1
v_fmac_f32 v64, v39, v56
v_fma_f32 v63, v42, v62, v58
v_fma_f32 v65, v42, v64, v60
v_fma_f32 v63, -v43, v64, v63
v_fmac_f32 v65, v43, v62
s_lshl_b32 s6, s75, 1
s_add_u32 s6, s6, 16777216
s_add_u32 s5, s6, 57344
v_pk_fma_f32 v[72:73], v[32:33], v[62:63], v[72:73] op_sel:[0,0,0] op_sel_hi:[0,1,1]
v_pk_fma_f32 v[88:89], v[32:33], v[64:65], v[88:89] op_sel:[0,0,0] op_sel_hi:[0,1,1]
v_pk_fma_f32 v[72:73], v[32:33], v[64:65], v[72:73] op_sel:[1,0,0] op_sel_hi:[1,1,1] neg_lo:[1,0,0] neg_hi:[1,0,0]
v_pk_fma_f32 v[88:89], v[32:33], v[62:63], v[88:89] op_sel:[1,0,0] op_sel_hi:[1,1,1]
s_add_u32 s47, s11, s39
buffer_load_dwordx4 a[100:103], v2, s[48:51], s47 offen sc1
v_pk_fma_f32 v[74:75], v[32:33], v[72:73], v[74:75] op_sel:[0,0,0] op_sel_hi:[0,1,1]
v_pk_fma_f32 v[90:91], v[32:33], v[88:89], v[90:91] op_sel:[0,0,0] op_sel_hi:[0,1,1]
v_pk_fma_f32 v[74:75], v[32:33], v[88:89], v[74:75] op_sel:[1,0,0] op_sel_hi:[1,1,1] neg_lo:[1,0,0] neg_hi:[1,0,0]
v_pk_fma_f32 v[90:91], v[32:33], v[72:73], v[90:91] op_sel:[1,0,0] op_sel_hi:[1,1,1]
v_pk_fma_f32 v[76:77], v[32:33], v[74:75], v[76:77] op_sel:[0,0,0] op_sel_hi:[0,1,1]
v_pk_fma_f32 v[92:93], v[32:33], v[90:91], v[92:93] op_sel:[0,0,0] op_sel_hi:[0,1,1]
v_pk_fma_f32 v[76:77], v[32:33], v[90:91], v[76:77] op_sel:[1,0,0] op_sel_hi:[1,1,1] neg_lo:[1,0,0] neg_hi:[1,0,0]
v_pk_fma_f32 v[92:93], v[32:33], v[74:75], v[92:93] op_sel:[1,0,0] op_sel_hi:[1,1,1]
v_pk_fma_f32 v[78:79], v[32:33], v[76:77], v[78:79] op_sel:[0,0,0] op_sel_hi:[0,1,1]
v_pk_fma_f32 v[94:95], v[32:33], v[92:93], v[94:95] op_sel:[0,0,0] op_sel_hi:[0,1,1]
v_pk_fma_f32 v[78:79], v[32:33], v[92:93], v[78:79] op_sel:[1,0,0] op_sel_hi:[1,1,1] neg_lo:[1,0,0] neg_hi:[1,0,0]
buffer_load_dwordx4 a[104:107], v249, s[48:51], s4 offen sc1
v_pk_fma_f32 v[94:95], v[32:33], v[76:77], v[94:95] op_sel:[1,0,0] op_sel_hi:[1,1,1]
v_pk_fma_f32 v[80:81], v[32:33], v[78:79], v[80:81] op_sel:[0,0,0] op_sel_hi:[0,1,1]
v_pk_fma_f32 v[96:97], v[32:33], v[94:95], v[96:97] op_sel:[0,0,0] op_sel_hi:[0,1,1]
v_pk_fma_f32 v[80:81], v[32:33], v[94:95], v[80:81] op_sel:[1,0,0] op_sel_hi:[1,1,1] neg_lo:[1,0,0] neg_hi:[1,0,0]
v_pk_fma_f32 v[96:97], v[32:33], v[78:79], v[96:97] op_sel:[1,0,0] op_sel_hi:[1,1,1]
v_pk_fma_f32 v[82:83], v[32:33], v[80:81], v[82:83] op_sel:[0,0,0] op_sel_hi:[0,1,1]
v_pk_fma_f32 v[98:99], v[32:33], v[96:97], v[98:99] op_sel:[0,0,0] op_sel_hi:[0,1,1]
v_pk_fma_f32 v[82:83], v[32:33], v[96:97], v[82:83] op_sel:[1,0,0] op_sel_hi:[1,1,1] neg_lo:[1,0,0] neg_hi:[1,0,0]
v_pk_fma_f32 v[98:99], v[32:33], v[80:81], v[98:99] op_sel:[1,0,0] op_sel_hi:[1,1,1]
v_pk_fma_f32 v[84:85], v[32:33], v[82:83], v[84:85] op_sel:[0,0,0] op_sel_hi:[0,1,1]
v_pk_fma_f32 v[100:101], v[32:33], v[98:99], v[100:101] op_sel:[0,0,0] op_sel_hi:[0,1,1]
v_pk_fma_f32 v[84:85], v[32:33], v[98:99], v[84:85] op_sel:[1,0,0] op_sel_hi:[1,1,1] neg_lo:[1,0,0] neg_hi:[1,0,0]
buffer_load_dwordx4 a[108:111], v249, s[48:51], s47 offen sc1
v_pk_fma_f32 v[100:101], v[32:33], v[82:83], v[100:101] op_sel:[1,0,0] op_sel_hi:[1,1,1]
v_pk_fma_f32 v[86:87], v[32:33], v[84:85], v[86:87] op_sel:[0,0,0] op_sel_hi:[0,1,1]
v_pk_fma_f32 v[102:103], v[32:33], v[100:101], v[102:103] op_sel:[0,0,0] op_sel_hi:[0,1,1]
v_pk_fma_f32 v[86:87], v[32:33], v[100:101], v[86:87] op_sel:[1,0,0] op_sel_hi:[1,1,1] neg_lo:[1,0,0] neg_hi:[1,0,0]
v_pk_fma_f32 v[102:103], v[32:33], v[84:85], v[102:103] op_sel:[1,0,0] op_sel_hi:[1,1,1]
v_and_b32 v68, 1, v1
v_lshlrev_b32 v68, 3, v68
v_xor_b32 v15, v15, v68
v_xor_b32 v16, v16, v68
v_add_u32 v69, 16, v255
v_xor_b32 v70, 1024, v12
v_cvt_pk_bf16_f32 v232, v72, v73
v_cvt_pk_bf16_f32 v233, v74, v75
v_cvt_pk_bf16_f32 v234, v76, v77
v_cvt_pk_bf16_f32 v235, v78, v79
v_cvt_pk_bf16_f32 v236, v80, v81
v_cvt_pk_bf16_f32 v237, v82, v83
v_cvt_pk_bf16_f32 v238, v84, v85
v_cvt_pk_bf16_f32 v239, v86, v87
ds_write_b128 v255, v[232:235] offset:0
ds_write_b128 v69, v[236:239] offset:0
ds_read_b64_tr_b16 v[136:137], v15 offset:0
ds_read_b64_tr_b16 v[138:139], v15 offset:512
ds_read_b64_tr_b16 v[140:141], v16 offset:0
ds_read_b64_tr_b16 v[142:143], v16 offset:512
v_cvt_pk_bf16_f32 v240, -v88, -v89
v_cvt_pk_bf16_f32 v241, -v90, -v91
v_cvt_pk_bf16_f32 v242, -v92, -v93
v_cvt_pk_bf16_f32 v243, -v94, -v95
v_cvt_pk_bf16_f32 v244, -v96, -v97
v_cvt_pk_bf16_f32 v245, -v98, -v99
v_cvt_pk_bf16_f32 v246, -v100, -v101
v_cvt_pk_bf16_f32 v247, -v102, -v103
ds_write_b128 v255, v[240:243] offset:8192
ds_write_b128 v69, v[244:247] offset:8192
ds_read_b64_tr_b16 v[144:145], v15 offset:8192
ds_read_b64_tr_b16 v[146:147], v15 offset:8704
ds_read_b64_tr_b16 v[148:149], v16 offset:8192
ds_read_b64_tr_b16 v[150:151], v16 offset:8704
s_waitcnt lgkmcnt(0)
s_cmp_eq_u32 s3, 0
s_cbranch_scc1 L_kp_st80
buffer_store_dwordx4 v[136:139], v12, s[48:51], s6 offen
buffer_store_dwordx4 v[140:143], v70, s[48:51], s6 offen
buffer_store_dwordx4 v[144:147], v12, s[48:51], s5 offen
buffer_store_dwordx4 v[148:151], v70, s[48:51], s5 offen
s_branch L_kp_st81
L_kp_st80:
buffer_store_dwordx4 v[136:139], v12, s[48:51], s6 offen sc1
buffer_store_dwordx4 v[140:143], v70, s[48:51], s6 offen sc1
buffer_store_dwordx4 v[144:147], v12, s[48:51], s5 offen sc1
buffer_store_dwordx4 v[148:151], v70, s[48:51], s5 offen sc1
s_waitcnt vmcnt(0)
L_kp_st81:
v_add_u32 v62, 57344, v14
v_add_u32 v63, 57344, v18
s_add_u32 s47, s6, 57344
s_lshl_b32 s72, s13, 13
s_add_u32 s72, s72, s6
v_add_u32 v46, v46, v47
v_lshrrev_b32 v46, 1, v46
v_mov_b32 v47, v46
ds_read_b128 v[72:75], v46 offset:0
ds_read_b128 v[76:79], v47 offset:4096
ds_read_b128 v[80:83], v46 offset:8192
ds_read_b128 v[84:87], v47 offset:12288
s_xor_b32 s14, s7, 1
s_mul_i32 s14, s14, 12288
s_add_u32 s14, s14, 0
v_add_u32 v55, s14, v2
s_xor_b32 s14, s7, 2
s_mul_i32 s14, s14, 12288
s_add_u32 s14, s14, 4096
v_add_u32 v56, s14, v2
s_xor_b32 s14, s7, 3
s_mul_i32 s14, s14, 12288
s_add_u32 s14, s14, 8192
v_add_u32 v57, s14, v2
s_mul_i32 s14, s7, 12288
s_add_u32 s14, s14, 0
v_add_u32 v58, s14, v2
s_waitcnt lgkmcnt(0)
v_mfma_f32_32x32x16_bf16 v[72:87], v[136:139], a[0:3], v[72:87]
s_add_u32 s4, s72, 8192
s_cmp_eq_u32 s4, s47
s_cselect_b32 s4, s6, s4
buffer_load_dwordx4 v[152:155], v14, s[48:51], s4 offen sc1
v_mfma_f32_32x32x16_bf16 v[88:103], v[136:139], a[4:7], 0
buffer_load_dwordx4 v[156:159], v18, s[48:51], s4 offen sc1
v_mfma_f32_32x32x16_bf16 v[104:119], v[140:143], a[0:3], 0
buffer_load_dwordx4 v[160:163], v62, s[48:51], s4 offen sc1
v_mfma_f32_32x32x16_bf16 v[120:135], v[140:143], a[4:7], 0
v_mfma_f32_32x32x16_bf16 v[72:87], v[144:147], a[8:11], v[72:87]
buffer_load_dwordx4 v[164:167], v63, s[48:51], s4 offen sc1
v_mfma_f32_32x32x16_bf16 v[88:103], v[144:147], a[12:15], v[88:103]
s_add_u32 s5, s4, 8192
s_cmp_eq_u32 s5, s47
s_cselect_b32 s5, s6, s5
buffer_load_dwordx4 v[168:171], v14, s[48:51], s5 offen sc1
v_mfma_f32_32x32x16_bf16 v[104:119], v[148:151], a[8:11], v[104:119]
buffer_load_dwordx4 v[172:175], v18, s[48:51], s5 offen sc1
v_mfma_f32_32x32x16_bf16 v[120:135], v[148:151], a[12:15], v[120:135]
s_waitcnt vmcnt(4)
v_max_u32 v54, v155, v159
v_cmp_eq_u32 vcc, -1, v54
s_nop 0
s_cbranch_vccnz L_kp_redo82
L_kp_back83:
v_mfma_f32_32x32x16_bf16 v[72:87], v[152:155], a[16:19], v[72:87]
buffer_load_dwordx4 v[176:179], v62, s[48:51], s5 offen sc1
v_mfma_f32_32x32x16_bf16 v[88:103], v[152:155], a[20:23], v[88:103]
buffer_load_dwordx4 v[180:183], v63, s[48:51], s5 offen sc1
v_mfma_f32_32x32x16_bf16 v[104:119], v[156:159], a[16:19], v[104:119]
s_add_u32 s17, s5, 8192
s_cmp_eq_u32 s17, s47
s_cselect_b32 s17, s6, s17
buffer_load_dwordx4 v[184:187], v14, s[48:51], s17 offen sc1
v_mfma_f32_32x32x16_bf16 v[120:135], v[156:159], a[20:23], v[120:135]
s_waitcnt vmcnt(5)
v_max_u32 v54, v163, v167
v_cmp_eq_u32 vcc, -1, v54
s_nop 0
s_cbranch_vccnz L_kp_redo84
L_kp_back85:
v_mfma_f32_32x32x16_bf16 v[72:87], v[160:163], a[24:27], v[72:87]
buffer_load_dwordx4 v[188:191], v18, s[48:51], s17 offen sc1
v_mfma_f32_32x32x16_bf16 v[88:103], v[160:163], a[28:31], v[88:103]
buffer_load_dwordx4 v[192:195], v62, s[48:51], s17 offen sc1
v_mfma_f32_32x32x16_bf16 v[104:119], v[164:167], a[24:27], v[104:119]
buffer_load_dwordx4 v[196:199], v63, s[48:51], s17 offen sc1
v_mfma_f32_32x32x16_bf16 v[120:135], v[164:167], a[28:31], v[120:135]
s_waitcnt vmcnt(6)
v_max_u32 v54, v171, v175
v_cmp_eq_u32 vcc, -1, v54
s_nop 0
s_cbranch_vccnz L_kp_redo86
L_kp_back87:
v_mfma_f32_32x32x16_bf16 v[72:87], v[168:171], a[32:35], v[72:87]
s_add_u32 s18, s17, 8192
s_cmp_eq_u32 s18, s47
s_cselect_b32 s18, s6, s18
buffer_load_dwordx4 v[200:203], v14, s[48:51], s18 offen sc1
v_mfma_f32_32x32x16_bf16 v[88:103], v[168:171], a[36:39], v[88:103]
buffer_load_dwordx4 v[204:207], v18, s[48:51], s18 offen sc1
v_mfma_f32_32x32x16_bf16 v[104:119], v[172:175], a[32:35], v[104:119]
buffer_load_dwordx4 v[208:211], v62, s[48:51], s18 offen sc1
v_mfma_f32_32x32x16_bf16 v[120:135], v[172:175], a[36:39], v[120:135]
s_waitcnt vmcnt(7)
v_max_u32 v54, v179, v183
v_cmp_eq_u32 vcc, -1, v54
s_nop 0
s_cbranch_vccnz L_kp_redo88
L_kp_back89:
v_mfma_f32_32x32x16_bf16 v[72:87], v[176:179], a[40:43], v[72:87]
buffer_load_dwordx4 v[212:215], v63, s[48:51], s18 offen sc1
v_mfma_f32_32x32x16_bf16 v[88:103], v[176:179], a[44:47], v[88:103]
s_add_u32 s19, s18, 8192
s_cmp_eq_u32 s19, s47
s_cselect_b32 s19, s6, s19
buffer_load_dwordx4 v[216:219], v14, s[48:51], s19 offen sc1
v_mfma_f32_32x32x16_bf16 v[104:119], v[180:183], a[40:43], v[104:119]
buffer_load_dwordx4 v[220:223], v18, s[48:51], s19 offen sc1
v_mfma_f32_32x32x16_bf16 v[120:135], v[180:183], a[44:47], v[120:135]
s_waitcnt vmcnt(8)
v_max_u32 v54, v187, v191
v_cmp_eq_u32 vcc, -1, v54
s_nop 0
s_cbranch_vccnz L_kp_redo90
L_kp_back91:
v_mfma_f32_32x32x16_bf16 v[72:87], v[184:187], a[48:51], v[72:87]
buffer_load_dwordx4 v[224:227], v62, s[48:51], s19 offen sc1
v_mfma_f32_32x32x16_bf16 v[88:103], v[184:187], a[52:55], v[88:103]
buffer_load_dwordx4 v[228:231], v63, s[48:51], s19 offen sc1
v_mfma_f32_32x32x16_bf16 v[104:119], v[188:191], a[48:51], v[104:119]
s_add_u32 s39, s19, 8192
s_cmp_eq_u32 s39, s47
s_cselect_b32 s39, s6, s39
buffer_load_dwordx4 v[232:235], v14, s[48:51], s39 offen sc1
v_mfma_f32_32x32x16_bf16 v[120:135], v[188:191], a[52:55], v[120:135]
s_waitcnt vmcnt(9)
v_max_u32 v54, v195, v199
v_cmp_eq_u32 vcc, -1, v54
s_nop 0
s_cbranch_vccnz L_kp_redo92
L_kp_back93:
v_mfma_f32_32x32x16_bf16 v[72:87], v[192:195], a[56:59], v[72:87]
buffer_load_dwordx4 v[236:239], v18, s[48:51], s39 offen sc1
v_mfma_f32_32x32x16_bf16 v[88:103], v[192:195], a[60:63], v[88:103]
buffer_load_dwordx4 v[240:243], v62, s[48:51], s39 offen sc1
v_mfma_f32_32x32x16_bf16 v[104:119], v[196:199], a[56:59], v[104:119]
buffer_load_dwordx4 v[244:247], v63, s[48:51], s39 offen sc1
v_mfma_f32_32x32x16_bf16 v[120:135], v[196:199], a[60:63], v[120:135]
s_waitcnt vmcnt(10)
v_max_u32 v54, v203, v207
v_cmp_eq_u32 vcc, -1, v54
s_nop 0
s_cbranch_vccnz L_kp_redo94
L_kp_back95:
v_mfma_f32_32x32x16_bf16 v[72:87], v[200:203], a[64:67], v[72:87]
v_mfma_f32_32x32x16_bf16 v[88:103], v[200:203], a[68:71], v[88:103]
v_mfma_f32_32x32x16_bf16 v[104:119], v[204:207], a[64:67], v[104:119]
v_mfma_f32_32x32x16_bf16 v[120:135], v[204:207], a[68:71], v[120:135]
s_waitcnt vmcnt(8)
v_max_u32 v54, v211, v215
v_cmp_eq_u32 vcc, -1, v54
s_nop 0
s_cbranch_vccnz L_kp_redo96
L_kp_back97:
v_mfma_f32_32x32x16_bf16 v[88:103], v[208:211], a[76:79], v[88:103]
s_waitcnt vmcnt(6)
v_max_u32 v54, v219, v223
v_cmp_eq_u32 vcc, -1, v54
s_nop 0
s_cbranch_vccnz L_kp_redo98
L_kp_back99:
v_mfma_f32_32x32x16_bf16 v[88:103], v[216:219], a[84:87], v[88:103]
s_waitcnt vmcnt(4)
v_max_u32 v54, v227, v231
v_cmp_eq_u32 vcc, -1, v54
s_nop 0
s_cbranch_vccnz L_kp_redo100
L_kp_back101:
v_mfma_f32_32x32x16_bf16 v[88:103], v[224:227], a[92:95], v[88:103]
s_waitcnt vmcnt(2)
v_max_u32 v54, v235, v239
v_cmp_eq_u32 vcc, -1, v54
s_nop 0
s_cbranch_vccnz L_kp_redo102
L_kp_back103:
v_mfma_f32_32x32x16_bf16 v[88:103], v[232:235], a[100:103], v[88:103]
s_waitcnt vmcnt(0)
v_max_u32 v54, v243, v247
v_cmp_eq_u32 vcc, -1, v54
s_nop 0
s_cbranch_vccnz L_kp_redo104
L_kp_back105:
v_mfma_f32_32x32x16_bf16 v[88:103], v[240:243], a[108:111], v[88:103]
v_mfma_f32_32x32x16_bf16 v[104:119], v[212:215], a[72:75], v[104:119]
v_mfma_f32_32x32x16_bf16 v[104:119], v[220:223], a[80:83], v[104:119]
s_nop 9
ds_write_b128 v55, v[88:91] offset:0
v_mfma_f32_32x32x16_bf16 v[104:119], v[228:231], a[88:91], v[104:119]
ds_write_b128 v55, v[92:95] offset:1024
v_mfma_f32_32x32x16_bf16 v[104:119], v[236:239], a[96:99], v[104:119]
ds_write_b128 v55, v[96:99] offset:2048
v_mfma_f32_32x32x16_bf16 v[104:119], v[244:247], a[104:107], v[104:119]
ds_write_b128 v55, v[100:103] offset:3072
v_mfma_f32_32x32x16_bf16 v[120:135], v[212:215], a[76:79], v[120:135]
v_mfma_f32_32x32x16_bf16 v[120:135], v[220:223], a[84:87], v[120:135]
s_nop 8
ds_write_b128 v56, v[104:107] offset:0
v_mfma_f32_32x32x16_bf16 v[120:135], v[228:231], a[92:95], v[120:135]
ds_write_b128 v56, v[108:111] offset:1024
v_mfma_f32_32x32x16_bf16 v[120:135], v[236:239], a[100:103], v[120:135]
ds_write_b128 v56, v[112:115] offset:2048
v_mfma_f32_32x32x16_bf16 v[120:135], v[244:247], a[108:111], v[120:135]
ds_write_b128 v56, v[116:119] offset:3072
v_mfma_f32_32x32x16_bf16 v[72:87], v[208:211], a[72:75], v[72:87]
v_mfma_f32_32x32x16_bf16 v[72:87], v[216:219], a[80:83], v[72:87]
s_nop 8
ds_write_b128 v57, v[120:123] offset:0
v_mfma_f32_32x32x16_bf16 v[72:87], v[224:227], a[88:91], v[72:87]
ds_write_b128 v57, v[124:127] offset:1024
v_mfma_f32_32x32x16_bf16 v[72:87], v[232:235], a[96:99], v[72:87]
ds_write_b128 v57, v[128:131] offset:2048
v_mfma_f32_32x32x16_bf16 v[72:87], v[240:243], a[104:107], v[72:87]
ds_write_b128 v57, v[132:135] offset:3072
s_waitcnt lgkmcnt(0)
s_barrier
ds_read_b128 v[88:91], v58 offset:0
ds_read_b128 v[92:95], v58 offset:1024
ds_read_b128 v[96:99], v58 offset:2048
ds_read_b128 v[100:103], v58 offset:3072
ds_read_b128 v[104:107], v58 offset:4096
ds_read_b128 v[108:111], v58 offset:5120
ds_read_b128 v[112:115], v58 offset:6144
ds_read_b128 v[116:119], v58 offset:7168
ds_read_b128 v[120:123], v58 offset:8192
ds_read_b128 v[124:127], v58 offset:9216
ds_read_b128 v[128:131], v58 offset:10240
ds_read_b128 v[132:135], v58 offset:11264
s_waitcnt lgkmcnt(11)
v_pk_add_f32 v[72:73], v[72:73], v[88:89] op_sel:[0,0] op_sel_hi:[1,1]
v_pk_add_f32 v[74:75], v[74:75], v[90:91] op_sel:[0,0] op_sel_hi:[1,1]
s_waitcnt lgkmcnt(10)
v_pk_add_f32 v[76:77], v[76:77], v[92:93] op_sel:[0,0] op_sel_hi:[1,1]
v_pk_add_f32 v[78:79], v[78:79], v[94:95] op_sel:[0,0] op_sel_hi:[1,1]
s_waitcnt lgkmcnt(9)
v_pk_add_f32 v[80:81], v[80:81], v[96:97] op_sel:[0,0] op_sel_hi:[1,1]
v_pk_add_f32 v[82:83], v[82:83], v[98:99] op_sel:[0,0] op_sel_hi:[1,1]
s_waitcnt lgkmcnt(8)
v_pk_add_f32 v[84:85], v[84:85], v[100:101] op_sel:[0,0] op_sel_hi:[1,1]
v_pk_add_f32 v[86:87], v[86:87], v[102:103] op_sel:[0,0] op_sel_hi:[1,1]
s_waitcnt lgkmcnt(3)
v_pk_add_f32 v[104:105], v[104:105], v[120:121] op_sel:[0,0] op_sel_hi:[1,1]
v_pk_add_f32 v[106:107], v[106:107], v[122:123] op_sel:[0,0] op_sel_hi:[1,1]
s_waitcnt lgkmcnt(2)
v_pk_add_f32 v[108:109], v[108:109], v[124:125] op_sel:[0,0] op_sel_hi:[1,1]
v_pk_add_f32 v[110:111], v[110:111], v[126:127] op_sel:[0,0] op_sel_hi:[1,1]
s_waitcnt lgkmcnt(1)
v_pk_add_f32 v[112:113], v[112:113], v[128:129] op_sel:[0,0] op_sel_hi:[1,1]
v_pk_add_f32 v[114:115], v[114:115], v[130:131] op_sel:[0,0] op_sel_hi:[1,1]
s_waitcnt lgkmcnt(0)
v_pk_add_f32 v[116:117], v[116:117], v[132:133] op_sel:[0,0] op_sel_hi:[1,1]
v_pk_add_f32 v[118:119], v[118:119], v[134:135] op_sel:[0,0] op_sel_hi:[1,1]
v_pk_add_f32 v[72:73], v[72:73], v[104:105] op_sel:[0,0] op_sel_hi:[1,1]
v_pk_add_f32 v[74:75], v[74:75], v[106:107] op_sel:[0,0] op_sel_hi:[1,1]
v_pk_add_f32 v[76:77], v[76:77], v[108:109] op_sel:[0,0] op_sel_hi:[1,1]
v_pk_add_f32 v[78:79], v[78:79], v[110:111] op_sel:[0,0] op_sel_hi:[1,1]
v_pk_add_f32 v[80:81], v[80:81], v[112:113] op_sel:[0,0] op_sel_hi:[1,1]
v_pk_add_f32 v[82:83], v[82:83], v[114:115] op_sel:[0,0] op_sel_hi:[1,1]
v_pk_add_f32 v[84:85], v[84:85], v[116:117] op_sel:[0,0] op_sel_hi:[1,1]
v_pk_add_f32 v[86:87], v[86:87], v[118:119] op_sel:[0,0] op_sel_hi:[1,1]
s_lshl_b32 s14, s12, 1
s_add_u32 s14, s14, s15
s_mul_i32 s14, s14, 57344
s_add_u32 s17, s14, 14336
buffer_store_dword v72, v48, s[64:67], s14 offen offset:0 sc1
buffer_store_dword v73, v48, s[64:67], s17 offen offset:0 sc1
buffer_store_dword v74, v48, s[64:67], s14 offen offset:1792 sc1
buffer_store_dword v75, v48, s[64:67], s17 offen offset:1792 sc1
s_add_u32 s14, s14, 3584
s_add_u32 s17, s17, 3584
buffer_store_dword v76, v48, s[64:67], s14 offen offset:0 sc1
buffer_store_dword v77, v48, s[64:67], s17 offen offset:0 sc1
buffer_store_dword v78, v48, s[64:67], s14 offen offset:1792 sc1
buffer_store_dword v79, v48, s[64:67], s17 offen offset:1792 sc1
s_add_u32 s14, s14, 3584
s_add_u32 s17, s17, 3584
buffer_store_dword v80, v48, s[64:67], s14 offen offset:0 sc1
buffer_store_dword v81, v48, s[64:67], s17 offen offset:0 sc1
buffer_store_dword v82, v48, s[64:67], s14 offen offset:1792 sc1
buffer_store_dword v83, v48, s[64:67], s17 offen offset:1792 sc1
s_add_u32 s14, s14, 3584
s_add_u32 s17, s17, 3584
buffer_store_dword v84, v48, s[64:67], s14 offen offset:0 sc1
buffer_store_dword v85, v48, s[64:67], s17 offen offset:0 sc1
buffer_store_dword v86, v48, s[64:67], s14 offen offset:1792 sc1
buffer_store_dword v87, v48, s[64:67], s17 offen offset:1792 sc1
L_kp_x:
s_endpgm
L_kp_r31:
v_min_u32 v70, 6, v1
v_lshlrev_b32 v70, 4, v70
s_add_u32 s17, s71, 28770304
v_mov_b32 v68, 0
L_kp_poll2:
buffer_load_dword v69, v70, s[48:51], s17 offen sc1
s_mov_b32 exec_lo, 0xffffffff
s_mov_b32 exec_hi, 0xffffff
buffer_load_dword v68, v13, s[48:51], s6 offen sc1
s_mov_b64 exec, -1
s_mov_b32 m0, s4
s_lshl_b32 s5, s24, 2
buffer_load_dwordx4 v53, s[48:51], s5 offen sc1 lds
s_add_u32 m0, m0, 4096
s_lshl_b32 s5, s25, 2
buffer_load_dwordx4 v53, s[48:51], s5 offen sc1 lds
s_waitcnt vmcnt(2)
v_cmp_eq_u32 s[18:19], -1, v69
v_cmp_eq_u32 vcc, -1, v68
s_nop 0
s_or_b64 vcc, vcc, s[18:19]
s_cbranch_scc0 L_kp_pollx3
s_sub_i32 s73, s73, 1
s_cmp_gt_i32 s73, 0
s_cbranch_scc1 L_kp_poll2
s_branch L_kp_pollx3
L_kp_redo8:
s_sub_i32 s73, s73, 1
s_cmp_gt_i32 s73, 0
s_cbranch_scc0 L_kp_back9
buffer_load_dwordx4 v[152:155], v14, s[48:51], s4 offen sc1
buffer_load_dwordx4 v[156:159], v18, s[48:51], s4 offen sc1
s_waitcnt vmcnt(0)
v_max_u32 v54, v155, v159
v_cmp_eq_u32 vcc, -1, v54
s_nop 0
s_cbranch_vccnz L_kp_redo8
s_branch L_kp_back9
L_kp_redo10:
s_sub_i32 s73, s73, 1
s_cmp_gt_i32 s73, 0
s_cbranch_scc0 L_kp_back11
buffer_load_dwordx4 v[160:163], v62, s[48:51], s4 offen sc1
buffer_load_dwordx4 v[164:167], v63, s[48:51], s4 offen sc1
s_waitcnt vmcnt(0)
v_max_u32 v54, v163, v167
v_cmp_eq_u32 vcc, -1, v54
s_nop 0
s_cbranch_vccnz L_kp_redo10
s_branch L_kp_back11
L_kp_redo12:
s_sub_i32 s73, s73, 1
s_cmp_gt_i32 s73, 0
s_cbranch_scc0 L_kp_back13
buffer_load_dwordx4 v[168:171], v14, s[48:51], s5 offen sc1
buffer_load_dwordx4 v[172:175], v18, s[48:51], s5 offen sc1
s_waitcnt vmcnt(0)
v_max_u32 v54, v171, v175
v_cmp_eq_u32 vcc, -1, v54
s_nop 0
s_cbranch_vccnz L_kp_redo12
s_branch L_kp_back13
L_kp_redo14:
s_sub_i32 s73, s73, 1
s_cmp_gt_i32 s73, 0
s_cbranch_scc0 L_kp_back15
buffer_load_dwordx4 v[176:179], v62, s[48:51], s5 offen sc1
buffer_load_dwordx4 v[180:183], v63, s[48:51], s5 offen sc1
s_waitcnt vmcnt(0)
v_max_u32 v54, v179, v183
v_cmp_eq_u32 vcc, -1, v54
s_nop 0
s_cbranch_vccnz L_kp_redo14
s_branch L_kp_back15
L_kp_redo16:
s_sub_i32 s73, s73, 1
s_cmp_gt_i32 s73, 0
s_cbranch_scc0 L_kp_back17
buffer_load_dwordx4 v[184:187], v14, s[48:51], s17 offen sc1
buffer_load_dwordx4 v[188:191], v18, s[48:51], s17 offen sc1
s_waitcnt vmcnt(0)
v_max_u32 v54, v187, v191
v_cmp_eq_u32 vcc, -1, v54
s_nop 0
s_cbranch_vccnz L_kp_redo16
s_branch L_kp_back17
L_kp_redo18:
s_sub_i32 s73, s73, 1
s_cmp_gt_i32 s73, 0
s_cbranch_scc0 L_kp_back19
buffer_load_dwordx4 v[192:195], v62, s[48:51], s17 offen sc1
buffer_load_dwordx4 v[196:199], v63, s[48:51], s17 offen sc1
s_waitcnt vmcnt(0)
v_max_u32 v54, v195, v199
v_cmp_eq_u32 vcc, -1, v54
s_nop 0
s_cbranch_vccnz L_kp_redo18
s_branch L_kp_back19
L_kp_redo20:
s_sub_i32 s73, s73, 1
s_cmp_gt_i32 s73, 0
s_cbranch_scc0 L_kp_back21
buffer_load_dwordx4 v[200:203], v14, s[48:51], s18 offen sc1
buffer_load_dwordx4 v[204:207], v18, s[48:51], s18 offen sc1
s_waitcnt vmcnt(0)
v_max_u32 v54, v203, v207
v_cmp_eq_u32 vcc, -1, v54
s_nop 0
s_cbranch_vccnz L_kp_redo20
s_branch L_kp_back21
L_kp_redo22:
s_sub_i32 s73, s73, 1
s_cmp_gt_i32 s73, 0
s_cbranch_scc0 L_kp_back23
buffer_load_dwordx4 v[208:211], v62, s[48:51], s18 offen sc1
buffer_load_dwordx4 v[212:215], v63, s[48:51], s18 offen sc1
s_waitcnt vmcnt(0)
v_max_u32 v54, v211, v215
v_cmp_eq_u32 vcc, -1, v54
s_nop 0
s_cbranch_vccnz L_kp_redo22
s_branch L_kp_back23
L_kp_redo24:
s_sub_i32 s73, s73, 1
s_cmp_gt_i32 s73, 0
s_cbranch_scc0 L_kp_back25
buffer_load_dwordx4 v[216:219], v14, s[48:51], s19 offen sc1
buffer_load_dwordx4 v[220:223], v18, s[48:51], s19 offen sc1
s_waitcnt vmcnt(0)
v_max_u32 v54, v219, v223
v_cmp_eq_u32 vcc, -1, v54
s_nop 0
s_cbranch_vccnz L_kp_redo24
s_branch L_kp_back25
L_kp_redo26:
s_sub_i32 s73, s73, 1
s_cmp_gt_i32 s73, 0
s_cbranch_scc0 L_kp_back27
buffer_load_dwordx4 v[224:227], v62, s[48:51], s19 offen sc1
buffer_load_dwordx4 v[228:231], v63, s[48:51], s19 offen sc1
s_waitcnt vmcnt(0)
v_max_u32 v54, v227, v231
v_cmp_eq_u32 vcc, -1, v54
s_nop 0
s_cbranch_vccnz L_kp_redo26
s_branch L_kp_back27
L_kp_redo28:
s_sub_i32 s73, s73, 1
s_cmp_gt_i32 s73, 0
s_cbranch_scc0 L_kp_back29
buffer_load_dwordx4 v[232:235], v14, s[48:51], s39 offen sc1
buffer_load_dwordx4 v[236:239], v18, s[48:51], s39 offen sc1
s_waitcnt vmcnt(0)
v_max_u32 v54, v235, v239
v_cmp_eq_u32 vcc, -1, v54
s_nop 0
s_cbranch_vccnz L_kp_redo28
s_branch L_kp_back29
L_kp_redo30:
s_sub_i32 s73, s73, 1
s_cmp_gt_i32 s73, 0
s_cbranch_scc0 L_kp_back31
buffer_load_dwordx4 v[240:243], v62, s[48:51], s39 offen sc1
buffer_load_dwordx4 v[244:247], v63, s[48:51], s39 offen sc1
s_waitcnt vmcnt(0)
v_max_u32 v54, v243, v247
v_cmp_eq_u32 vcc, -1, v54
s_nop 0
s_cbranch_vccnz L_kp_redo30
s_branch L_kp_back31
L_kp_redo32:
s_sub_i32 s73, s73, 1
s_cmp_gt_i32 s73, 0
s_cbranch_scc0 L_kp_back33
global_load_dword v60, v61, s[42:43] offset:136 sc1
s_waitcnt vmcnt(0)
v_cmp_eq_u32 vcc, 0, v60
s_nop 0
s_cbranch_vccnz L_kp_redo32
s_branch L_kp_back33
L_kp_qw35:
v_cvt_pk_bf16_f32 v82, v66, v67
v_cvt_pk_bf16_f32 v83, v68, v69
v_cvt_pk_bf16_f32 v84, v70, v71
v_cvt_pk_bf16_f32 v85, v72, v73
v_cndmask_b32 v82, v82, v63, s[18:19]
s_branch L_kp_qb36
L_kp_qw37:
v_pk_mul_f32 v[66:67], v[66:67], v[58:59] op_sel:[0,0] op_sel_hi:[1,0]
v_pk_mul_f32 v[68:69], v[68:69], v[58:59] op_sel:[0,0] op_sel_hi:[1,0]
v_pk_mul_f32 v[70:71], v[70:71], v[58:59] op_sel:[0,0] op_sel_hi:[1,0]
v_pk_mul_f32 v[72:73], v[72:73], v[58:59] op_sel:[0,0] op_sel_hi:[1,0]
v_pk_mul_f32 v[74:75], v[74:75], v[58:59] op_sel:[0,0] op_sel_hi:[1,0]
v_pk_mul_f32 v[76:77], v[76:77], v[58:59] op_sel:[0,0] op_sel_hi:[1,0]
v_pk_mul_f32 v[78:79], v[78:79], v[58:59] op_sel:[0,0] op_sel_hi:[1,0]
v_pk_mul_f32 v[80:81], v[80:81], v[58:59] op_sel:[0,0] op_sel_hi:[1,0]
v_cvt_pk_bf16_f32 v82, v74, v75
v_cvt_pk_bf16_f32 v83, v76, v77
v_cvt_pk_bf16_f32 v84, v78, v79
v_cvt_pk_bf16_f32 v85, v80, v81
v_cndmask_b32 v82, v82, v63, s[18:19]
s_branch L_kp_qb38
L_kp_qw39:
v_pk_mul_f32 v[66:67], v[66:67], v[58:59] op_sel:[0,0] op_sel_hi:[1,0]
v_pk_mul_f32 v[68:69], v[68:69], v[58:59] op_sel:[0,0] op_sel_hi:[1,0]
v_pk_mul_f32 v[70:71], v[70:71], v[58:59] op_sel:[0,0] op_sel_hi:[1,0]
v_pk_mul_f32 v[72:73], v[72:73], v[58:59] op_sel:[0,0] op_sel_hi:[1,0]
v_pk_mul_f32 v[74:75], v[74:75], v[58:59] op_sel:[0,0] op_sel_hi:[1,0]
v_pk_mul_f32 v[76:77], v[76:77], v[58:59] op_sel:[0,0] op_sel_hi:[1,0]
v_pk_mul_f32 v[78:79], v[78:79], v[58:59] op_sel:[0,0] op_sel_hi:[1,0]
v_pk_mul_f32 v[80:81], v[80:81], v[58:59] op_sel:[0,0] op_sel_hi:[1,0]
v_cvt_pk_bf16_f32 v82, v66, v67
v_cvt_pk_bf16_f32 v83, v68, v69
v_cvt_pk_bf16_f32 v84, v70, v71
v_cvt_pk_bf16_f32 v85, v72, v73
v_cndmask_b32 v82, v82, v63, s[18:19]
s_branch L_kp_qb40
L_kp_qw41:
v_pk_mul_f32 v[66:67], v[66:67], v[58:59] op_sel:[0,0] op_sel_hi:[1,0]
v_pk_mul_f32 v[68:69], v[68:69], v[58:59] op_sel:[0,0] op_sel_hi:[1,0]
v_pk_mul_f32 v[70:71], v[70:71], v[58:59] op_sel:[0,0] op_sel_hi:[1,0]
v_pk_mul_f32 v[72:73], v[72:73], v[58:59] op_sel:[0,0] op_sel_hi:[1,0]
v_pk_mul_f32 v[74:75], v[74:75], v[58:59] op_sel:[0,0] op_sel_hi:[1,0]
v_pk_mul_f32 v[76:77], v[76:77], v[58:59] op_sel:[0,0] op_sel_hi:[1,0]
v_pk_mul_f32 v[78:79], v[78:79], v[58:59] op_sel:[0,0] op_sel_hi:[1,0]
v_pk_mul_f32 v[80:81], v[80:81], v[58:59] op_sel:[0,0] op_sel_hi:[1,0]
v_cvt_pk_bf16_f32 v82, v74, v75
v_cvt_pk_bf16_f32 v83, v76, v77
v_cvt_pk_bf16_f32 v84, v78, v79
v_cvt_pk_bf16_f32 v85, v80, v81
v_cndmask_b32 v82, v82, v63, s[18:19]
s_branch L_kp_qb42
L_kp_qw43:
v_pk_mul_f32 v[66:67], v[66:67], v[58:59] op_sel:[0,0] op_sel_hi:[1,0]
v_pk_mul_f32 v[68:69], v[68:69], v[58:59] op_sel:[0,0] op_sel_hi:[1,0]
v_pk_mul_f32 v[70:71], v[70:71], v[58:59] op_sel:[0,0] op_sel_hi:[1,0]
v_pk_mul_f32 v[72:73], v[72:73], v[58:59] op_sel:[0,0] op_sel_hi:[1,0]
v_pk_mul_f32 v[74:75], v[74:75], v[58:59] op_sel:[0,0] op_sel_hi:[1,0]
v_pk_mul_f32 v[76:77], v[76:77], v[58:59] op_sel:[0,0] op_sel_hi:[1,0]
v_pk_mul_f32 v[78:79], v[78:79], v[58:59] op_sel:[0,0] op_sel_hi:[1,0]
v_pk_mul_f32 v[80:81], v[80:81], v[58:59] op_sel:[0,0] op_sel_hi:[1,0]
v_cvt_pk_bf16_f32 v82, v66, v67
v_cvt_pk_bf16_f32 v83, v68, v69
v_cvt_pk_bf16_f32 v84, v70, v71
v_cvt_pk_bf16_f32 v85, v72, v73
v_cndmask_b32 v82, v82, v63, s[18:19]
s_branch L_kp_qb44
L_kp_qw45:
v_pk_mul_f32 v[66:67], v[66:67], v[58:59] op_sel:[0,0] op_sel_hi:[1,0]
v_pk_mul_f32 v[68:69], v[68:69], v[58:59] op_sel:[0,0] op_sel_hi:[1,0]
v_pk_mul_f32 v[70:71], v[70:71], v[58:59] op_sel:[0,0] op_sel_hi:[1,0]
v_pk_mul_f32 v[72:73], v[72:73], v[58:59] op_sel:[0,0] op_sel_hi:[1,0]
v_pk_mul_f32 v[74:75], v[74:75], v[58:59] op_sel:[0,0] op_sel_hi:[1,0]
v_pk_mul_f32 v[76:77], v[76:77], v[58:59] op_sel:[0,0] op_sel_hi:[1,0]
v_pk_mul_f32 v[78:79], v[78:79], v[58:59] op_sel:[0,0] op_sel_hi:[1,0]
v_pk_mul_f32 v[80:81], v[80:81], v[58:59] op_sel:[0,0] op_sel_hi:[1,0]
v_cvt_pk_bf16_f32 v82, v74, v75
v_cvt_pk_bf16_f32 v83, v76, v77
v_cvt_pk_bf16_f32 v84, v78, v79
v_cvt_pk_bf16_f32 v85, v80, v81
v_cndmask_b32 v82, v82, v63, s[18:19]
s_branch L_kp_qb46
L_kp_qw47:
v_pk_mul_f32 v[66:67], v[66:67], v[58:59] op_sel:[0,0] op_sel_hi:[1,0]
v_pk_mul_f32 v[68:69], v[68:69], v[58:59] op_sel:[0,0] op_sel_hi:[1,0]
v_pk_mul_f32 v[70:71], v[70:71], v[58:59] op_sel:[0,0] op_sel_hi:[1,0]
v_pk_mul_f32 v[72:73], v[72:73], v[58:59] op_sel:[0,0] op_sel_hi:[1,0]
v_pk_mul_f32 v[74:75], v[74:75], v[58:59] op_sel:[0,0] op_sel_hi:[1,0]
v_pk_mul_f32 v[76:77], v[76:77], v[58:59] op_sel:[0,0] op_sel_hi:[1,0]
v_pk_mul_f32 v[78:79], v[78:79], v[58:59] op_sel:[0,0] op_sel_hi:[1,0]
v_pk_mul_f32 v[80:81], v[80:81], v[58:59] op_sel:[0,0] op_sel_hi:[1,0]
v_cvt_pk_bf16_f32 v82, v66, v67
v_cvt_pk_bf16_f32 v83, v68, v69
v_cvt_pk_bf16_f32 v84, v70, v71
v_cvt_pk_bf16_f32 v85, v72, v73
v_cndmask_b32 v82, v82, v63, s[18:19]
s_branch L_kp_qb48
L_kp_qw49:
v_pk_mul_f32 v[66:67], v[66:67], v[58:59] op_sel:[0,0] op_sel_hi:[1,0]
v_pk_mul_f32 v[68:69], v[68:69], v[58:59] op_sel:[0,0] op_sel_hi:[1,0]
v_pk_mul_f32 v[70:71], v[70:71], v[58:59] op_sel:[0,0] op_sel_hi:[1,0]
v_pk_mul_f32 v[72:73], v[72:73], v[58:59] op_sel:[0,0] op_sel_hi:[1,0]
v_pk_mul_f32 v[74:75], v[74:75], v[58:59] op_sel:[0,0] op_sel_hi:[1,0]
v_pk_mul_f32 v[76:77], v[76:77], v[58:59] op_sel:[0,0] op_sel_hi:[1,0]
v_pk_mul_f32 v[78:79], v[78:79], v[58:59] op_sel:[0,0] op_sel_hi:[1,0]
v_pk_mul_f32 v[80:81], v[80:81], v[58:59] op_sel:[0,0] op_sel_hi:[1,0]
v_cvt_pk_bf16_f32 v82, v74, v75
v_cvt_pk_bf16_f32 v83, v76, v77
v_cvt_pk_bf16_f32 v84, v78, v79
v_cvt_pk_bf16_f32 v85, v80, v81
v_cndmask_b32 v82, v82, v63, s[18:19]
s_branch L_kp_qb50
L_kp_qw51:
v_pk_mul_f32 v[66:67], v[66:67], v[58:59] op_sel:[0,0] op_sel_hi:[1,0]
v_pk_mul_f32 v[68:69], v[68:69], v[58:59] op_sel:[0,0] op_sel_hi:[1,0]
v_pk_mul_f32 v[70:71], v[70:71], v[58:59] op_sel:[0,0] op_sel_hi:[1,0]
v_pk_mul_f32 v[72:73], v[72:73], v[58:59] op_sel:[0,0] op_sel_hi:[1,0]
v_pk_mul_f32 v[74:75], v[74:75], v[58:59] op_sel:[0,0] op_sel_hi:[1,0]
v_pk_mul_f32 v[76:77], v[76:77], v[58:59] op_sel:[0,0] op_sel_hi:[1,0]
v_pk_mul_f32 v[78:79], v[78:79], v[58:59] op_sel:[0,0] op_sel_hi:[1,0]
v_pk_mul_f32 v[80:81], v[80:81], v[58:59] op_sel:[0,0] op_sel_hi:[1,0]
v_cvt_pk_bf16_f32 v82, v66, v67
v_cvt_pk_bf16_f32 v83, v68, v69
v_cvt_pk_bf16_f32 v84, v70, v71
v_cvt_pk_bf16_f32 v85, v72, v73
v_cndmask_b32 v82, v82, v63, s[18:19]
s_branch L_kp_qb52
L_kp_qw53:
v_pk_mul_f32 v[66:67], v[66:67], v[58:59] op_sel:[0,0] op_sel_hi:[1,0]
v_pk_mul_f32 v[68:69], v[68:69], v[58:59] op_sel:[0,0] op_sel_hi:[1,0]
v_pk_mul_f32 v[70:71], v[70:71], v[58:59] op_sel:[0,0] op_sel_hi:[1,0]
v_pk_mul_f32 v[72:73], v[72:73], v[58:59] op_sel:[0,0] op_sel_hi:[1,0]
v_pk_mul_f32 v[74:75], v[74:75], v[58:59] op_sel:[0,0] op_sel_hi:[1,0]
v_pk_mul_f32 v[76:77], v[76:77], v[58:59] op_sel:[0,0] op_sel_hi:[1,0]
v_pk_mul_f32 v[78:79], v[78:79], v[58:59] op_sel:[0,0] op_sel_hi:[1,0]
v_pk_mul_f32 v[80:81], v[80:81], v[58:59] op_sel:[0,0] op_sel_hi:[1,0]
v_cvt_pk_bf16_f32 v82, v74, v75
v_cvt_pk_bf16_f32 v83, v76, v77
v_cvt_pk_bf16_f32 v84, v78, v79
v_cvt_pk_bf16_f32 v85, v80, v81
v_cndmask_b32 v82, v82, v63, s[18:19]
s_branch L_kp_qb54
L_kp_qw55:
v_pk_mul_f32 v[66:67], v[66:67], v[58:59] op_sel:[0,0] op_sel_hi:[1,0]
v_pk_mul_f32 v[68:69], v[68:69], v[58:59] op_sel:[0,0] op_sel_hi:[1,0]
v_pk_mul_f32 v[70:71], v[70:71], v[58:59] op_sel:[0,0] op_sel_hi:[1,0]
v_pk_mul_f32 v[72:73], v[72:73], v[58:59] op_sel:[0,0] op_sel_hi:[1,0]
v_pk_mul_f32 v[74:75], v[74:75], v[58:59] op_sel:[0,0] op_sel_hi:[1,0]
v_pk_mul_f32 v[76:77], v[76:77], v[58:59] op_sel:[0,0] op_sel_hi:[1,0]
v_pk_mul_f32 v[78:79], v[78:79], v[58:59] op_sel:[0,0] op_sel_hi:[1,0]
v_pk_mul_f32 v[80:81], v[80:81], v[58:59] op_sel:[0,0] op_sel_hi:[1,0]
v_cvt_pk_bf16_f32 v82, v66, v67
v_cvt_pk_bf16_f32 v83, v68, v69
v_cvt_pk_bf16_f32 v84, v70, v71
v_cvt_pk_bf16_f32 v85, v72, v73
v_cndmask_b32 v82, v82, v63, s[18:19]
s_branch L_kp_qb56
L_kp_qw57:
v_pk_mul_f32 v[66:67], v[66:67], v[58:59] op_sel:[0,0] op_sel_hi:[1,0]
v_pk_mul_f32 v[68:69], v[68:69], v[58:59] op_sel:[0,0] op_sel_hi:[1,0]
v_pk_mul_f32 v[70:71], v[70:71], v[58:59] op_sel:[0,0] op_sel_hi:[1,0]
v_pk_mul_f32 v[72:73], v[72:73], v[58:59] op_sel:[0,0] op_sel_hi:[1,0]
v_pk_mul_f32 v[74:75], v[74:75], v[58:59] op_sel:[0,0] op_sel_hi:[1,0]
v_pk_mul_f32 v[76:77], v[76:77], v[58:59] op_sel:[0,0] op_sel_hi:[1,0]
v_pk_mul_f32 v[78:79], v[78:79], v[58:59] op_sel:[0,0] op_sel_hi:[1,0]
v_pk_mul_f32 v[80:81], v[80:81], v[58:59] op_sel:[0,0] op_sel_hi:[1,0]
v_cvt_pk_bf16_f32 v82, v74, v75
v_cvt_pk_bf16_f32 v83, v76, v77
v_cvt_pk_bf16_f32 v84, v78, v79
v_cvt_pk_bf16_f32 v85, v80, v81
v_cndmask_b32 v82, v82, v63, s[18:19]
s_branch L_kp_qb58
L_kp_qw59:
v_pk_mul_f32 v[66:67], v[66:67], v[58:59] op_sel:[0,0] op_sel_hi:[1,0]
v_pk_mul_f32 v[68:69], v[68:69], v[58:59] op_sel:[0,0] op_sel_hi:[1,0]
v_pk_mul_f32 v[70:71], v[70:71], v[58:59] op_sel:[0,0] op_sel_hi:[1,0]
v_pk_mul_f32 v[72:73], v[72:73], v[58:59] op_sel:[0,0] op_sel_hi:[1,0]
v_pk_mul_f32 v[74:75], v[74:75], v[58:59] op_sel:[0,0] op_sel_hi:[1,0]
v_pk_mul_f32 v[76:77], v[76:77], v[58:59] op_sel:[0,0] op_sel_hi:[1,0]
v_pk_mul_f32 v[78:79], v[78:79], v[58:59] op_sel:[0,0] op_sel_hi:[1,0]
v_pk_mul_f32 v[80:81], v[80:81], v[58:59] op_sel:[0,0] op_sel_hi:[1,0]
v_cvt_pk_bf16_f32 v82, v66, v67
v_cvt_pk_bf16_f32 v83, v68, v69
v_cvt_pk_bf16_f32 v84, v70, v71
v_cvt_pk_bf16_f32 v85, v72, v73
v_cndmask_b32 v82, v82, v63, s[18:19]
s_branch L_kp_qb60
L_kp_qw61:
v_pk_mul_f32 v[66:67], v[66:67], v[58:59] op_sel:[0,0] op_sel_hi:[1,0]
v_pk_mul_f32 v[68:69], v[68:69], v[58:59] op_sel:[0,0] op_sel_hi:[1,0]
v_pk_mul_f32 v[70:71], v[70:71], v[58:59] op_sel:[0,0] op_sel_hi:[1,0]
v_pk_mul_f32 v[72:73], v[72:73], v[58:59] op_sel:[0,0] op_sel_hi:[1,0]
v_pk_mul_f32 v[74:75], v[74:75], v[58:59] op_sel:[0,0] op_sel_hi:[1,0]
v_pk_mul_f32 v[76:77], v[76:77], v[58:59] op_sel:[0,0] op_sel_hi:[1,0]
v_pk_mul_f32 v[78:79], v[78:79], v[58:59] op_sel:[0,0] op_sel_hi:[1,0]
v_pk_mul_f32 v[80:81], v[80:81], v[58:59] op_sel:[0,0] op_sel_hi:[1,0]
v_cvt_pk_bf16_f32 v82, v74, v75
v_cvt_pk_bf16_f32 v83, v76, v77
v_cvt_pk_bf16_f32 v84, v78, v79
v_cvt_pk_bf16_f32 v85, v80, v81
v_cndmask_b32 v82, v82, v63, s[18:19]
s_branch L_kp_qb62
L_kp_h5r65:
s_sub_i32 s73, s73, 1
s_cmp_gt_i32 s73, 0
s_cbranch_scc0 L_kp_h5x64
v_max3_u32 v140, v104, v105, v106
v_max_u32 v140, v140, v107
v_cmp_eq_u32 vcc, -1, v140
s_nop 0
s_cbranch_vccz L_kp_h5s66
buffer_load_dwordx4 v[104:107], v3, s[48:51], s17 offen sc1
L_kp_h5s66:
v_max3_u32 v140, v108, v109, v110
v_max_u32 v140, v140, v111
v_cmp_eq_u32 vcc, -1, v140
s_nop 0
s_cbranch_vccz L_kp_h5s67
buffer_load_dwordx4 v[108:111], v3, s[48:51], s18 offen sc1
L_kp_h5s67:
v_max3_u32 v140, v112, v113, v114
v_max_u32 v140, v140, v115
v_cmp_eq_u32 vcc, -1, v140
s_nop 0
s_cbranch_vccz L_kp_h5s68
s_mov_b32 s14, 27394048
buffer_load_dwordx4 v[112:115], v3, s[48:51], s14 offen sc1
L_kp_h5s68:
v_max3_u32 v140, v116, v117, v118
v_max_u32 v140, v140, v119
v_cmp_eq_u32 vcc, -1, v140
s_nop 0
s_cbranch_vccz L_kp_h5s69
s_mov_b32 s14, 27398144
buffer_load_dwordx4 v[116:119], v3, s[48:51], s14 offen sc1
L_kp_h5s69:
v_max3_u32 v140, v120, v121, v122
v_max_u32 v140, v140, v123
v_cmp_eq_u32 vcc, -1, v140
s_nop 0
s_cbranch_vccz L_kp_h5s70
s_mov_b32 s14, 27402240
buffer_load_dwordx4 v[120:123], v3, s[48:51], s14 offen sc1
L_kp_h5s70:
v_max3_u32 v140, v124, v125, v126
v_max_u32 v140, v140, v127
v_cmp_eq_u32 vcc, -1, v140
s_nop 0
s_cbranch_vccz L_kp_h5s71
s_mov_b32 s14, 27406336
buffer_load_dwordx4 v[124:127], v3, s[48:51], s14 offen sc1
L_kp_h5s71:
v_max3_u32 v140, v128, v129, v130
v_max_u32 v140, v140, v131
v_cmp_eq_u32 vcc, -1, v140
s_nop 0
s_cbranch_vccz L_kp_h5s72
s_mov_b32 s14, 27410432
buffer_load_dwordx4 v[128:131], v3, s[48:51], s14 offen sc1
L_kp_h5s72:
v_max3_u32 v140, v132, v133, v134
v_max_u32 v140, v140, v135
v_cmp_eq_u32 vcc, -1, v140
s_nop 0
s_cbranch_vccz L_kp_h5s73
s_mov_b32 s14, 27414528
buffer_load_dwordx4 v[132:135], v3, s[48:51], s14 offen sc1
L_kp_h5s73:
v_max3_u32 v140, v136, v137, v138
v_max_u32 v140, v140, v139
v_cmp_eq_u32 vcc, -1, v140
s_nop 0
s_cbranch_vccz L_kp_h5s74
s_mov_b32 s14, 27418624
buffer_load_dwordx4 v[136:139], v3, s[48:51], s14 offen sc1
L_kp_h5s74:
s_branch L_kp_h563
L_kp_r375:
v_mov_b32 v70, 0
v_mov_b32 v68, 0
L_kp_poll76:
global_load_dword v69, v70, s[42:43] offset:140 sc1
s_mov_b32 exec_lo, 0xffffffff
s_mov_b32 exec_hi, 0xffffff
buffer_load_dword v68, v13, s[48:51], s6 offen sc1
s_mov_b64 exec, -1
s_mov_b32 m0, s4
s_lshl_b32 s5, s24, 2
buffer_load_dwordx4 v53, s[48:51], s5 offen sc1 lds
s_add_u32 m0, m0, 4096
s_lshl_b32 s5, s25, 2
buffer_load_dwordx4 v53, s[48:51], s5 offen sc1 lds
s_waitcnt vmcnt(2)
v_cmp_eq_u32 s[18:19], 0, v69
v_cmp_eq_u32 vcc, -1, v68
s_nop 0
s_or_b64 vcc, vcc, s[18:19]
s_cbranch_scc0 L_kp_pollx77
s_sub_i32 s73, s73, 1
s_cmp_gt_i32 s73, 0
s_cbranch_scc1 L_kp_poll76
s_branch L_kp_pollx77
L_kp_redo82:
s_sub_i32 s73, s73, 1
s_cmp_gt_i32 s73, 0
s_cbranch_scc0 L_kp_back83
buffer_load_dwordx4 v[152:155], v14, s[48:51], s4 offen sc1
buffer_load_dwordx4 v[156:159], v18, s[48:51], s4 offen sc1
s_waitcnt vmcnt(0)
v_max_u32 v54, v155, v159
v_cmp_eq_u32 vcc, -1, v54
s_nop 0
s_cbranch_vccnz L_kp_redo82
s_branch L_kp_back83
L_kp_redo84:
s_sub_i32 s73, s73, 1
s_cmp_gt_i32 s73, 0
s_cbranch_scc0 L_kp_back85
buffer_load_dwordx4 v[160:163], v62, s[48:51], s4 offen sc1
buffer_load_dwordx4 v[164:167], v63, s[48:51], s4 offen sc1
s_waitcnt vmcnt(0)
v_max_u32 v54, v163, v167
v_cmp_eq_u32 vcc, -1, v54
s_nop 0
s_cbranch_vccnz L_kp_redo84
s_branch L_kp_back85
L_kp_redo86:
s_sub_i32 s73, s73, 1
s_cmp_gt_i32 s73, 0
s_cbranch_scc0 L_kp_back87
buffer_load_dwordx4 v[168:171], v14, s[48:51], s5 offen sc1
buffer_load_dwordx4 v[172:175], v18, s[48:51], s5 offen sc1
s_waitcnt vmcnt(0)
v_max_u32 v54, v171, v175
v_cmp_eq_u32 vcc, -1, v54
s_nop 0
s_cbranch_vccnz L_kp_redo86
s_branch L_kp_back87
L_kp_redo88:
s_sub_i32 s73, s73, 1
s_cmp_gt_i32 s73, 0
s_cbranch_scc0 L_kp_back89
buffer_load_dwordx4 v[176:179], v62, s[48:51], s5 offen sc1
buffer_load_dwordx4 v[180:183], v63, s[48:51], s5 offen sc1
s_waitcnt vmcnt(0)
v_max_u32 v54, v179, v183
v_cmp_eq_u32 vcc, -1, v54
s_nop 0
s_cbranch_vccnz L_kp_redo88
s_branch L_kp_back89
L_kp_redo90:
s_sub_i32 s73, s73, 1
s_cmp_gt_i32 s73, 0
s_cbranch_scc0 L_kp_back91
buffer_load_dwordx4 v[184:187], v14, s[48:51], s17 offen sc1
buffer_load_dwordx4 v[188:191], v18, s[48:51], s17 offen sc1
s_waitcnt vmcnt(0)
v_max_u32 v54, v187, v191
v_cmp_eq_u32 vcc, -1, v54
s_nop 0
s_cbranch_vccnz L_kp_redo90
s_branch L_kp_back91
L_kp_redo92:
s_sub_i32 s73, s73, 1
s_cmp_gt_i32 s73, 0
s_cbranch_scc0 L_kp_back93
buffer_load_dwordx4 v[192:195], v62, s[48:51], s17 offen sc1
buffer_load_dwordx4 v[196:199], v63, s[48:51], s17 offen sc1
s_waitcnt vmcnt(0)
v_max_u32 v54, v195, v199
v_cmp_eq_u32 vcc, -1, v54
s_nop 0
s_cbranch_vccnz L_kp_redo92
s_branch L_kp_back93
L_kp_redo94:
s_sub_i32 s73, s73, 1
s_cmp_gt_i32 s73, 0
s_cbranch_scc0 L_kp_back95
buffer_load_dwordx4 v[200:203], v14, s[48:51], s18 offen sc1
buffer_load_dwordx4 v[204:207], v18, s[48:51], s18 offen sc1
s_waitcnt vmcnt(0)
v_max_u32 v54, v203, v207
v_cmp_eq_u32 vcc, -1, v54
s_nop 0
s_cbranch_vccnz L_kp_redo94
s_branch L_kp_back95
L_kp_redo96:
s_sub_i32 s73, s73, 1
s_cmp_gt_i32 s73, 0
s_cbranch_scc0 L_kp_back97
buffer_load_dwordx4 v[208:211], v62, s[48:51], s18 offen sc1
buffer_load_dwordx4 v[212:215], v63, s[48:51], s18 offen sc1
s_waitcnt vmcnt(0)
v_max_u32 v54, v211, v215
v_cmp_eq_u32 vcc, -1, v54
s_nop 0
s_cbranch_vccnz L_kp_redo96
s_branch L_kp_back97
L_kp_redo98:
s_sub_i32 s73, s73, 1
s_cmp_gt_i32 s73, 0
s_cbranch_scc0 L_kp_back99
buffer_load_dwordx4 v[216:219], v14, s[48:51], s19 offen sc1
buffer_load_dwordx4 v[220:223], v18, s[48:51], s19 offen sc1
s_waitcnt vmcnt(0)
v_max_u32 v54, v219, v223
v_cmp_eq_u32 vcc, -1, v54
s_nop 0
s_cbranch_vccnz L_kp_redo98
s_branch L_kp_back99
L_kp_redo100:
s_sub_i32 s73, s73, 1
s_cmp_gt_i32 s73, 0
s_cbranch_scc0 L_kp_back101
buffer_load_dwordx4 v[224:227], v62, s[48:51], s19 offen sc1
buffer_load_dwordx4 v[228:231], v63, s[48:51], s19 offen sc1
s_waitcnt vmcnt(0)
v_max_u32 v54, v227, v231
v_cmp_eq_u32 vcc, -1, v54
s_nop 0
s_cbranch_vccnz L_kp_redo100
s_branch L_kp_back101
L_kp_redo102:
s_sub_i32 s73, s73, 1
s_cmp_gt_i32 s73, 0
s_cbranch_scc0 L_kp_back103
buffer_load_dwordx4 v[232:235], v14, s[48:51], s39 offen sc1
buffer_load_dwordx4 v[236:239], v18, s[48:51], s39 offen sc1
s_waitcnt vmcnt(0)
v_max_u32 v54, v235, v239
v_cmp_eq_u32 vcc, -1, v54
s_nop 0
s_cbranch_vccnz L_kp_redo102
s_branch L_kp_back103
L_kp_redo104:
s_sub_i32 s73, s73, 1
s_cmp_gt_i32 s73, 0
s_cbranch_scc0 L_kp_back105
buffer_load_dwordx4 v[240:243], v62, s[48:51], s39 offen sc1
buffer_load_dwordx4 v[244:247], v63, s[48:51], s39 offen sc1
s_waitcnt vmcnt(0)
v_max_u32 v54, v243, v247
v_cmp_eq_u32 vcc, -1, v54
s_nop 0
s_cbranch_vccnz L_kp_redo104
s_branch L_kp_back105
L_kp_help:
s_lshr_b32 s3, s2, 3
v_lshlrev_b32 v1, 4, v0
v_mov_b32 v8, -1
v_mov_b32 v9, -1
v_mov_b32 v10, -1
v_mov_b32 v11, -1
v_mov_b32 v12, 1
v_mov_b32 v13, 0
s_waitcnt lgkmcnt(0)
s_mov_b32 s48, s44
s_and_b32 s49, s45, 0xffff
s_mov_b32 s50, 0x2000000
s_mov_b32 s51, 0x20000
s_mov_b32 s60, s44
s_and_b32 s61, s45, 0xffff
s_mov_b32 s62, 0x2000000
s_mov_b32 s63, 0x20000
s_cmp_ge_u32 s2, 28
s_cbranch_scc1 L_kp_rp106
s_load_dwordx4 s[24:27], s[0:1], 64
v_lshrrev_b32 v3, 6, v0
v_and_b32 v15, 63, v0
v_readfirstlane_b32 s7, v3
s_lshr_b32 s5, s2, 1
s_lshl_b32 s8, s5, 5
v_and_b32 v3, 31, v15
v_add_u32 v3, s8, v3
v_mul_u32_u24 v16, 896, v3
v_lshrrev_b32 v3, 5, v15
v_lshl_add_u32 v16, v3, 4, v16
v_lshlrev_b32 v15, 4, v15
s_mul_i32 s8, s7, 224
s_mul_i32 s9, s2, 28
s_mul_i32 s12, s7, 7
s_add_u32 s9, s9, s12
s_lshl_b32 s9, s9, 10
s_add_u32 s9, s9, 26214400
s_waitcnt lgkmcnt(0)
s_bitcmp0_b32 s2, 0
s_cselect_b32 s14, s24, s26
s_cselect_b32 s15, s25, s27
s_mov_b32 s64, s14
s_and_b32 s65, s15, 0xffff
s_mov_b32 s66, 0x62000
s_mov_b32 s67, 0x20000
buffer_load_dwordx4 v[20:23], v16, s[64:67], s8 offen offset:0
buffer_load_dwordx4 v[24:27], v16, s[64:67], s8 offen offset:32
buffer_load_dwordx4 v[28:31], v16, s[64:67], s8 offen offset:64
buffer_load_dwordx4 v[32:35], v16, s[64:67], s8 offen offset:96
buffer_load_dwordx4 v[36:39], v16, s[64:67], s8 offen offset:128
buffer_load_dwordx4 v[40:43], v16, s[64:67], s8 offen offset:160
buffer_load_dwordx4 v[44:47], v16, s[64:67], s8 offen offset:192
s_waitcnt vmcnt(0)
buffer_store_dwordx4 v[20:23], v15, s[48:51], s9 offen offset:0 sc1
buffer_store_dwordx4 v[24:27], v15, s[48:51], s9 offen offset:1024 sc1
buffer_store_dwordx4 v[28:31], v15, s[48:51], s9 offen offset:2048 sc1
buffer_store_dwordx4 v[32:35], v15, s[48:51], s9 offen offset:3072 sc1
s_add_u32 s9, s9, 4096
buffer_store_dwordx4 v[36:39], v15, s[48:51], s9 offen offset:0 sc1
buffer_store_dwordx4 v[40:43], v15, s[48:51], s9 offen offset:1024 sc1
buffer_store_dwordx4 v[44:47], v15, s[48:51], s9 offen offset:2048 sc1
L_kp_rp106:
s_mul_i32 s4, s2, 114688
v_add_u32 v2, s4, v1
s_mov_b32 s4, 12582912
s_mov_b32 s62, 3670016
s_add_u32 s60, s44, s4
s_addc_u32 s61, s45, 0
s_and_b32 s61, s61, 0xffff
s_mov_b32 s4, 28
L_kp_f107:
buffer_store_dwordx4 v[8:11], v2, s[60:63], 0 offen sc1
v_add_u32 v2, 4096, v2
s_waitcnt vmcnt(24)
s_sub_u32 s4, s4, 1
s_cmp_lg_u32 s4, 0
s_cbranch_scc1 L_kp_f107
s_waitcnt vmcnt(0)
s_barrier
v_cmp_eq_u32 vcc, 0, v0
s_nop 0
s_and_saveexec_b64 s[8:9], vcc
s_cbranch_execz L_kp_fl108
global_atomic_add v14, v13, v12, s[42:43] offset:4 sc0 sc1
s_waitcnt vmcnt(0)
v_cmp_eq_u32 vcc, 31, v14
s_nop 0
s_cbranch_vccz L_kp_fl108
global_store_dword v13, v12, s[42:43] offset:132 sc1
L_kp_fl108:
s_mov_b64 exec, -1
s_mul_i32 s4, s3, 200704
s_add_u32 s4, s4, 25165824
s_add_u32 s5, s4, 200704
L_kp_h111:
buffer_load_dwordx4 v[4:7], v1, s[48:51], s4 offen
s_add_u32 s4, s4, 4096
s_waitcnt vmcnt(12)
s_cmp_lt_u32 s4, s5
s_cbranch_scc1 L_kp_h111
L_kp_w0x110n:
s_mul_i32 s4, s2, 57344
v_add_u32 v2, s4, v1
s_mov_b32 s4, 6291456
s_mov_b32 s62, 1835008
s_add_u32 s60, s44, s4
s_addc_u32 s61, s45, 0
s_and_b32 s61, s61, 0xffff
s_mov_b32 s4, 14
L_kp_f112:
buffer_store_dwordx4 v[8:11], v2, s[60:63], 0 offen sc1
v_add_u32 v2, 4096, v2
s_waitcnt vmcnt(24)
s_sub_u32 s4, s4, 1
s_cmp_lg_u32 s4, 0
s_cbranch_scc1 L_kp_f112
s_mul_i32 s4, s2, 57344
v_add_u32 v2, s4, v1
s_mov_b32 s4, 8388608
s_mov_b32 s62, 1835008
s_add_u32 s60, s44, s4
s_addc_u32 s61, s45, 0
s_and_b32 s61, s61, 0xffff
s_mov_b32 s4, 14
L_kp_f113:
buffer_store_dwordx4 v[8:11], v2, s[60:63], 0 offen sc1
v_add_u32 v2, 4096, v2
s_waitcnt vmcnt(24)
s_sub_u32 s4, s4, 1
s_cmp_lg_u32 s4, 0
s_cbranch_scc1 L_kp_f113
s_waitcnt vmcnt(0)
s_barrier
v_cmp_eq_u32 vcc, 0, v0
s_nop 0
s_and_saveexec_b64 s[8:9], vcc
s_cbranch_execz L_kp_fl114
global_atomic_add v14, v13, v12, s[42:43] offset:8 sc0 sc1
s_waitcnt vmcnt(0)
v_cmp_eq_u32 vcc, 31, v14
s_nop 0
s_cbranch_vccz L_kp_fl114
global_store_dword v13, v12, s[42:43] offset:136 sc1
L_kp_fl114:
s_mov_b64 exec, -1
s_mov_b32 s4, 3000
L_kp_w3115:
global_load_dword v14, v13, s[42:43] offset:132 sc1
s_waitcnt vmcnt(0)
v_cmp_ne_u32 vcc, 0, v14
s_nop 0
s_cbranch_vccnz L_kp_w3x116
s_sub_u32 s4, s4, 1
s_cmp_lg_u32 s4, 0
s_cbranch_scc1 L_kp_w3115
s_branch L_kp_w3x116n
L_kp_w3x116:
s_mul_i32 s4, s3, 200704
s_add_u32 s4, s4, 26214400
s_add_u32 s5, s4, 200704
L_kp_h117:
buffer_load_dwordx4 v[4:7], v1, s[48:51], s4 offen
s_add_u32 s4, s4, 4096
s_waitcnt vmcnt(12)
s_cmp_lt_u32 s4, s5
s_cbranch_scc1 L_kp_h117
L_kp_w3x116n:
s_mul_i32 s4, s2, 114688
v_add_u32 v2, s4, v1
s_mov_b32 s4, 16777216
s_mov_b32 s62, 3670016
s_add_u32 s60, s44, s4
s_addc_u32 s61, s45, 0
s_and_b32 s61, s61, 0xffff
s_mov_b32 s4, 28
L_kp_f118:
buffer_store_dwordx4 v[8:11], v2, s[60:63], 0 offen sc1
v_add_u32 v2, 4096, v2
s_waitcnt vmcnt(24)
s_sub_u32 s4, s4, 1
s_cmp_lg_u32 s4, 0
s_cbranch_scc1 L_kp_f118
s_waitcnt vmcnt(0)
s_barrier
v_cmp_eq_u32 vcc, 0, v0
s_nop 0
s_and_saveexec_b64 s[8:9], vcc
s_cbranch_execz L_kp_fl119
global_atomic_add v14, v13, v12, s[42:43] offset:12 sc0 sc1
s_waitcnt vmcnt(0)
v_cmp_eq_u32 vcc, 31, v14
s_nop 0
s_cbranch_vccz L_kp_fl119
global_store_dword v13, v12, s[42:43] offset:140 sc1
L_kp_fl119:
s_mov_b64 exec, -1
L_kp_hx:
s_endpgm
.section .rodata,"a"
.p2align 6
.amdhsa_kernel k1_kernel
  .amdhsa_next_free_vgpr 256
  .amdhsa_next_free_sgpr 76
  .amdhsa_accum_offset 256
  .amdhsa_group_segment_fixed_size 0
  .amdhsa_kernarg_size 120
  .amdhsa_user_sgpr_count 2
  .amdhsa_user_sgpr_kernarg_segment_ptr 1
  .amdhsa_system_sgpr_workgroup_id_x 1
.end_amdhsa_kernel
.p2align 6
.amdhsa_kernel kp_kernel
  .amdhsa_next_free_vgpr 512
  .amdhsa_next_free_sgpr 76
  .amdhsa_accum_offset 256
  .amdhsa_group_segment_fixed_size 0
  .amdhsa_kernarg_size 120
  .amdhsa_user_sgpr_count 2
  .amdhsa_user_sgpr_kernarg_segment_ptr 1
  .amdhsa_system_sgpr_workgroup_id_x 1
.end_amdhsa_kernel
.p2align 8
.type tab_fft,@object
tab_fft:
.quad 0x800000003f800000,0x800000003f800000,0x800000003f800000,0xbcc90ab03f7fec43,0x800000003f800000,0xbd48fb303f7fb10f,0x800000003f800000,0xbd96a9053f7f4e6d
.quad 0x800000003f800000,0xbdc8bd363f7ec46d,0x800000003f800000,0xbdfab2733f7e1324,0x800000003f800000,0xbe1640833f7d3aac,0x800000003f800000,0xbe2f10a23f7c3b28
.quad 0x800000003f800000,0xbe47c5c23f7b14be,0x800000003f800000,0xbe605c133f79c79d,0x800000003f800000,0xbe78cfcc3f7853f8,0x800000003f800000,0xbe888e933f76ba07
.quad 0x800000003f800000,0xbe94a0313f74fa0b,0x800000003f800000,0xbea09ae53f731447,0x800000003f800000,0xbeac7cd43f710908,0x800000003f800000,0xbeb8442a3f6ed89e
.quad 0x800000003f800000,0x800000003f800000,0xbc490e903f7ffb11,0xbd16c32c3f7fd397,0xbcc90ab03f7fec43,0xbd96a9053f7f4e6d,0xbd16c32c3f7fd397,0xbde1bc2e3f7e70b0
.quad 0xbd48fb303f7fb10f,0xbe1640833f7d3aac,0xbd7b2b743f7f84ab,0xbe3b6ecf3f7baccd,0xbd96a9053f7f4e6d,0xbe605c133f79c79d,0xbdafb6803f7f0e58,0xbe827dc03f778bc5
.quad 0xbdc8bd363f7ec46d,0xbe94a0313f74fa0b,0xbde1bc2e3f7e70b0,0xbea68f123f721352,0xbdfab2733f7e1324,0xbeb8442a3f6ed89e,0xbe09cf863f7dabcc,0xbec9b9533f6b4b0c
.quad 0xbe1640833f7d3aac,0xbedae8803f676bd8,0xbe22abb63f7cbfc9,0xbeebcbbb3f633c5a,0xbe2f10a23f7c3b28,0xbefc5d273f5ebe05,0xbe3b6ecf3f7baccd,0xbf064b823f59f26a
.quad 0x800000003f800000,0x800000003f800000,0xbd6214693f7f9c18,0xbda3308c3f7f2f9d,0xbde1bc2e3f7e70b0,0xbe22abb63f7cbfc9,0xbe28defc3f7c7eb0,0xbe72b6513f78b47b
.quad 0xbe605c133f79c79d,0xbea09ae53f731447,0xbe8b95073f764d97,0xbec6d5293f6be858,0xbea68f123f721352,0xbeebcbbb3f633c5a,0xbec1071e3f6d1c1d,0xbf07a1363f591e6a
.quad 0xbedae8803f676bd8,0xbf187fc03f4d9f02,0xbef41f073f6106f2,0xbf2866053f40d0da,0xbf064b823f59f26a,0xbf373a233f32c8c9,0xbf121eb03f5233c6,0xbf44e3f53f239da9
.quad 0xbf1d7fd13f49d112,0xbf514d3d3f13682a,0xbf2866053f40d0da,0xbf5c61c73f0242b1,0xbf32c8c93f373a23,0xbf660f883ee0924f,0xbf3ca0033f2d1469,0xbf6e46be3ebb31a0
.quad 0x800000003f800000,0x800000003f800000,0xbd8a200a3f7f6ac7,0xbdbc3ac33f7eea9d,0xbe09cf863f7dabcc,0xbe3b6ecf3f7baccd,0xbe4dee603f7ac516,0xbe8b95073f764d97
.quad 0xbe888e933f76ba07,0xbeb8442a3f6ed89e,0xbea986c43f718f57,0xbee363fa3f655e0b,0xbec9b9533f6b4b0c,0xbf064b823f59f26a,0xbee900b73f63f473,0xbf19c2003f4cae79
.quad 0xbf039c3d3f5b941a,0xbf2beb4a3f3daef9,0xbf121eb03f5233c6,0xbf3ca0033f2d1469,0xbf1ff6cb3f47de65,0xbf4bbbf83f1b02c6,0xbf2d14693f3ca003,0xbf591e6a3f07a136
.quad 0xbf3968423f3085bb,0xbf64aa593ee63375,0xbf44e3f53f239da9,0xbf6e46be3ebb31a0,0xbf4f7a1f3f15f6d9,0xbf75dec63e8e9a22,0xbf591e6a3f07a136,0xbf7b61fc3e419b37
.quad 0x800000003f800000,0x800000003f800000,0xbb490fc63f7fffb1,0xbce22a7a3f7fe705,0xbbc90f883f7ffec4,0xbd6214693f7f9c18,0xbc16cb583f7ffd39,0xbda973ba3f7f1f49
.quad 0xbc490e903f7ffb11,0xbde1bc2e3f7e70b0,0xbc7b514b3f7ff84a,0xbe0cec4a3f7d906e,0xbc96c9b63f7ff4e6,0xbe28defc3f7c7eb0,0xbcafea693f7ff0e3,0xbe44b0b93f7b3bab
.quad 0xbcc90ab03f7fec43,0xbe605c133f79c79d,0xbce22a7a3f7fe705,0xbe7bdba43f7822d1,0xbcfb49ba3f7fe129,0xbe8b95073f764d97,0xbd0a342f3f7fdaaf,0xbe9920fe3f74484b
.quad 0xbd16c32c3f7fd397,0xbea68f123f721352,0xbd2351cb3f7fcbe2,0xbeb3dca53f6faf1b,0xbd2fe0073f7fc38f,0xbec1071e3f6d1c1d,0xbd3c6dd53f7fba9e,0xbece0bea3f6a5ad9
.quad 0x800000003f800000,0x800000003f800000,0xbc7b514b3f7ff84a,0xbd2351cb3f7fcbe2,0xbcfb49ba3f7fe129,0xbda3308c3f7f2f9d,0xbd3c6dd53f7fba9e,0xbdf475c03f7e2b72
.quad 0xbd7b2b743f7f84ab,0xbe22abb63f7cbfc9,0xbd9cecf93f7f3f54,0xbe4ada4f3f7aed37,0xbdbc3ac33f7eea9d,0xbe72b6513f78b47b,0xbddb7d373f7e868b,0xbe8d17c03f76167a
.quad 0xbdfab2733f7e1324,0xbea09ae53f731447,0xbe0cec4a3f7d906e,0xbeb3dca53f6faf1b,0xbe1c76de3f7cfe73,0xbec6d5293f6be858,0xbe2bf8043f7c5d3a,0xbed97cb93f67c187
.quad 0xbe3b6ecf3f7baccd,0xbeebcbbb3f633c5a,0xbe4ada4f3f7aed37,0xbefdbabb3f5e5aa6,0xbe5a39973f7a1e84,0xbf07a1363f591e6a,0xbe698bba3f7940c0,0xbf102dd53f5389c7
.quad 0x800000003f800000,0x800000003f800000,0xbd6ea0383f7f90b1,0xbda973ba3f7f1f49,0xbdee38763f7e4323,0xbe28defc3f7c7eb0,0xbe3228d43f7c187a,0xbe7bdba43f7822d1
.quad 0xbe6c9a7f3f791298,0xbea68f123f721352,0xbe931f353f75341d,0xbece0bea3f6a5ad9,0xbeaf713a3f708066,0xbef41f073f6106f2,0xbecb2aae3f6afb8c,0xbf0c42c93f5627fe
.quad 0xbee633753f64aa59,0xbf1d7fd13f49d112,0xbf003a063f5d924d,0xbf2da8593f3c17d9,0xbf0cead03f55b993,0xbf3ca0033f2d1469,0xbf19210f3f4d26fd,0xbf4a4c873f1ce11f
.quad 0xbf24d2253f43e200,0xbf5695e53f0b9a6b,0xbf2ff3e63f39f2ac,0xbf61668a3ef2bd43,0xbf3a7ca43f2f61a5,0xbf6aab7b3ecc9b8b,0xbf4463373f24381a,0xbf7254703ea5129f
.quad 0x800000003f800000,0x800000003f800000,0xbd9064b43f7f5ce9,0xbdc27c393f7ed7d4,0xbe1008b73f7d7474,0xbe419b373f7b61fc,0xbe57278f3f7a4910,0xbe901c2c3f75a67b
.quad 0xbe8e9a223f75dec6,0xbebe1d4a3f6db293,0xbeb0eacb3f703b37,0xbeea66813f6398ac,0xbed25a093f696591,0xbf0a48ad3f577026,0xbef2bd433f61668a,0xbf1e1e223f495521
.quad 0xbf08f59b3f584853,0xbf3085bb3f396842,0xbf17de123f4e1689,0xbf4154e13f27ce61,0xbf26050a3f42de29,0xbf5064af3f14b039,0xbf33587a3f36ad7f,0xbf5d924d3f003a06
.quad 0xbf3fc7673f299415,0xbf68bf3c3ed53641,0xbf4b41fa3f1ba299,0xbf71d19f3ea80b1f,0xbf55b9933f0cead0,0xbf78b47b3e72b651,0xbf5f20db3efafef7,0xbf7d57de3e1324ca
.quad 0x800000003f800000,0x800000003f800000,0xbbc90f883f7ffec4,0xbcfb49ba3f7fe129,0xbc490e903f7ffb11,0xbd7b2b743f7f84ab,0xbc96c9b63f7ff4e6,0xbdbc3ac33f7eea9d
.quad 0xbcc90ab03f7fec43,0xbdfab2733f7e1324,0xbcfb49ba3f7fe129,0xbe1c76de3f7cfe73,0xbd16c32c3f7fd397,0xbe3b6ecf3f7baccd,0xbd2fe0073f7fc38f,0xbe5a39973f7a1e84
.quad 0xbd48fb303f7fb10f,0xbe78cfcc3f7853f8,0xbd6214693f7f9c18,0xbe8b95073f764d97,0xbd7b2b743f7f84ab,0xbe9aa0863f740bdd,0xbd8a200a3f7f6ac7,0xbea986c43f718f57
.quad 0xbd96a9053f7f4e6d,0xbeb8442a3f6ed89e,0xbda3308c3f7f2f9d,0xbec6d5293f6be858,0xbdafb6803f7f0e58,0xbed536413f68bf3c,0xbdbc3ac33f7eea9d,0xbee363fa3f655e0b
.quad 0x800000003f800000,0x800000003f800000,0xbc96c9b63f7ff4e6,0xbd2fe0073f7fc38f,0xbd16c32c3f7fd397,0xbdafb6803f7f0e58,0xbd6214693f7f9c18,0xbe0395023f7de0b1
.quad 0xbd96a9053f7f4e6d,0xbe2f10a23f7c3b28,0xbdbc3ac33f7eea9d,0xbe5a39973f7a1e84,0xbde1bc2e3f7e70b0,0xbe827dc03f778bc5,0xbe0395023f7de0b1,0xbe97a1173f748422
.quad 0xbe1640833f7d3aac,0xbeac7cd43f710908,0xbe28defc3f7c7eb0,0xbec1071e3f6d1c1d,0xbe3b6ecf3f7baccd,0xbed536413f68bf3c,0xbe4dee603f7ac516,0xbee900b73f63f473
.quad 0xbe605c133f79c79d,0xbefc5d273f5ebe05,0xbe72b6513f78b47b,0xbf07a1363f591e6a,0xbe827dc03f778bc5,0xbf10d3cd3f531849,0xbe8b95073f764d97,0xbf19c2003f4cae79
.quad 0x800000003f800000,0x800000003f800000,0xbd48fb303f7fb10f,0xbd96a9053f7f4e6d,0xbdc8bd363f7ec46d,0xbe1640833f7d3aac,0xbe1640833f7d3aac,0xbe605c133f79c79d
.quad 0xbe47c5c23f7b14be,0xbe94a0313f74fa0b,0xbe78cfcc3f7853f8,0xbeb8442a3f6ed89e,0xbe94a0313f74fa0b,0xbedae8803f676bd8,0xbeac7cd43f710908,0xbefc5d273f5ebe05
.quad 0xbec3ef153f6c835e,0xbf0e39da3f54db31,0xbedae8803f676bd8,0xbf1d7fd13f49d112,0xbef15aea3f61c598,0xbf2beb4a3f3daef9,0xbf039c3d3f5b941a,0xbf3968423f3085bb
.quad 0xbf0e39da3f54db31,0xbf45e4033f226799,0xbf187fc03f4d9f02,0xbf514d3d3f13682a,0xbf2267993f45e403,0xbf5b941a3f039c3d,0xbf2beb4a3f3daef9,0xbf64aa593ee63375
.quad 0x800000003f800000,0x800000003f800000,0xbd7b2b743f7f84ab,0xbdafb6803f7f0e58,0xbdfab2733f7e1324,0xbe2f10a23f7c3b28,0xbe3b6ecf3f7baccd,0xbe827dc03f778bc5
.quad 0xbe78cfcc3f7853f8,0xbeac7cd43f710908,0xbe9aa0863f740bdd,0xbed536413f68bf3c,0xbeb8442a3f6ed89e,0xbefc5d273f5ebe05,0xbed536413f68bf3c,0xbf10d3cd3f531849
.quad 0xbef15aea3f61c598,0xbf2267993f45e403,0xbf064b823f59f26a,0xbf32c8c93f373a23,0xbf13682a3f514d3d,0xbf41d8703f273656,0xbf1ff6cb3f47de65,0xbf4f7a1f3f15f6d9
.quad 0xbf2beb4a3f3daef9,0xbf5b941a3f039c3d,0xbf373a233f32c8c9,0xbf660f883ee0924f,0xbf41d8703f273656,0xbf6ed89e3eb8442a,0xbf4bbbf83f1b02c6,0xbf75dec63e8e9a22
.quad 0x800000003f800000,0x800000003f800000,0xbc16cb583f7ffd39,0xbd0a342f3f7fdaaf,0xbc96c9b63f7ff4e6,0xbd8a200a3f7f6ac7,0xbce22a7a3f7fe705,0xbdcefdb73f7eb069
.quad 0xbd16c32c3f7fd397,0xbe09cf863f7dabcc,0xbd3c6dd53f7fba9e,0xbe2bf8043f7c5d3a,0xbd6214693f7f9c18,0xbe4dee603f7ac516,0xbd83db0a3f7f7808,0xbe6fa8b23f78e3d6
.quad 0xbd96a9053f7f4e6d,0xbe888e933f76ba07,0xbda973ba3f7f1f49,0xbe9920fe3f74484b,0xbdbc3ac33f7eea9d,0xbea986c43f718f57,0xbdcefdb73f7eb069,0xbeb9bb1e3f6e8ff8
.quad 0xbde1bc2e3f7e70b0,0xbec9b9533f6b4b0c,0xbdf475c03f7e2b72,0xbed97cb93f67c187,0xbe0395023f7de0b1,0xbee900b73f63f473,0xbe0cec4a3f7d906e,0xbef840c83f5fe4e9
.quad 0x800000003f800000,0x800000003f800000,0xbcafea693f7ff0e3,0xbd3c6dd53f7fba9e,0xbd2fe0073f7fc38f,0xbdbc3ac33f7eea9d,0xbd83db0a3f7f7808,0xbe0cec4a3f7d906e
.quad 0xbdafb6803f7f0e58,0xbe3b6ecf3f7baccd,0xbddb7d373f7e868b,0xbe698bba3f7940c0,0xbe0395023f7de0b1,0xbe8b95073f764d97,0xbe195be03f7d1cdd,0xbea218873f72d4eb
.quad 0xbe2f10a23f7c3b28,0xbeb8442a3f6ed89e,0xbe44b0b93f7b3bab,0xbece0bea3f6a5ad9,0xbe5a39973f7a1e84,0xbee363fa3f655e0b,0xbe6fa8b23f78e3d6,0xbef840c83f5fe4e9
.quad 0xbe827dc03f778bc5,0xbf064b823f59f26a,0xbe8d17c03f76167a,0xbf102dd53f5389c7,0xbe97a1173f748422,0xbf19c2003f4cae79,0xbea218873f72d4eb,0xbf2302d33f456439
.quad 0x800000003f800000,0x800000003f800000,0xbd55880e3f7fa6e3,0xbd9cecf93f7f3f54,0xbdd53db93f7e9bc9,0xbe1c76de3f7cfe73,0xbe1f917b3f7cdf6c,0xbe698bba3f7940c0
.quad 0xbe5415013f7a7302,0xbe9aa0863f740bdd,0xbe8402703f77583a,0xbebf926f3f6d67a1,0xbe9d9e783f73913f,0xbee363fa3f655e0b,0xbeb6ccc33f6f20b0,0xbf02ef9f3f5bfb34
.quad 0xbecf7bca3f6a09a7,0xbf13682a3f514d3d,0xbee79a5d3f644fac,0xbf2302d33f456439,0xbeff17b23f5df6be,0xbf31a81d3f385216,0xbf0af1b73f570348,0xbf3f41fc3f2a2a80
.quad 0xbf15f6d93f4f7a1f,0xbf4bbbf83f1b02c6,0xbf2093933f476085,0xbf5703483f0af1b7,0xbf2ac0823f3ebc1b,0xbf6106f23ef41f07,0xbf34768f3f3592e7,0xbf69b7e43ed0eb2a
.quad 0x800000003f800000,0x800000003f800000,0xbd83db0a3f7f7808,0xbdb5f8da3f7efcc9,0xbe0395023f7de0b1,0xbe3540983f7bf531,0xbe44b0b93f7b3bab,0xbe870ada3f76ef5b
.quad 0xbe827dc03f778bc5,0xbeb263ef3f6ff573,0xbea218873f72d4eb,0xbedc53c13f671599,0xbec1071e3f6d1c1d,0xbf0242b13f5c61c7,0xbedf28a93f666771,0xbf1553b73f4fefa8
.quad 0xbefc5d273f5ebe05,0xbf2736563f41d870,0xbf0c42c93f5627fe,0xbf37c6553f3238aa,0xbf19c2003f4cae79,0xbf46e22a3f212ff9,0xbf269de33f425b89,0xbf546b3b3f0ee0db
.quad 0xbf32c8c93f373a23,0xbf6046213ef6e0cb,0xbf3e35c53f2b561b,0xbf6a5ad93ece0bea,0xbf48d8b33f1ebc12,0xbf7294f83ea395c5,0xbf52a6493f11796b,0xbf78e3d63e6fa8b2
.quad 0x3a000000,0x3a000000,0x3a000000,0x37490ab039ffec43,0x3a000000,0x35c90fc639ffffb1,0x3a000000,0x37622a7a39ffe705
.quad 0x3a000000,0x36c90e9039fffb11,0x3a000000,0x3796c32c39ffd397,0x3a000000,0x36fb514b39fff84a,0x3a000000,0x37a351cb39ffcbe2
.quad 0x3a000000,0x37e2146939ff9c18,0x3a000000,0x3823308c39ff2f9d,0x3a000000,0x37eea03839ff90b1,0x3a000000,0x382973ba39ff1f49
.quad 0x3a000000,0x380a200a39ff6ac7,0x3a000000,0x383c3ac339feea9d,0x3a000000,0x381064b439ff5ce9,0x3a000000,0x38427c3939fed7d4
.quad 0x3a000000,0x3a000000,0x3848bd3639fec46d,0x387ab27339fe1324,0x36c90e9039fffb11,0x36fb514b39fff84a,0x3861bc2e39fe70b0,0x388cec4a39fd906e
.quad 0x37c8fb3039ffb10f,0x37fb2b7439ff84ab,0x3896408339fd3aac,0x38bb6ecf39fbaccd,0x37fb2b7439ff84ab,0x381cecf939ff3f54,0x38a2abb639fcbfc9,0x38cada4f39faed37
.quad 0x38e05c1339f9c79d,0x390b950739f64d97,0x39209ae539f31447,0x3946d52939ebe858,0x38ec9a7f39f91298,0x39131f3539f5341d,0x39268f1239f21352,0x394e0bea39ea5ad9
.quad 0x39088e9339f6ba07,0x392986c439f18f57,0x3938442a39eed89e,0x396363fa39e55e0b,0x390e9a2239f5dec6,0x3930eacb39f03b37,0x393e1d4a39edb293,0x396a668139e398ac
.quad 0x3a000000,0x3a000000,0x38c7c5c239fb14be,0x38e05c1339f9c79d,0x37490ab039ffec43,0x37622a7a39ffe705,0x38e05c1339f9c79d,0x38fbdba439f822d1
.quad 0x3848bd3639fec46d,0x3861bc2e39fe70b0,0x3914a03139f4fa0b,0x39268f1239f21352,0x387ab27339fe1324,0x388cec4a39fd906e,0x39209ae539f31447,0x3933dca539efaf1b
.quad 0x395ae88039e76bd8,0x39741f0739e106f2,0x39987fc039cd9f02,0x39a8660539c0d0da,0x3966337539e4aa59,0x39803a0639dd924d,0x399d7fd139c9d112,0x39ada85939bc17d9
.quad 0x39839c3d39db941a,0x39921eb039d233c6,0x39abeb4a39bdaef9,0x39bca00339ad1469,0x3988f59b39d84853,0x3997de1239ce1689,0x39b085bb39b96842,0x39c154e139a7ce61
.quad 0x3a000000,0x3a000000,0x3914a03139f4fa0b,0x39209ae539f31447,0x3796c32c39ffd397,0x37a351cb39ffcbe2,0x39268f1239f21352,0x3933dca539efaf1b
.quad 0x3896408339fd3aac,0x38a2abb639fcbfc9,0x395ae88039e76bd8,0x396bcbbb39e33c5a,0x38bb6ecf39fbaccd,0x38cada4f39faed37,0x396bcbbb39e33c5a,0x397dbabb39de5aa6
.quad 0x399d7fd139c9d112,0x39a8660539c0d0da,0x39d14d3d3993682a,0x39dc61c7398242b1,0x39a4d22539c3e200,0x39aff3e639b9f2ac,0x39d695e5398b9a6b,0x39e1668a3972bd43
.quad 0x39b9684239b085bb,0x39c4e3f539a39da9,0x39e4aa5939663375,0x39ee46be393b31a0,0x39bfc76739a99415,0x39cb41fa399ba299,0x39e8bf3c39553641,0x39f1d19f39280b1f
.quad 0x3a000000,0x3a000000,0x37c8fb3039ffb10f,0x3816a90539ff4e6d,0x36490f8839fffec4,0x3696cb5839fffd39,0x37e2146939ff9c18,0x382973ba39ff1f49
.quad 0x37490ab039ffec43,0x3796c32c39ffd397,0x3816a90539ff4e6d,0x3861bc2e39fe70b0,0x377b49ba39ffe129,0x37bc6dd539ffba9e,0x3823308c39ff2f9d,0x387475c039fe2b72
.quad 0x3861bc2e39fe70b0,0x38a8defc39fc7eb0,0x38a2abb639fcbfc9,0x38f2b65139f8b47b,0x386e387639fe4323,0x38b228d439fc187a,0x38a8defc39fc7eb0,0x38fbdba439f822d1
.quad 0x3889cf8639fdabcc,0x38cdee6039fac516,0x38bb6ecf39fbaccd,0x390b950739f64d97,0x389008b739fd7474,0x38d7278f39fa4910,0x38c19b3739fb61fc,0x39101c2c39f5a67b
.quad 0x3a000000,0x3a000000,0x3896408339fd3aac,0x38af10a239fc3b28,0x3716c9b639fff4e6,0x372fea6939fff0e3,0x38a8defc39fc7eb0,0x38c4b0b939fb3bab
.quad 0x3816a90539ff4e6d,0x382fb68039ff0e58,0x38e05c1339f9c79d,0x39027dc039f78bc5,0x383c3ac339feea9d,0x385b7d3739fe868b,0x38f2b65139f8b47b,0x390d17c039f6167a
.quad 0x39268f1239f21352,0x3941071e39ed1c1d,0x396bcbbb39e33c5a,0x3987a13639d91e6a,0x392f713a39f08066,0x394b2aae39eafb8c,0x39741f0739e106f2,0x398c42c939d627fe
.quad 0x3949b95339eb4b0c,0x396900b739e3f473,0x39864b8239d9f26a,0x3999c20039ccae79,0x39525a0939e96591,0x3972bd4339e1668a,0x398a48ad39d77026,0x399e1e2239c95521
.quad 0x3a000000,0x3a000000,0x38f8cfcc39f853f8,0x39088e9339f6ba07,0x377b49ba39ffe129,0x378a342f39ffdaaf,0x390b950739f64d97,0x391920fe39f4484b
.quad 0x387ab27339fe1324,0x3889cf8639fdabcc,0x3938442a39eed89e,0x3949b95339eb4b0c,0x389c76de39fcfe73,0x38abf80439fc5d3a,0x3946d52939ebe858,0x39597cb939e7c187
.quad 0x39864b8239d9f26a,0x39921eb039d233c6,0x39b73a2339b2c8c9,0x39c4e3f539a39da9,0x398cead039d5b993,0x3999210f39cd26fd,0x39bca00339ad1469,0x39ca4c87399ce11f
.quad 0x399ff6cb39c7de65,0x39ad146939bca003,0x39cbbbf8399b02c6,0x39d91e6a3987a136,0x39a6050a39c2de29,0x39b3587a39b6ad7f,0x39d064af3994b039,0x39dd924d39803a06
.quad 0x3a000000,0x3a000000,0x392c7cd439f10908,0x3938442a39eed89e,0x37afe00739ffc38f,0x37bc6dd539ffba9e,0x3941071e39ed1c1d,0x394e0bea39ea5ad9
.quad 0x38af10a239fc3b28,0x38bb6ecf39fbaccd,0x397c5d2739debe05,0x39864b8239d9f26a,0x38da399739fa1e84,0x38e98bba39f940c0,0x3987a13639d91e6a,0x39902dd539d389c7
.quad 0x39b2c8c939b73a23,0x39bca00339ad1469,0x39e60f883960924f,0x39ee46be393b31a0,0x39ba7ca439af61a5,0x39c4633739a4381a,0x39eaab7b394c9b8b,0x39f254703925129f
.quad 0x39cf7a1f3995f6d9,0x39d91e6a3987a136,0x39f5dec6390e9a22,0x39fb61fc38c19b37,0x39d5b993398cead0,0x39df20db397afef7,0x39f8b47b38f2b651,0x39fd57de389324ca
.quad 0x3a000000,0x36490f8839fffec4,0x3a000000,0x377b49ba39ffe129,0x3a000000,0x3696cb5839fffd39,0x3a000000,0x378a342f39ffdaaf
.quad 0x3a000000,0x3716c9b639fff4e6,0x3a000000,0x37afe00739ffc38f,0x3a000000,0x372fea6939fff0e3,0x3a000000,0x37bc6dd539ffba9e
.quad 0x3a000000,0x37c8fb3039ffb10f,0x3a000000,0x3816a90539ff4e6d,0x3a000000,0x37d5880e39ffa6e3,0x3a000000,0x381cecf939ff3f54
.quad 0x3a000000,0x37fb2b7439ff84ab,0x3a000000,0x382fb68039ff0e58,0x3a000000,0x3803db0a39ff7808,0x3a000000,0x3835f8da39fefcc9
.quad 0x37490ab039ffec43,0x377b49ba39ffe129,0x387ab27339fe1324,0x389c76de39fcfe73,0x3796c32c39ffd397,0x37bc6dd539ffba9e,0x3889cf8639fdabcc,0x38abf80439fc5d3a
.quad 0x3816a90539ff4e6d,0x383c3ac339feea9d,0x38af10a239fc3b28,0x38da399739fa1e84,0x382fb68039ff0e58,0x385b7d3739fe868b,0x38bb6ecf39fbaccd,0x38e98bba39f940c0
.quad 0x38c7c5c239fb14be,0x38f8cfcc39f853f8,0x3914a03139f4fa0b,0x3938442a39eed89e,0x38d4150139fa7302,0x3904027039f7583a,0x391aa08639f40bdd,0x393f926f39ed67a1
.quad 0x38f8cfcc39f853f8,0x391aa08639f40bdd,0x392c7cd439f10908,0x3955364139e8bf3c,0x39027dc039f78bc5,0x3922188739f2d4eb,0x393263ef39eff573,0x395c53c139e71599
.quad 0x37c8fb3039ffb10f,0x37e2146939ff9c18,0x38f8cfcc39f853f8,0x390b950739f64d97,0x3816a90539ff4e6d,0x382973ba39ff1f49,0x39088e9339f6ba07,0x391920fe39f4484b
.quad 0x3896408339fd3aac,0x38a8defc39fc7eb0,0x392c7cd439f10908,0x3941071e39ed1c1d,0x38af10a239fc3b28,0x38c4b0b939fb3bab,0x3938442a39eed89e,0x394e0bea39ea5ad9
.quad 0x3943ef1539ec835e,0x395ae88039e76bd8,0x398e39da39d4db31,0x399d7fd139c9d112,0x394f7bca39ea09a7,0x39679a5d39e44fac,0x3993682a39d14d3d,0x39a302d339c56439
.quad 0x39715aea39e1c598,0x39864b8239d9f26a,0x39a2679939c5e403,0x39b2c8c939b73a23,0x397c5d2739debe05,0x398c42c939d627fe,0x39a7365639c1d870,0x39b7c65539b238aa
.quad 0x3816a90539ff4e6d,0x3823308c39ff2f9d,0x3938442a39eed89e,0x3946d52939ebe858,0x3861bc2e39fe70b0,0x387475c039fe2b72,0x3949b95339eb4b0c,0x39597cb939e7c187
.quad 0x38e05c1339f9c79d,0x38f2b65139f8b47b,0x397c5d2739debe05,0x3987a13639d91e6a,0x39027dc039f78bc5,0x390d17c039f6167a,0x39864b8239d9f26a,0x39902dd539d389c7
.quad 0x398e39da39d4db31,0x39987fc039cd9f02,0x39c5e40339a26799,0x39d14d3d3993682a,0x3995f6d939cf7a1f,0x39a0939339c76085,0x39cbbbf8399b02c6,0x39d70348398af1b7
.quad 0x39abeb4a39bdaef9,0x39b73a2339b2c8c9,0x39db941a39839c3d,0x39e60f883960924f,0x39b2c8c939b73a23,0x39be35c539ab561b,0x39e046213976e0cb,0x39ea5ad9394e0bea
.quad 0x36c90e9039fffb11,0x3716c9b639fff4e6,0x37fb2b7439ff84ab,0x383c3ac339feea9d,0x3716c9b639fff4e6,0x37622a7a39ffe705,0x380a200a39ff6ac7,0x384efdb739feb069
.quad 0x3796c32c39ffd397,0x37e2146939ff9c18,0x382fb68039ff0e58,0x3883950239fde0b1,0x37afe00739ffc38f,0x3803db0a39ff7808,0x383c3ac339feea9d,0x388cec4a39fd906e
.quad 0x3848bd3639fec46d,0x3896408339fd3aac,0x3896408339fd3aac,0x38e05c1339f9c79d,0x38553db939fe9bc9,0x389f917b39fcdf6c,0x389c76de39fcfe73,0x38e98bba39f940c0
.quad 0x387ab27339fe1324,0x38bb6ecf39fbaccd,0x38af10a239fc3b28,0x39027dc039f78bc5,0x3883950239fde0b1,0x38c4b0b939fb3bab,0x38b5409839fbf531,0x39070ada39f6ef5b
.quad 0x3796c32c39ffd397,0x37afe00739ffc38f,0x38bb6ecf39fbaccd,0x38da399739fa1e84,0x37e2146939ff9c18,0x3803db0a39ff7808,0x38cdee6039fac516,0x38efa8b239f8e3d6
.quad 0x3861bc2e39fe70b0,0x3883950239fde0b1,0x39027dc039f78bc5,0x3917a11739f48422,0x3883950239fde0b1,0x38995be039fd1cdd,0x390b950739f64d97,0x3922188739f2d4eb
.quad 0x3914a03139f4fa0b,0x392c7cd439f10908,0x395ae88039e76bd8,0x397c5d2739debe05,0x391d9e7839f3913f,0x3936ccc339ef20b0,0x396363fa39e55e0b,0x3982ef9f39dbfb34
.quad 0x3938442a39eed89e,0x3955364139e8bf3c,0x397c5d2739debe05,0x3990d3cd39d31849,0x3941071e39ed1c1d,0x395f28a939e66771,0x398242b139dc61c7,0x399553b739cfefa8
.quad 0x37fb2b7439ff84ab,0x380a200a39ff6ac7,0x391aa08639f40bdd,0x392986c439f18f57,0x383c3ac339feea9d,0x384efdb739feb069,0x392986c439f18f57,0x3939bb1e39ee8ff8
.quad 0x38bb6ecf39fbaccd,0x38cdee6039fac516,0x3955364139e8bf3c,0x396900b739e3f473,0x38da399739fa1e84,0x38efa8b239f8e3d6,0x396363fa39e55e0b,0x397840c839dfe4e9
.quad 0x39715aea39e1c598,0x39839c3d39db941a,0x39abeb4a39bdaef9,0x39b9684239b085bb,0x397f17b239ddf6be,0x398af1b739d70348,0x39b1a81d39b85216,0x39bf41fc39aa2a80
.quad 0x3993682a39d14d3d,0x399ff6cb39c7de65,0x39c1d87039a73656,0x39cf7a1f3995f6d9,0x3999c20039ccae79,0x39a69de339c25b89,0x39c6e22a39a12ff9,0x39d46b3b398ee0db
.quad 0x382fb68039ff0e58,0x383c3ac339feea9d,0x3955364139e8bf3c,0x396363fa39e55e0b,0x3883950239fde0b1,0x388cec4a39fd906e,0x396900b739e3f473,0x397840c839dfe4e9
.quad 0x39027dc039f78bc5,0x390b950739f64d97,0x3990d3cd39d31849,0x3999c20039ccae79,0x3917a11739f48422,0x3922188739f2d4eb,0x3999c20039ccae79,0x39a302d339c56439
.quad 0x39a2679939c5e403,0x39abeb4a39bdaef9,0x39db941a39839c3d,0x39e4aa5939663375,0x39aac08239bebc1b,0x39b4768f39b592e7,0x39e106f239741f07,0x39e9b7e43950eb2a
.quad 0x39c1d87039a73656,0x39cbbbf8399b02c6,0x39eed89e3938442a,0x39f5dec6390e9a22,0x39c8d8b3399ebc12,0x39d2a6493991796b,0x39f294f8392395c5,0x39f8e3d638efa8b2
.quad 0x800000003f800000,0xbec3ef153f6c835e,0x800000003f800000,0xbecf7bca3f6a09a7,0x800000003f800000,0xbedae8803f676bd8,0x800000003f800000,0xbee633753f64aa59
.quad 0x800000003f800000,0xbef15aea3f61c598,0x800000003f800000,0xbefc5d273f5ebe05,0x800000003f800000,0xbf039c3d3f5b941a,0x800000003f800000,0xbf08f59b3f584853
.quad 0x800000003f800000,0xbf0e39da3f54db31,0x800000003f800000,0xbf13682a3f514d3d,0x800000003f800000,0xbf187fc03f4d9f02,0x800000003f800000,0xbf1d7fd13f49d112
.quad 0x800000003f800000,0xbf2267993f45e403,0x800000003f800000,0xbf2736563f41d870,0x800000003f800000,0xbf2beb4a3f3daef9,0x800000003f800000,0xbf3085bb3f396842
.quad 0xbe47c5c23f7b14be,0xbf0e39da3f54db31,0xbe5415013f7a7302,0xbf15f6d93f4f7a1f,0xbe605c133f79c79d,0xbf1d7fd13f49d112,0xbe6c9a7f3f791298,0xbf24d2253f43e200
.quad 0xbe78cfcc3f7853f8,0xbf2beb4a3f3daef9,0xbe827dc03f778bc5,0xbf32c8c93f373a23,0xbe888e933f76ba07,0xbf3968423f3085bb,0xbe8e9a223f75dec6,0xbf3fc7673f299415
.quad 0xbe94a0313f74fa0b,0xbf45e4033f226799,0xbe9aa0863f740bdd,0xbf4bbbf83f1b02c6,0xbea09ae53f731447,0xbf514d3d3f13682a,0xbea68f123f721352,0xbf5695e53f0b9a6b
.quad 0xbeac7cd43f710908,0xbf5b941a3f039c3d,0xbeb263ef3f6ff573,0xbf6046213ef6e0cb,0xbeb8442a3f6ed89e,0xbf64aa593ee63375,0xbebe1d4a3f6db293,0xbf68bf3c3ed53641
.quad 0xbf45e4033f226799,0xbf74fa0b3e94a031,0xbf4e8d903f173c07,0xbf7a1e843e5a3997,0xbf5695e53f0b9a6b,0xbf7dabcc3e09cf86,0xbf5df6be3eff17b2,0xbf7f9c183d621469
.quad 0xbf64aa593ee63375,0xbf7fec43bcc90ab0,0xbf6aab7b3ecc9b8b,0xbf7e9bc9bdd53db9,0xbf6ff5733eb263ef,0xbf7baccdbe3b6ecf,0xbf7484223e97a117,0xbf772417be8586ce
.quad 0xbf7853f83e78cfcc,0xbf710908beac7cd4,0xbf7b61fc3e419b37,0xbf696591bed25a09,0xbf7dabcc3e09cf86,0xbf604621bef6e0cb,0xbf7f2f9d3da3308c,0xbf55b993bf0cead0
.quad 0xbf7fec433cc90ab0,0xbf49d112bf1d7fd1,0xbf7fe129bcfb49ba,0xbf3ca003bf2d1469,0xbf7f0e58bdafb680,0xbf2e3bdebf3b8f3b,0xbf7d7474be1008b7,0xbf1ebc12bf48d8b3
.quad 0xbf61c5983ef15aea,0xbf7ec46d3dc8bd36,0xbf6965913ed25a09,0xbf7ffec43bc90f88,0xbf6ff5733eb263ef,0xbf7f0e58bdafb680,0xbf756d973e919ddd,0xbf7bf531be354098
.quad 0xbf79c79d3e605c13,0xbf76ba07be888e93,0xbf7cfe733e1c76de,0xbf6f6830beb554ec,0xbf7f0e583dafb680,0xbf660f88bee0924f,0xbf7ff4e63c96c9b6,0xbf5ac450bf04f484
.quad 0xbf7fb10fbd48fb30,0xbf4d9f02bf187fc0,0xbf7e4323bdee3876,0xbf3ebc1bbf2ac082,0xbf7baccdbe3b6ecf,0xbf2e3bdebf3b8f3b,0xbf77f110be7ee6e1,0xbf1c420cbf4ac77f
.quad 0xbf731447bea09ae5,0xbf08f59bbf584853,0xbf6d1c1dbec1071e,0xbee900b7bf63f473,0xbf660f88bee0924f,0xbebe1d4abf6db293,0xbf5df6bebeff17b2,0xbe919dddbf756d97
.quad 0xbd48fb303f7fb10f,0xbedae8803f676bd8,0xbd55880e3f7fa6e3,0xbee79a5d3f644fac,0xbd6214693f7f9c18,0xbef41f073f6106f2,0xbd6ea0383f7f90b1,0xbf003a063f5d924d
.quad 0xbd7b2b743f7f84ab,0xbf064b823f59f26a,0xbd83db0a3f7f7808,0xbf0c42c93f5627fe,0xbd8a200a3f7f6ac7,0xbf121eb03f5233c6,0xbd9064b43f7f5ce9,0xbf17de123f4e1689
.quad 0xbd96a9053f7f4e6d,0xbf1d7fd13f49d112,0xbd9cecf93f7f3f54,0xbf2302d33f456439,0xbda3308c3f7f2f9d,0xbf2866053f40d0da,0xbda973ba3f7f1f49,0xbf2da8593f3c17d9
.quad 0xbdafb6803f7f0e58,0xbf32c8c93f373a23,0xbdb5f8da3f7efcc9,0xbf37c6553f3238aa,0xbdbc3ac33f7eea9d,0xbf3ca0033f2d1469,0xbdc27c393f7ed7d4,0xbf4154e13f27ce61
.quad 0xbe78cfcc3f7853f8,0xbf187fc03f4d9f02,0xbe8402703f77583a,0xbf2093933f476085,0xbe8b95073f764d97,0xbf2866053f40d0da,0xbe931f353f75341d,0xbf2ff3e63f39f2ac
.quad 0xbe9aa0863f740bdd,0xbf373a233f32c8c9,0xbea218873f72d4eb,0xbf3e35c53f2b561b,0xbea986c43f718f57,0xbf44e3f53f239da9,0xbeb0eacb3f703b37,0xbf4b41fa3f1ba299
.quad 0xbeb8442a3f6ed89e,0xbf514d3d3f13682a,0xbebf926f3f6d67a1,0xbf5703483f0af1b7,0xbec6d5293f6be858,0xbf5c61c73f0242b1,0xbece0bea3f6a5ad9,0xbf61668a3ef2bd43
.quad 0xbed536413f68bf3c,0xbf660f883ee0924f,0xbedc53c13f671599,0xbf6a5ad93ece0bea,0xbee363fa3f655e0b,0xbf6e46be3ebb31a0,0xbeea66813f6398ac,0xbf71d19f3ea80b1f
.quad 0xbf4d9f023f187fc0,0xbf7853f83e78cfcc,0xbf5627fe3f0c42c9,0xbf7c9f8a3e25c58c,0xbf5df6be3eff17b2,0xbf7f2f9d3da3308c,0xbf6504793ee4cbfe,0xbf7fffb1bb490fc6
.quad 0xbf6b4b0c3ec9b953,0xbf7f0e58bdafb680,0xbf70c5013eadf73c,0xbf7c5d3abe2bf804,0xbf756d973e919ddd,0xbf77f110be7ee6e1,0xbf7940c03e698bba,0xbf71d19fbea80b1f
.quad 0xbf7c3b283e2f10a2,0xbf6a09a7becf7bca,0xbf7e5a383de7fa9a,0xbf60a6cfbef58035,0xbf7f9c183d621469,0xbf55b993bf0cead0,0xbf7fffb1bb490fc6,0xbf495521bf1e1e22
.quad 0xbf7f84abbd7b2b74,0xbf3b8f3bbf2e3bde,0xbf7e2b72bdf475c0,0xbf2c800fbf3d27b8,0xbf7bf531be354098,0xbf1c420cbf4ac77f,0xbf78e3d6be6fa8b2,0xbf0af1b7bf570348
.quad 0xbf676bd83edae880,0xbf7fb10f3d48fb30,0xbf6e8ff83eb9bb1e,0xbf7fba9ebd3c6dd5,0xbf7484223e97a117,0xbf7d7474be1008b7,0xbf7940c03e698bba,0xbf78e3d6be6fa8b2
.quad 0xbf7cbfc93e22abb6,0xbf721352bea68f12,0xbf7efcc93db5f8da,0xbf6912aebed3c867,0xbf7ff4e63c96c9b6,0xbf5df6bebeff17b2,0xbf7fa6e3bd55880e,0xbf50d937bf140c5f
.quad 0xbf7e1324bdfab273,0xbf41d870bf273656,0xbf7b3babbe44b0b9,0xbf311722bf38dd65,0xbf772417be8586ce,0xbf1ebc12bf48d8b3,0xbf71d19fbea80b1f,0xbf0af1b7bf570348
.quad 0xbf6b4b0cbec9b953,0xbeebcbbbbf633c5a,0xbf6398acbeea6681,0xbebf926fbf6d67a1,0xbf5ac450bf04f484,0xbe919dddbf756d97,0xbf50d937bf140c5f,0xbe44b0b9bf7b3bab
.quad 0xbdc8bd363f7ec46d,0xbef15aea3f61c598,0xbdd53db93f7e9bc9,0xbeff17b23f5df6be,0xbde1bc2e3f7e70b0,0xbf064b823f59f26a,0xbdee38763f7e4323,0xbf0cead03f55b993
.quad 0xbdfab2733f7e1324,0xbf13682a3f514d3d,0xbe0395023f7de0b1,0xbf19c2003f4cae79,0xbe09cf863f7dabcc,0xbf1ff6cb3f47de65,0xbe1008b73f7d7474,0xbf26050a3f42de29
.quad 0xbe1640833f7d3aac,0xbf2beb4a3f3daef9,0xbe1c76de3f7cfe73,0xbf31a81d3f385216,0xbe22abb63f7cbfc9,0xbf373a233f32c8c9,0xbe28defc3f7c7eb0,0xbf3ca0033f2d1469
.quad 0xbe2f10a23f7c3b28,0xbf41d8703f273656,0xbe3540983f7bf531,0xbf46e22a3f212ff9,0xbe3b6ecf3f7baccd,0xbf4bbbf83f1b02c6,0xbe419b373f7b61fc,0xbf5064af3f14b039
.quad 0xbe94a0313f74fa0b,0xbf2267993f45e403,0xbe9d9e783f73913f,0xbf2ac0823f3ebc1b,0xbea68f123f721352,0xbf32c8c93f373a23,0xbeaf713a3f708066,0xbf3a7ca43f2f61a5
.quad 0xbeb8442a3f6ed89e,0xbf41d8703f273656,0xbec1071e3f6d1c1d,0xbf48d8b33f1ebc12,0xbec9b9533f6b4b0c,0xbf4f7a1f3f15f6d9,0xbed25a093f696591,0xbf55b9933f0cead0
.quad 0xbedae8803f676bd8,0xbf5b941a3f039c3d,0xbee363fa3f655e0b,0xbf6106f23ef41f07,0xbeebcbbb3f633c5a,0xbf660f883ee0924f,0xbef41f073f6106f2,0xbf6aab7b3ecc9b8b
.quad 0xbefc5d273f5ebe05,0xbf6ed89e3eb8442a,0xbf0242b13f5c61c7,0xbf7294f83ea395c5,0xbf064b823f59f26a,0xbf75dec63e8e9a22,0xbf0a48ad3f577026,0xbf78b47b3e72b651
.quad 0xbf3504f33f3504f3,0xbf6c835e3ec3ef15,0xbf3daef93f2beb4a,0xbf7314473ea09ae5,0xbf45e4033f226799,0xbf7853f83e78cfcc,0xbf4d9f023f187fc0,0xbf7c3b283e2f10a2
.quad 0xbf54db313f0e39da,0xbf7ec46d3dc8bd36,0xbf5b941a3f039c3d,0xbf7fec433cc90ab0,0xbf61c5983ef15aea,0xbf7fb10fbd48fb30,0xbf676bd83edae880,0xbf7e1324bdfab273
.quad 0xbf6c835e3ec3ef15,0xbf7b14bebe47c5c2,0xbf7109083eac7cd4,0xbf76ba07be888e93,0xbf74fa0b3e94a031,0xbf710908beac7cd4,0xbf7853f83e78cfcc,0xbf6a09a7becf7bca
.quad 0xbf7b14be3e47c5c2,0xbf61c598bef15aea,0xbf7d3aac3e164083,0xbf584853bf08f59b,0xbf7ec46d3dc8bd36,0xbf4d9f02bf187fc0,0xbf7fb10f3d48fb30,0xbf41d870bf273656
.quad 0xbf54db313f0e39da,0xbf7b14be3e47c5c2,0xbf5d2d533f00e7e4,0xbf7e70b03de1bc2e,0xbf64aa593ee63375,0xbf7fec433cc90ab0,0xbf6b4b0c3ec9b953,0xbf7f84abbd7b2b74
.quad 0xbf7109083eac7cd4,0xbf7d3aacbe164083,0xbf75dec63e8e9a22,0xbf791298be6c9a7f,0xbf79c79d3e605c13,0xbf731447bea09ae5,0xbf7cbfc93e22abb6,0xbf6b4b0cbec9b953
.quad 0xbf7ec46d3dc8bd36,0xbf61c598bef15aea,0xbf7fd3973d16c32c,0xbf5695e5bf0b9a6b,0xbf7fec43bcc90ab0,0xbf49d112bf1d7fd1,0xbf7f0e58bdafb680,0xbf3b8f3bbf2e3bde
.quad 0xbf7d3aacbe164083,0xbf2beb4abf3daef9,0xbf7a7302be541501,0xbf1b02c6bf4bbbf8,0xbf76ba07be888e93,0xbf08f59bbf584853,0xbf721352bea68f12,0xbeebcbbbbf633c5a
.quad 0xbe1640833f7d3aac,0xbf039c3d3f5b941a,0xbe1f917b3f7cdf6c,0xbf0af1b73f570348,0xbe28defc3f7c7eb0,0xbf121eb03f5233c6,0xbe3228d43f7c187a,0xbf19210f3f4d26fd
.quad 0xbe3b6ecf3f7baccd,0xbf1ff6cb3f47de65,0xbe44b0b93f7b3bab,0xbf269de33f425b89,0xbe4dee603f7ac516,0xbf2d14693f3ca003,0xbe57278f3f7a4910,0xbf33587a3f36ad7f
.quad 0xbe605c133f79c79d,0xbf3968423f3085bb,0xbe698bba3f7940c0,0xbf3f41fc3f2a2a80,0xbe72b6513f78b47b,0xbf44e3f53f239da9,0xbe7bdba43f7822d1,0xbf4a4c873f1ce11f
.quad 0xbe827dc03f778bc5,0xbf4f7a1f3f15f6d9,0xbe870ada3f76ef5b,0xbf546b3b3f0ee0db,0xbe8b95073f764d97,0xbf591e6a3f07a136,0xbe901c2c3f75a67b,0xbf5d924d3f003a06
.quad 0xbeac7cd43f710908,0xbf2beb4a3f3daef9,0xbeb6ccc33f6f20b0,0xbf34768f3f3592e7,0xbec1071e3f6d1c1d,0xbf3ca0033f2d1469,0xbecb2aae3f6afb8c,0xbf4463373f24381a
.quad 0xbed536413f68bf3c,0xbf4bbbf83f1b02c6,0xbedf28a93f666771,0xbf52a6493f11796b,0xbee900b73f63f473,0xbf591e6a3f07a136,0xbef2bd433f61668a,0xbf5f20db3efafef7
.quad 0xbefc5d273f5ebe05,0xbf64aa593ee63375,0xbf02ef9f3f5bfb34,0xbf69b7e43ed0eb2a,0xbf07a1363f591e6a,0xbf6e46be3ebb31a0,0xbf0c42c93f5627fe,0xbf7254703ea5129f
.quad 0xbf10d3cd3f531849,0xbf75dec63e8e9a22,0xbf1553b73f4fefa8,0xbf78e3d63e6fa8b2,0xbf19c2003f4cae79,0xbf7b61fc3e419b37,0xbf1e1e223f495521,0xbf7d57de3e1324ca
.quad 0xbf3daef93f2beb4a,0xbf7109083eac7cd4,0xbf4663543f21cbfb,0xbf76ef5b3e870ada,0xbf4e8d903f173c07,0xbf7b61fc3e419b37,0xbf5627fe3f0c42c9,0xbf7e5a383de7fa9a
.quad 0xbf5d2d533f00e7e4,0xbf7fd3973d16c32c,0xbf6398ac3eea6681,0xbf7fcbe2bd2351cb,0xbf6965913ed25a09,0xbf7e4323bdee3876,0xbf6e8ff83eb9bb1e,0xbf7b3babbe44b0b9
.quad 0xbf7314473ea09ae5,0xbf76ba07be888e93,0xbf76ef5b3e870ada,0xbf70c501beadf73c,0xbf7a1e843e5a3997,0xbf696591bed25a09,0xbf7c9f8a3e25c58c,0xbf60a6cfbef58035
.quad 0xbf7e70b03de1bc2e,0xbf5695e5bf0b9a6b,0xbf7f90b13d6ea038,0xbf4b41fabf1ba299,0xbf7ffec43bc90f88,0xbf3ebc1bbf2ac082,0xbf7fba9ebd3c6dd5,0xbf311722bf38dd65
.quad 0xbf5b941a3f039c3d,0xbf7d3aac3e164083,0xbf6398ac3eea6681,0xbf7f90b13d6ea038,0xbf6aab7b3ecc9b8b,0xbf7fe129bcfb49ba,0xbf70c5013eadf73c,0xbf7e2b72bdf475c0
.quad 0xbf75dec63e8e9a22,0xbf7a7302be541501,0xbf79f35e3e5d4b1a,0xbf74bf62be9620d2,0xbf7cfe733e1c76de,0xbf6d1c1dbec1071e,0xbf7efcc93db5f8da,0xbf6398acbeea6681
.quad 0xbf7fec433cc90ab0,0xbf584853bf08f59b,0xbf7fcbe2bd2351cb,0xbf4b41fabf1ba299,0xbf7e9bc9bdd53db9,0xbf3ca003bf2d1469,0xbf7c5d3abe2bf804,0xbf2c800fbf3d27b8
.quad 0xbf791298be6c9a7f,0xbf1b02c6bf4bbbf8,0xbf74bf62be9620d2,0xbf084b92bf58b3a1,0xbf6f6830beb554ec,0xbee900b7bf63f473,0xbf6912aebed3c867,0xbebf926fbf6d67a1
.quad 0x3a000000,0x3a000000,0x3943ef1539ec835e,0x394f7bca39ea09a7,0x37c8fb3039ffb10f,0x37d5880e39ffa6e3,0x395ae88039e76bd8,0x39679a5d39e44fac
.quad 0x38c7c5c239fb14be,0x38d4150139fa7302,0x398e39da39d4db31,0x3995f6d939cf7a1f,0x38f8cfcc39f853f8,0x3904027039f7583a,0x39987fc039cd9f02,0x39a0939339c76085
.quad 0x39c5e40339a26799,0x39ce8d9039973c07,0x39f4fa0b3914a031,0x39fa1e8438da3997,0x39cd9f0239987fc0,0x39d627fe398c42c9,0x39f853f838f8cfcc,0x39fc9f8a38a5c58c
.quad 0x39e1c59839715aea,0x39e9659139525a09,0x39fec46d3848bd36,0x39fffec436490f88,0x39e76bd8395ae880,0x39ee8ff83939bb1e,0x39ffb10f37c8fb30,0x39ffba9eb7bc6dd5
.quad 0x3a000000,0x3a000000,0x39715aea39e1c598,0x397c5d2739debe05,0x37fb2b7439ff84ab,0x3803db0a39ff7808,0x39864b8239d9f26a,0x398c42c939d627fe
.quad 0x38f8cfcc39f853f8,0x39027dc039f78bc5,0x39abeb4a39bdaef9,0x39b2c8c939b73a23,0x391aa08639f40bdd,0x3922188739f2d4eb,0x39b73a2339b2c8c9,0x39be35c539ab561b
.quad 0x39e4aa5939663375,0x39eaab7b394c9b8b,0x39ffec43b7490ab0,0x39fe9bc9b8553db9,0x39eb4b0c3949b953,0x39f0c501392df73c,0x39ff0e58b82fb680,0x39fc5d3ab8abf804
.quad 0x39f9c79d38e05c13,0x39fcfe73389c76de,0x39f6ba07b9088e93,0x39ef6830b93554ec,0x39fcbfc938a2abb6,0x39fefcc93835f8da,0x39f21352b9268f12,0x39e912aeb953c867
.quad 0x3a000000,0x3a000000,0x398e39da39d4db31,0x3993682a39d14d3d,0x3816a90539ff4e6d,0x381cecf939ff3f54,0x399d7fd139c9d112,0x39a302d339c56439
.quad 0x3914a03139f4fa0b,0x391aa08639f40bdd,0x39c5e40339a26799,0x39cbbbf8399b02c6,0x3938442a39eed89e,0x393f926f39ed67a1,0x39d14d3d3993682a,0x39d70348398af1b7
.quad 0x39f853f838f8cfcc,0x39fb61fc38c19b37,0x39f10908b92c7cd4,0x39e96591b9525a09,0x39fc3b2838af10a2,0x39fe5a383867fa9a,0x39ea09a7b94f7bca,0x39e0a6cfb9758035
.quad 0x39ffb10fb7c8fb30,0x39fe4323b86e3876,0x39cd9f02b9987fc0,0x39bebc1bb9aac082,0x39fe1324b87ab273,0x39fb3babb8c4b0b9,0x39c1d870b9a73656,0x39b11722b9b8dd65
.quad 0x3a000000,0x3a000000,0x39a2679939c5e403,0x39a7365639c1d870,0x382fb68039ff0e58,0x3835f8da39fefcc9,0x39b2c8c939b73a23,0x39b7c65539b238aa
.quad 0x392c7cd439f10908,0x393263ef39eff573,0x39db941a39839c3d,0x39e046213976e0cb,0x3955364139e8bf3c,0x395c53c139e71599,0x39e60f883960924f,0x39ea5ad9394e0bea
.quad 0x39ffec4337490ab0,0x39ffe129b77b49ba,0x39c9d112b99d7fd1,0x39bca003b9ad1469,0x39ff84abb7fb2b74,0x39fe2b72b87475c0,0x39bb8f3bb9ae3bde,0x39ac800fb9bd27b8
.quad 0x39f31447b9209ae5,0x39ed1c1db941071e,0x3988f59bb9d84853,0x396900b7b9e3f473,0x39eb4b0cb949b953,0x39e398acb96a6681,0x396bcbbbb9e33c5a,0x393f926fb9ed67a1
.quad 0x3a000000,0x3a000000,0x395ae88039e76bd8,0x3966337539e4aa59,0x37e2146939ff9c18,0x37eea03839ff90b1,0x39741f0739e106f2,0x39803a0639dd924d
.quad 0x38e05c1339f9c79d,0x38ec9a7f39f91298,0x399d7fd139c9d112,0x39a4d22539c3e200,0x390b950739f64d97,0x39131f3539f5341d,0x39a8660539c0d0da,0x39aff3e639b9f2ac
.quad 0x39d695e5398b9a6b,0x39ddf6be397f17b2,0x39fdabcc3889cf86,0x39ff9c1837e21469,0x39ddf6be397f17b2,0x39e504793964cbfe,0x39ff2f9d3823308c,0x39ffffb1b5c90fc6
.quad 0x39eff573393263ef,0x39f56d9739119ddd,0x39ff0e58b82fb680,0x39fbf531b8b54098,0x39f484223917a117,0x39f940c038e98bba,0x39fd7474b89008b7,0x39f8e3d6b8efa8b2
.quad 0x3a000000,0x3a000000,0x39839c3d39db941a,0x3988f59b39d84853,0x380a200a39ff6ac7,0x381064b439ff5ce9,0x39921eb039d233c6,0x3997de1239ce1689
.quad 0x39088e9339f6ba07,0x390e9a2239f5dec6,0x39b9684239b085bb,0x39bfc76739a99415,0x392986c439f18f57,0x3930eacb39f03b37,0x39c4e3f539a39da9,0x39cb41fa399ba299
.quad 0x39eff573393263ef,0x39f484223917a117,0x39fbaccdb8bb6ecf,0x39f72417b90586ce,0x39f56d9739119ddd,0x39f940c038e98bba,0x39f7f110b8fee6e1,0x39f1d19fb9280b1f
.quad 0x39ff0e58382fb680,0x39fff4e63716c9b6,0x39e60f88b960924f,0x39dac450b984f484,0x39fff4e63716c9b6,0x39ffa6e3b7d5880e,0x39ddf6beb97f17b2,0x39d0d937b9940c5f
.quad 0x3a000000,0x3a000000,0x39987fc039cd9f02,0x399d7fd139c9d112,0x3823308c39ff2f9d,0x382973ba39ff1f49,0x39a8660539c0d0da,0x39ada85939bc17d9
.quad 0x39209ae539f31447,0x39268f1239f21352,0x39d14d3d3993682a,0x39d695e5398b9a6b,0x3946d52939ebe858,0x394e0bea39ea5ad9,0x39dc61c7398242b1,0x39e1668a3972bd43
.quad 0x39fdabcc3889cf86,0x39ff2f9d3823308c,0x39e04621b976e0cb,0x39d5b993b98cead0,0x39ff9c1837e21469,0x39ffffb1b5c90fc6,0x39d5b993b98cead0,0x39c95521b99e1e22
.quad 0x39fbaccdb8bb6ecf,0x39f7f110b8fee6e1,0x39ae3bdeb9bb8f3b,0x399c420cb9cac77f,0x39f72417b90586ce,0x39f1d19fb9280b1f,0x399ebc12b9c8d8b3,0x398af1b7b9d70348
.quad 0x3a000000,0x3a000000,0x39abeb4a39bdaef9,0x39b085bb39b96842,0x383c3ac339feea9d,0x38427c3939fed7d4,0x39bca00339ad1469,0x39c154e139a7ce61
.quad 0x3938442a39eed89e,0x393e1d4a39edb293,0x39e4aa5939663375,0x39e8bf3c39553641,0x396363fa39e55e0b,0x396a668139e398ac,0x39ee46be393b31a0,0x39f1d19f39280b1f
.quad 0x39ff0e58b82fb680,0x39fd7474b89008b7,0x39ae3bdeb9bb8f3b,0x399ebc12b9c8d8b3,0x39fbf531b8b54098,0x39f8e3d6b8efa8b2,0x399c420cb9cac77f,0x398af1b7b9d70348
.quad 0x39e60f88b960924f,0x39ddf6beb97f17b2,0x393e1d4ab9edb293,0x39119dddb9f56d97,0x39dac450b984f484,0x39d0d937b9940c5f,0x39119dddb9f56d97,0x38c4b0b9b9fb3bab
.quad 0x3848bd3639fec46d,0x38553db939fe9bc9,0x39715aea39e1c598,0x397f17b239ddf6be,0x3896408339fd3aac,0x389f917b39fcdf6c,0x39839c3d39db941a,0x398af1b739d70348
.quad 0x3914a03139f4fa0b,0x391d9e7839f3913f,0x39a2679939c5e403,0x39aac08239bebc1b,0x392c7cd439f10908,0x3936ccc339ef20b0,0x39abeb4a39bdaef9,0x39b4768f39b592e7
.quad 0x39b504f339b504f3,0x39bdaef939abeb4a,0x39ec835e3943ef15,0x39f3144739209ae5,0x39bdaef939abeb4a,0x39c6635439a1cbfb,0x39f10908392c7cd4,0x39f6ef5b39070ada
.quad 0x39d4db31398e39da,0x39dd2d533980e7e4,0x39fb14be38c7c5c2,0x39fe70b03861bc2e,0x39db941a39839c3d,0x39e398ac396a6681,0x39fd3aac38964083,0x39ff90b137eea038
.quad 0x387ab27339fe1324,0x3883950239fde0b1,0x3993682a39d14d3d,0x3999c20039ccae79,0x38bb6ecf39fbaccd,0x38c4b0b939fb3bab,0x399ff6cb39c7de65,0x39a69de339c25b89
.quad 0x3938442a39eed89e,0x3941071e39ed1c1d,0x39c1d87039a73656,0x39c8d8b3399ebc12,0x3955364139e8bf3c,0x395f28a939e66771,0x39cbbbf8399b02c6,0x39d2a6493991796b
.quad 0x39d4db31398e39da,0x39db941a39839c3d,0x39fec46d3848bd36,0x39ffec4337490ab0,0x39dd2d533980e7e4,0x39e398ac396a6681,0x39ffd3973796c32c,0x39ffcbe2b7a351cb
.quad 0x39f10908392c7cd4,0x39f5dec6390e9a22,0x39fd3aacb8964083,0x39f91298b8ec9a7f,0x39f5dec6390e9a22,0x39f9f35e38dd4b1a,0x39fa7302b8d41501,0x39f4bf62b91620d2
.quad 0x3896408339fd3aac,0x389c76de39fcfe73,0x39abeb4a39bdaef9,0x39b1a81d39b85216,0x38e05c1339f9c79d,0x38e98bba39f940c0,0x39b9684239b085bb,0x39bf41fc39aa2a80
.quad 0x395ae88039e76bd8,0x396363fa39e55e0b,0x39db941a39839c3d,0x39e106f239741f07,0x397c5d2739debe05,0x3982ef9f39dbfb34,0x39e4aa5939663375,0x39e9b7e43950eb2a
.quad 0x39ec835e3943ef15,0x39f10908392c7cd4,0x39fb14beb8c7c5c2,0x39f6ba07b9088e93,0x39f3144739209ae5,0x39f6ef5b39070ada,0x39f6ba07b9088e93,0x39f0c501b92df73c
.quad 0x39fec46d3848bd36,0x39ffd3973796c32c,0x39e1c598b9715aea,0x39d695e5b98b9a6b,0x39ffec4337490ab0,0x39ffcbe2b7a351cb,0x39d84853b988f59b,0x39cb41fab99ba299
.quad 0x38af10a239fc3b28,0x38b5409839fbf531,0x39c1d87039a73656,0x39c6e22a39a12ff9,0x39027dc039f78bc5,0x39070ada39f6ef5b,0x39cf7a1f3995f6d9,0x39d46b3b398ee0db
.quad 0x397c5d2739debe05,0x398242b139dc61c7,0x39eed89e3938442a,0x39f294f8392395c5,0x3990d3cd39d31849,0x399553b739cfefa8,0x39f5dec6390e9a22,0x39f8e3d638efa8b2
.quad 0x39fb14be38c7c5c2,0x39fd3aac38964083,0x39e1c598b9715aea,0x39d84853b988f59b,0x39fe70b03861bc2e,0x39ff90b137eea038,0x39d695e5b98b9a6b,0x39cb41fab99ba299
.quad 0x39fd3aacb8964083,0x39fa7302b8d41501,0x39abeb4ab9bdaef9,0x399b02c6b9cbbbf8,0x39f91298b8ec9a7f,0x39f4bf62b91620d2,0x399b02c6b9cbbbf8,0x39884b92b9d8b3a1
.quad 0x3861bc2e39fe70b0,0x386e387639fe4323,0x39864b8239d9f26a,0x398cead039d5b993,0x38a8defc39fc7eb0,0x38b228d439fc187a,0x39921eb039d233c6,0x3999210f39cd26fd
.quad 0x39268f1239f21352,0x392f713a39f08066,0x39b2c8c939b73a23,0x39ba7ca439af61a5,0x3941071e39ed1c1d,0x394b2aae39eafb8c,0x39bca00339ad1469,0x39c4633739a4381a
.quad 0x39c5e40339a26799,0x39cd9f0239987fc0,0x39f853f838f8cfcc,0x39fc3b2838af10a2,0x39ce8d9039973c07,0x39d627fe398c42c9,0x39fb61fc38c19b37,0x39fe5a383867fa9a
.quad 0x39e4aa5939663375,0x39eb4b0c3949b953,0x39ffec4337490ab0,0x39ff84abb7fb2b74,0x39eaab7b394c9b8b,0x39f0c501392df73c,0x39ffe129b77b49ba,0x39fe2b72b87475c0
.quad 0x3889cf8639fdabcc,0x389008b739fd7474,0x399ff6cb39c7de65,0x39a6050a39c2de29,0x38cdee6039fac516,0x38d7278f39fa4910,0x39ad146939bca003,0x39b3587a39b6ad7f
.quad 0x3949b95339eb4b0c,0x39525a0939e96591,0x39cf7a1f3995f6d9,0x39d5b993398cead0,0x396900b739e3f473,0x3972bd4339e1668a,0x39d91e6a3987a136,0x39df20db397afef7
.quad 0x39e1c59839715aea,0x39e76bd8395ae880,0x39ffb10fb7c8fb30,0x39fe1324b87ab273,0x39e9659139525a09,0x39ee8ff83939bb1e,0x39fe4323b86e3876,0x39fb3babb8c4b0b9
.quad 0x39f9c79d38e05c13,0x39fcbfc938a2abb6,0x39f31447b9209ae5,0x39eb4b0cb949b953,0x39fcfe73389c76de,0x39fefcc93835f8da,0x39ed1c1db941071e,0x39e398acb96a6681
.quad 0x38a2abb639fcbfc9,0x38a8defc39fc7eb0,0x39b73a2339b2c8c9,0x39bca00339ad1469,0x38f2b65139f8b47b,0x38fbdba439f822d1,0x39c4e3f539a39da9,0x39ca4c87399ce11f
.quad 0x396bcbbb39e33c5a,0x39741f0739e106f2,0x39e60f883960924f,0x39eaab7b394c9b8b,0x3987a13639d91e6a,0x398c42c939d627fe,0x39ee46be393b31a0,0x39f254703925129f
.quad 0x39f4fa0b3914a031,0x39f853f838f8cfcc,0x39f10908b92c7cd4,0x39ea09a7b94f7bca,0x39fa1e8438da3997,0x39fc9f8a38a5c58c,0x39e96591b9525a09,0x39e0a6cfb9758035
.quad 0x39ffec43b7490ab0,0x39ff0e58b82fb680,0x39c9d112b99d7fd1,0x39bb8f3bb9ae3bde,0x39fe9bc9b8553db9,0x39fc5d3ab8abf804,0x39bca003b9ad1469,0x39ac800fb9bd27b8
.quad 0x38bb6ecf39fbaccd,0x38c19b3739fb61fc,0x39cbbbf8399b02c6,0x39d064af3994b039,0x390b950739f64d97,0x39101c2c39f5a67b,0x39d91e6a3987a136,0x39dd924d39803a06
.quad 0x39864b8239d9f26a,0x398a48ad39d77026,0x39f5dec6390e9a22,0x39f8b47b38f2b651,0x3999c20039ccae79,0x399e1e2239c95521,0x39fb61fc38c19b37,0x39fd57de389324ca
.quad 0x39fec46d3848bd36,0x39ffb10f37c8fb30,0x39cd9f02b9987fc0,0x39c1d870b9a73656,0x39fffec436490f88,0x39ffba9eb7bc6dd5,0x39bebc1bb9aac082,0x39b11722b9b8dd65
.quad 0x39f6ba07b9088e93,0x39f21352b9268f12,0x3988f59bb9d84853,0x396bcbbbb9e33c5a,0x39ef6830b93554ec,0x39e912aeb953c867,0x396900b7b9e3f473,0x393f926fb9ed67a1
.quad 0x800000003f800000,0xbf3504f33f3504f3,0x800000003f800000,0xbf3968423f3085bb,0x800000003f800000,0xbf3daef93f2beb4a,0x800000003f800000,0xbf41d8703f273656
.quad 0x800000003f800000,0xbf45e4033f226799,0x800000003f800000,0xbf49d1123f1d7fd1,0x800000003f800000,0xbf4d9f023f187fc0,0x800000003f800000,0xbf514d3d3f13682a
.quad 0x800000003f800000,0xbf54db313f0e39da,0x800000003f800000,0xbf5848533f08f59b,0x800000003f800000,0xbf5b941a3f039c3d,0x800000003f800000,0xbf5ebe053efc5d27
.quad 0x800000003f800000,0xbf61c5983ef15aea,0x800000003f800000,0xbf64aa593ee63375,0x800000003f800000,0xbf676bd83edae880,0x800000003f800000,0xbf6a09a73ecf7bca
.quad 0xbec3ef153f6c835e,0xbf6c835e3ec3ef15,0xbec9b9533f6b4b0c,0xbf6ff5733eb263ef,0xbecf7bca3f6a09a7,0xbf7314473ea09ae5,0xbed536413f68bf3c,0xbf75dec63e8e9a22
.quad 0xbedae8803f676bd8,0xbf7853f83e78cfcc,0xbee0924f3f660f88,0xbf7a73023e541501,0xbee633753f64aa59,0xbf7c3b283e2f10a2,0xbeebcbbb3f633c5a,0xbf7dabcc3e09cf86
.quad 0xbef15aea3f61c598,0xbf7ec46d3dc8bd36,0xbef6e0cb3f604621,0xbf7f84ab3d7b2b74,0xbefc5d273f5ebe05,0xbf7fec433cc90ab0,0xbf00e7e43f5d2d53,0xbf7ffb11bc490e90
.quad 0xbf039c3d3f5b941a,0xbf7fb10fbd48fb30,0xbf064b823f59f26a,0xbf7f0e58bdafb680,0xbf08f59b3f584853,0xbf7e1324bdfab273,0xbf0b9a6b3f5695e5,0xbf7cbfc9be22abb6
.quad 0xbf7b14bebe47c5c2,0xbf0e39dabf54db31,0xbf77f110be7ee6e1,0xbef9a02dbf5f8327,0xbf740bddbe9aa086,0xbed53641bf68bf3c,0xbf6f6830beb554ec,0xbeaf713abf708066
.quad 0xbf6a09a7becf7bca,0xbe888e93bf76ba07,0xbf63f473bee900b7,0xbe419b37bf7b61fc,0xbf5d2d53bf00e7e4,0xbde1bc2ebf7e70b0,0xbf55b993bf0cead0,0xbcfb49babf7fe129
.quad 0xbf4d9f02bf187fc0,0x3d48fb30bf7fb10f,0xbf44e3f5bf239da9,0x3e039502bf7de0b1,0xbf3b8f3bbf2e3bde,0x3e541501bf7a7302,0xbf31a81dbf385216,0x3e919dddbf756d97
.quad 0xbf273656bf41d870,0x3eb8442abf6ed89e,0xbf1c420cbf4ac77f,0x3eddbe79bf66becc,0xbf10d3cdbf531849,0x3f00e7e4bf5d2d53,0xbf04f484bf5ac450,0x3f121eb0bf5233c6
.quad 0xbf54db31bf0e39da,0xbe47c5c2bf7b14be,0xbf4ac77fbf1c420c,0xbdd53db9bf7e9bc9,0xbf3fc767bf299415,0xbc490e90bf7ffb11,0xbf33e7bcbf36206c,0x3da3308cbf7f2f9d
.quad 0xbf273656bf41d870,0x3e2f10a2bf7c3b28,0xbf19c200bf4cae79,0x3e8586cebf772417,0xbf0b9a6bbf5695e5,0x3eb263efbf6ff573,0xbef9a02dbf5f8327,0x3eddbe79bf66becc
.quad 0xbedae880bf676bd8,0x3f039c3dbf5b941a,0xbebb31a0bf6e46be,0x3f173c07bf4e8d90,0xbe9aa086bf740bdd,0x3f299415bf3fc767,0xbe72b651bf78b47b,0x3f3a7ca4bf2f61a5
.quad 0xbe2f10a2bf7c3b28,0x3f49d112bf1d7fd1,0xbdd53db9bf7e9bc9,0x3f577026bf0a48ad,0xbd16c32cbf7fd397,0x3f633c5abeebcbbb,0x3cfb49babf7fe129,0x3f6d1c1dbec1071e
.quad 0xbdc8bd363f7ec46d,0xbf45e4033f226799,0xbdcefdb73f7eb069,0xbf4a4c873f1ce11f,0xbdd53db93f7e9bc9,0xbf4e8d903f173c07,0xbddb7d373f7e868b,0xbf52a6493f11796b
.quad 0xbde1bc2e3f7e70b0,0xbf5695e53f0b9a6b,0xbde7fa9a3f7e5a38,0xbf5a5ba03f05a02c,0xbdee38763f7e4323,0xbf5df6be3eff17b2,0xbdf475c03f7e2b72,0xbf61668a3ef2bd43
.quad 0xbdfab2733f7e1324,0xbf64aa593ee63375,0xbe0077453f7dfa38,0xbf67c1873ed97cb9,0xbe0395023f7de0b1,0xbf6aab7b3ecc9b8b,0xbe06b26e3f7dc68c,0xbf6d67a13ebf926f
.quad 0xbe09cf863f7dabcc,0xbf6ff5733eb263ef,0xbe0cec4a3f7d906e,0xbf7254703ea5129f,0xbe1008b73f7d7474,0xbf7484223e97a117,0xbe1324ca3f7d57de,0xbf76841b3e8a11f7
.quad 0xbef15aea3f61c598,0xbf74fa0b3e94a031,0xbef840c83f5fe4e9,0xbf77beb73e80f8c0,0xbeff17b23f5df6be,0xbf7a1e843e5a3997,0xbf02ef9f3f5bfb34,0xbf7c187a3e3228d4
.quad 0xbf064b823f59f26a,0xbf7dabcc3e09cf86,0xbf099f4e3f57dc7f,0xbf7ed7d43dc27c39,0xbf0cead03f55b993,0xbf7f9c183d621469,0xbf102dd53f5389c7,0xbf7ff84a3c7b514b
.quad 0xbf13682a3f514d3d,0xbf7fec43bcc90ab0,0xbf16999f3f4f0417,0xbf7f7808bd83db0a,0xbf19c2003f4cae79,0xbf7e9bc9bdd53db9,0xbf1ce11f3f4a4c87,0xbf7d57debe1324ca
.quad 0xbf1ff6cb3f47de65,0xbf7baccdbe3b6ecf,0xbf2302d33f456439,0xbf799b43be636c83,0xbf26050a3f42de29,0xbf772417be8586ce,0xbf28fd413f404c5c,0xbf74484bbe9920fe
.quad 0xbf74fa0bbe94a031,0xbef15aeabf61c598,0xbf703b37beb0eacb,0xbecb2aaebf6afb8c,0xbf6aab7bbecc9b8b,0xbea395c5bf7294f8,0xbf644facbee79a5d,0xbe75c35abf788486
.quad 0xbf5d2d53bf00e7e4,0xbe22abb6bf7cbfc9,0xbf554aa4bf0d9281,0xbd9cecf9bf7f3f54,0xbf4cae79bf19c200,0x3bc90f88bf7ffec4,0xbf436051bf256bcb,0x3db5f8dabf7efcc9
.quad 0xbf396842bf3085bb,0x3e2f10a2bf7c3b28,0xbf2ecef7bf3b0629,0x3e80f8c0bf77beb7,0xbf239da9bf44e3f5,0x3ea986c4bf718f57,0xbf17de12bf4e1689,0x3ed0eb2abf69b7e4
.quad 0xbf0b9a6bbf5695e5,0x3ef6e0cbbf604621,0xbefdbabbbf5e5aa6,0x3f0d9281bf554aa4,0xbee363fabf655e0b,0x3f1ebc12bf48d8b3,0xbec8477cbf6b99fb,0x3f2ecef7bf3b0629
.quad 0xbf45e403bf226799,0xbdc8bd36bf7ec46d,0xbf39f2acbf2ff3e6,0xbb490fc6bf7fffb1,0xbf2d1469bf3ca003,0x3dbc3ac3bf7eea9d,0xbf1f599fbf485bca,0x3e3e853ebf7b87b2
.quad 0xbf10d3cdbf531849,0x3e8e9a22bf75dec6,0xbf019573bf5cc7d1,0x3ebca7afbf6dfcf2,0xbee363fabf655e0b,0x3ee900b7bf63f473,0xbec27b55bf6cd007,0x3f099f4ebf57dc7f
.quad 0xbea09ae5bf731447,0x3f1d7fd1bf49d112,0xbe7bdba4bf7822d1,0x3f2ff3e6bf39f2ac,0xbe354098bf7bf531,0x3f40d0dabf286605,0xbddb7d37bf7e868b,0x3f4fefa8bf1553b7
.quad 0xbd16c32cbf7fd397,0x3f5d2d53bf00e7e4,0x3d0a342fbf7fdaaf,0x3f686b39bed6a399,0x3dd53db9bf7e9bc9,0x3f718f57bea986c4,0x3e3228d4bf7c187a,0x3f788486be75c35a
.quad 0xbe47c5c23f7b14be,0xbf54db313f0e39da,0xbe4dee603f7ac516,0xbf591e6a3f07a136,0xbe5415013f7a7302,0xbf5d2d533f00e7e4,0xbe5a39973f7a1e84,0xbf6106f23ef41f07
.quad 0xbe605c133f79c79d,0xbf64aa593ee63375,0xbe667c663f796e4e,0xbf6816a83ed8106b,0xbe6c9a7f3f791298,0xbf6b4b0c3ec9b953,0xbe72b6513f78b47b,0xbf6e46be3ebb31a0
.quad 0xbe78cfcc3f7853f8,0xbf7109083eac7cd4,0xbe7ee6e13f77f110,0xbf73913f3e9d9e78,0xbe827dc03f778bc5,0xbf75dec63e8e9a22,0xbe8586ce3f772417,0xbf77f1103e7ee6e1
.quad 0xbe888e933f76ba07,0xbf79c79d3e605c13,0xbe8b95073f764d97,0xbf7b61fc3e419b37,0xbe8e9a223f75dec6,0xbf7cbfc93e22abb6,0xbe919ddd3f756d97,0xbf7de0b13e039502
.quad 0xbf0e39da3f54db31,0xbf7b14be3e47c5c2,0xbf121eb03f5233c6,0xbf7cfe733e1c76de,0xbf15f6d93f4f7a1f,0xbf7e70b03de1bc2e,0xbf19c2003f4cae79,0xbf7f6ac73d8a200a
.quad 0xbf1d7fd13f49d112,0xbf7fec433cc90ab0,0xbf212ff93f46e22a,0xbf7ff4e6bc96c9b6,0xbf24d2253f43e200,0xbf7f84abbd7b2b74,0xbf2866053f40d0da,0xbf7e9bc9bdd53db9
.quad 0xbf2beb4a3f3daef9,0xbf7d3aacbe164083,0xbf2f61a53f3a7ca4,0xbf7b61fcbe419b37,0xbf32c8c93f373a23,0xbf791298be6c9a7f,0xbf36206c3f33e7bc,0xbf764d97be8b9507
.quad 0xbf3968423f3085bb,0xbf731447bea09ae5,0xbf3ca0033f2d1469,0xbf6f6830beb554ec,0xbf3fc7673f299415,0xbf6b4b0cbec9b953,0xbf42de293f26050a,0xbf66beccbeddbe79
.quad 0xbf800000248d3132,0xbf3504f3bf3504f3,0xbf7fb10fbd48fb30,0xbf273656bf41d870,0xbf7ec46dbdc8bd36,0xbf187fc0bf4d9f02,0xbf7d3aacbe164083,0xbf08f59bbf584853
.quad 0xbf7b14bebe47c5c2,0xbef15aeabf61c598,0xbf7853f8be78cfcc,0xbecf7bcabf6a09a7,0xbf74fa0bbe94a031,0xbeac7cd4bf710908,0xbf710908beac7cd4,0xbe888e93bf76ba07
.quad 0xbf6c835ebec3ef15,0xbe47c5c2bf7b14be,0xbf676bd8bedae880,0xbdfab273bf7e1324,0xbf61c598bef15aea,0xbd48fb30bf7fb10f,0xbf5b941abf039c3d,0x3cc90ab0bf7fec43
.quad 0xbf54db31bf0e39da,0x3dc8bd36bf7ec46d,0xbf4d9f02bf187fc0,0x3e2f10a2bf7c3b28,0xbf45e403bf226799,0x3e78cfccbf7853f8,0xbf3daef9bf2beb4a,0x3ea09ae5bf731447
.quad 0xbf6c835ebec3ef15,0xbec3ef15bf6c835e,0xbf660f88bee0924f,0xbe9aa086bf740bdd,0xbf5ebe05befc5d27,0xbe605c13bf79c79d,0xbf5695e5bf0b9a6b,0xbe09cf86bf7dabcc
.quad 0xbf4d9f02bf187fc0,0xbd48fb30bf7fb10f,0xbf43e200bf24d225,0x3d16c32cbf7fd397,0xbf396842bf3085bb,0x3dfab273bf7e1324,0xbf2e3bdebf3b8f3b,0x3e541501bf7a7302
.quad 0xbf226799bf45e403,0x3e94a031bf74fa0b,0xbf15f6d9bf4f7a1f,0x3ebe1d4abf6db293,0xbf08f59bbf584853,0x3ee63375bf64aa59,0xbef6e0cbbf604621,0x3f064b82bf59f26a
.quad 0xbedae880bf676bd8,0x3f187fc0bf4d9f02,0xbebe1d4abf6db293,0x3f299415bf3fc767,0xbea09ae5bf731447,0x3f396842bf3085bb,0xbe827dc0bf778bc5,0x3f47de65bf1ff6cb
.quad 0xbe94a0313f74fa0b,0xbf61c5983ef15aea,0xbe9920fe3f74484b,0xbf65b7103ee1fb6a,0xbe9d9e783f73913f,0xbf6965913ed25a09,0xbea218873f72d4eb,0xbf6cd0073ec27b55
.quad 0xbea68f123f721352,0xbf6ff5733eb263ef,0xbeab02013f714c7a,0xbf72d4eb3ea21887,0xbeaf713a3f708066,0xbf756d973e919ddd,0xbeb3dca53f6faf1b,0xbf77beb73e80f8c0
.quad 0xbeb8442a3f6ed89e,0xbf79c79d3e605c13,0xbebca7af3f6dfcf2,0xbf7b87b23e3e853e,0xbec1071e3f6d1c1d,0xbf7cfe733e1c76de,0xbec5625c3f6c3624,0xbf7e2b723df475c0
.quad 0xbec9b9533f6b4b0c,0xbf7f0e583dafb680,0xbece0bea3f6a5ad9,0xbf7fa6e33d55880e,0xbed25a093f696591,0xbf7ff4e63c96c9b6,0xbed6a3993f686b39,0xbf7ff84abc7b514b
.quad 0xbf2267993f45e403,0xbf7ec46d3dc8bd36,0xbf269de33f425b89,0xbf7fa6e33d55880e,0xbf2ac0823f3ebc1b,0xbf7ffec43bc90f88,0xbf2ecef73f3b0629,0xbf7fcbe2bd2351cb
.quad 0xbf32c8c93f373a23,0xbf7f0e58bdafb680,0xbf36ad7f3f33587a,0xbf7dc68cbe06b26e,0xbf3a7ca43f2f61a5,0xbf7bf531be354098,0xbf3e35c53f2b561b,0xbf799b43be636c83
.quad 0xbf41d8703f273656,0xbf76ba07be888e93,0xbf4564393f2302d3,0xbf73530ebe9f1cdf,0xbf48d8b33f1ebc12,0xbf6f6830beb554ec,0xbf4c35783f1a6293,0xbf6afb8cbecb2aae
.quad 0xbf4f7a1f3f15f6d9,0xbf660f88bee0924f,0xbf52a6493f11796b,0xbf60a6cfbef58035,0xbf55b9933f0cead0,0xbf5ac450bf04f484,0xbf58b3a13f084b92,0xbf546b3bbf0ee0db
.quad 0xbf7ec46dbdc8bd36,0xbf226799bf45e403,0xbf7d1cddbe195be0,0xbf12c39abf51c0c2,0xbf7ac516be4dee60,0xbf0242b1bf5c61c7,0xbf77beb7be80f8c0,0xbee1fb6abf65b710
.quad 0xbf740bddbe9aa086,0xbebe1d4abf6db293,0xbf6faf1bbeb3dca5,0xbe9920febf74484b,0xbf6aab7bbecc9b8b,0xbe667c66bf796e4e,0xbf650479bee4cbfe,0xbe195be0bf7d1cdd
.quad 0xbf5ebe05befc5d27,0xbd96a905bf7f4e6d,0xbf57dc7fbf099f4e,0x3b490fc6bf7fffb1,0xbf5064afbf14b039,0x3da3308cbf7f2f9d,0xbf485bcabf1f599f,0x3e1f917bbf7cdf6c
.quad 0xbf3fc767bf299415,0x3e6c9a7fbf791298,0xbf36ad7fbf33587a,0x3e9c1fafbf73ced9,0xbf2d1469bf3ca003,0x3ec1071ebf6d1c1d,0xbf2302d3bf456439,0x3ee4cbfebf650479
.quad 0xbf61c598bef15aea,0xbe94a031bf74fa0b,0xbf5988adbf06f686,0xbe5101f1bf7a9c59,0xbf5064afbf14b039,0xbdee3876bf7e4323,0xbf466354bf21cbfb,0xbce22a7abf7fe705
.quad 0xbf3b8f3bbf2e3bde,0x3d7b2b74bf7f84ab,0xbf2ff3e6bf39f2ac,0x3e195be0bf7d1cdd,0xbf239da9bf44e3f5,0x3e72b651bf78b47b,0xbf16999fbf4f0417,0x3ea5129fbf725470
.quad 0xbf08f59bbf584853,0x3ecf7bcabf6a09a7,0xbef58035bf60a6cf,0x3ef840c8bf5fe4e9,0xbed8106bbf6816a8,0x3f0f8784bf53fac3,0xbeb9bb1ebf6e8ff8,0x3f21cbfbbf466354
.quad 0xbe9aa086bf740bdd,0x3f32c8c9bf373a23,0xbe75c35abf788486,0x3f425b89bf269de3,0xbe354098bf7bf531,0x3f5064afbf14b039,0xbde7fa9abf7e5a38,0x3f5cc7d1bf019573
.quad 0x3a000000,0x3a000000,0x39b504f339b504f3,0x39b9684239b085bb,0x3848bd3639fec46d,0x384efdb739feb069,0x39c5e40339a26799,0x39ca4c87399ce11f
.quad 0x3943ef1539ec835e,0x3949b95339eb4b0c,0x39ec835e3943ef15,0x39eff573393263ef,0x39715aea39e1c598,0x397840c839dfe4e9,0x39f4fa0b3914a031,0x39f7beb73900f8c0
.quad 0x39fb14beb8c7c5c2,0x39f7f110b8fee6e1,0x398e39dab9d4db31,0x3979a02db9df8327,0x39f4fa0bb914a031,0x39f03b37b930eacb,0x39715aeab9e1c598,0x394b2aaeb9eafb8c
.quad 0x39d4db31b98e39da,0x39cac77fb99c420c,0x38c7c5c2b9fb14be,0x38553db9b9fe9bc9,0x39c5e403b9a26799,0x39b9f2acb9aff3e6,0x3848bd36b9fec46d,0x35c90fc6b9ffffb1
.quad 0x3a000000,0x3a000000,0x39c5e40339a26799,0x39c9d112399d7fd1,0x3861bc2e39fe70b0,0x3867fa9a39fe5a38,0x39d695e5398b9a6b,0x39da5ba03985a02c
.quad 0x395ae88039e76bd8,0x3960924f39e60f88,0x39f853f838f8cfcc,0x39fa730238d41501,0x39864b8239d9f26a,0x39899f4e39d7dc7f,0x39fdabcc3889cf86,0x39fed7d438427c39
.quad 0x39ea09a7b94f7bca,0x39e3f473b96900b7,0x39088e93b9f6ba07,0x38c19b37b9fb61fc,0x39dd2d53b980e7e4,0x39d54aa4b98d9281,0x38a2abb6b9fcbfc9,0x381cecf9b9ff3f54
.quad 0x39a73656b9c1d870,0x3999c200b9ccae79,0xb8af10a2b9fc3b28,0xb90586ceb9f72417,0x3990d3cdb9d31849,0x39819573b9dcc7d1,0xb90e9a22b9f5dec6,0xb93ca7afb9edfcf2
.quad 0x3a000000,0x3a000000,0x39d4db31398e39da,0x39d848533988f59b,0x387ab27339fe1324,0x3880774539fdfa38,0x39e4aa5939663375,0x39e7c18739597cb9
.quad 0x39715aea39e1c598,0x3976e0cb39e04621,0x39fec46d3848bd36,0x39ff84ab37fb2b74,0x3993682a39d14d3d,0x3996999f39cf0417,0x39ffec43b7490ab0,0x39ff7808b803db0a
.quad 0x39cd9f02b9987fc0,0x39c4e3f5b9a39da9,0xb7c8fb30b9ffb10f,0xb8839502b9fde0b1,0x39b96842b9b085bb,0x39aecef7b9bb0629,0xb8af10a2b9fc3b28,0xb900f8c0b9f7beb7
.quad 0x395ae880b9e76bd8,0x393b31a0b9ee46be,0xb9839c3db9db941a,0xb9973c07b9ce8d90,0x39209ae5b9f31447,0x38fbdba4b9f822d1,0xb99d7fd1b9c9d112,0xb9aff3e6b9b9f2ac
.quad 0x3a000000,0x3a000000,0x39e1c59839715aea,0x39e4aa5939663375,0x3889cf8639fdabcc,0x388cec4a39fd906e,0x39eff573393263ef,0x39f254703925129f
.quad 0x39839c3d39db941a,0x39864b8239d9f26a,0x39ffb10fb7c8fb30,0x39ff0e58b82fb680,0x399ff6cb39c7de65,0x39a302d339c56439,0x39fbaccdb8bb6ecf,0x39f99b43b8e36c83
.quad 0x39a73656b9c1d870,0x399c420cb9cac77f,0xb938442ab9eed89e,0xb95dbe79b9e6becc,0x398b9a6bb9d695e5,0x397dbabbb9de5aa6,0xb976e0cbb9e04621,0xb98d9281b9d54aa4
.quad 0x38af10a2b9fc3b28,0x38553db9b9fe9bc9,0xb9c9d112b99d7fd1,0xb9d77026b98a48ad,0x3796c32cb9ffd397,0xb78a342fb9ffdaaf,0xb9dd2d53b980e7e4,0xb9e86b39b956a399
.quad 0x3a000000,0x3a000000,0x39bdaef939abeb4a,0x39c1d87039a73656,0x38553db939fe9bc9,0x385b7d3739fe868b,0x39ce8d9039973c07,0x39d2a6493991796b
.quad 0x394f7bca39ea09a7,0x3955364139e8bf3c,0x39f3144739209ae5,0x39f5dec6390e9a22,0x397f17b239ddf6be,0x3982ef9f39dbfb34,0x39fa1e8438da3997,0x39fc187a38b228d4
.quad 0x39f40bddb91aa086,0x39ef6830b93554ec,0x39553641b9e8bf3c,0x392f713ab9f08066,0x39eaab7bb94c9b8b,0x39e44facb9679a5d,0x392395c5b9f294f8,0x38f5c35ab9f88486
.quad 0x39bfc767b9a99415,0x39b3e7bcb9b6206c,0x36c90e90b9fffb11,0xb823308cb9ff2f9d,0x39ad1469b9bca003,0x399f599fb9c85bca,0xb83c3ac3b9feea9d,0xb8be853eb9fb87b2
.quad 0x3a000000,0x3a000000,0x39cd9f0239987fc0,0x39d14d3d3993682a,0x386e387639fe4323,0x387475c039fe2b72,0x39ddf6be397f17b2,0x39e1668a3972bd43
.quad 0x3966337539e4aa59,0x396bcbbb39e33c5a,0x39fc3b2838af10a2,0x39fdabcc3889cf86,0x398cead039d5b993,0x39902dd539d389c7,0x39ff9c1837e21469,0x39fff84a36fb514b
.quad 0x39dd2d53b980e7e4,0x39d5b993b98cead0,0x3861bc2eb9fe70b0,0x377b49bab9ffe129,0x39ccae79b999c200,0x39c36051b9a56bcb,0xb6490f88b9fffec4,0xb835f8dab9fefcc9
.quad 0x398b9a6bb9d695e5,0x3979a02db9df8327,0xb93263efb9eff573,0xb95dbe79b9e6becc,0x396363fab9e55e0b,0x39427b55b9ecd007,0xb96900b7b9e3f473,0xb9899f4eb9d7dc7f
.quad 0x3a000000,0x3a000000,0x39db941a39839c3d,0x39debe05397c5d27,0x3883950239fde0b1,0x3886b26e39fdc68c,0x39eaab7b394c9b8b,0x39ed67a1393f926f
.quad 0x397c5d2739debe05,0x3980e7e439dd2d53,0x39ffec4337490ab0,0x39fffb11b6c90e90,0x3999c20039ccae79,0x399ce11f39ca4c87,0x39fe9bc9b8553db9,0x39fd57deb89324ca
.quad 0x39bb8f3bb9ae3bde,0x39b1a81db9b85216,0xb8d41501b9fa7302,0xb9119dddb9f56d97,0x39a39da9b9c4e3f5,0x3997de12b9ce1689,0xb92986c4b9f18f57,0xb950eb2ab9e9b7e4
.quad 0x391aa086b9f40bdd,0x38f2b651b9f8b47b,0xb9a99415b9bfc767,0xb9ba7ca4b9af61a5,0x38b54098b9fbf531,0x385b7d37b9fe868b,0xb9c0d0dab9a86605,0xb9cfefa8b99553b7
.quad 0x3a000000,0x3a000000,0x39e76bd8395ae880,0x39ea09a7394f7bca,0x389008b739fd7474,0x389324ca39fd57de,0x39f484223917a117,0x39f6841b390a11f7
.quad 0x3988f59b39d84853,0x398b9a6b39d695e5,0x39fe1324b87ab273,0x39fcbfc9b8a2abb6,0x39a6050a39c2de29,0x39a8fd4139c04c5c,0x39f72417b90586ce,0x39f4484bb91920fe
.quad 0x3990d3cdb9d31849,0x3984f484b9dac450,0xb980e7e4b9dd2d53,0xb9921eb0b9d233c6,0x396363fab9e55e0b,0x3948477cb9eb99fb,0xb99ebc12b9c8d8b3,0xb9aecef7b9bb0629
.quad 0x3796c32cb9ffd397,0xb77b49bab9ffe129,0xb9e33c5ab96bcbbb,0xb9ed1c1db941071e,0xb8553db9b9fe9bc9,0xb8b228d4b9fc187a,0xb9f18f57b92986c4,0xb9f88486b8f5c35a
.quad 0x38c7c5c239fb14be,0x38cdee6039fac516,0x39d4db31398e39da,0x39d91e6a3987a136,0x3914a03139f4fa0b,0x391920fe39f4484b,0x39e1c59839715aea,0x39e5b7103961fb6a
.quad 0x398e39da39d4db31,0x39921eb039d233c6,0x39fb14be38c7c5c2,0x39fcfe73389c76de,0x39a2679939c5e403,0x39a69de339c25b89,0x39fec46d3848bd36,0x39ffa6e337d5880e
.quad 0x3a0000001f0d3132,0x39ffb10fb7c8fb30,0x39b504f3b9b504f3,0x39a73656b9c1d870,0x39fec46db848bd36,0x39fd1cddb8995be0,0x39a26799b9c5e403,0x3992c39ab9d1c0c2
.quad 0x39ec835eb943ef15,0x39e60f88b960924f,0x3943ef15b9ec835e,0x391aa086b9f40bdd,0x39e1c598b9715aea,0x39d988adb986f686,0x3914a031b9f4fa0b,0x38d101f1b9fa9c59
.quad 0x38e05c1339f9c79d,0x38e67c6639f96e4e,0x39e4aa5939663375,0x39e816a83958106b,0x39268f1239f21352,0x392b020139f14c7a,0x39eff573393263ef,0x39f2d4eb39221887
.quad 0x399d7fd139c9d112,0x39a12ff939c6e22a,0x39ffec4337490ab0,0x39fff4e6b716c9b6,0x39b2c8c939b73a23,0x39b6ad7f39b3587a,0x39ff0e58b82fb680,0x39fdc68cb886b26e
.quad 0x39fb14beb8c7c5c2,0x39f853f8b8f8cfcc,0x39715aeab9e1c598,0x394f7bcab9ea09a7,0x39f40bddb91aa086,0x39efaf1bb933dca5,0x393e1d4ab9edb293,0x391920feb9f4484b
.quad 0x39cd9f02b9987fc0,0x39c3e200b9a4d225,0x37c8fb30b9ffb10f,0xb796c32cb9ffd397,0x39bb8f3bb9ae3bde,0x39aff3e6b9b9f2ac,0xb7fb2b74b9ff84ab,0xb8995be0b9fd1cdd
.quad 0x38f8cfcc39f853f8,0x38fee6e139f7f110,0x39f10908392c7cd4,0x39f3913f391d9e78,0x3938442a39eed89e,0x393ca7af39edfcf2,0x39f9c79d38e05c13,0x39fb87b238be853e
.quad 0x39abeb4a39bdaef9,0x39af61a539ba7ca4,0x39fd3aacb8964083,0x39fb61fcb8c19b37,0x39c1d87039a73656,0x39c5643939a302d3,0x39f6ba07b9088e93,0x39f3530eb91f1cdf
.quad 0x39ec835eb943ef15,0x39e76bd8b95ae880,0x38c7c5c2b9fb14be,0x387ab273b9fe1324,0x39debe05b97c5d27,0x39d7dc7fb9899f4e,0x3816a905b9ff4e6d,0xb5c90fc6b9ffffb1
.quad 0x39a26799b9c5e403,0x3995f6d9b9cf7a1f,0xb914a031b9f4fa0b,0xb93e1d4ab9edb293,0x3988f59bb9d84853,0x39758035b9e0a6cf,0xb94f7bcab9ea09a7,0xb97840c8b9dfe4e9
.quad 0x39088e9339f6ba07,0x390b950739f64d97,0x39f9c79d38e05c13,0x39fb61fc38c19b37,0x3949b95339eb4b0c,0x394e0bea39ea5ad9,0x39ff0e58382fb680,0x39ffa6e337d5880e
.quad 0x39b9684239b085bb,0x39bca00339ad1469,0x39f31447b9209ae5,0x39ef6830b93554ec,0x39cf7a1f3995f6d9,0x39d2a6493991796b,0x39e60f88b960924f,0x39e0a6cfb9758035
.quad 0x39d4db31b98e39da,0x39cd9f02b9987fc0,0xb848bd36b9fec46d,0xb8af10a2b9fc3b28,0x39bfc767b9a99415,0x39b6ad7fb9b3587a,0xb8ec9a7fb9f91298,0xb91c1fafb9f3ced9
.quad 0x395ae880b9e76bd8,0x393e1d4ab9edb293,0xb9987fc0b9cd9f02,0xb9a99415b9bfc767,0x391aa086b9f40bdd,0x38f5c35ab9f88486,0xb9b2c8c9b9b73a23,0xb9c25b89b9a69de3
.quad 0x38d4150139fa7302,0x38da399739fa1e84,0x39dd2d533980e7e4,0x39e106f239741f07,0x391d9e7839f3913f,0x3922188739f2d4eb,0x39e9659139525a09,0x39ecd00739427b55
.quad 0x3995f6d939cf7a1f,0x3999c20039ccae79,0x39fe70b03861bc2e,0x39ff6ac7380a200a,0x39aac08239bebc1b,0x39aecef739bb0629,0x39fffec436490f88,0x39ffcbe2b7a351cb
.quad 0x39fec46db848bd36,0x39fd3aacb8964083,0x39987fc0b9cd9f02,0x3988f59bb9d84853,0x39fac516b8cdee60,0x39f7beb7b900f8c0,0x398242b1b9dc61c7,0x3961fb6ab9e5b710
.quad 0x39debe05b97c5d27,0x39d695e5b98b9a6b,0x38e05c13b9f9c79d,0x3889cf86b9fdabcc,0x39d064afb994b039,0x39c66354b9a1cbfb,0x386e3876b9fe4323,0x37622a7ab9ffe705
.quad 0x38ec9a7f39f91298,0x38f2b65139f8b47b,0x39eb4b0c3949b953,0x39ee46be393b31a0,0x392f713a39f08066,0x3933dca539efaf1b,0x39f56d9739119ddd,0x39f7beb73900f8c0
.quad 0x39a4d22539c3e200,0x39a8660539c0d0da,0x39ff84abb7fb2b74,0x39fe9bc9b8553db9,0x39ba7ca439af61a5,0x39be35c539ab561b,0x39fbf531b8b54098,0x39f99b43b8e36c83
.quad 0x39f4fa0bb914a031,0x39f10908b92c7cd4,0x392c7cd4b9f10908,0x39088e93b9f6ba07,0x39eaab7bb94c9b8b,0x39e50479b964cbfe,0x38e67c66b9f96e4e,0x38995be0b9fd1cdd
.quad 0x39b96842b9b085bb,0x39ae3bdeb9bb8f3b,0xb87ab273b9fe1324,0xb8d41501b9fa7302,0x39a39da9b9c4e3f5,0x3996999fb9cf0417,0xb8f2b651b9f8b47b,0xb925129fb9f25470
.quad 0x39027dc039f78bc5,0x390586ce39f72417,0x39f5dec6390e9a22,0x39f7f11038fee6e1,0x3941071e39ed1c1d,0x3945625c39ec3624,0x39fcfe73389c76de,0x39fe2b72387475c0
.quad 0x39b2c8c939b73a23,0x39b6206c39b3e7bc,0x39f91298b8ec9a7f,0x39f64d97b90b9507,0x39c8d8b3399ebc12,0x39cc3578399a6293,0x39ef6830b93554ec,0x39eafb8cb94b2aae
.quad 0x39e1c598b9715aea,0x39db941ab9839c3d,0x37c8fb30b9ffb10f,0xb7490ab0b9ffec43,0x39d064afb994b039,0x39c85bcab99f599f,0xb823308cb9ff2f9d,0xb89f917bb9fcdf6c
.quad 0x3988f59bb9d84853,0x3976e0cbb9e04621,0xb9663375b9e4aa59,0xb9864b82b9d9f26a,0x3958106bb9e816a8,0x3939bb1eb9ee8ff8,0xb98f8784b9d3fac3,0xb9a1cbfbb9c66354
.quad 0x390e9a2239f5dec6,0x39119ddd39f56d97,0x39fcbfc938a2abb6,0x39fde0b138839502,0x39525a0939e96591,0x3956a39939e86b39,0x39fff4e63716c9b6,0x39fff84ab6fb514b
.quad 0x39bfc76739a99415,0x39c2de2939a6050a,0x39eb4b0cb949b953,0x39e6beccb95dbe79,0x39d5b993398cead0,0x39d8b3a139884b92,0x39dac450b984f484,0x39d46b3bb98ee0db
.quad 0x39c5e403b9a26799,0x39bdaef9b9abeb4a,0xb8f8cfccb9f853f8,0xb9209ae5b9f31447,0x39ad1469b9bca003,0x39a302d3b9c56439,0xb941071eb9ed1c1d,0xb964cbfeb9e50479
.quad 0x39209ae5b9f31447,0x39027dc0b9f78bc5,0xb9b96842b9b085bb,0xb9c7de65b99ff6cb,0x38b54098b9fbf531,0x3867fa9ab9fe5a38,0xb9d064afb994b039,0xb9dcc7d1b9819573
.quad 0x800000003f800000,0xbf6c835e3ec3ef15,0x800000003f800000,0xbf6ed89e3eb8442a,0x800000003f800000,0xbf7109083eac7cd4,0x800000003f800000,0xbf7314473ea09ae5
.quad 0x800000003f800000,0xbf74fa0b3e94a031,0x800000003f800000,0xbf76ba073e888e93,0x800000003f800000,0xbf7853f83e78cfcc,0x800000003f800000,0xbf79c79d3e605c13
.quad 0x800000003f800000,0xbf7b14be3e47c5c2,0x800000003f800000,0xbf7c3b283e2f10a2,0x800000003f800000,0xbf7d3aac3e164083,0x800000003f800000,0xbf7e13243dfab273
.quad 0x800000003f800000,0xbf7ec46d3dc8bd36,0x800000003f800000,0xbf7f4e6d3d96a905,0x800000003f800000,0xbf7fb10f3d48fb30,0x800000003f800000,0xbf7fec433cc90ab0
.quad 0xbf0e39da3f54db31,0xbf7b14bebe47c5c2,0xbf10d3cd3f531849,0xbf791298be6c9a7f,0xbf13682a3f514d3d,0xbf76ba07be888e93,0xbf15f6d93f4f7a1f,0xbf740bddbe9aa086
.quad 0xbf187fc03f4d9f02,0xbf710908beac7cd4,0xbf1b02c63f4bbbf8,0xbf6db293bebe1d4a,0xbf1d7fd13f49d112,0xbf6a09a7becf7bca,0xbf1ff6cb3f47de65,0xbf660f88bee0924f
.quad 0xbf2267993f45e403,0xbf61c598bef15aea,0xbf24d2253f43e200,0xbf5d2d53bf00e7e4,0xbf2736563f41d870,0xbf584853bf08f59b,0xbf2994153f3fc767,0xbf531849bf10d3cd
.quad 0xbf2beb4a3f3daef9,0xbf4d9f02bf187fc0,0xbf2e3bde3f3b8f3b,0xbf47de65bf1ff6cb,0xbf3085bb3f396842,0xbf41d870bf273656,0xbf32c8c93f373a23,0xbf3b8f3bbf2e3bde
.quad 0xbef15aeabf61c598,0x3f226799bf45e403,0xbed8106bbf6816a8,0x3f31a81dbf385216,0xbebe1d4abf6db293,0x3f3fc767bf299415,0xbea395c5bf7294f8,0x3f4cae79bf19c200
.quad 0xbe888e93bf76ba07,0x3f584853bf08f59b,0xbe5a3997bf7a1e84,0x3f628210beee9479,0xbe22abb6bf7cbfc9,0x3f6b4b0cbec9b953,0xbdd53db9bf7e9bc9,0x3f7294f8bea395c5
.quad 0xbd48fb30bf7fb10f,0x3f7853f8be78cfcc,0x3bc90f88bf7ffec4,0x3f7c7eb0be28defc,0x3d7b2b74bf7f84ab,0x3f7f0e58bdafb680,0x3dee3876bf7e4323,0x3f7ffec4bbc90f88
.quad 0x3e2f10a2bf7c3b28,0x3f7f4e6d3d96a905,0x3e667c66bf796e4e,0x3f7cfe733e1c76de,0x3e8e9a22bf75dec6,0x3f7912983e6c9a7f,0x3ea986c4bf718f57,0x3f73913f3e9d9e78
.quad 0x3dc8bd36bf7ec46d,0x3f74fa0bbe94a031,0x3e28defcbf7c7eb0,0x3f7ac516be4dee60,0x3e6c9a7fbf791298,0x3f7e70b0bde1bc2e,0x3e97a117bf748422,0x3f7ff4e6bc96c9b6
.quad 0x3eb8442abf6ed89e,0x3f7f4e6d3d96a905,0x3ed8106bbf6816a8,0x3f7c7eb03e28defc,0x3ef6e0cbbf604621,0x3f778bc53e827dc0,0x3f0a48adbf577026,0x3f7080663eaf713a
.quad 0x3f187fc0bf4d9f02,0x3f676bd83edae880,0x3f26050abf42de29,0x3f5c61c73f0242b1,0x3f32c8c9bf373a23,0x3f4f7a1f3f15f6d9,0x3f3ebc1bbf2ac082,0x3f40d0da3f286605
.quad 0x3f49d112bf1d7fd1,0x3f3085bb3f396842,0x3f53fac3bf0f8784,0x3f1ebc123f48d8b3,0x3f5d2d53bf00e7e4,0x3f0b9a6b3f5695e5,0x3f655e0bbee363fa,0x3eee94793f628210
.quad 0xbe1640833f7d3aac,0xbf7853f83e78cfcc,0xbe195be03f7d1cdd,0xbf79f35e3e5d4b1a,0xbe1c76de3f7cfe73,0xbf7b61fc3e419b37,0xbe1f917b3f7cdf6c,0xbf7c9f8a3e25c58c
.quad 0xbe22abb63f7cbfc9,0xbf7dabcc3e09cf86,0xbe25c58c3f7c9f8a,0xbf7e868b3ddb7d37,0xbe28defc3f7c7eb0,0xbf7f2f9d3da3308c,0xbe2bf8043f7c5d3a,0xbf7fa6e33d55880e
.quad 0xbe2f10a23f7c3b28,0xbf7fec433cc90ab0,0xbe3228d43f7c187a,0xbf7fffb1bb490fc6,0xbe3540983f7bf531,0xbf7fe129bcfb49ba,0xbe3857ec3f7bd14d,0xbf7f90b1bd6ea038
.quad 0xbe3b6ecf3f7baccd,0xbf7f0e58bdafb680,0xbe3e853e3f7b87b2,0xbf7e5a38bde7fa9a,0xbe419b373f7b61fc,0xbf7d7474be1008b7,0xbe44b0b93f7b3bab,0xbf7c5d3abe2bf804
.quad 0xbf2beb4a3f3daef9,0xbf710908beac7cd4,0xbf2ecef73f3b0629,0xbf6d67a1bebf926f,0xbf31a81d3f385216,0xbf696591bed25a09,0xbf34768f3f3592e7,0xbf650479bee4cbfe
.quad 0xbf373a233f32c8c9,0xbf604621bef6e0cb,0xbf39f2ac3f2ff3e6,0xbf5b2c79bf044889,0xbf3ca0033f2d1469,0xbf55b993bf0cead0,0xbf3f41fc3f2a2a80,0xbf4fefa8bf1553b7
.quad 0xbf41d8703f273656,0xbf49d112bf1d7fd1,0xbf4463373f24381a,0xbf436051bf256bcb,0xbf46e22a3f212ff9,0xbf3ca003bf2d1469,0xbf4955213f1e1e22,0xbf3592e7bf34768f
.quad 0xbf4bbbf83f1b02c6,0xbf2e3bdebf3b8f3b,0xbf4e16893f17de12,0xbf269de3bf425b89,0xbf5064af3f14b039,0xbf1ebc12bf48d8b3,0xbf52a6493f11796b,0xbf16999fbf4f0417
.quad 0xbeac7cd4bf710908,0x3f3daef9bf2beb4a,0xbe901c2cbf75a67b,0x3f4b41fabf1ba299,0xbe667c66bf796e4e,0x3f577026bf0a48ad,0xbe2bf804bf7c5d3a,0x3f62241abeeff7fb
.quad 0xbde1bc2ebf7e70b0,0x3f6b4b0cbec9b953,0xbd55880ebf7fa6e3,0x3f72d4ebbea21887,0x3bc90f88bf7ffec4,0x3f78b47bbe72b651,0x3d83db0abf7f7808,0x3f7cdf6cbe1f917b
.quad 0x3dfab273bf7e1324,0x3f7f4e6dbd96a905,0x3e3857ecbf7bd14d,0x3f7ffd393c16cb58,0x3e72b651bf78b47b,0x3f7eea9d3dbc3ac3,0x3e9620d2bf74bf62,0x3f7c187a3e3228d4
.quad 0x3eb263efbf6ff573,0x3f778bc53e827dc0,0x3ece0beabf6a5ad9,0x3f714c7a3eab0201,0x3ee900b7bf63f473,0x3f6965913ed25a09,0x3f019573bf5cc7d1,0x3f5fe4e93ef840c8
.quad 0x3e78cfccbf7853f8,0x3f7d3aacbe164083,0x3e9f1cdfbf73530e,0x3f7fa6e3bd55880e,0x3ec1071ebf6d1c1d,0x3f7fc38f3d2fe007,0x3ee1fb6abf65b710,0x3f7d906e3e0cec4a
.quad 0x3f00e7e4bf5d2d53,0x3f7912983e6c9a7f,0x3f102dd5bf5389c7,0x3f7254703ea5129f,0x3f1ebc12bf48d8b3,0x3f6965913ed25a09,0x3f2c800fbf3d27b8,0x3f5e5aa63efdbabb
.quad 0x3f396842bf3085bb,0x3f514d3d3f13682a,0x3f456439bf2302d3,0x3f425b893f269de3,0x3f5064afbf14b039,0x3f31a81d3f385216,0x3f5a5ba0bf05a02c,0x3f1f599f3f485bca
.quad 0x3f633c5abeebcbbb,0x3f0b9a6b3f5695e5,0x3f6afb8cbecb2aae,0x3eed30633f62df7b,0x3f718f57bea986c4,0x3ec1071e3f6d1c1d,0x3f76ef5bbe870ada,0x3e931f353f75341d
.quad 0xbe94a0313f74fa0b,0xbf7ec46d3dc8bd36,0xbe97a1173f748422,0xbf7f6ac73d8a200a,0xbe9aa0863f740bdd,0xbf7fd3973d16c32c,0xbe9d9e783f73913f,0xbf7ffec43bc90f88
.quad 0xbea09ae53f731447,0xbf7fec43bcc90ab0,0xbea395c53f7294f8,0xbf7f9c18bd621469,0xbea68f123f721352,0xbf7f0e58bdafb680,0xbea986c43f718f57,0xbf7e4323bdee3876
.quad 0xbeac7cd43f710908,0xbf7d3aacbe164083,0xbeaf713a3f708066,0xbf7bf531be354098,0xbeb263ef3f6ff573,0xbf7a7302be541501,0xbeb554ec3f6f6830,0xbf78b47bbe72b651
.quad 0xbeb8442a3f6ed89e,0xbf76ba07be888e93,0xbebb31a03f6e46be,0xbf748422be97a117,0xbebe1d4a3f6db293,0xbf721352bea68f12,0xbec1071e3f6d1c1d,0xbf6f6830beb554ec
.quad 0xbf45e4033f226799,0xbf61c598bef15aea,0xbf48d8b33f1ebc12,0xbf5c61c7bf0242b1,0xbf4bbbf83f1b02c6,0xbf5695e5bf0b9a6b,0xbf4e8d903f173c07,0xbf5064afbf14b039
.quad 0xbf514d3d3f13682a,0xbf49d112bf1d7fd1,0xbf53fac33f0f8784,0xbf42de29bf26050a,0xbf5695e53f0b9a6b,0xbf3b8f3bbf2e3bde,0xbf591e6a3f07a136,0xbf33e7bcbf36206c
.quad 0xbf5b941a3f039c3d,0xbf2beb4abf3daef9,0xbf5df6be3eff17b2,0xbf239da9bf44e3f5,0xbf6046213ef6e0cb,0xbf1b02c6bf4bbbf8,0xbf6282103eee9479,0xbf121eb0bf5233c6
.quad 0xbf64aa593ee63375,0xbf08f59bbf584853,0xbf66becc3eddbe79,0xbeff17b2bf5df6be,0xbf68bf3c3ed53641,0xbeebcbbbbf633c5a,0xbf6aab7b3ecc9b8b,0xbed8106bbf6816a8
.quad 0xbf3504f3bf3504f3,0x3ec3ef15bf6c835e,0xbf2beb4abf3daef9,0x3ee63375bf64aa59,0xbf226799bf45e403,0x3f039c3dbf5b941a,0xbf187fc0bf4d9f02,0x3f13682abf514d3d
.quad 0xbf0e39dabf54db31,0x3f226799bf45e403,0xbf039c3dbf5b941a,0x3f3085bbbf396842,0xbef15aeabf61c598,0x3f3daef9bf2beb4a,0xbedae880bf676bd8,0x3f49d112bf1d7fd1
.quad 0xbec3ef15bf6c835e,0x3f54db31bf0e39da,0xbeac7cd4bf710908,0x3f5ebe05befc5d27,0xbe94a031bf74fa0b,0x3f676bd8bedae880,0xbe78cfccbf7853f8,0x3f6ed89ebeb8442a
.quad 0xbe47c5c2bf7b14be,0x3f74fa0bbe94a031,0xbe164083bf7d3aac,0x3f79c79dbe605c13,0xbdc8bd36bf7ec46d,0x3f7d3aacbe164083,0xbd48fb30bf7fb10f,0x3f7f4e6dbd96a905
.quad 0xbe47c5c2bf7b14be,0x3f54db31bf0e39da,0xbe09cf86bf7dabcc,0x3f604621bef6e0cb,0xbd96a905bf7f4e6d,0x3f6a09a7becf7bca,0xbc490e90bf7ffb11,0x3f721352bea68f12
.quad 0x3d48fb30bf7fb10f,0x3f7853f8be78cfcc,0x3de1bc2ebf7e70b0,0x3f7cbfc9be22abb6,0x3e2f10a2bf7c3b28,0x3f7f4e6dbd96a905,0x3e6c9a7fbf791298,0x3f7ffb113c490e90
.quad 0x3e94a031bf74fa0b,0x3f7ec46d3dc8bd36,0x3eb263efbf6ff573,0x3f7baccd3e3b6ecf,0x3ecf7bcabf6a09a7,0x3f76ba073e888e93,0x3eebcbbbbf633c5a,0x3f6ff5733eb263ef
.quad 0x3f039c3dbf5b941a,0x3f676bd83edae880,0x3f10d3cdbf531849,0x3f5d2d533f00e7e4,0x3f1d7fd1bf49d112,0x3f514d3d3f13682a,0x3f299415bf3fc767,0x3f43e2003f24d225
.quad 0xbedae8803f676bd8,0xbf7fb10fbd48fb30,0xbedf28a93f666771,0xbf7f1f49bda973ba,0xbee363fa3f655e0b,0xbf7e4323bdee3876,0xbee79a5d3f644fac,0xbf7d1cddbe195be0
.quad 0xbeebcbbb3f633c5a,0xbf7baccdbe3b6ecf,0xbeeff7fb3f62241a,0xbf79f35ebe5d4b1a,0xbef41f073f6106f2,0xbf77f110be7ee6e1,0xbef840c83f5fe4e9,0xbf75a67bbe901c2c
.quad 0xbefc5d273f5ebe05,0xbf731447bea09ae5,0xbf003a063f5d924d,0xbf703b37beb0eacb,0xbf0242b13f5c61c7,0xbf6d1c1dbec1071e,0xbf0448893f5b2c79,0xbf69b7e4bed0eb2a
.quad 0xbf064b823f59f26a,0xbf660f88bee0924f,0xbf084b923f58b3a1,0xbf62241abeeff7fb,0xbf0a48ad3f577026,0xbf5df6bebeff17b2,0xbf0c42c93f5627fe,0xbf5988adbf06f686
.quad 0xbf5b941a3f039c3d,0xbf4d9f02bf187fc0,0xbf5e5aa63efdbabb,0xbf466354bf21cbfb,0xbf6106f23ef41f07,0xbf3ebc1bbf2ac082,0xbf6398ac3eea6681,0xbf36ad7fbf33587a
.quad 0xbf660f883ee0924f,0xbf2e3bdebf3b8f3b,0xbf686b393ed6a399,0xbf256bcbbf436051,0xbf6aab7b3ecc9b8b,0xbf1c420cbf4ac77f,0xbf6cd0073ec27b55,0xbf12c39abf51c0c2
.quad 0xbf6ed89e3eb8442a,0xbf08f59bbf584853,0xbf70c5013eadf73c,0xbefdbabbbf5e5aa6,0xbf7294f83ea395c5,0xbee900b7bf63f473,0xbf74484b3e9920fe,0xbed3c867bf6912ae
.quad 0xbf75dec63e8e9a22,0xbebe1d4abf6db293,0xbf77583a3e840270,0xbea80b1fbf71d19f,0xbf78b47b3e72b651,0xbe919dddbf756d97,0xbf79f35e3e5d4b1a,0xbe75c35abf788486
.quad 0xbf187fc0bf4d9f02,0x3f039c3dbf5b941a,0xbf0d9281bf554aa4,0x3f140c5fbf50d937,0xbf0242b1bf5c61c7,0x3f239da9bf44e3f5,0xbeed3063bf62df7b,0x3f3238aabf37c655
.quad 0xbed53641bf68bf3c,0x3f3fc767bf299415,0xbebca7afbf6dfcf2,0x3f4c3578bf1a6293,0xbea395c5bf7294f8,0x3f577026bf0a48ad,0xbe8a11f7bf76841b,0x3f61668abef2bd43
.quad 0xbe605c13bf79c79d,0x3f6a09a7becf7bca,0xbe2bf804bf7c5d3a,0x3f714c7abeab0201,0xbdee3876bf7e4323,0x3f772417be8586ce,0xbd83db0abf7f7808,0x3f7b87b2be3e853e
.quad 0xbc490e90bf7ffb11,0x3f7e70b0bde1bc2e,0x3d2351cbbf7fcbe2,0x3f7fdaafbd0a342f,0x3dbc3ac3bf7eea9d,0x3f7fc38f3d2fe007,0x3e1324cabf7d57de,0x3f7e2b723df475c0
.quad 0xbd48fb30bf7fb10f,0x3f676bd8bedae880,0x3c7b514bbf7ff84a,0x3f703b37beb0eacb,0x3da3308cbf7f2f9d,0x3f772417be8586ce,0x3e1324cabf7d57de,0x3f7c187abe3228d4
.quad 0x3e541501bf7a7302,0x3f7f0e58bdafb680,0x3e8a11f7bf76841b,0x3f7fffb13b490fc6,0x3ea986c4bf718f57,0x3f7eea9d3dbc3ac3,0x3ec8477cbf6b99fb,0x3f7bd14d3e3857ec
.quad 0x3ee63375bf64aa59,0x3f76ba073e888e93,0x3f019573bf5cc7d1,0x3f6faf1b3eb3dca5,0x3f0f8784bf53fac3,0x3f66becc3eddbe79,0x3f1ce11fbf4a4c87,0x3f5bfb343f02ef9f
.quad 0x3f299415bf3fc767,0x3f4f7a1f3f15f6d9,0x3f3592e7bf34768f,0x3f4154e13f27ce61,0x3f40d0dabf286605,0x3f31a81d3f385216,0x3f4b41fabf1ba299,0x3f2093933f476085
.quad 0x3a000000,0x3a000000,0x39ec835e3943ef15,0x39eed89e3938442a,0x3896408339fd3aac,0x38995be039fd1cdd,0x39f853f838f8cfcc,0x39f9f35e38dd4b1a
.quad 0x398e39da39d4db31,0x3990d3cd39d31849,0x39fb14beb8c7c5c2,0x39f91298b8ec9a7f,0x39abeb4a39bdaef9,0x39aecef739bb0629,0x39f10908b92c7cd4,0x39ed67a1b93f926f
.quad 0x39715aeab9e1c598,0x3958106bb9e816a8,0xb9a26799b9c5e403,0xb9b1a81db9b85216,0x392c7cd4b9f10908,0x39101c2cb9f5a67b,0xb9bdaef9b9abeb4a,0xb9cb41fab99ba299
.quad 0xb848bd36b9fec46d,0xb8a8defcb9fc7eb0,0xb9f4fa0bb914a031,0xb9fac516b8cdee60,0xb8f8cfccb9f853f8,0xb91f1cdfb9f3530e,0xb9fd3aacb8964083,0xb9ffa6e3b7d5880e
.quad 0x3a000000,0x3a000000,0x39f4fa0b3914a031,0x39f6ba0739088e93,0x38a2abb639fcbfc9,0x38a5c58c39fc9f8a,0x39fdabcc3889cf86,0x39fe868b385b7d37
.quad 0x39987fc039cd9f02,0x399b02c639cbbbf8,0x39f10908b92c7cd4,0x39edb293b93e1d4a,0x39b73a2339b2c8c9,0x39b9f2ac39aff3e6,0x39e04621b976e0cb,0x39db2c79b9844889
.quad 0x39088e93b9f6ba07,0x38da3997b9fa1e84,0xb9d84853b988f59b,0xb9e28210b96e9479,0x3861bc2eb9fe70b0,0x37d5880eb9ffa6e3,0xb9eb4b0cb949b953,0xb9f2d4ebb9221887
.quad 0xb938442ab9eed89e,0xb958106bb9e816a8,0xb9ff4e6d3816a905,0xb9fc7eb038a8defc,0xb980e7e4b9dd2d53,0xb9902dd5b9d389c7,0xb9f9129838ec9a7f,0xb9f254703925129f
.quad 0x3a000000,0x3a000000,0x39fb14be38c7c5c2,0x39fc3b2838af10a2,0x38af10a239fc3b28,0x38b228d439fc187a,0x39ffec4337490ab0,0x39ffffb1b5c90fc6
.quad 0x39a2679939c5e403,0x39a4d22539c3e200,0x39e1c598b9715aea,0x39dd2d53b980e7e4,0x39c1d87039a73656,0x39c4633739a4381a,0x39c9d112b99d7fd1,0x39c36051b9a56bcb
.quad 0x37c8fb30b9ffb10f,0xb6490f88b9fffec4,0xb9f853f8b8f8cfcc,0xb9fc7eb0b8a8defc,0xb87ab273b9fe1324,0xb8b857ecb9fbd14d,0xb9ff4e6db816a905,0xb9fffd393696cb58
.quad 0xb9987fc0b9cd9f02,0xb9a6050ab9c2de29,0xb9e76bd8395ae880,0xb9dc61c7398242b1,0xb9b96842b9b085bb,0xb9c56439b9a302d3,0xb9d14d3d3993682a,0xb9c25b8939a69de3
.quad 0x3a000000,0x3a000000,0x39fec46d3848bd36,0x39ff4e6d3816a905,0x38bb6ecf39fbaccd,0x38be853e39fb87b2,0x39ff0e58b82fb680,0x39fe5a38b867fa9a
.quad 0x39abeb4a39bdaef9,0x39ae3bde39bb8f3b,0x39cd9f02b9987fc0,0x39c7de65b99ff6cb,0x39cbbbf8399b02c6,0x39ce16893997de12,0x39ae3bdeb9bb8f3b,0x39a69de3b9c25b89
.quad 0xb8af10a2b9fc3b28,0xb8e67c66b9f96e4e,0xb9ff4e6d3816a905,0xb9fcfe73389c76de,0xb93263efb9eff573,0xb94e0beab9ea5ad9,0xb9f78bc539027dc0,0xb9f14c7a392b0201
.quad 0xb9c9d112b99d7fd1,0xb9d3fac3b98f8784,0xb9b085bb39b96842,0xb99ebc1239c8d8b3,0xb9e33c5ab96bcbbb,0xb9eafb8cb94b2aae,0xb98b9a6b39d695e5,0xb96d306339e2df7b
.quad 0x3a000000,0x3a000000,0x39f10908392c7cd4,0x39f3144739209ae5,0x389c76de39fcfe73,0x389f917b39fcdf6c,0x39fb61fc38c19b37,0x39fc9f8a38a5c58c
.quad 0x3993682a39d14d3d,0x3995f6d939cf7a1f,0x39f6ba07b9088e93,0x39f40bddb91aa086,0x39b1a81d39b85216,0x39b4768f39b592e7,0x39e96591b9525a09,0x39e50479b964cbfe
.quad 0x393e1d4ab9edb293,0x392395c5b9f294f8,0xb9bfc767b9a99415,0xb9ccae79b999c200,0x38e67c66b9f96e4e,0x38abf804b9fc5d3a,0xb9d77026b98a48ad,0xb9e2241ab96ff7fb
.quad 0xb8ec9a7fb9f91298,0xb917a117b9f48422,0xb9fe70b0b861bc2e,0xb9fff4e6b716c9b6,0xb941071eb9ed1c1d,0xb961fb6ab9e5b710,0xb9ffc38f37afe007,0xb9fd906e388cec4a
.quad 0x3a000000,0x3a000000,0x39f853f838f8cfcc,0x39f9c79d38e05c13,0x38a8defc39fc7eb0,0x38abf80439fc5d3a,0x39ff2f9d3823308c,0x39ffa6e337d5880e
.quad 0x399d7fd139c9d112,0x399ff6cb39c7de65,0x39ea09a7b94f7bca,0x39e60f88b960924f,0x39bca00339ad1469,0x39bf41fc39aa2a80,0x39d5b993b98cead0,0x39cfefa8b99553b7
.quad 0x38a2abb6b9fcbfc9,0x38553db9b9fe9bc9,0xb9eb4b0cb949b953,0xb9f294f8b92395c5,0xb6490f88b9fffec4,0xb803db0ab9ff7808,0xb9f8b47bb8f2b651,0xb9fcdf6cb89f917b
.quad 0xb976e0cbb9e04621,0xb98a48adb9d77026,0xb9f78bc539027dc0,0xb9f08066392f713a,0xb99ebc12b9c8d8b3,0xb9ac800fb9bd27b8,0xb9e9659139525a09,0xb9de5aa6397dbabb
.quad 0x3a000000,0x3a000000,0x39fd3aac38964083,0x39fe1324387ab273,0x38b5409839fbf531,0x38b857ec39fbd14d,0x39ffe129b77b49ba,0x39ff90b1b7eea038
.quad 0x39a7365639c1d870,0x39a9941539bfc767,0x39d84853b988f59b,0x39d31849b990d3cd,0x39c6e22a39a12ff9,0x39c95521399e1e22,0x39bca003b9ad1469,0x39b592e7b9b4768f
.quad 0xb7fb2b74b9ff84ab,0xb86e3876b9fe4323,0xb9ff0e58b82fb680,0xb9fffec4b6490f88,0xb8f2b651b9f8b47b,0xb91620d2b9f4bf62,0xb9feea9d383c3ac3,0xb9fc187a38b228d4
.quad 0xb9b2c8c9b9b73a23,0xb9bebc1bb9aac082,0xb9cf7a1f3995f6d9,0xb9c0d0da39a86605,0xb9d064afb994b039,0xb9da5ba0b985a02c,0xb9b1a81d39b85216,0xb99f599f39c85bca
.quad 0x3a000000,0x3a000000,0x39ffb10f37c8fb30,0x39ffec4337490ab0,0x38c19b3739fb61fc,0x38c4b0b939fb3bab,0x39fd7474b89008b7,0x39fc5d3ab8abf804
.quad 0x39b085bb39b96842,0x39b2c8c939b73a23,0x39c1d870b9a73656,0x39bb8f3bb9ae3bde,0x39d064af3994b039,0x39d2a6493991796b,0x399ebc12b9c8d8b3,0x3996999fb9cf0417
.quad 0xb90e9a22b9f5dec6,0xb92986c4b9f18f57,0xb9f9129838ec9a7f,0xb9f3913f391d9e78,0xb96900b7b9e3f473,0xb9819573b9dcc7d1,0xb9e9659139525a09,0xb9dfe4e9397840c8
.quad 0xb9dd2d53b980e7e4,0xb9e55e0bb96363fa,0xb98b9a6b39d695e5,0xb96e947939e28210,0xb9f18f57b92986c4,0xb9f6ef5bb9070ada,0xb941071e39ed1c1d,0xb9131f3539f5341d
.quad 0x3914a03139f4fa0b,0x3917a11739f48422,0x39fec46d3848bd36,0x39ff6ac7380a200a,0x395ae88039e76bd8,0x395f28a939e66771,0x39ffb10fb7c8fb30,0x39ff1f49b82973ba
.quad 0x39c5e40339a26799,0x39c8d8b3399ebc12,0x39e1c598b9715aea,0x39dc61c7b98242b1,0x39db941a39839c3d,0x39de5aa6397dbabb,0x39cd9f02b9987fc0,0x39c66354b9a1cbfb
.quad 0x39b504f3b9b504f3,0x39abeb4ab9bdaef9,0xb943ef15b9ec835e,0xb9663375b9e4aa59,0x39987fc0b9cd9f02,0x398d9281b9d54aa4,0xb9839c3db9db941a,0xb9940c5fb9d0d937
.quad 0x38c7c5c2b9fb14be,0x3889cf86b9fdabcc,0xb9d4db31b98e39da,0xb9e04621b976e0cb,0x37c8fb30b9ffb10f,0xb6fb514bb9fff84a,0xb9e76bd8b95ae880,0xb9f03b37b930eacb
.quad 0x39209ae539f31447,0x392395c539f294f8,0x39ffec43b7490ab0,0x39ff9c18b7e21469,0x396bcbbb39e33c5a,0x396ff7fb39e2241a,0x39fbaccdb8bb6ecf,0x39f9f35eb8dd4b1a
.quad 0x39d14d3d3993682a,0x39d3fac3398f8784,0x39c9d112b99d7fd1,0x39c2de29b9a6050a,0x39e60f883960924f,0x39e86b393956a399,0x39ae3bdeb9bb8f3b,0x39a56bcbb9c36051
.quad 0x398e39dab9d4db31,0x39839c3db9db941a,0xb9a26799b9c5e403,0xb9b085bbb9b96842,0x39553641b9e8bf3c,0x393ca7afb9edfcf2,0xb9bfc767b9a99415,0xb9cc3578b99a6293
.quad 0xb7c8fb30b9ffb10f,0xb861bc2eb9fe70b0,0xb9f853f8b8f8cfcc,0xb9fcbfc9b8a2abb6,0xb8d41501b9fa7302,0xb90a11f7b9f6841b,0xb9ff0e58b82fb680,0xb9ffffb135c90fc6
.quad 0x392c7cd439f10908,0x392f713a39f08066,0x39fd3aacb8964083,0x39fbf531b8b54098,0x397c5d2739debe05,0x39803a0639dd924d,0x39f31447b9209ae5,0x39f03b37b930eacb
.quad 0x39db941a39839c3d,0x39ddf6be397f17b2,0x39abeb4ab9bdaef9,0x39a39da9b9c4e3f5,0x39eed89e3938442a,0x39f0c501392df73c,0x3988f59bb9d84853,0x397dbabbb9de5aa6
.quad 0x3943ef15b9ec835e,0x392c7cd4b9f10908,0xb9d4db31b98e39da,0xb9debe05b97c5d27,0x38e05c13b9f9c79d,0x38abf804b9fc5d3a,0xb9ea09a7b94f7bca,0xb9f14c7ab92b0201
.quad 0xb914a031b9f4fa0b,0xb93263efb9eff573,0xb9fec46d3848bd36,0xb9fbaccd38bb6ecf,0xb9663375b9e4aa59,0xb9819573b9dcc7d1,0xb9f6ba0739088e93,0xb9efaf1b3933dca5
.quad 0x3938442a39eed89e,0x393b31a039ee46be,0x39f6ba07b9088e93,0x39f48422b917a117,0x39864b8239d9f26a,0x39884b9239d8b3a1,0x39e60f88b960924f,0x39e2241ab96ff7fb
.quad 0x39e4aa5939663375,0x39e6becc395dbe79,0x3988f59bb9d84853,0x397f17b2b9ddf6be,0x39f5dec6390e9a22,0x39f7583a39040270,0x393e1d4ab9edb293,0x39280b1fb9f1d19f
.quad 0x38c7c5c2b9fb14be,0x38964083b9fd3aac,0xb9f4fa0bb914a031,0xb9f9c79db8e05c13,0x36c90e90b9fffb11,0xb7a351cbb9ffcbe2,0xb9fe70b0b861bc2e,0xb9ffdaafb78a342f
.quad 0xb9839c3db9db941a,0xb990d3cdb9d31849,0xb9e76bd8395ae880,0xb9dd2d533980e7e4,0xb9a99415b9bfc767,0xb9b592e7b9b4768f,0xb9cf7a1f3995f6d9,0xb9c154e139a7ce61
.quad 0x391aa08639f40bdd,0x391d9e7839f3913f,0x39ffd3973796c32c,0x39fffec436490f88,0x396363fa39e55e0b,0x39679a5d39e44fac,0x39fe4323b86e3876,0x39fd1cddb8995be0
.quad 0x39cbbbf8399b02c6,0x39ce8d9039973c07,0x39d695e5b98b9a6b,0x39d064afb994b039,0x39e106f239741f07,0x39e398ac396a6681,0x39bebc1bb9aac082,0x39b6ad7fb9b3587a
.quad 0x39a26799b9c5e403,0x39987fc0b9cd9f02,0xb9839c3db9db941a,0xb993682ab9d14d3d,0x398242b1b9dc61c7,0x396d3063b9e2df7b,0xb9a39da9b9c4e3f5,0xb9b238aab9b7c655
.quad 0x3816a905b9ff4e6d,0x36c90e90b9fffb11,0xb9ea09a7b94f7bca,0xb9f21352b9268f12,0xb823308cb9ff2f9d,0xb89324cab9fd57de,0xb9f72417b90586ce,0xb9fc187ab8b228d4
.quad 0x39268f1239f21352,0x392986c439f18f57,0x39ff0e58b82fb680,0x39fe4323b86e3876,0x39741f0739e106f2,0x397840c839dfe4e9,0x39f7f110b8fee6e1,0x39f5a67bb9101c2c
.quad 0x39d695e5398b9a6b,0x39d91e6a3987a136,0x39bb8f3bb9ae3bde,0x39b3e7bcb9b6206c,0x39eaab7b394c9b8b,0x39ecd00739427b55,0x399c420cb9cac77f,0x3992c39ab9d1c0c2
.quad 0x39715aeab9e1c598,0x395ae880b9e76bd8,0xb9bdaef9b9abeb4a,0xb9c9d112b99d7fd1,0x392395c5b9f294f8,0x390a11f7b9f6841b,0xb9d77026b98a48ad,0xb9e1668ab972bd43
.quad 0xb8af10a2b9fc3b28,0xb8ec9a7fb9f91298,0xb9ff4e6db816a905,0xb9fffb1136c90e90,0xb92986c4b9f18f57,0xb948477cb9eb99fb,0xb9feea9d383c3ac3,0xb9fbd14d38b857ec
.quad 0x393263ef39eff573,0x393554ec39ef6830,0x39fa7302b8d41501,0x39f8b47bb8f2b651,0x398242b139dc61c7,0x3984488939db2c79,0x39ed1c1db941071e,0x39e9b7e4b950eb2a
.quad 0x39e046213976e0cb,0x39e28210396e9479,0x399b02c6b9cbbbf8,0x39921eb0b9d233c6,0x39f294f8392395c5,0x39f4484b391920fe,0x396900b7b9e3f473,0x3953c867b9e912ae
.quad 0x3914a031b9f4fa0b,0x38f8cfccb9f853f8,0xb9e76bd8b95ae880,0xb9eed89eb938442a,0x386e3876b9fe4323,0x3803db0ab9ff7808,0xb9f72417b90586ce,0xb9fb87b2b8be853e
.quad 0xb94f7bcab9ea09a7,0xb96bcbbbb9e33c5a,0xb9f6ba0739088e93,0xb9eff573393263ef,0xb98f8784b9d3fac3,0xb99ce11fb9ca4c87,0xb9e6becc395dbe79,0xb9dbfb343982ef9f
.quad 0x393e1d4a39edb293,0x3941071e39ed1c1d,0x39f21352b9268f12,0x39ef6830b93554ec,0x398a48ad39d77026,0x398c42c939d627fe,0x39ddf6beb97f17b2,0x39d988adb986f686
.quad 0x39e8bf3c39553641,0x39eaab7b394c9b8b,0x396bcbbbb9e33c5a,0x3958106bb9e816a8,0x39f8b47b38f2b651,0x39f9f35e38dd4b1a,0x39119dddb9f56d97,0x38f5c35ab9f88486
.quad 0x3848bd36b9fec46d,0x37c8fb30b9ffb10f,0xb9fd3aacb8964083,0xb9ff4e6db816a905,0xb83c3ac3b9feea9d,0xb89324cab9fd57de,0xb9ffc38f37afe007,0xb9fe2b72387475c0
.quad 0xb99d7fd1b9c9d112,0xb9a99415b9bfc767,0xb9d14d3d3993682a,0xb9c3e20039a4d225,0xb9c0d0dab9a86605,0xb9cb41fab99ba299,0xb9b1a81d39b85216,0xb9a0939339c76085
.quad 0x3f803f803f803f80,0x3f803f803f803f80,0x248d248d3f803f80,0xa554a554bf80bf80,0xbe483f7b248d3f80,0xbf0e3f55bec43f6d,0xbf7bbe48248d3f80,0x3f553f0e3ec4bf6d
.quad 0x3f353f353f803f80,0xbf35bf35248d248d,0xbf35bf353f803f80,0x3f353f35a554a554,0xbf553f0e248d3f80,0xbe48bf7bbf6dbec4,0xbf0ebf55248d3f80,0xbf7b3e483f6d3ec4
.quad 0x3f6dbf6dbf803f80,0x3ec4bec4bf353f35,0xbec43ec4bf803f80,0x3f6dbf6d3f35bf35,0xbf0ebf55a5543f80,0xbf7b3e483f6d3ec4,0xbf553f0ea5543f80,0xbe48bf7bbf6dbec4
.quad 0x3ec4bec4bf803f80,0xbf6d3f6d3f35bf35,0xbf6d3f6dbf803f80,0xbec43ec4bf353f35,0xbf7bbe48a5543f80,0x3f553f0e3ec4bf6d,0xbe483f7ba5543f80,0xbf0e3f55bec43f6d
.quad 0x3f803f803f803f80,0x3f803f803f803f80,0x248d248d3f803f80,0xa554a554bf80bf80,0xbf553f0ebf353f35,0xbf7b3e48bf6d3ec4,0xbf0ebf55bf353f35,0x3e483f7b3f6dbec4
.quad 0xbf35bf35bf80bf80,0x3f353f35a554a554,0x3f353f35bf80bf80,0xbf35bf35248d248d,0x3f7b3e483f35bf35,0xbf0e3f553ec43f6d,0xbe483f7b3f35bf35,0x3f553f0ebec4bf6d
.quad 0xbec43ec4a554248d,0xbf6d3f6d3f35bf35,0xbf6d3f6da554248d,0x3ec4bec4bf353f35,0xbe483f7b3f35bf35,0x3f553f0ebec4bf6d,0x3f7b3e483f35bf35,0xbf0e3f553ec43f6d
.quad 0x3f6dbf6d248da554,0xbec43ec4bf353f35,0x3ec4bec4248da554,0x3f6dbf6d3f35bf35,0xbf0ebf55bf353f35,0x3e483f7b3f6dbec4,0xbf553f0ebf353f35,0xbf7b3e48bf6d3ec4
.quad 0x3f803f803f803f80,0x3f803f803f803f80,0xa554a554bf80bf80,0x248d248d3f803f80,0x3f0ebf553ec4bf6d,0x3e48bf7ba554bf80,0xbf55bf0ebec43f6d,0x3f7b3e48a554bf80
.quad 0xbf35bf35248d248d,0x3f353f353f803f80,0x3f353f35a554a554,0xbf35bf353f803f80,0x3e483f7b3f6d3ec4,0x3f55bf0ea554bf80,0x3f7bbe48bf6dbec4,0x3f0e3f55a554bf80
.quad 0x3ec4bec4bf353f35,0x3f6dbf6dbf803f80,0x3f6dbf6d3f35bf35,0xbec43ec4bf803f80,0x3f7bbe48bf6dbec4,0x3f0e3f55248dbf80,0x3e483f7b3f6d3ec4,0x3f55bf0e248dbf80
.quad 0xbf6d3f6d3f35bf35,0x3ec4bec4bf803f80,0xbec43ec4bf353f35,0xbf6d3f6dbf803f80,0xbf55bf0ebec43f6d,0x3f7b3e48248dbf80,0x3f0ebf553ec4bf6d,0x3e48bf7b248dbf80
.quad 0x3f803f803f803f80,0x3f803f803f803f80,0xa554a554bf80bf80,0x248d248d3f803f80,0x3f7bbe483f6dbec4,0x3f55bf0e3f35bf35,0xbe48bf7bbf6d3ec4,0x3f0e3f553f35bf35
.quad 0x3f353f35a554a554,0xbf35bf35bf80bf80,0xbf35bf35248d248d,0x3f353f35bf80bf80,0x3f0ebf55bec4bf6d,0xbf7bbe48bf353f35,0xbf55bf0e3ec43f6d,0x3e48bf7bbf353f35
.quad 0xbf6d3f6d3f35bf35,0xbec43ec4a554248d,0x3ec4bec4bf353f35,0xbf6d3f6da554248d,0xbf55bf0e3ec43f6d,0x3e48bf7bbf353f35,0x3f0ebf55bec4bf6d,0xbf7bbe48bf353f35
.quad 0xbec43ec4bf353f35,0x3f6dbf6d248da554,0x3f6dbf6d3f35bf35,0x3ec4bec4248da554,0xbe48bf7bbf6d3ec4,0x3f0e3f553f35bf35,0x3f7bbe483f6dbec4,0x3f55bf0e3f35bf35
.quad 0xbf6d3f6dbf803f80,0xbec43ec4bf353f35,0x3ec4bec4bf803f80,0xbf6d3f6d3f35bf35,0x3f0e3f55a5543f80,0x3f7bbe483f6d3ec4,0x3f55bf0ea5543f80,0x3e483f7bbf6dbec4
.quad 0xbec43ec4bf803f80,0x3f6dbf6d3f35bf35,0x3f6dbf6dbf803f80,0x3ec4bec4bf353f35,0x3f7b3e48a5543f80,0xbf55bf0e3ec4bf6d,0x3e48bf7ba5543f80,0x3f0ebf55bec43f6d
.quad 0xbf80bf803f803f80,0xbf80bf803f803f80,0xa554a5543f803f80,0x248d248dbf80bf80,0x3e48bf7b248d3f80,0x3f0ebf55bec43f6d,0x3f7b3e48248d3f80,0xbf55bf0e3ec4bf6d
.quad 0xbf35bf353f803f80,0x3f353f35248d248d,0x3f353f353f803f80,0xbf35bf35a554a554,0x3f55bf0e248d3f80,0x3e483f7bbf6dbec4,0x3f0e3f55248d3f80,0x3f7bbe483f6d3ec4
.quad 0x3ec4bec4a554248d,0x3f6dbf6d3f35bf35,0x3f6dbf6da554248d,0xbec43ec4bf353f35,0x3e48bf7b3f35bf35,0xbf55bf0ebec4bf6d,0xbf7bbe483f35bf35,0x3f0ebf553ec43f6d
.quad 0xbf6d3f6d248da554,0x3ec4bec4bf353f35,0xbec43ec4248da554,0xbf6d3f6d3f35bf35,0x3f0e3f55bf353f35,0xbe48bf7b3f6dbec4,0x3f55bf0ebf353f35,0x3f7bbe48bf6d3ec4
.quad 0xbf80bf803f803f80,0xbf80bf803f803f80,0xa554a5543f803f80,0x248d248dbf80bf80,0x3f55bf0ebf353f35,0x3f7bbe48bf6d3ec4,0x3f0e3f55bf353f35,0xbe48bf7b3f6dbec4
.quad 0x3f353f35bf80bf80,0xbf35bf35a554a554,0xbf35bf35bf80bf80,0x3f353f35248d248d,0xbf7bbe483f35bf35,0x3f0ebf553ec43f6d,0x3e48bf7b3f35bf35,0xbf55bf0ebec4bf6d
.quad 0xbec43ec4bf353f35,0xbf6d3f6dbf803f80,0xbf6d3f6d3f35bf35,0x3ec4bec4bf803f80,0xbf7b3e48bf6dbec4,0xbf0ebf55248dbf80,0xbe48bf7b3f6d3ec4,0xbf553f0e248dbf80
.quad 0x3f6dbf6d3f35bf35,0xbec43ec4bf803f80,0x3ec4bec4bf353f35,0x3f6dbf6dbf803f80,0x3f553f0ebec43f6d,0xbf7bbe48248dbf80,0xbf0e3f553ec4bf6d,0xbe483f7b248dbf80
.quad 0xbf80bf803f803f80,0xbf80bf803f803f80,0x248d248dbf80bf80,0xa554a5543f803f80,0xbf0e3f553ec4bf6d,0xbe483f7ba554bf80,0x3f553f0ebec43f6d,0xbf7bbe48a554bf80
.quad 0x3f353f35248d248d,0xbf35bf353f803f80,0xbf35bf35a554a554,0x3f353f353f803f80,0xbe48bf7b3f6d3ec4,0xbf553f0ea554bf80,0xbf7b3e48bf6dbec4,0xbf0ebf55a554bf80
.quad 0x3f6dbf6d3f35bf35,0x3ec4bec4a554248d,0xbec43ec4bf353f35,0x3f6dbf6da554248d,0x3f553f0e3ec43f6d,0xbe483f7bbf353f35,0xbf0e3f55bec4bf6d,0x3f7b3e48bf353f35
.quad 0x3ec4bec4bf353f35,0xbf6d3f6d248da554,0xbf6d3f6d3f35bf35,0xbec43ec4248da554,0x3e483f7bbf6d3ec4,0xbf0ebf553f35bf35,0xbf7b3e483f6dbec4,0xbf553f0e3f35bf35
.quad 0xbf80bf803f803f80,0xbf80bf803f803f80,0x248d248dbf80bf80,0xa554a5543f803f80,0xbf7b3e483f6dbec4,0xbf553f0e3f35bf35,0x3e483f7bbf6d3ec4,0xbf0ebf553f35bf35
.quad 0xbf35bf35a554a554,0x3f353f35bf80bf80,0x3f353f35248d248d,0xbf35bf35bf80bf80,0xbf0e3f55bec4bf6d,0x3f7b3e48bf353f35,0x3f553f0e3ec43f6d,0xbe483f7bbf353f35
.quad 0x0,0x0,0x3f803f8000000000,0xbf80bf80250d250d,0x3f7b3e483f800000,0x3f553f0e3f6d3ec4,0xbe483f7b3f800000,0x3f0ebf55bf6dbec4
.quad 0x3f353f3500000000,0x3f353f353f803f80,0x3f353f3500000000,0x3f353f35bf80bf80,0x3f0e3f553f800000,0xbf7b3e48bec43f6d,0xbf553f0e3f800000,0x3e483f7b3ec4bf6d
.quad 0x3ec4bec4250d0000,0x3f6dbf6dbf353f35,0x3f6dbf6d250d0000,0xbec43ec43f35bf35,0x3f55bf0ebf800000,0xbe48bf7bbec43f6d,0xbf0ebf55bf800000,0x3f7bbe483ec4bf6d
.quad 0x3f6dbf6d250d0000,0xbec43ec4bf353f35,0x3ec4bec4250d0000,0x3f6dbf6d3f35bf35,0x3e48bf7bbf800000,0xbf0e3f553f6d3ec4,0xbf7bbe48bf800000,0xbf55bf0ebf6dbec4
.quad 0x0,0x0,0x3f803f8000000000,0xbf80bf80250d250d,0x3f0e3f553f353f35,0x3e483f7b3ec43f6d,0xbf553f0e3f353f35,0x3f7bbe48bec4bf6d
.quad 0xbf35bf35250d250d,0xbf35bf35bf80bf80,0xbf35bf35250d250d,0xbf35bf353f803f80,0x3e48bf7bbf35bf35,0x3f553f0e3f6dbec4,0x3f7b3e48bf35bf35,0x3f0ebf55bf6d3ec4
.quad 0x3f6dbf6dbf803f80,0x3ec4bec4bf353f35,0xbec43ec4bf803f80,0x3f6dbf6d3f35bf35,0xbf7bbe483f353f35,0xbf0e3f553f6dbec4,0xbe483f7b3f353f35,0xbf55bf0ebf6d3ec4
.quad 0xbec43ec43f80bf80,0x3f6dbf6dbf353f35,0x3f6dbf6d3f80bf80,0x3ec4bec43f35bf35,0x3f55bf0ebf35bf35,0xbf7b3e483ec43f6d,0xbf0ebf55bf35bf35,0xbe48bf7bbec4bf6d
.quad 0x0,0x0,0xbf80bf80250d250d,0x3f803f8000000000,0xbf55bf0ebf6dbec4,0xbf7bbe48bf80250d,0xbf0e3f553f6d3ec4,0x3e48bf7bbf80250d
.quad 0x3f353f353f803f80,0x3f353f3500000000,0x3f353f35bf80bf80,0x3f353f3500000000,0x3f7bbe483ec4bf6d,0xbf0ebf55bf80250d,0xbe48bf7bbec43f6d,0x3f55bf0ebf80250d
.quad 0x3f6dbf6dbf353f35,0x3ec4bec4250d0000,0xbec43ec43f35bf35,0x3f6dbf6d250d0000,0x3e483f7b3ec4bf6d,0xbf553f0e3f80250d,0xbf7b3e48bec43f6d,0x3f0e3f553f80250d
.quad 0xbec43ec4bf353f35,0x3f6dbf6d250d0000,0x3f6dbf6d3f35bf35,0x3ec4bec4250d0000,0x3f0ebf55bf6dbec4,0xbe483f7b3f80250d,0x3f553f0e3f6d3ec4,0x3f7b3e483f80250d
.quad 0x0,0x0,0xbf80bf80250d250d,0x3f803f8000000000,0xbe48bf7bbec4bf6d,0xbf0ebf55bf35bf35,0xbf7b3e483ec43f6d,0x3f55bf0ebf35bf35
.quad 0xbf35bf35bf80bf80,0xbf35bf35250d250d,0xbf35bf353f803f80,0xbf35bf35250d250d,0xbf55bf0ebf6d3ec4,0xbe483f7b3f353f35,0xbf0e3f553f6dbec4,0xbf7bbe483f353f35
.quad 0x3ec4bec4bf353f35,0x3f6dbf6dbf803f80,0x3f6dbf6d3f35bf35,0xbec43ec4bf803f80,0x3f0ebf55bf6d3ec4,0x3f7b3e48bf35bf35,0x3f553f0e3f6dbec4,0x3e48bf7bbf35bf35
.quad 0x3f6dbf6dbf353f35,0xbec43ec43f80bf80,0x3ec4bec43f35bf35,0x3f6dbf6d3f80bf80,0x3f7bbe48bec4bf6d,0xbf553f0e3f353f35,0x3e483f7b3ec43f6d,0x3f0e3f553f353f35
.quad 0xbec43ec4250d0000,0xbf6d3f6dbf353f35,0xbf6d3f6d250d0000,0x3ec4bec43f35bf35,0xbf553f0ebf800000,0x3e483f7bbec43f6d,0x3f0e3f55bf800000,0xbf7b3e483ec4bf6d
.quad 0xbf6d3f6d250d0000,0x3ec4bec4bf353f35,0xbec43ec4250d0000,0xbf6d3f6d3f35bf35,0xbe483f7bbf800000,0x3f0ebf553f6d3ec4,0x3f7b3e48bf800000,0x3f553f0ebf6dbec4
.quad 0x250d250d00000000,0x250d250d00000000,0xbf80bf8000000000,0x3f803f80250d250d,0xbf7bbe483f800000,0xbf55bf0e3f6d3ec4,0x3e48bf7b3f800000,0xbf0e3f55bf6dbec4
.quad 0xbf35bf3500000000,0xbf35bf353f803f80,0xbf35bf3500000000,0xbf35bf35bf80bf80,0xbf0ebf553f800000,0x3f7bbe48bec43f6d,0x3f55bf0e3f800000,0xbe48bf7b3ec4bf6d
.quad 0xbf6d3f6dbf803f80,0xbec43ec4bf353f35,0x3ec4bec4bf803f80,0xbf6d3f6d3f35bf35,0x3f7b3e483f353f35,0x3f0ebf553f6dbec4,0x3e48bf7b3f353f35,0x3f553f0ebf6d3ec4
.quad 0x3ec4bec43f80bf80,0xbf6d3f6dbf353f35,0xbf6d3f6d3f80bf80,0xbec43ec43f35bf35,0xbf553f0ebf35bf35,0x3f7bbe483ec43f6d,0x3f0e3f55bf35bf35,0x3e483f7bbec4bf6d
.quad 0x250d250d00000000,0x250d250d00000000,0xbf80bf8000000000,0x3f803f80250d250d,0xbf0ebf553f353f35,0xbe48bf7b3ec43f6d,0x3f55bf0e3f353f35,0xbf7b3e48bec4bf6d
.quad 0x3f353f35250d250d,0x3f353f35bf80bf80,0x3f353f35250d250d,0x3f353f353f803f80,0xbe483f7bbf35bf35,0xbf55bf0e3f6dbec4,0xbf7bbe48bf35bf35,0xbf0e3f55bf6d3ec4
.quad 0xbf6d3f6dbf353f35,0xbec43ec4250d0000,0x3ec4bec43f35bf35,0xbf6d3f6d250d0000,0xbe48bf7b3ec4bf6d,0x3f55bf0e3f80250d,0x3f7bbe48bec43f6d,0xbf0ebf553f80250d
.quad 0x3ec4bec4bf353f35,0xbf6d3f6d250d0000,0xbf6d3f6d3f35bf35,0xbec43ec4250d0000,0xbf0e3f55bf6dbec4,0x3e48bf7b3f80250d,0xbf55bf0e3f6d3ec4,0xbf7bbe483f80250d
.quad 0x250d250d00000000,0x250d250d00000000,0x3f803f80250d250d,0xbf80bf8000000000,0x3f553f0ebf6dbec4,0x3f7b3e48bf80250d,0x3f0ebf553f6d3ec4,0xbe483f7bbf80250d
.quad 0xbf35bf353f803f80,0xbf35bf3500000000,0xbf35bf35bf80bf80,0xbf35bf3500000000,0xbf7b3e483ec4bf6d,0x3f0e3f55bf80250d,0x3e483f7bbec43f6d,0xbf553f0ebf80250d
.quad 0xbec43ec4bf353f35,0xbf6d3f6dbf803f80,0xbf6d3f6d3f35bf35,0x3ec4bec4bf803f80,0xbf0e3f55bf6d3ec4,0xbf7bbe48bf35bf35,0xbf55bf0e3f6dbec4,0xbe483f7bbf35bf35
.quad 0xbf6d3f6dbf353f35,0x3ec4bec43f80bf80,0xbec43ec43f35bf35,0xbf6d3f6d3f80bf80,0xbf7b3e48bec4bf6d,0x3f55bf0e3f353f35,0xbe48bf7b3ec43f6d,0xbf0ebf553f353f35
.quad 0x250d250d00000000,0x250d250d00000000,0x3f803f80250d250d,0xbf80bf8000000000,0x3e483f7bbec4bf6d,0x3f0e3f55bf35bf35,0x3f7bbe483ec43f6d,0xbf553f0ebf35bf35
.quad 0x3f353f35bf80bf80,0x3f353f35250d250d,0x3f353f353f803f80,0x3f353f35250d250d,0x3f553f0ebf6d3ec4,0x3e48bf7b3f353f35,0x3f0ebf553f6dbec4,0x3f7b3e483f353f35
.quad 0x8000800080008000,0x8000800080008000,0xbf80bf8080008000,0x3f803f80a50da50d,0xbf7bbe48bf808000,0xbf55bf0ebf6dbec4,0x3e48bf7bbf808000,0xbf0e3f553f6d3ec4
.quad 0xbf35bf3580008000,0xbf35bf35bf80bf80,0xbf35bf3580008000,0xbf35bf353f803f80,0xbf0ebf55bf808000,0x3f7bbe483ec4bf6d,0x3f55bf0ebf808000,0xbe48bf7bbec43f6d
.quad 0xbec43ec4a50d8000,0xbf6d3f6d3f35bf35,0xbf6d3f6da50d8000,0x3ec4bec4bf353f35,0xbf553f0e3f808000,0x3e483f7b3ec4bf6d,0x3f0e3f553f808000,0xbf7b3e48bec43f6d
.quad 0xbf6d3f6da50d8000,0x3ec4bec43f35bf35,0xbec43ec4a50d8000,0xbf6d3f6dbf353f35,0xbe483f7b3f808000,0x3f0ebf55bf6dbec4,0x3f7b3e483f808000,0x3f553f0e3f6d3ec4
.quad 0x8000800080008000,0x8000800080008000,0xbf80bf8080008000,0x3f803f80a50da50d,0xbf0ebf55bf35bf35,0xbe48bf7bbec4bf6d,0x3f55bf0ebf35bf35,0xbf7b3e483ec43f6d
.quad 0x3f353f35a50da50d,0x3f353f353f803f80,0x3f353f35a50da50d,0x3f353f35bf80bf80,0xbe483f7b3f353f35,0xbf55bf0ebf6d3ec4,0xbf7bbe483f353f35,0xbf0e3f553f6dbec4
.quad 0xbf6d3f6d3f80bf80,0xbec43ec43f35bf35,0x3ec4bec43f80bf80,0xbf6d3f6dbf353f35,0x3f7b3e48bf35bf35,0x3f0ebf55bf6d3ec4,0x3e48bf7bbf35bf35,0x3f553f0e3f6dbec4
.quad 0x3ec4bec4bf803f80,0xbf6d3f6d3f35bf35,0xbf6d3f6dbf803f80,0xbec43ec4bf353f35,0xbf553f0e3f353f35,0x3f7bbe48bec4bf6d,0x3f0e3f553f353f35,0x3e483f7b3ec43f6d
.quad 0x8000800080008000,0x8000800080008000,0x3f803f80a50da50d,0xbf80bf8080008000,0x3f553f0e3f6d3ec4,0x3f7b3e483f80a50d,0x3f0ebf55bf6dbec4,0xbe483f7b3f80a50d
.quad 0xbf35bf35bf80bf80,0xbf35bf3580008000,0xbf35bf353f803f80,0xbf35bf3580008000,0xbf7b3e48bec43f6d,0x3f0e3f553f80a50d,0x3e483f7b3ec4bf6d,0xbf553f0e3f80a50d
.quad 0xbf6d3f6d3f35bf35,0xbec43ec4a50d8000,0x3ec4bec4bf353f35,0xbf6d3f6da50d8000,0xbe48bf7bbec43f6d,0x3f55bf0ebf80a50d,0x3f7bbe483ec4bf6d,0xbf0ebf55bf80a50d
.quad 0x3ec4bec43f35bf35,0xbf6d3f6da50d8000,0xbf6d3f6dbf353f35,0xbec43ec4a50d8000,0xbf0e3f553f6d3ec4,0x3e48bf7bbf80a50d,0xbf55bf0ebf6dbec4,0xbf7bbe48bf80a50d
.quad 0x8000800080008000,0x8000800080008000,0x3f803f80a50da50d,0xbf80bf8080008000,0x3e483f7b3ec43f6d,0x3f0e3f553f353f35,0x3f7bbe48bec4bf6d,0xbf553f0e3f353f35
.quad 0x3f353f353f803f80,0x3f353f35a50da50d,0x3f353f35bf80bf80,0x3f353f35a50da50d,0x3f553f0e3f6dbec4,0x3e48bf7bbf35bf35,0x3f0ebf55bf6d3ec4,0x3f7b3e48bf35bf35
.quad 0xbec43ec43f35bf35,0xbf6d3f6d3f80bf80,0xbf6d3f6dbf353f35,0x3ec4bec43f80bf80,0xbf0e3f553f6dbec4,0xbf7bbe483f353f35,0xbf55bf0ebf6d3ec4,0xbe483f7b3f353f35
.quad 0xbf6d3f6d3f35bf35,0x3ec4bec4bf803f80,0xbec43ec4bf353f35,0xbf6d3f6dbf803f80,0xbf7b3e483ec43f6d,0x3f55bf0ebf35bf35,0xbe48bf7bbec4bf6d,0xbf0ebf55bf35bf35
.quad 0x3ec4bec4a50d8000,0x3f6dbf6d3f35bf35,0x3f6dbf6da50d8000,0xbec43ec4bf353f35,0x3f55bf0e3f808000,0xbe48bf7b3ec4bf6d,0xbf0ebf553f808000,0x3f7bbe48bec43f6d
.quad 0x3f6dbf6da50d8000,0xbec43ec43f35bf35,0x3ec4bec4a50d8000,0x3f6dbf6dbf353f35,0x3e48bf7b3f808000,0xbf0e3f55bf6dbec4,0xbf7bbe483f808000,0xbf55bf0e3f6d3ec4
.quad 0xa50da50d80008000,0xa50da50d80008000,0x3f803f8080008000,0xbf80bf80a50da50d,0x3f7b3e48bf808000,0x3f553f0ebf6dbec4,0xbe483f7bbf808000,0x3f0ebf553f6d3ec4
.quad 0x3f353f3580008000,0x3f353f35bf80bf80,0x3f353f3580008000,0x3f353f353f803f80,0x3f0e3f55bf808000,0xbf7b3e483ec4bf6d,0xbf553f0ebf808000,0x3e483f7bbec43f6d
.quad 0x3f6dbf6d3f80bf80,0x3ec4bec43f35bf35,0xbec43ec43f80bf80,0x3f6dbf6dbf353f35,0xbf7bbe48bf35bf35,0xbf0e3f55bf6d3ec4,0xbe483f7bbf35bf35,0xbf55bf0e3f6dbec4
.quad 0xbec43ec4bf803f80,0x3f6dbf6d3f35bf35,0x3f6dbf6dbf803f80,0x3ec4bec4bf353f35,0x3f55bf0e3f353f35,0xbf7b3e48bec4bf6d,0xbf0ebf553f353f35,0xbe48bf7b3ec43f6d
.quad 0xa50da50d80008000,0xa50da50d80008000,0x3f803f8080008000,0xbf80bf80a50da50d,0x3f0e3f55bf35bf35,0x3e483f7bbec4bf6d,0xbf553f0ebf35bf35,0x3f7bbe483ec43f6d
.quad 0xbf35bf35a50da50d,0xbf35bf353f803f80,0xbf35bf35a50da50d,0xbf35bf35bf80bf80,0x3e48bf7b3f353f35,0x3f553f0ebf6d3ec4,0x3f7b3e483f353f35,0x3f0ebf553f6dbec4
.quad 0x3f6dbf6d3f35bf35,0x3ec4bec4a50d8000,0xbec43ec4bf353f35,0x3f6dbf6da50d8000,0x3e483f7bbec43f6d,0xbf553f0ebf80a50d,0xbf7b3e483ec4bf6d,0x3f0e3f55bf80a50d
.quad 0xbec43ec43f35bf35,0x3f6dbf6da50d8000,0x3f6dbf6dbf353f35,0x3ec4bec4a50d8000,0x3f0ebf553f6d3ec4,0xbe483f7bbf80a50d,0x3f553f0ebf6dbec4,0x3f7b3e48bf80a50d
.quad 0xa50da50d80008000,0xa50da50d80008000,0xbf80bf80a50da50d,0x3f803f8080008000,0xbf55bf0e3f6d3ec4,0xbf7bbe483f80a50d,0xbf0e3f55bf6dbec4,0x3e48bf7b3f80a50d
.quad 0x3f353f35bf80bf80,0x3f353f3580008000,0x3f353f353f803f80,0x3f353f3580008000,0x3f7bbe48bec43f6d,0xbf0ebf553f80a50d,0xbe48bf7b3ec4bf6d,0x3f55bf0e3f80a50d
.quad 0x3ec4bec43f35bf35,0x3f6dbf6d3f80bf80,0x3f6dbf6dbf353f35,0xbec43ec43f80bf80,0x3f0ebf553f6dbec4,0x3f7b3e483f353f35,0x3f553f0ebf6d3ec4,0x3e48bf7b3f353f35
.quad 0x3f6dbf6d3f35bf35,0xbec43ec4bf803f80,0x3ec4bec4bf353f35,0x3f6dbf6dbf803f80,0x3f7bbe483ec43f6d,0xbf553f0ebf35bf35,0x3e483f7bbec4bf6d,0x3f0e3f55bf35bf35
.quad 0xa50da50d80008000,0xa50da50d80008000,0xbf80bf80a50da50d,0x3f803f8080008000,0xbe48bf7b3ec43f6d,0xbf0ebf553f353f35,0xbf7b3e48bec4bf6d,0x3f55bf0e3f353f35
.quad 0xbf35bf353f803f80,0xbf35bf35a50da50d,0xbf35bf35bf80bf80,0xbf35bf35a50da50d,0xbf55bf0e3f6dbec4,0xbe483f7bbf35bf35,0xbf0e3f55bf6d3ec4,0xbf7bbe48bf35bf35
```
